```python
import torch

def _softmax(x, axis=-1):
    return torch.softmax(x, dim=axis)

def _gelu(x):
    return torch.nn.functional.gelu(x, approximate='tanh')

def _silu(x):
    return torch.nn.functional.silu(x)

def _sigmoid(x):
    return torch.sigmoid(x)

def _layernorm(x, axis=-1, eps=1e-05):
    m = x.mean(dim=axis, keepdim=True)
    v = x.var(dim=axis, keepdim=True, unbiased=False)
    return (x - m) / torch.sqrt(v + eps)

def _scatter_add(tgt, idx, src, axis=0):
    return tgt.clone().index_add_(axis, idx, src)

def _segment_sum(src, seg, n):
    out = torch.zeros((n,) + src.shape[1:], dtype=src.dtype)
    return out.index_add_(0, seg, src)

def _pad(x, pw):
    flat = tuple((v for pair in reversed(pw) for v in pair))
    return torch.nn.functional.pad(x, flat)
kernel_name = 'interleave_layers__spectral_fnet__mixer_gmlp__prompt'

def setup_inputs():

    _w = lambda a: (lambda t: t.to(torch.bfloat16) if t.is_floating_point() else t)(torch.as_tensor(a))

    def _A_setup():
        B, S, D = (1, 2048, 576)
        ns = torch.arange(S)[:, None] * torch.arange(S)[None, :]
        nd = torch.arange(D)[:, None] * torch.arange(D)[None, :]
        Ws_re = torch.cos(-2.0 * torch.pi * ns / S).to(float)
        Ws_im = torch.sin(-2.0 * torch.pi * ns / S).to(float)
        Wd_re = torch.cos(-2.0 * torch.pi * nd / D).to(float)
        Wd_im = torch.sin(-2.0 * torch.pi * nd / D).to(float)
        return {'x': _w((lambda *s: torch.randn(*s, dtype=torch.bfloat16) * 0.05)(B, S, D)), 'dft_seq_re': _w(Ws_re), 'dft_seq_im': _w(Ws_im), 'dft_hid_re': _w(Wd_re), 'dft_hid_im': _w(Wd_im)}
    _A_in = _A_setup()

    def _B_setup():
        B, S, D, F = (1, 2048, 576, 4608)
        Fh = F // 2
        return {'x': _w((lambda *s: torch.randn(*s, dtype=torch.bfloat16) * 0.05)(B, S, D)), 'w_in': _w((lambda *s: torch.randn(*s, dtype=torch.bfloat16) * 1.6)(D, 2 * Fh)), 'w_sp': _w(0.01 * (lambda *s: torch.randn(*s, dtype=torch.bfloat16) * 1.6)(S, S)), 'b_sp': _w(1.0 + 0.01 * (lambda *s: torch.randn(*s, dtype=torch.bfloat16) * 1.6)(S)), 'w_out': _w((lambda *s: torch.randn(*s, dtype=torch.bfloat16) * 1.6)(Fh, D))}
    _B_in = _B_setup()
    return {'A_x': _A_in['x'], 'A_dft_seq_re': _A_in['dft_seq_re'], 'A_dft_seq_im': _A_in['dft_seq_im'], 'A_dft_hid_re': _A_in['dft_hid_re'], 'A_dft_hid_im': _A_in['dft_hid_im'], 'B_x': _B_in['x'], 'B_w_in': _B_in['w_in'], 'B_w_sp': _B_in['w_sp'], 'B_b_sp': _B_in['b_sp'], 'B_w_out': _B_in['w_out']}

def reference(A_x, A_dft_seq_re, A_dft_seq_im, A_dft_hid_re, A_dft_hid_im, B_x, B_w_in, B_w_sp, B_b_sp, B_w_out):

    def _A_ref(x, dft_seq_re, dft_seq_im, dft_hid_re, dft_hid_im):
        a = torch.einsum('bsd,ed->bse', x, dft_hid_re)
        b = torch.einsum('bsd,ed->bse', x, dft_hid_im)
        y = torch.einsum('ts,bse->bte', dft_seq_re, a) - torch.einsum('ts,bse->bte', dft_seq_im, b)
        return y

    def _B_ref(x, w_in, w_sp, b_sp, w_out):
        B, S, D = x.shape
        F = w_in.shape[-1]
        Fh = F // 2
        z = _gelu(torch.einsum('bsd,df->bsf', x, w_in))
        z1 = z[..., :Fh].clone()
        z2 = _layernorm(z[..., Fh:], axis=-1)
        g = torch.einsum('ts,bsf->btf', w_sp, z2) + b_sp[None, :, None]
        return torch.einsum('bsf,fd->bsd', z1 * g, w_out)
    x = A_x
    x = x + _A_ref(_layernorm(x, axis=-1), A_dft_seq_re, A_dft_seq_im, A_dft_hid_re, A_dft_hid_im)
    x = x + _B_ref(_layernorm(x, axis=-1), B_w_in, B_w_sp, B_b_sp, B_w_out)
    x = x + _A_ref(_layernorm(x, axis=-1), A_dft_seq_re, A_dft_seq_im, A_dft_hid_re, A_dft_hid_im)
    x = x + _B_ref(_layernorm(x, axis=-1), B_w_in, B_w_sp, B_b_sp, B_w_out)
    return x
```

```asm
; @launch grid=(256,1,1) block=(256,1,1) lds=163840
.amdgcn_target "amdgcn-amd-amdhsa--gfx950"
.text
.globl interleave_layers__spectral_fnet__mixer_gmlp__prompt_kernel
.p2align 8
.type interleave_layers__spectral_fnet__mixer_gmlp__prompt_kernel,@function
interleave_layers__spectral_fnet__mixer_gmlp__prompt_kernel:
    s_cmp_ge_u32 s2, 256
    s_cbranch_scc1 L_end_interleave_layers__spectral_fnet__mixer_gmlp__prompt_kernel
    s_load_dwordx2 s[64:65], s[0:1], 0
    s_load_dwordx8 s[68:75], s[0:1], 48
    s_getpc_b64 s[88:89]
L_pc_interleave_layers__spectral_fnet__mixer_gmlp__prompt_kernel:
    s_lshr_b32 s11, s2, 3
    s_lshl_b32 s92, s11, 12
    v_lshl_add_u32 v240, v0, 4, s92
    v_min_u32 v240, L_last_interleave_layers__spectral_fnet__mixer_gmlp__prompt_kernel-L_pc_interleave_layers__spectral_fnet__mixer_gmlp__prompt_kernel-16, v240
    v_add_co_u32 v240, vcc, s88, v240
    v_mov_b32 v241, s89
    v_lshrrev_b32 v2, 6, v0
    v_addc_co_u32 v241, vcc, 0, v241, vcc
    global_load_dwordx4 v[240:243], v[240:241], off
    s_load_dwordx2 s[8:9], s[0:1], 96
    s_load_dwordx4 s[76:79], s[0:1], 80
    v_and_b32 v1, 63, v0
    v_readfirstlane_b32 s3, v2
    v_and_b32 v2, 15, v1
    v_lshrrev_b32 v3, 4, v1
    v_lshlrev_b32 v1, 4, v1
    s_and_b32 s6, s2, 1
    s_lshr_b32 s7, s11, 2
    s_lshl_b32 s5, s6, 3
    s_add_u32 s5, s5, s7
    s_and_b32 s4, s2, 6
    s_lshl_b32 s4, s4, 1
    s_and_b32 s11, s11, 3
    s_add_u32 s4, s4, s11
    s_sub_u32 s11, 32, s4
    s_cmp_eq_u32 s4, 0
    s_cselect_b32 s11, 16, s11
    s_cmp_eq_u32 s6, 0
    s_cselect_b32 s10, s4, s11
    s_lshr_b32 s56, s3, 1
    s_lshl_b32 s56, s56, 5
    s_add_u32 s56, s56, s10
    s_and_b32 s57, s3, 1
    s_lshl_b32 s57, s57, 10
    s_add_u32 s56, s56, s57
    s_mul_i32 s56, s56, 1152
    v_min_u32 v248, 8, v2
    v_lshlrev_b32 v248, 7, v248
    v_and_b32 v249, 1, v3
    v_mul_u32_u24 v249, 73728, v249
    v_add_u32 v248, v248, v249
    s_mul_i32 s53, s7, 147456
    s_add_u32 s53, s53, s56
    s_waitcnt lgkmcnt(0)
    s_mov_b32 s16, s64
    s_and_b32 s17, s65, 0xffff
    s_mov_b32 s18, 2359296
    s_mov_b32 s19, 0x00020000
    s_mov_b64 exec, 0x01ff01ff
    buffer_load_dword v249, v248, s[16:19], s53 offen
    s_mov_b64 exec, -1
    s_mov_b32 s28, 33554432
    s_mov_b32 s29, 18874368
    s_mov_b32 s30, 0
    s_mov_b32 s63, 0
    s_lshl_b32 s60, s4, 4
    s_add_u32 s60, s60, s5
    s_lshl_b32 s37, s60, 2
    s_add_u32 s37, s37, s3
    s_lshl_b32 s37, s37, 11
    s_mul_i32 s32, s3, 9216
    v_lshrrev_b32 v20, 6, v1
    v_and_b32 v21, 48, v1
    v_mul_u32_u24 v22, 73728, v20
    v_add_u32 v22, v22, v21
    s_lshl_b32 s45, s7, 6
    s_add_u32 s57, s56, s45
    s_sub_u32 s58, s56, s45
    s_add_u32 s58, s58, 1088
    s_bfe_u32 s46, s7, 0x10001
    s_lshl_b32 s46, s46, 5
    s_add_u32 s47, s46, 512
    s_sub_u32 s46, 608, s46
    s_bitcmp1_b32 s7, 0
    s_cselect_b32 s46, s46, s47
    s_sub_u32 s45, 1104, s45
    s_cmp_eq_u32 s7, 0
    s_cselect_b32 s45, 528, s45
    v_mov_b32 v23, s46
    v_mov_b32 v24, s45
    v_cmp_eq_u32 vcc, 48, v21
    s_nop 1
    v_cndmask_b32 v23, v23, v24, vcc
    v_add_u32 v23, v23, v22
    v_mov_b32 v36, 0
    v_mov_b32 v37, 0
    v_mov_b32 v38, 0
    v_mov_b32 v39, 0
    s_mul_i32 s59, s3, 3072
    s_add_u32 s59, s59, 61440
    s_add_u32 s11, s37, 18874368
    s_lshr_b32 s62, s7, 1
    s_add_u32 s62, s62, 1
    s_and_b32 s62, s62, 3
    s_lshl_b32 s62, s62, 5
    s_lshr_b32 s40, s60, 3
    s_add_u32 s62, s62, s40
    s_lshl_b32 s62, s62, 1
    s_and_b32 s40, s7, 1
    s_add_u32 s62, s62, s40
    s_mov_b32 s12, s8
    s_and_b32 s13, s9, 0xffff
    s_mov_b32 s14, 268435456
    s_mov_b32 s15, 0x00020000
    v_lshrrev_b32 v250, 7, v1
    v_mul_u32_u24 v250, 73728, v250
    v_and_b32 v251, 0x70, v1
    v_add_u32 v250, v250, v251
    s_add_u32 s91, s56, 589824
    buffer_store_dwordx4 v[36:39], v1, s[12:15], s11 offen offset:0 sc1
    buffer_store_dwordx4 v[36:39], v1, s[12:15], s11 offen offset:1024 sc1
    s_mov_b32 s64, s70
    s_and_b32 s65, s71, 0xffff
    s_mov_b32 s66, 8388608
    s_mov_b32 s67, 0x00020000
    s_lshl_b32 s53, s7, 2
    s_add_u32 s53, s53, s3
    s_lshl_b32 s53, s53, 5
    s_add_u32 s53, s53, s10
    s_lshl_b32 s61, s53, 12
    s_cmp_ge_u32 s7, 6
    s_cselect_b32 s61, 268435456, s61
    v_lshlrev_b32 v245, 3, v1
    s_mov_b32 exec_hi, 0
    buffer_load_dword v244, v245, s[64:67], s61 offen
    s_mov_b32 exec_hi, -1
    buffer_load_dwordx4 v[112:115], v250, s[16:19], s56 offen offset:0
    buffer_load_dwordx4 v[116:119], v250, s[16:19], s56 offen offset:128
    buffer_load_dwordx4 v[120:123], v250, s[16:19], s56 offen offset:256
    buffer_load_dwordx4 v[124:127], v250, s[16:19], s56 offen offset:384
    s_mov_b32 s20, s78
    s_and_b32 s21, s79, 0xffff
    s_mov_b32 s22, 256
    s_mov_b32 s23, 0x00020000
    v_lshrrev_b32 v30, 7, v1
    s_and_b32 s47, s3, 1
    s_lshl_b32 s47, s47, 3
    v_add_u32 v30, s47, v30
    s_cmp_ge_u32 s62, 144
    s_nop 0
    s_cbranch_scc1 L_interleave_layers__spectral_fnet__mixer_gmlp__prompt_kernel_1
    s_mov_b32 s80, s68
    s_and_b32 s81, s69, 0xffff
    s_mov_b32 s82, 5308416
    s_mov_b32 s83, 0x00020000
    s_lshr_b32 s46, s62, 3
    s_lshl_b32 s45, s46, 4
    v_add_u32 v30, s45, v30
    v_sub_u32 v31, 576, v30
    v_mov_b32 v29, 288
    v_cmp_eq_u32 vcc, 0, v30
    s_nop 1
    v_cndmask_b32 v31, v31, v29, vcc
    s_cmp_ge_u32 s3, 2
    s_cselect_b64 vcc, -1, 0
    v_cndmask_b32 v31, v30, v31, vcc
    v_mul_u32_u24 v31, 9216, v31
    s_and_b32 s44, s62, 7
    s_mul_i32 s44, s44, 1152
    s_and_b32 s42, s62, 3
    s_lshl_b32 s42, s42, 2
    s_add_u32 s42, s42, s3
    s_mul_i32 s42, s42, 331776
    s_bitcmp1_b32 s62, 2
    s_cselect_b32 s45, 0, 165888
    s_add_u32 s42, s42, s45
    s_lshl_b32 s45, s46, 10
    s_add_u32 s42, s42, s45
    s_mov_b32 s43, 18432
    v_mov_b32 v19, v1
    s_mov_b64 s[92:93], 0
    s_nop 0
    s_branch L_interleave_layers__spectral_fnet__mixer_gmlp__prompt_kernel_2
L_interleave_layers__spectral_fnet__mixer_gmlp__prompt_kernel_1:
    s_mov_b32 s80, s74
    s_and_b32 s81, s75, 0xffff
    s_mov_b32 s82, 2654208
    s_mov_b32 s83, 0x00020000
    s_sub_u32 s46, s62, 144
    s_min_u32 s46, s46, 71
    s_mul_i32 s47, s46, 57
    s_lshr_b32 s47, s47, 9
    s_mul_i32 s48, s47, 9
    s_sub_u32 s48, s46, s48
    s_lshr_b32 s49, s3, 1
    s_lshr_b32 s50, s48, 2
    s_mul_i32 s50, s50, 9
    s_and_b32 s51, s48, 3
    s_lshl_b32 s51, s51, 1
    s_add_u32 s50, s50, s51
    s_add_u32 s50, s50, s49
    s_mul_i32 s51, s49, 9
    s_add_u32 s51, s51, 8
    s_cmp_eq_u32 s48, 8
    s_cselect_b32 s50, s51, s50
    s_mul_i32 s47, s47, 18
    s_add_u32 s50, s50, s47
    s_mul_i32 s44, s50, 18432
    v_mul_u32_u24 v31, 1152, v30
    s_mul_i32 s42, s46, 36864
    s_add_u32 s42, s42, 14680064
    v_sub_u32 v19, 16, v2
    v_and_b32 v19, 15, v19
    v_lshlrev_b32 v19, 4, v19
    v_lshl_add_u32 v19, v3, 8, v19
    s_mul_i32 s45, s3, 18432
    s_sub_u32 s46, 72704, s45
    s_cmp_ge_u32 s3, 2
    s_cselect_b32 s45, s46, s45
    s_cselect_b32 s43, -1, 1
    s_cselect_b64 vcc, -1, 0
    s_cselect_b32 s46, 0, -1
    s_lshl_b32 s43, s43, 11
    s_add_u32 s42, s42, s45
    v_cndmask_b32 v19, v1, v19, vcc
    v_cmp_eq_u32 s[92:93], s46, v2
    s_cmp_ge_u32 s62, 216
    s_cselect_b32 s42, 268500992, s42
    s_nop 2
L_interleave_layers__spectral_fnet__mixer_gmlp__prompt_kernel_2:
    v_and_b32 v30, 0x70, v1
    v_add_u32 v31, v31, v30
    s_lshl_b32 s11, s3, 4
    v_add_u32 v48, s11, v2
    v_lshrrev_b32 v49, 1, v48
    v_and_b32 v50, 1, v48
    v_lshlrev_b32 v50, 4, v50
    v_cmp_eq_u32 vcc, 1, v48
    s_nop 1
    v_cndmask_b32 v49, v49, 32, vcc
    v_cndmask_b32 v50, v50, 0, vcc
    v_lshlrev_b32 v48, 3, v3
    v_mad_u32_u24 v50, v49, v48, v50
    v_cvt_f32_u32 v49, v49
    buffer_load_dwordx4 v[128:131], v250, s[16:19], s56 offen offset:512
    v_cvt_f32_u32 v50, v50
    v_mul_f32 v49, 0x3c800000, v49
    v_mul_f32 v50, 0x3c800000, v50
    v_mov_b32 v40, v50
    v_fmamk_f32 v41, v49, 0x40000000, v50
    v_fmamk_f32 v42, v49, 0x40800000, v50
    v_fmamk_f32 v43, v49, 0x40c00000, v50
    v_fmamk_f32 v44, v49, 0x42000000, v50
    v_fmamk_f32 v45, v49, 0x42080000, v50
    v_fmamk_f32 v46, v49, 0x42100000, v50
    buffer_load_dwordx4 v[132:135], v250, s[16:19], s56 offen offset:640
    v_fmamk_f32 v47, v49, 0x42180000, v50
    v_cos_f32 v40, v40
    v_cos_f32 v41, v41
    v_cos_f32 v42, v42
    v_cos_f32 v43, v43
    v_cos_f32 v44, v44
    v_cos_f32 v45, v45
    v_cos_f32 v46, v46
    v_cos_f32 v47, v47
    v_cvt_pk_bf16_f32 v104, v40, v41
    buffer_load_dwordx4 v[136:139], v250, s[16:19], s56 offen offset:768
    v_cvt_pk_bf16_f32 v105, v42, v43
    v_cvt_pk_bf16_f32 v106, v44, v45
    v_cvt_pk_bf16_f32 v107, v46, v47
    v_fmamk_f32 v40, v49, 0x3f800000, v50
    v_fmamk_f32 v41, v49, 0x40400000, v50
    v_fmamk_f32 v42, v49, 0x40a00000, v50
    v_fmamk_f32 v43, v49, 0x40e00000, v50
    v_fmamk_f32 v44, v49, 0x42040000, v50
    v_fmamk_f32 v45, v49, 0x420c0000, v50
    v_fmamk_f32 v46, v49, 0x42140000, v50
    buffer_load_dwordx4 v[140:143], v250, s[16:19], s56 offen offset:896
    v_fmamk_f32 v47, v49, 0x421c0000, v50
    v_cos_f32 v40, v40
    v_cos_f32 v41, v41
    v_cos_f32 v42, v42
    v_cos_f32 v43, v43
    v_cos_f32 v44, v44
    v_cos_f32 v45, v45
    v_cos_f32 v46, v46
    v_cos_f32 v47, v47
    v_cvt_pk_bf16_f32 v108, v40, v41
    buffer_load_dwordx4 v[144:147], v250, s[16:19], s56 offen offset:1024
    v_cvt_pk_bf16_f32 v109, v42, v43
    v_cvt_pk_bf16_f32 v110, v44, v45
    v_cvt_pk_bf16_f32 v111, v46, v47
    s_mul_i32 s11, s3, 2560
    s_add_u32 s11, s11, 147456
    v_mul_u32_u24 v188, 160, v2
    v_lshl_add_u32 v188, v3, 3, v188
    v_add_u32 v188, s11, v188
    v_lshrrev_b32 v189, 2, v2
    v_lshl_add_u32 v189, v3, 2, v189
    v_mul_u32_u24 v189, 160, v189
    v_and_b32 v190, 3, v2
    v_lshl_add_u32 v189, v190, 3, v189
    buffer_load_dwordx4 v[148:151], v250, s[16:19], s91 offen offset:0
    v_add_u32 v189, 147456, v189
    v_lshrrev_b32 v190, 1, v2
    v_mul_u32_u24 v190, 73728, v190
    v_and_b32 v192, 1, v2
    v_lshl_add_u32 v191, v192, 3, v190
    v_lshl_add_u32 v191, v3, 4, v191
    v_lshl_add_u32 v190, v192, 4, v190
    v_lshl_add_u32 v190, v3, 5, v190
    v_and_b32 v192, 2, v3
    v_lshl_add_u32 v190, v192, 5, v190
    buffer_load_dwordx4 v[152:155], v250, s[16:19], s91 offen offset:128
    v_lshrrev_b32 v192, 1, v1
    s_lshl_b32 s24, s3, 5
    s_lshr_b32 s25, s10, 3
    s_add_u32 s24, s24, s25
    s_mul_i32 s24, s24, 18432
    s_bfe_u32 s25, s10, 0x20001
    s_lshl_b32 s25, s25, 8
    s_add_u32 s24, s24, s25
    s_and_b32 s25, s10, 1
    s_lshl_b32 s25, s25, 6
    s_add_u32 s24, s24, s25
    s_add_u32 s24, s24, s28
    s_add_u32 s24, s24, 3145728
    s_lshr_b32 s25, s7, 1
    s_lshl_b32 s25, s25, 10
    s_and_b32 s11, s7, 1
    s_lshl_b32 s11, s11, 7
    s_add_u32 s25, s25, s11
    s_add_u32 s25, s25, s24
    s_add_u32 s25, s25, 16384
    s_lshl_b32 s11, s7, 11
    s_add_u32 s24, s24, s11
    s_lshl_b32 s26, s4, 3
    s_lshl_b32 s27, s6, 2
    s_add_u32 s26, s26, s27
    s_add_u32 s26, s26, s3
    s_mul_i32 s26, s26, 18432
    s_add_u32 s26, s26, s28
    s_lshl_b32 s27, s7, 9
    s_add_u32 s27, s27, s26
    s_add_u32 s27, s27, 16384
    s_add_u32 s26, s26, s11
    s_cmp_ge_u32 s7, 4
    s_cselect_b32 s25, 268435456, s25
    s_cselect_b32 s27, 268435456, s27
    v_mov_b32 v12, 0x3f803f80
    v_mov_b32 v13, 0x3f803f80
    v_mov_b32 v14, 0x3f803f80
    v_mov_b32 v15, 0x3f803f80
    v_lshl_add_u32 v32, v2, 6, s59
    v_lshlrev_b32 v35, 3, v3
    v_add_u32 v33, v32, v35
    v_sub_u32 v34, v32, v35
    v_add_u32 v34, 24, v34
    v_cmp_eq_u32 vcc, 0, v3
    buffer_load_dwordx4 v[156:159], v250, s[16:19], s91 offen offset:256
    v_add_u32 v35, 1032, v32
    v_cndmask_b32 v35, v34, v35, vcc
    v_and_b32 v30, 7, v2
    v_lshlrev_b32 v30, 5, v30
    v_lshrrev_b32 v24, 3, v2
    v_lshl_add_u32 v30, v24, 4, v30
    s_mul_i32 s11, s7, 48
    v_add_u32 v96, s11, v2
    v_mov_b32 v99, 288
    v_add_u32 v97, 16, v96
    v_add_u32 v98, 32, v96
    v_cmp_eq_u32 vcc, 0, v96
    buffer_load_dwordx4 v[160:163], v250, s[16:19], s91 offen offset:384
    s_nop 0
    v_cndmask_b32 v96, v96, v99, vcc
    s_lshl_b32 s11, s3, 6
    v_lshl_add_u32 v99, v3, 2, s11
    v_and_b32 v100, 1, v2
    v_xor_b32 v100, 1, v100
    v_or_b32 v100, v100, v99
    v_cmp_eq_u32 s[54:55], 0, v100
    v_cvt_f32_u32 v96, v96
    v_cvt_f32_u32 v97, v97
    v_cvt_f32_u32 v98, v98
    v_cvt_f32_u32 v99, v99
    v_mul_f32 v96, 0x3ae38e39, v96
    buffer_load_dwordx4 v[164:167], v250, s[16:19], s91 offen offset:512
    v_mul_f32 v97, 0x3ae38e39, v97
    v_mul_f32 v98, 0x3ae38e39, v98
    s_mul_i32 s11, s3, 12288
    v_add_u32 v101, s11, v1
    s_mul_i32 s11, s3, 3072
    v_add_u32 v102, s11, v1
    v_mul_f32 v100, v99, v96
    v_mov_b32 v80, v100
    v_fmamk_f32 v81, v96, 0x3f800000, v100
    v_fmamk_f32 v82, v96, 0x40000000, v100
    v_fmamk_f32 v83, v96, 0x40400000, v100
    v_fmamk_f32 v84, v96, 0x41800000, v100
    v_fmamk_f32 v85, v96, 0x41880000, v100
    v_fmamk_f32 v86, v96, 0x41900000, v100
    buffer_load_dwordx4 v[168:171], v250, s[16:19], s91 offen offset:640
    v_fmamk_f32 v87, v96, 0x41980000, v100
    v_cos_f32 v72, v80
    v_cos_f32 v73, v81
    v_cos_f32 v74, v82
    v_cos_f32 v75, v83
    v_cos_f32 v76, v84
    v_cos_f32 v77, v85
    v_cos_f32 v78, v86
    v_cos_f32 v79, v87
    v_cvt_pk_bf16_f32 v88, v72, v73
    buffer_load_dwordx4 v[172:175], v250, s[16:19], s91 offen offset:768
    v_cvt_pk_bf16_f32 v89, v74, v75
    v_cvt_pk_bf16_f32 v90, v76, v77
    v_cvt_pk_bf16_f32 v91, v78, v79
    v_and_b32 v72, 0xffff0000, v88
    v_cndmask_b32 v88, v88, v72, s[54:55]
    ds_write_b128 v101, v[88:91] offset:0
    v_sin_f32 v72, -v80
    v_sin_f32 v73, -v81
    v_sin_f32 v74, -v82
    v_sin_f32 v75, -v83
    v_sin_f32 v76, -v84
    buffer_load_dwordx4 v[176:179], v250, s[16:19], s91 offen offset:896
    v_sin_f32 v77, -v85
    v_sin_f32 v78, -v86
    v_sin_f32 v79, -v87
    v_cvt_pk_bf16_f32 v92, v72, v73
    v_cvt_pk_bf16_f32 v93, v74, v75
    v_cvt_pk_bf16_f32 v94, v76, v77
    v_cvt_pk_bf16_f32 v95, v78, v79
    ds_write_b128 v101, v[92:95] offset:3072
    v_fmamk_f32 v80, v96, 0x42000000, v100
    v_fmamk_f32 v81, v96, 0x42040000, v100
    v_fmamk_f32 v82, v96, 0x42080000, v100
    buffer_load_dwordx4 v[180:183], v250, s[16:19], s91 offen offset:1024
    v_fmamk_f32 v83, v96, 0x420c0000, v100
    v_fmamk_f32 v84, v96, 0x42400000, v100
    v_fmamk_f32 v85, v96, 0x42440000, v100
    v_fmamk_f32 v86, v96, 0x42480000, v100
    v_fmamk_f32 v87, v96, 0x424c0000, v100
    v_cos_f32 v72, v80
    v_cos_f32 v73, v81
    v_cos_f32 v74, v82
    v_cos_f32 v75, v83
    v_cos_f32 v76, v84
    s_add_u32 m0, s59, 0
    s_nop 0
    buffer_load_dwordx4 v22, s[16:19], s57 offen lds
    v_cos_f32 v77, v85
    v_cos_f32 v78, v86
    v_cos_f32 v79, v87
    v_cvt_pk_bf16_f32 v88, v72, v73
    v_cvt_pk_bf16_f32 v89, v74, v75
    v_cvt_pk_bf16_f32 v90, v76, v77
    v_cvt_pk_bf16_f32 v91, v78, v79
    ds_write_b128 v101, v[88:91] offset:6144
    v_sin_f32 v72, -v80
    v_sin_f32 v73, -v81
    v_sin_f32 v74, -v82
    s_add_u32 m0, s59, 1024
    s_nop 0
    buffer_load_dwordx4 v22, s[16:19], s58 offen lds
    v_sin_f32 v75, -v83
    v_sin_f32 v76, -v84
    v_sin_f32 v77, -v85
    v_sin_f32 v78, -v86
    v_sin_f32 v79, -v87
    v_cvt_pk_bf16_f32 v92, v72, v73
    v_cvt_pk_bf16_f32 v93, v74, v75
    v_cvt_pk_bf16_f32 v94, v76, v77
    v_cvt_pk_bf16_f32 v95, v78, v79
    ds_write_b128 v101, v[92:95] offset:9216
    v_mul_f32 v100, v99, v97
    s_add_u32 m0, s59, 2048
    s_nop 0
    buffer_load_dwordx4 v23, s[16:19], s56 offen lds
    v_mov_b32 v80, v100
    v_fmamk_f32 v81, v97, 0x3f800000, v100
    v_fmamk_f32 v82, v97, 0x40000000, v100
    v_fmamk_f32 v83, v97, 0x40400000, v100
    v_fmamk_f32 v84, v97, 0x41800000, v100
    v_fmamk_f32 v85, v97, 0x41880000, v100
    v_fmamk_f32 v86, v97, 0x41900000, v100
    v_fmamk_f32 v87, v97, 0x41980000, v100
    v_cos_f32 v72, v80
    v_cos_f32 v73, v81
    s_lshl_b32 s31, s4, 2
    s_add_u32 s31, s31, s3
    s_lshr_b32 s88, s31, 2
    s_bfe_u32 s89, s31, 0x10001
    s_sub_u32 s90, 32, s88
    s_cmp_eq_u32 s88, 0
    s_cselect_b32 s90, 16, s90
    s_cmp_eq_u32 s89, 0
    s_cselect_b32 s33, s88, s90
    s_and_b32 s88, s31, 1
    s_lshl_b32 s88, s88, 5
    s_add_u32 s33, s33, s88
    s_mov_b32 s84, s72
    s_and_b32 s85, s73, 0xffff
    s_mov_b32 s86, 4096
    s_mov_b32 s87, 0x00020000
    v_lshl_add_u32 v10, v2, 6, s33
    v_lshlrev_b32 v247, 1, v10
    v_mov_b32 v10, 0
    v_mov_b32 v11, 0
    buffer_load_short_d16_hi v10, v247, s[84:87], 0 offen offset:0
    buffer_load_short_d16_hi v11, v247, s[84:87], 0 offen offset:2048
    v_cos_f32 v74, v82
    v_cos_f32 v75, v83
    v_cos_f32 v76, v84
    v_cos_f32 v77, v85
    v_cos_f32 v78, v86
    v_cos_f32 v79, v87
    v_cvt_pk_bf16_f32 v88, v72, v73
    v_cvt_pk_bf16_f32 v89, v74, v75
    v_cvt_pk_bf16_f32 v90, v76, v77
    v_cvt_pk_bf16_f32 v91, v78, v79
    s_waitcnt vmcnt(24)
    s_barrier
    v_mov_b32 v18, 1
    s_lshl_b32 s88, s6, 7
    s_lshl_b32 s89, s3, 8
    s_add_u32 s88, s88, s89
    s_mov_b64 exec, 1
    buffer_atomic_add v18, off, s[20:23], s88
    s_mov_b64 exec, -1
    v_and_b32 v72, 0xffff0000, v88
    v_cndmask_b32 v88, v88, v72, s[54:55]
    ds_write_b128 v101, v[88:91] offset:1024
    s_add_u32 m0, s32, 73728
    s_nop 0
    buffer_load_dwordx4 v31, s[80:83], s44 offen lds
    s_add_u32 s44, s44, 128
    s_add_u32 m0, s32, 74752
    s_nop 0
    buffer_load_dwordx4 v31, s[80:83], s44 offen lds
    s_add_u32 s44, s44, 128
    s_add_u32 m0, s32, 75776
    s_nop 0
    buffer_load_dwordx4 v31, s[80:83], s44 offen lds
    s_add_u32 s44, s44, 128
    s_add_u32 m0, s32, 76800
    s_nop 0
    buffer_load_dwordx4 v31, s[80:83], s44 offen lds
    s_add_u32 s44, s44, 128
    s_add_u32 m0, s32, 77824
    s_nop 0
    buffer_load_dwordx4 v31, s[80:83], s44 offen lds
    s_add_u32 s44, s44, 128
    s_add_u32 m0, s32, 78848
    s_nop 0
    buffer_load_dwordx4 v31, s[80:83], s44 offen lds
    s_add_u32 s44, s44, 128
    s_add_u32 m0, s32, 79872
    s_nop 0
    buffer_load_dwordx4 v31, s[80:83], s44 offen lds
    s_add_u32 s44, s44, 128
    s_add_u32 m0, s32, 80896
    s_nop 0
    buffer_load_dwordx4 v31, s[80:83], s44 offen lds
    s_add_u32 s44, s44, 128
    s_add_u32 m0, s32, 81920
    s_nop 0
    buffer_load_dwordx4 v31, s[80:83], s44 offen lds
    s_add_u32 s44, s44, 128
    s_waitcnt vmcnt(30)
    v_dot2_f32_bf16 v24, v112, v12, 0
    v_dot2_f32_bf16 v25, v112, v112, 0
    v_dot2_f32_bf16 v26, v113, v12, 0
    v_dot2_f32_bf16 v27, v113, v113, 0
    v_dot2_f32_bf16 v24, v114, v12, v24
    v_dot2_f32_bf16 v25, v114, v114, v25
    v_dot2_f32_bf16 v26, v115, v12, v26
    v_dot2_f32_bf16 v27, v115, v115, v27
    v_dot2_f32_bf16 v24, v116, v12, v24
    v_dot2_f32_bf16 v25, v116, v116, v25
    v_dot2_f32_bf16 v26, v117, v12, v26
    v_dot2_f32_bf16 v27, v117, v117, v27
    v_dot2_f32_bf16 v24, v118, v12, v24
    v_dot2_f32_bf16 v25, v118, v118, v25
    v_dot2_f32_bf16 v26, v119, v12, v26
    v_dot2_f32_bf16 v27, v119, v119, v27
    v_dot2_f32_bf16 v24, v120, v12, v24
    v_dot2_f32_bf16 v25, v120, v120, v25
    v_dot2_f32_bf16 v26, v121, v12, v26
    v_dot2_f32_bf16 v27, v121, v121, v27
    v_dot2_f32_bf16 v24, v122, v12, v24
    v_dot2_f32_bf16 v25, v122, v122, v25
    v_dot2_f32_bf16 v26, v123, v12, v26
    v_dot2_f32_bf16 v27, v123, v123, v27
    s_waitcnt vmcnt(27)
    v_dot2_f32_bf16 v24, v124, v12, v24
    v_dot2_f32_bf16 v25, v124, v124, v25
    v_dot2_f32_bf16 v26, v125, v12, v26
    v_dot2_f32_bf16 v27, v125, v125, v27
    v_dot2_f32_bf16 v24, v126, v12, v24
    v_dot2_f32_bf16 v25, v126, v126, v25
    v_dot2_f32_bf16 v26, v127, v12, v26
    v_dot2_f32_bf16 v27, v127, v127, v27
    v_dot2_f32_bf16 v24, v128, v12, v24
    v_dot2_f32_bf16 v25, v128, v128, v25
    v_dot2_f32_bf16 v26, v129, v12, v26
    v_dot2_f32_bf16 v27, v129, v129, v27
    v_dot2_f32_bf16 v24, v130, v12, v24
    v_dot2_f32_bf16 v25, v130, v130, v25
    v_dot2_f32_bf16 v26, v131, v12, v26
    v_dot2_f32_bf16 v27, v131, v131, v27
    v_dot2_f32_bf16 v24, v132, v12, v24
    v_dot2_f32_bf16 v25, v132, v132, v25
    v_dot2_f32_bf16 v26, v133, v12, v26
    v_dot2_f32_bf16 v27, v133, v133, v27
    v_dot2_f32_bf16 v24, v134, v12, v24
    v_dot2_f32_bf16 v25, v134, v134, v25
    v_dot2_f32_bf16 v26, v135, v12, v26
    v_dot2_f32_bf16 v27, v135, v135, v27
    s_waitcnt vmcnt(24)
    v_dot2_f32_bf16 v24, v136, v12, v24
    v_dot2_f32_bf16 v25, v136, v136, v25
    v_dot2_f32_bf16 v26, v137, v12, v26
    v_dot2_f32_bf16 v27, v137, v137, v27
    v_dot2_f32_bf16 v24, v138, v12, v24
    v_dot2_f32_bf16 v25, v138, v138, v25
    v_dot2_f32_bf16 v26, v139, v12, v26
    v_dot2_f32_bf16 v27, v139, v139, v27
    v_dot2_f32_bf16 v24, v140, v12, v24
    v_dot2_f32_bf16 v25, v140, v140, v25
    v_dot2_f32_bf16 v26, v141, v12, v26
    v_dot2_f32_bf16 v27, v141, v141, v27
    v_dot2_f32_bf16 v24, v142, v12, v24
    v_dot2_f32_bf16 v25, v142, v142, v25
    v_dot2_f32_bf16 v26, v143, v12, v26
    v_dot2_f32_bf16 v27, v143, v143, v27
    v_dot2_f32_bf16 v24, v144, v12, v24
    v_dot2_f32_bf16 v25, v144, v144, v25
    v_dot2_f32_bf16 v26, v145, v12, v26
    v_dot2_f32_bf16 v27, v145, v145, v27
    v_dot2_f32_bf16 v24, v146, v12, v24
    v_dot2_f32_bf16 v25, v146, v146, v25
    v_dot2_f32_bf16 v26, v147, v12, v26
    v_dot2_f32_bf16 v27, v147, v147, v27
    s_waitcnt vmcnt(21)
    v_dot2_f32_bf16 v64, v148, v12, 0
    v_dot2_f32_bf16 v65, v148, v148, 0
    v_dot2_f32_bf16 v66, v149, v12, 0
    v_dot2_f32_bf16 v67, v149, v149, 0
    v_dot2_f32_bf16 v64, v150, v12, v64
    v_dot2_f32_bf16 v65, v150, v150, v65
    v_dot2_f32_bf16 v66, v151, v12, v66
    v_dot2_f32_bf16 v67, v151, v151, v67
    v_dot2_f32_bf16 v64, v152, v12, v64
    v_dot2_f32_bf16 v65, v152, v152, v65
    v_dot2_f32_bf16 v66, v153, v12, v66
    v_dot2_f32_bf16 v67, v153, v153, v67
    v_dot2_f32_bf16 v64, v154, v12, v64
    v_dot2_f32_bf16 v65, v154, v154, v65
    v_dot2_f32_bf16 v66, v155, v12, v66
    v_dot2_f32_bf16 v67, v155, v155, v67
    v_dot2_f32_bf16 v64, v156, v12, v64
    v_dot2_f32_bf16 v65, v156, v156, v65
    v_dot2_f32_bf16 v66, v157, v12, v66
    v_dot2_f32_bf16 v67, v157, v157, v67
    v_dot2_f32_bf16 v64, v158, v12, v64
    v_dot2_f32_bf16 v65, v158, v158, v65
    v_dot2_f32_bf16 v66, v159, v12, v66
    v_dot2_f32_bf16 v67, v159, v159, v67
    s_waitcnt vmcnt(18)
    v_dot2_f32_bf16 v64, v160, v12, v64
    v_dot2_f32_bf16 v65, v160, v160, v65
    v_dot2_f32_bf16 v66, v161, v12, v66
    v_dot2_f32_bf16 v67, v161, v161, v67
    v_dot2_f32_bf16 v64, v162, v12, v64
    v_dot2_f32_bf16 v65, v162, v162, v65
    v_dot2_f32_bf16 v66, v163, v12, v66
    v_dot2_f32_bf16 v67, v163, v163, v67
    v_dot2_f32_bf16 v64, v164, v12, v64
    v_dot2_f32_bf16 v65, v164, v164, v65
    v_dot2_f32_bf16 v66, v165, v12, v66
    v_dot2_f32_bf16 v67, v165, v165, v67
    v_dot2_f32_bf16 v64, v166, v12, v64
    v_dot2_f32_bf16 v65, v166, v166, v65
    v_dot2_f32_bf16 v66, v167, v12, v66
    v_dot2_f32_bf16 v67, v167, v167, v67
    v_dot2_f32_bf16 v64, v168, v12, v64
    v_dot2_f32_bf16 v65, v168, v168, v65
    v_dot2_f32_bf16 v66, v169, v12, v66
    v_dot2_f32_bf16 v67, v169, v169, v67
    v_dot2_f32_bf16 v64, v170, v12, v64
    v_dot2_f32_bf16 v65, v170, v170, v65
    v_dot2_f32_bf16 v66, v171, v12, v66
    v_dot2_f32_bf16 v67, v171, v171, v67
    s_waitcnt vmcnt(15)
    v_dot2_f32_bf16 v64, v172, v12, v64
    v_dot2_f32_bf16 v65, v172, v172, v65
    s_waitcnt vmcnt(12)
    ds_read_b64 v[196:197], v33 offset:0
    ds_read_b64 v[198:199], v34 offset:1056
    ds_read_u16 v200, v35 offset:1064
    ds_read_b64 v[202:203], v33 offset:32
    ds_read_b64 v[204:205], v34 offset:1024
    ds_read_u16 v206, v34 offset:1032
    ds_read_b64 v[208:209], v33 offset:2048
    ds_read_b64 v[210:211], v34 offset:2048
    ds_read_u16 v212, v34 offset:2056
    v_dot2_f32_bf16 v66, v173, v12, v66
    v_dot2_f32_bf16 v67, v173, v173, v67
    v_dot2_f32_bf16 v64, v174, v12, v64
    v_dot2_f32_bf16 v65, v174, v174, v65
    v_dot2_f32_bf16 v66, v175, v12, v66
    v_dot2_f32_bf16 v67, v175, v175, v67
    v_dot2_f32_bf16 v64, v176, v12, v64
    v_dot2_f32_bf16 v65, v176, v176, v65
    v_dot2_f32_bf16 v66, v177, v12, v66
    v_dot2_f32_bf16 v67, v177, v177, v67
    v_dot2_f32_bf16 v64, v178, v12, v64
    v_dot2_f32_bf16 v65, v178, v178, v65
    v_dot2_f32_bf16 v66, v179, v12, v66
    v_dot2_f32_bf16 v67, v179, v179, v67
    v_dot2_f32_bf16 v64, v180, v12, v64
    v_dot2_f32_bf16 v65, v180, v180, v65
    v_dot2_f32_bf16 v66, v181, v12, v66
    v_dot2_f32_bf16 v67, v181, v181, v67
    v_dot2_f32_bf16 v64, v182, v12, v64
    v_dot2_f32_bf16 v65, v182, v182, v65
    v_dot2_f32_bf16 v66, v183, v12, v66
    v_dot2_f32_bf16 v67, v183, v183, v67
    s_bitcmp1_b32 s7, 0
    s_cselect_b64 vcc, -1, 0
    v_add_f32 v24, v24, v26
    v_add_f32 v25, v25, v27
    v_add_f32 v64, v64, v66
    v_add_f32 v65, v65, v67
    v_add_f32_dpp v24, v24, v24 row_half_mirror row_mask:0xf bank_mask:0x5
    v_add_f32_dpp v25, v25, v25 row_half_mirror row_mask:0xf bank_mask:0x5
    s_nop 0
    v_add_f32_dpp v24, v64, v64 row_half_mirror row_mask:0xf bank_mask:0xa
    v_add_f32_dpp v25, v65, v65 row_half_mirror row_mask:0xf bank_mask:0xa
    s_nop 0
    v_add_f32_dpp v24, v24, v24 quad_perm:[1,0,3,2] row_mask:0xf bank_mask:0xf
    v_add_f32_dpp v25, v25, v25 quad_perm:[1,0,3,2] row_mask:0xf bank_mask:0xf
    s_nop 0
    v_add_f32_dpp v24, v24, v24 quad_perm:[2,3,0,1] row_mask:0xf bank_mask:0xf
    v_add_f32_dpp v25, v25, v25 quad_perm:[2,3,0,1] row_mask:0xf bank_mask:0xf
    ds_bpermute_b32 v28, v30, v24
    ds_bpermute_b32 v29, v30, v25
    s_waitcnt lgkmcnt(2)
    v_lshlrev_b32 v40, 16, v196
    v_and_b32 v41, 0xffff0000, v196
    v_lshlrev_b32 v42, 16, v197
    v_and_b32 v43, 0xffff0000, v197
    v_lshlrev_b32 v44, 16, v200
    v_and_b32 v45, 0xffff0000, v199
    v_lshlrev_b32 v46, 16, v199
    v_and_b32 v47, 0xffff0000, v198
    v_lshlrev_b32 v48, 16, v202
    v_and_b32 v49, 0xffff0000, v202
    v_lshlrev_b32 v50, 16, v203
    v_and_b32 v51, 0xffff0000, v203
    v_lshlrev_b32 v52, 16, v206
    v_and_b32 v53, 0xffff0000, v205
    v_lshlrev_b32 v54, 16, v205
    v_and_b32 v55, 0xffff0000, v204
    v_lshlrev_b32 v56, 16, v208
    v_and_b32 v57, 0xffff0000, v208
    v_lshlrev_b32 v58, 16, v209
    v_and_b32 v59, 0xffff0000, v209
    v_lshlrev_b32 v60, 16, v212
    v_and_b32 v61, 0xffff0000, v211
    v_lshlrev_b32 v62, 16, v211
    v_and_b32 v63, 0xffff0000, v210
    v_cndmask_b32 v56, v56, v60, vcc
    v_cndmask_b32 v57, v57, v61, vcc
    v_cndmask_b32 v58, v58, v62, vcc
    v_cndmask_b32 v59, v59, v63, vcc
    v_pk_add_f32 v[196:197], v[40:41], v[44:45]
    v_pk_add_f32 v[204:205], v[40:41], v[44:45] neg_lo:[0,1] neg_hi:[0,1]
    v_pk_add_f32 v[200:201], v[48:49], v[52:53]
    v_pk_add_f32 v[208:209], v[48:49], v[52:53] neg_lo:[0,1] neg_hi:[0,1]
    v_pk_add_f32 v[198:199], v[42:43], v[46:47]
    v_pk_add_f32 v[206:207], v[42:43], v[46:47] neg_lo:[0,1] neg_hi:[0,1]
    v_pk_add_f32 v[202:203], v[50:51], v[54:55]
    v_pk_add_f32 v[210:211], v[50:51], v[54:55] neg_lo:[0,1] neg_hi:[0,1]
    v_mov_b32 v212, v56
    v_mov_b32 v213, v57
    v_mov_b32 v214, v58
    v_mov_b32 v215, v59
    s_waitcnt lgkmcnt(0)
    v_mul_f32 v17, 0x3ae38e39, v28
    v_mul_f32 v29, 0x3ae38e39, v29
    v_fma_f32 v29, -v17, v17, v29
    v_max_f32 v29, 0, v29
    v_add_f32 v29, 0x3727c5ac, v29
    v_rsq_f32 v29, v29
    s_nop 0
    v_mul_f32 v28, -v17, v29
    v_pk_mul_f32 v[204:205], v[204:205], v[28:29] op_sel:[0,1] op_sel_hi:[1,1]
    v_pk_mul_f32 v[206:207], v[206:207], v[28:29] op_sel:[0,1] op_sel_hi:[1,1]
    v_pk_mul_f32 v[208:209], v[208:209], v[28:29] op_sel:[0,1] op_sel_hi:[1,1]
    v_pk_mul_f32 v[210:211], v[210:211], v[28:29] op_sel:[0,1] op_sel_hi:[1,1]
    v_pk_fma_f32 v[212:213], v[212:213], v[28:29], v[28:29] op_sel:[0,1,0] op_sel_hi:[1,1,0]
    v_pk_fma_f32 v[214:215], v[214:215], v[28:29], v[28:29] op_sel:[0,1,0] op_sel_hi:[1,1,0]
    v_add_f32 v28, v28, v28
    v_pk_fma_f32 v[196:197], v[196:197], v[28:29], v[28:29] op_sel:[0,1,0] op_sel_hi:[1,1,0]
    v_pk_fma_f32 v[198:199], v[198:199], v[28:29], v[28:29] op_sel:[0,1,0] op_sel_hi:[1,1,0]
    v_pk_fma_f32 v[200:201], v[200:201], v[28:29], v[28:29] op_sel:[0,1,0] op_sel_hi:[1,1,0]
    v_pk_fma_f32 v[202:203], v[202:203], v[28:29], v[28:29] op_sel:[0,1,0] op_sel_hi:[1,1,0]
    v_cvt_pk_bf16_f32 v204, v204, v205
    v_cvt_pk_bf16_f32 v205, v206, v207
    ds_write_b64 v188, v[204:205] offset:64
    v_cvt_pk_bf16_f32 v208, v208, v209
    v_cvt_pk_bf16_f32 v209, v210, v211
    ds_write_b64 v188, v[208:209] offset:96
    v_cvt_pk_bf16_f32 v212, v212, v213
    v_cvt_pk_bf16_f32 v213, v214, v215
    ds_write_b64 v188, v[212:213] offset:128
    v_cvt_pk_bf16_f32 v196, v196, v197
    v_cvt_pk_bf16_f32 v197, v198, v199
    ds_write_b64 v188, v[196:197] offset:0
    v_cvt_pk_bf16_f32 v200, v200, v201
    v_cvt_pk_bf16_f32 v201, v202, v203
    ds_write_b64 v188, v[200:201] offset:32
    v_pk_add_f32 v[40:41], v[40:41], v[16:17] op_sel:[0,1] op_sel_hi:[1,1] neg_lo:[0,1] neg_hi:[0,1]
    v_pk_add_f32 v[42:43], v[42:43], v[16:17] op_sel:[0,1] op_sel_hi:[1,1] neg_lo:[0,1] neg_hi:[0,1]
    v_pk_add_f32 v[44:45], v[44:45], v[16:17] op_sel:[0,1] op_sel_hi:[1,1] neg_lo:[0,1] neg_hi:[0,1]
    v_pk_add_f32 v[46:47], v[46:47], v[16:17] op_sel:[0,1] op_sel_hi:[1,1] neg_lo:[0,1] neg_hi:[0,1]
    v_pk_add_f32 v[48:49], v[48:49], v[16:17] op_sel:[0,1] op_sel_hi:[1,1] neg_lo:[0,1] neg_hi:[0,1]
    v_pk_add_f32 v[50:51], v[50:51], v[16:17] op_sel:[0,1] op_sel_hi:[1,1] neg_lo:[0,1] neg_hi:[0,1]
    v_pk_add_f32 v[52:53], v[52:53], v[16:17] op_sel:[0,1] op_sel_hi:[1,1] neg_lo:[0,1] neg_hi:[0,1]
    v_pk_add_f32 v[54:55], v[54:55], v[16:17] op_sel:[0,1] op_sel_hi:[1,1] neg_lo:[0,1] neg_hi:[0,1]
    v_pk_add_f32 v[56:57], v[56:57], v[16:17] op_sel:[0,1] op_sel_hi:[1,1] neg_lo:[0,1] neg_hi:[0,1]
    v_pk_add_f32 v[58:59], v[58:59], v[16:17] op_sel:[0,1] op_sel_hi:[1,1] neg_lo:[0,1] neg_hi:[0,1]
    s_waitcnt lgkmcnt(0)
    s_barrier
    ds_read_b64_tr_b16 v[128:129], v189 offset:0
    ds_read_b64_tr_b16 v[130:131], v189 offset:2560
    ds_read_b64_tr_b16 v[132:133], v189 offset:5120
    ds_read_b64_tr_b16 v[134:135], v189 offset:7680
    ds_read_b64_tr_b16 v[136:137], v189 offset:32
    ds_read_b64_tr_b16 v[138:139], v189 offset:2592
    ds_read_b64_tr_b16 v[140:141], v189 offset:5152
    ds_read_b64_tr_b16 v[142:143], v189 offset:7712
    ds_read_b64_tr_b16 v[144:145], v189 offset:64
    ds_read_b64_tr_b16 v[146:147], v189 offset:2624
    ds_read_b64_tr_b16 v[148:149], v189 offset:5184
    ds_read_b64_tr_b16 v[150:151], v189 offset:7744
    ds_read_b64_tr_b16 v[152:153], v189 offset:96
    ds_read_b64_tr_b16 v[154:155], v189 offset:2656
    ds_read_b64_tr_b16 v[156:157], v189 offset:5216
    ds_read_b64_tr_b16 v[158:159], v189 offset:7776
    ds_read_b64_tr_b16 v[160:161], v189 offset:128
    ds_read_b64_tr_b16 v[162:163], v189 offset:2688
    ds_read_b64_tr_b16 v[164:165], v189 offset:5248
    ds_read_b64_tr_b16 v[166:167], v189 offset:7808
    s_waitcnt lgkmcnt(15)
    v_mfma_f32_16x16x32_bf16 v[168:171], v[128:131], v[104:107], 0
    v_cvt_pk_bf16_f32 v40, v40, v41
    v_mfma_f32_16x16x32_bf16 v[168:171], v[132:135], v[108:111], v[168:171]
    v_cvt_pk_bf16_f32 v41, v42, v43
    s_waitcnt lgkmcnt(12)
    v_mfma_f32_16x16x32_bf16 v[172:175], v[136:139], v[104:107], 0
    v_cvt_pk_bf16_f32 v42, v44, v45
    v_mfma_f32_16x16x32_bf16 v[172:175], v[140:143], v[108:111], v[172:175]
    v_cvt_pk_bf16_f32 v43, v46, v47
    s_waitcnt lgkmcnt(8)
    v_mfma_f32_16x16x32_bf16 v[176:179], v[144:147], v[104:107], 0
    v_cvt_pk_bf16_f32 v44, v48, v49
    v_mfma_f32_16x16x32_bf16 v[176:179], v[148:151], v[108:111], v[176:179]
    v_cvt_pk_bf16_f32 v45, v50, v51
    s_waitcnt lgkmcnt(4)
    v_mfma_f32_16x16x32_bf16 v[180:183], v[152:155], v[104:107], 0
    v_cvt_pk_bf16_f32 v46, v52, v53
    v_mfma_f32_16x16x32_bf16 v[180:183], v[156:159], v[108:111], v[180:183]
    v_cvt_pk_bf16_f32 v47, v54, v55
    s_waitcnt lgkmcnt(0)
    v_mfma_f32_16x16x32_bf16 v[184:187], v[160:163], v[104:107], 0
    v_cvt_pk_bf16_f32 v48, v56, v57
    v_mfma_f32_16x16x32_bf16 v[184:187], v[164:167], v[108:111], v[184:187]
    v_cvt_pk_bf16_f32 v49, v58, v59
    v_cvt_pk_bf16_f32 v196, v168, v169
    v_cvt_pk_bf16_f32 v197, v170, v171
    v_cvt_pk_bf16_f32 v198, v172, v173
    v_cvt_pk_bf16_f32 v199, v174, v175
    buffer_store_dwordx4 v[196:199], v190, s[12:15], s24 offen offset:0 sc1
    v_cvt_pk_bf16_f32 v200, v176, v177
    v_cvt_pk_bf16_f32 v201, v178, v179
    v_cvt_pk_bf16_f32 v202, v180, v181
    v_cvt_pk_bf16_f32 v203, v182, v183
    buffer_store_dwordx4 v[200:203], v190, s[12:15], s24 offen offset:1024 sc1
    v_cvt_pk_bf16_f32 v204, v184, v185
    v_cvt_pk_bf16_f32 v205, v186, v187
    buffer_store_dwordx2 v[204:205], v191, s[12:15], s25 offen sc1
    buffer_store_dwordx2 v[40:41], v192, s[12:15], s26 offen offset:0 sc1
    buffer_store_dwordx2 v[42:43], v192, s[12:15], s26 offen offset:512 sc1
    buffer_store_dwordx2 v[44:45], v192, s[12:15], s26 offen offset:1024 sc1
    buffer_store_dwordx2 v[46:47], v192, s[12:15], s26 offen offset:1536 sc1
    buffer_store_dwordx2 v[48:49], v192, s[12:15], s27 offen sc1
    s_add_u32 s61, s61, 3145728
    s_mov_b32 exec_hi, 0
    buffer_load_dword v244, v245, s[64:67], s61 offen
    s_mov_b32 exec_hi, -1
    v_sin_f32 v72, -v80
    v_sin_f32 v73, -v81
    v_sin_f32 v74, -v82
    v_sin_f32 v75, -v83
    v_sin_f32 v76, -v84
    v_sin_f32 v77, -v85
    v_sin_f32 v78, -v86
    v_sin_f32 v79, -v87
    v_cvt_pk_bf16_f32 v92, v72, v73
    v_cvt_pk_bf16_f32 v93, v74, v75
    v_cvt_pk_bf16_f32 v94, v76, v77
    v_cvt_pk_bf16_f32 v95, v78, v79
    ds_write_b128 v101, v[92:95] offset:4096
    v_fmamk_f32 v80, v97, 0x42000000, v100
    v_fmamk_f32 v81, v97, 0x42040000, v100
    v_fmamk_f32 v82, v97, 0x42080000, v100
    v_fmamk_f32 v83, v97, 0x420c0000, v100
    v_fmamk_f32 v84, v97, 0x42400000, v100
    v_fmamk_f32 v85, v97, 0x42440000, v100
    v_fmamk_f32 v86, v97, 0x42480000, v100
    v_fmamk_f32 v87, v97, 0x424c0000, v100
    v_cos_f32 v72, v80
    v_cos_f32 v73, v81
    v_cos_f32 v74, v82
    v_cos_f32 v75, v83
    v_cos_f32 v76, v84
    v_cos_f32 v77, v85
    v_cos_f32 v78, v86
    v_cos_f32 v79, v87
    v_cvt_pk_bf16_f32 v88, v72, v73
    v_cvt_pk_bf16_f32 v89, v74, v75
    v_cvt_pk_bf16_f32 v90, v76, v77
    v_cvt_pk_bf16_f32 v91, v78, v79
    ds_write_b128 v101, v[88:91] offset:7168
    v_sin_f32 v72, -v80
    v_sin_f32 v73, -v81
    v_sin_f32 v74, -v82
    v_sin_f32 v75, -v83
    v_sin_f32 v76, -v84
    v_sin_f32 v77, -v85
    v_sin_f32 v78, -v86
    v_sin_f32 v79, -v87
    v_cvt_pk_bf16_f32 v92, v72, v73
    v_cvt_pk_bf16_f32 v93, v74, v75
    v_cvt_pk_bf16_f32 v94, v76, v77
    v_cvt_pk_bf16_f32 v95, v78, v79
    ds_write_b128 v101, v[92:95] offset:10240
    v_mul_f32 v100, v99, v98
    v_mov_b32 v80, v100
    v_fmamk_f32 v81, v98, 0x3f800000, v100
    v_fmamk_f32 v82, v98, 0x40000000, v100
    v_fmamk_f32 v83, v98, 0x40400000, v100
    v_fmamk_f32 v84, v98, 0x41800000, v100
    v_fmamk_f32 v85, v98, 0x41880000, v100
    v_fmamk_f32 v86, v98, 0x41900000, v100
    v_fmamk_f32 v87, v98, 0x41980000, v100
    v_cos_f32 v72, v80
    v_cos_f32 v73, v81
    v_cos_f32 v74, v82
    v_cos_f32 v75, v83
    v_cos_f32 v76, v84
    v_cos_f32 v77, v85
    v_cos_f32 v78, v86
    v_cos_f32 v79, v87
    v_cvt_pk_bf16_f32 v88, v72, v73
    v_cvt_pk_bf16_f32 v89, v74, v75
    v_cvt_pk_bf16_f32 v90, v76, v77
    v_cvt_pk_bf16_f32 v91, v78, v79
    v_and_b32 v72, 0xffff0000, v88
    v_cndmask_b32 v88, v88, v72, s[54:55]
    ds_write_b128 v101, v[88:91] offset:2048
    v_sin_f32 v72, -v80
    v_sin_f32 v73, -v81
    v_sin_f32 v74, -v82
    v_sin_f32 v75, -v83
    v_sin_f32 v76, -v84
    v_sin_f32 v77, -v85
    v_sin_f32 v78, -v86
    v_sin_f32 v79, -v87
    v_cvt_pk_bf16_f32 v92, v72, v73
    v_cvt_pk_bf16_f32 v93, v74, v75
    v_cvt_pk_bf16_f32 v94, v76, v77
    v_cvt_pk_bf16_f32 v95, v78, v79
    ds_write_b128 v101, v[92:95] offset:5120
    v_lshrrev_b32 v28, 2, v2
    v_lshl_add_u32 v28, v3, 2, v28
    v_and_b32 v29, 3, v2
    v_lshrrev_b32 v24, 3, v28
    v_mul_u32_u24 v24, 9216, v24
    v_and_b32 v25, 7, v28
    v_lshl_add_u32 v24, v25, 7, v24
    v_lshl_add_u32 v24, v29, 3, v24
    s_add_u32 s45, s3, 0
    s_lshr_b32 s46, s45, 2
    s_mul_i32 s46, s46, 896
    s_lshl_b32 s45, s45, 5
    s_add_u32 s45, s45, s46
    v_add_u32 v32, s45, v24
    s_add_u32 s45, s3, 1
    s_lshr_b32 s46, s45, 2
    s_mul_i32 s46, s46, 896
    s_lshl_b32 s45, s45, 5
    s_add_u32 s45, s45, s46
    v_add_u32 v33, s45, v24
    s_add_u32 s45, s3, 2
    s_lshr_b32 s46, s45, 2
    s_mul_i32 s46, s46, 896
    s_lshl_b32 s45, s45, 5
    s_add_u32 s45, s45, s46
    v_add_u32 v34, s45, v24
    s_add_u32 s45, s3, 3
    s_lshr_b32 s46, s45, 2
    s_mul_i32 s46, s46, 896
    s_lshl_b32 s45, s45, 5
    s_add_u32 s45, s45, s46
    v_add_u32 v35, s45, v24
    s_lshl_b32 s45, s3, 11
    s_add_u32 s45, s45, 73728
    v_add_u32 v32, s45, v32
    v_add_u32 v33, s45, v33
    v_add_u32 v34, s45, v34
    v_add_u32 v35, s45, v35
    s_cmp_eq_u32 s3, 3
    s_cselect_b32 s45, 5056, 0
    v_subrev_u32 v36, s45, v33
    v_and_b32 v30, 1, v2
    v_lshlrev_b32 v30, 7, v30
    s_waitcnt vmcnt(1)
    s_waitcnt lgkmcnt(0)
    s_barrier
    v_lshlrev_b32 v24, 2, v2
    s_add_u32 s95, s37, s29
    s_mov_b64 exec, 0xffff
    buffer_store_dword v12, v24, s[12:15], s95 offen offset:0 sc1
    s_mov_b64 exec, -1
    buffer_load_dword v31, v30, s[20:23], 0 offen sc1
    ds_read_b64_tr_b16 v[128:129], v32 offset:0
    ds_read_b64_tr_b16 v[130:131], v32 offset:18432
    ds_read_b64_tr_b16 v[132:133], v33 offset:0
    ds_read_b64_tr_b16 v[134:135], v33 offset:18432
    ds_read_b64_tr_b16 v[136:137], v34 offset:0
    ds_read_b64_tr_b16 v[138:139], v34 offset:18432
    ds_read_b64_tr_b16 v[140:141], v35 offset:0
    ds_read_b64_tr_b16 v[142:143], v35 offset:18432
    ds_read_b64_tr_b16 v[144:145], v32 offset:1024
    ds_read_b64_tr_b16 v[146:147], v32 offset:19456
    ds_read_b64_tr_b16 v[148:149], v33 offset:1024
    ds_read_b64_tr_b16 v[150:151], v33 offset:19456
    ds_read_b64_tr_b16 v[152:153], v34 offset:1024
    ds_read_b64_tr_b16 v[154:155], v34 offset:19456
    ds_read_b64_tr_b16 v[156:157], v35 offset:1024
    ds_read_b64_tr_b16 v[158:159], v35 offset:19456
    ds_read_b64_tr_b16 v[160:161], v32 offset:2048
    ds_read_b64_tr_b16 v[162:163], v32 offset:20480
    ds_read_b64_tr_b16 v[164:165], v36 offset:2048
    ds_read_b64_tr_b16 v[166:167], v36 offset:20480
    s_waitcnt lgkmcnt(0)
    s_cmp_ge_u32 s7, 6
    s_cbranch_scc1 L_interleave_layers__spectral_fnet__mixer_gmlp__prompt_kernel_3
    v_fmamk_f32 v80, v98, 0x42000000, v100
    v_fmamk_f32 v81, v98, 0x42040000, v100
    v_fmamk_f32 v82, v98, 0x42080000, v100
    v_fmamk_f32 v83, v98, 0x420c0000, v100
    v_fmamk_f32 v84, v98, 0x42400000, v100
    v_cndmask_b32 v128, v128, v132, s[92:93]
    v_cndmask_b32 v129, v129, v133, s[92:93]
    v_cndmask_b32 v130, v130, v134, s[92:93]
    v_cndmask_b32 v131, v131, v135, s[92:93]
    buffer_store_dwordx4 v[128:131], v19, s[12:15], s42 offen sc1
    s_add_u32 s42, s42, s43
    v_fmamk_f32 v85, v98, 0x42440000, v100
    v_fmamk_f32 v86, v98, 0x42480000, v100
    v_fmamk_f32 v87, v98, 0x424c0000, v100
    v_cos_f32 v72, v80
    v_cos_f32 v73, v81
    v_cos_f32 v74, v82
    v_cndmask_b32 v132, v132, v136, s[92:93]
    v_cndmask_b32 v133, v133, v137, s[92:93]
    v_cndmask_b32 v134, v134, v138, s[92:93]
    v_cndmask_b32 v135, v135, v139, s[92:93]
    buffer_store_dwordx4 v[132:135], v19, s[12:15], s42 offen sc1
    s_add_u32 s42, s42, s43
    v_cos_f32 v75, v83
    v_cos_f32 v76, v84
    v_cos_f32 v77, v85
    v_cos_f32 v78, v86
    v_cos_f32 v79, v87
    v_cvt_pk_bf16_f32 v88, v72, v73
    v_cndmask_b32 v136, v136, v140, s[92:93]
    v_cndmask_b32 v137, v137, v141, s[92:93]
    v_cndmask_b32 v138, v138, v142, s[92:93]
    v_cndmask_b32 v139, v139, v143, s[92:93]
    buffer_store_dwordx4 v[136:139], v19, s[12:15], s42 offen sc1
    s_add_u32 s42, s42, s43
    v_cvt_pk_bf16_f32 v89, v74, v75
    v_cvt_pk_bf16_f32 v90, v76, v77
    v_cvt_pk_bf16_f32 v91, v78, v79
    ds_write_b128 v101, v[88:91] offset:8192
    v_sin_f32 v72, -v80
    v_sin_f32 v73, -v81
    v_sin_f32 v74, -v82
    v_cndmask_b32 v140, v140, v144, s[92:93]
    v_cndmask_b32 v141, v141, v145, s[92:93]
    v_cndmask_b32 v142, v142, v146, s[92:93]
    v_cndmask_b32 v143, v143, v147, s[92:93]
    buffer_store_dwordx4 v[140:143], v19, s[12:15], s42 offen sc1
    s_add_u32 s42, s42, s43
    v_sin_f32 v75, -v83
    v_sin_f32 v76, -v84
    v_sin_f32 v77, -v85
    v_sin_f32 v78, -v86
    v_sin_f32 v79, -v87
    v_cvt_pk_bf16_f32 v92, v72, v73
    v_cndmask_b32 v144, v144, v148, s[92:93]
    v_cndmask_b32 v145, v145, v149, s[92:93]
    v_cndmask_b32 v146, v146, v150, s[92:93]
    v_cndmask_b32 v147, v147, v151, s[92:93]
    buffer_store_dwordx4 v[144:147], v19, s[12:15], s42 offen sc1
    s_add_u32 s42, s42, s43
    v_cvt_pk_bf16_f32 v93, v74, v75
    v_cvt_pk_bf16_f32 v94, v76, v77
    v_cvt_pk_bf16_f32 v95, v78, v79
    ds_write_b128 v101, v[92:95] offset:11264
    s_lshr_b32 s11, s3, 1
    s_lshl_b32 s11, s11, 4
    s_add_u32 s11, s11, 256
    v_lshl_add_u32 v99, v3, 2, s11
    v_cvt_f32_u32 v99, v99
    s_bitcmp1_b32 s3, 0
    s_cselect_b32 s11, 0x3e800000, 0
    v_fma_f32 v100, v99, v96, s11
    v_fma_f32 v103, -v99, v96, s11
    v_mov_b32 v72, v100
    v_cndmask_b32 v148, v148, v152, s[92:93]
    v_cndmask_b32 v149, v149, v153, s[92:93]
    v_cndmask_b32 v150, v150, v154, s[92:93]
    v_cndmask_b32 v151, v151, v155, s[92:93]
    buffer_store_dwordx4 v[148:151], v19, s[12:15], s42 offen sc1
    s_add_u32 s42, s42, s43
    v_fmamk_f32 v73, v96, 0x3f800000, v100
    v_fmamk_f32 v74, v96, 0x40000000, v100
    v_fmamk_f32 v75, v96, 0x40400000, v100
    v_mov_b32 v76, v103
    v_fmamk_f32 v77, v96, 0xbf800000, v103
    v_fmamk_f32 v78, v96, 0xc0000000, v103
    v_cndmask_b32 v152, v152, v156, s[92:93]
    v_cndmask_b32 v153, v153, v157, s[92:93]
    v_cndmask_b32 v154, v154, v158, s[92:93]
    v_cndmask_b32 v155, v155, v159, s[92:93]
    buffer_store_dwordx4 v[152:155], v19, s[12:15], s42 offen sc1
    s_add_u32 s42, s42, s43
    v_fmamk_f32 v79, v96, 0xc0400000, v103
    v_cos_f32 v72, v72
    v_cos_f32 v73, v73
    v_cos_f32 v74, v74
    v_cos_f32 v75, v75
    v_cos_f32 v76, v76
    v_cndmask_b32 v156, v156, v160, s[92:93]
    v_cndmask_b32 v157, v157, v161, s[92:93]
    v_cndmask_b32 v158, v158, v162, s[92:93]
    v_cndmask_b32 v159, v159, v163, s[92:93]
    buffer_store_dwordx4 v[156:159], v19, s[12:15], s42 offen sc1
    s_add_u32 s42, s42, s43
    v_cos_f32 v77, v77
    v_cos_f32 v78, v78
    v_cos_f32 v79, v79
    v_cvt_pk_bf16_f32 v88, v72, v73
    v_cvt_pk_bf16_f32 v89, v74, v75
    v_cvt_pk_bf16_f32 v90, v76, v77
    v_cndmask_b32 v160, v160, v164, s[92:93]
    v_cndmask_b32 v161, v161, v165, s[92:93]
    v_cndmask_b32 v162, v162, v166, s[92:93]
    v_cndmask_b32 v163, v163, v167, s[92:93]
    buffer_store_dwordx4 v[160:163], v19, s[12:15], s42 offen sc1
    s_add_u32 s42, s42, s43
    v_cvt_pk_bf16_f32 v91, v78, v79
    ds_write_b128 v102, v[88:91] offset:49152
    v_fma_f32 v100, v99, v97, s11
    v_fma_f32 v103, -v99, v97, s11
    v_mov_b32 v72, v100
    v_fmamk_f32 v73, v97, 0x3f800000, v100
    v_fmamk_f32 v74, v97, 0x40000000, v100
    s_add_u32 s61, s61, 2097152
    s_cmp_lt_u32 s7, 2
    s_cselect_b32 s61, 268435456, s61
    s_mov_b32 exec_hi, 0
    buffer_load_dword v244, v245, s[64:67], s61 offen
    s_mov_b32 exec_hi, -1
    v_fmamk_f32 v75, v97, 0x40400000, v100
    v_mov_b32 v76, v103
    v_fmamk_f32 v77, v97, 0xbf800000, v103
    v_fmamk_f32 v78, v97, 0xc0000000, v103
    v_fmamk_f32 v79, v97, 0xc0400000, v103
    v_cos_f32 v72, v72
    v_cos_f32 v73, v73
    v_cos_f32 v74, v74
    v_cos_f32 v75, v75
    v_cos_f32 v76, v76
    v_cos_f32 v77, v77
    v_cos_f32 v78, v78
    v_cos_f32 v79, v79
    v_cvt_pk_bf16_f32 v92, v72, v73
    v_cvt_pk_bf16_f32 v93, v74, v75
    v_cvt_pk_bf16_f32 v94, v76, v77
    v_cvt_pk_bf16_f32 v95, v78, v79
    ds_write_b128 v102, v[92:95] offset:50176
    v_fma_f32 v100, v99, v98, s11
    v_fma_f32 v103, -v99, v98, s11
    v_mov_b32 v72, v100
    v_fmamk_f32 v73, v98, 0x3f800000, v100
    v_fmamk_f32 v74, v98, 0x40000000, v100
    v_fmamk_f32 v75, v98, 0x40400000, v100
    v_mov_b32 v76, v103
    v_fmamk_f32 v77, v98, 0xbf800000, v103
    v_fmamk_f32 v78, v98, 0xc0000000, v103
    v_fmamk_f32 v79, v98, 0xc0400000, v103
    v_cos_f32 v72, v72
    v_cos_f32 v73, v73
    v_cos_f32 v74, v74
    v_cos_f32 v75, v75
    v_cos_f32 v76, v76
    v_cos_f32 v77, v77
    v_cos_f32 v78, v78
    v_cos_f32 v79, v79
    v_cvt_pk_bf16_f32 v88, v72, v73
    v_cvt_pk_bf16_f32 v89, v74, v75
    v_cvt_pk_bf16_f32 v90, v76, v77
    v_cvt_pk_bf16_f32 v91, v78, v79
    ds_write_b128 v102, v[88:91] offset:51200
    s_lshl_b32 s45, s6, 1
    s_add_u32 s46, s45, 1
    s_sub_u32 s47, 3, s45
    s_cmp_eq_u32 s4, 0
    s_cselect_b32 s46, s46, s47
    s_cmp_lt_u32 s3, 2
    s_cselect_b32 s45, s45, s46
    s_cselect_b32 s49, 3, 1
    s_cselect_b32 s50, 0, 16
    s_lshl_b32 s46, s4, 2
    s_add_u32 s45, s45, s46
    s_lshr_b32 s52, s45, 2
    s_bfe_u32 s53, s45, 0x10001
    s_sub_u32 s54, 32, s52
    s_cmp_eq_u32 s52, 0
    s_cselect_b32 s54, 16, s54
    s_cmp_eq_u32 s53, 0
    s_cselect_b32 s46, s52, s54
    s_and_b32 s52, s45, 1
    s_lshl_b32 s52, s52, 5
    s_add_u32 s46, s46, s52
    s_and_b32 s47, s3, 1
    s_lshl_b32 s48, s45, 1
    s_add_u32 s48, s48, s47
    s_lshl_b32 s47, s47, 10
    s_add_u32 s46, s46, s47
    s_lshl_b32 s49, s49, 9
    s_lshl_b32 s50, 0xffff, s50
    s_cmp_eq_u32 s10, 0
    s_cselect_b32 s49, 0, s49
    s_cselect_b32 s50, s50, -1
    v_lshl_add_u32 v176, v2, 6, s46
    v_lshlrev_b32 v177, 1, v3
    v_mul_u32_u24 v177, v177, v176
    v_add_u32 v178, s49, v177
    v_cvt_f32_u32 v176, v176
    v_cvt_f32_u32 v177, v177
    v_cvt_f32_u32 v178, v178
    v_mul_f32 v176, 0x3a000000, v176
    v_mul_f32 v177, 0x3a000000, v177
    v_mul_f32 v178, 0x3a000000, v178
    v_mov_b32 v180, v177
    v_mov_b32 v181, v178
    v_fmamk_f32 v182, v176, 0x3f800000, v177
    v_fmamk_f32 v183, v176, 0x3f800000, v178
    v_fmamk_f32 v184, v176, 0x41000000, v177
    v_fmamk_f32 v185, v176, 0x41000000, v178
    v_fmamk_f32 v186, v176, 0x41100000, v177
    v_fmamk_f32 v187, v176, 0x41100000, v178
    v_cos_f32 v168, v180
    v_cos_f32 v169, v181
    v_cos_f32 v170, v182
    v_cos_f32 v171, v183
    v_cos_f32 v172, v184
    v_cos_f32 v173, v185
    v_cos_f32 v174, v186
    v_cos_f32 v175, v187
    v_cvt_pk_bf16_f32 v224, v168, v169
    v_cvt_pk_bf16_f32 v225, v170, v171
    v_cvt_pk_bf16_f32 v226, v172, v173
    v_cvt_pk_bf16_f32 v227, v174, v175
    v_sin_f32 v168, -v180
    v_sin_f32 v169, -v181
    v_sin_f32 v170, -v182
    v_sin_f32 v171, -v183
    v_sin_f32 v172, -v184
    v_sin_f32 v173, -v185
    v_sin_f32 v174, -v186
    v_sin_f32 v175, -v187
    v_cvt_pk_bf16_f32 v232, v168, v169
    v_cvt_pk_bf16_f32 v233, v170, v171
    v_cvt_pk_bf16_f32 v234, v172, v173
    v_cvt_pk_bf16_f32 v235, v174, v175
    v_fmamk_f32 v180, v176, 0x41800000, v177
    v_fmamk_f32 v181, v176, 0x41800000, v178
    v_fmamk_f32 v182, v176, 0x41880000, v177
    v_fmamk_f32 v183, v176, 0x41880000, v178
    v_fmamk_f32 v184, v176, 0x41c00000, v177
    v_fmamk_f32 v185, v176, 0x41c00000, v178
    v_fmamk_f32 v186, v176, 0x41c80000, v177
    v_fmamk_f32 v187, v176, 0x41c80000, v178
    v_cos_f32 v168, v180
    v_cos_f32 v169, v181
    s_waitcnt vmcnt(1)
    v_lshlrev_b32 v247, 2, v2
    s_add_u32 s95, s37, 18874368
    s_mov_b64 exec, 0xffff
    buffer_store_dword v12, v247, s[12:15], s95 offen offset:1664 sc1
    s_mov_b64 exec, -1
    v_cos_f32 v170, v182
    v_cos_f32 v171, v183
    v_cos_f32 v172, v184
    v_cos_f32 v173, v185
    v_cos_f32 v174, v186
    v_cos_f32 v175, v187
    v_cvt_pk_bf16_f32 v228, v168, v169
    v_cvt_pk_bf16_f32 v229, v170, v171
    v_cvt_pk_bf16_f32 v230, v172, v173
    v_cvt_pk_bf16_f32 v231, v174, v175
    v_sin_f32 v168, -v180
    v_sin_f32 v169, -v181
    v_sin_f32 v170, -v182
    v_sin_f32 v171, -v183
    v_sin_f32 v172, -v184
    v_sin_f32 v173, -v185
    v_sin_f32 v174, -v186
    v_sin_f32 v175, -v187
    v_cvt_pk_bf16_f32 v236, v168, v169
    v_cvt_pk_bf16_f32 v237, v170, v171
    v_cvt_pk_bf16_f32 v238, v172, v173
    v_cvt_pk_bf16_f32 v239, v174, v175
    v_and_b32 v224, s50, v224
    v_and_b32 v225, s50, v225
    v_and_b32 v226, s50, v226
    v_and_b32 v227, s50, v227
    v_and_b32 v228, s50, v228
    v_and_b32 v229, s50, v229
    v_and_b32 v230, s50, v230
    v_and_b32 v231, s50, v231
    v_and_b32 v232, s50, v232
    v_and_b32 v233, s50, v233
    v_and_b32 v234, s50, v234
    v_and_b32 v235, s50, v235
    v_and_b32 v236, s50, v236
    v_and_b32 v237, s50, v237
    v_and_b32 v238, s50, v238
    v_and_b32 v239, s50, v239
    s_mov_b32 s16, s76
    s_and_b32 s17, s77, 0xffff
    s_mov_b32 s18, 2359296
    s_mov_b32 s19, 0x00020000
    s_mov_b32 s80, s8
    s_or_b32 s81, s13, 0x100000
    s_mov_b32 s82, 0x10000000
    s_mov_b32 s83, 0x00800000
    s_mul_i32 s34, s5, 331776
    s_add_u32 s34, s34, s32
    s_mul_i32 s38, s5, 589824
    s_add_u32 s38, s38, s32
    s_add_u32 s38, s38, 9437184
    s_lshl_b32 s36, s31, 17
    s_add_u32 s36, s36, 6291456
    s_lshl_b32 s39, s6, 2
    s_add_u32 s39, s39, s3
    s_mul_i32 s39, s39, 331776
    s_lshl_b32 s11, s7, 12
    s_add_u32 s39, s39, s11
    s_add_u32 s39, s39, 14680064
    s_mul_i32 s11, s7, 3072
    s_sub_u32 s11, 32768, s11
    s_cmp_ge_u32 s7, 4
    s_cselect_b32 s11, 268435456, s11
    v_add_u32 v16, s11, v1
    v_add_u32 v4, 0, v1
    v_add_u32 v5, 36864, v1
    v_add_u32 v6, 73728, v1
    v_add_u32 v7, 110592, v1
    v_cmp_gt_u32 vcc, 128, v31
    s_nop 3
    s_cbranch_vccnz L_interleave_layers__spectral_fnet__mixer_gmlp__prompt_kernel_4
L_interleave_layers__spectral_fnet__mixer_gmlp__prompt_kernel_5:
L_layer_interleave_layers__spectral_fnet__mixer_gmlp__prompt_kernel:
    s_add_u32 s35, s28, s38
    s_cmp_ge_u32 s7, 6
    s_cbranch_scc1 L_interleave_layers__spectral_fnet__mixer_gmlp__prompt_kernel_6
    v_lshrrev_b32 v209, 2, v2
    v_lshlrev_b32 v209, 8, v209
    v_and_b32 v197, 2, v2
    v_lshl_add_u32 v209, v197, 5, v209
    v_and_b32 v197, 2, v3
    v_lshl_add_u32 v196, v197, 5, v209
    v_lshl_add_u32 v196, v3, 5, v196
    v_and_b32 v197, 1, v2
    v_lshl_add_u32 v196, v197, 4, v196
    v_lshl_add_u32 v209, v197, 3, v209
    v_lshl_add_u32 v209, v3, 4, v209
    v_lshrrev_b32 v210, 1, v1
    v_mul_u32_u24 v200, 0x3f80, v197
    v_cmp_eq_u32 vcc, 0, v3
    s_nop 1
    v_cndmask_b32 v200, 0, v200, vcc
    v_mov_b32 v201, 0
    v_mov_b32 v202, 0
    v_mov_b32 v203, 0
    v_mov_b32 v212, 0xbf00
    v_cndmask_b32 v212, 0, v212, vcc
    v_mov_b32 v213, 0
    v_mov_b32 v214, 0
    v_mov_b32 v215, 0
    s_lshl_b32 s49, s48, 3
    s_add_u32 s49, s49, s7
    s_lshl_b32 s49, s49, 7
    s_add_u32 s49, s49, s28
    s_add_u32 s49, s49, 2621440
    s_lshl_b32 s45, s10, 2
    s_add_u32 s45, s45, s3
    s_mul_i32 s45, s45, 18432
    s_add_u32 s45, s45, s28
    s_add_u32 s45, s45, 3145728
    s_mul_i32 s48, s48, 18432
    s_mul_i32 s47, s7, 3072
    s_add_u32 s48, s48, s47
    s_add_u32 s48, s48, s28
    s_lshr_b32 s46, s3, 1
    s_lshl_b32 s46, s46, 10
    s_and_b32 s47, s3, 1
    s_lshl_b32 s47, s47, 3
    s_add_u32 s46, s46, s47
    s_add_u32 s46, s46, 147456
    v_add_u32 v204, s46, v1
    v_add_u32 v205, 147456, v1
    s_and_b32 s11, s3, 1
    s_mul_i32 s11, s11, 72
    v_min_u32 v206, 8, v2
    v_lshl_add_u32 v206, v206, 3, s11
    s_lshr_b32 s11, s5, 2
    v_and_b32 v207, 1, v3
    v_lshl_add_u32 v207, v207, 2, s11
    v_add_u32 v206, v206, v207
    v_lshrrev_b32 v207, 6, v206
    v_add_u32 v207, 3, v207
    v_and_b32 v207, 3, v207
    v_lshlrev_b32 v207, 1, v207
    v_bfe_u32 v208, v206, 1, 5
    v_lshl_add_u32 v207, v208, 3, v207
    v_and_b32 v206, 1, v206
    v_add_u32 v206, v206, v207
    s_and_b32 s11, s5, 3
    s_lshl_b32 s11, s11, 11
    v_lshl_add_u32 v206, v206, 13, s11
    v_lshrrev_b32 v197, 7, v1
    s_and_b32 s46, s3, 1
    s_lshl_b32 s46, s46, 3
    v_add_u32 v197, s46, v197
    v_sub_u32 v198, 16, v197
    v_and_b32 v198, 15, v198
    s_cmp_ge_u32 s3, 2
    s_cselect_b64 vcc, -1, 0
    s_cselect_b32 s46, 0x10000, 0
    v_cndmask_b32 v197, v197, v198, vcc
    v_and_b32 v198, 7, v2
    v_lshl_add_u32 v197, v197, 4, v198
    v_lshlrev_b32 v197, 13, v197
    s_lshr_b32 s47, s10, 3
    s_lshl_b32 s47, s47, 11
    s_add_u32 s46, s46, s47
    s_add_u32 s46, s46, s29
    s_mov_b32 s40, 0
    s_mov_b64 vcc, -1
L_interleave_layers__spectral_fnet__mixer_gmlp__prompt_kernel_7:
    s_mov_b64 exec, vcc
    buffer_load_dword v198, v197, s[12:15], s46 offen offset:0 sc1
    s_add_u32 s40, s40, 1
    s_cmp_gt_u32 s40, 2000000
    s_cbranch_scc1 L_interleave_layers__spectral_fnet__mixer_gmlp__prompt_kernel_8
    s_waitcnt vmcnt(0)
    v_cmp_eq_u32 vcc, 0, v198
    s_nop 3
    s_cbranch_vccnz L_interleave_layers__spectral_fnet__mixer_gmlp__prompt_kernel_7
L_interleave_layers__spectral_fnet__mixer_gmlp__prompt_kernel_9:
    s_mov_b64 exec, -1
    s_mov_b32 s47, 18874368
    buffer_load_dwordx4 a[0:3], v196, s[12:15], s45 offen offset:0 sc1
    buffer_load_dwordx4 a[4:7], v196, s[12:15], s45 offen offset:1024 sc1
    buffer_load_dwordx4 a[8:11], v196, s[12:15], s45 offen offset:2048 sc1
    buffer_load_dwordx4 a[12:15], v196, s[12:15], s45 offen offset:3072 sc1
    s_add_u32 s45, s45, 4096
    buffer_load_dwordx4 a[16:19], v196, s[12:15], s45 offen offset:0 sc1
    buffer_load_dwordx4 a[20:23], v196, s[12:15], s45 offen offset:1024 sc1
    buffer_load_dword v207, v206, s[12:15], s47 offen offset:1664 sc1
    buffer_load_dwordx4 a[24:27], v196, s[12:15], s45 offen offset:2048 sc1
    buffer_load_dwordx4 a[28:31], v196, s[12:15], s45 offen offset:3072 sc1
    s_add_u32 s45, s45, 4096
    buffer_load_dwordx4 a[32:35], v196, s[12:15], s45 offen offset:0 sc1
    buffer_load_dwordx4 a[36:39], v196, s[12:15], s45 offen offset:1024 sc1
    s_waitcnt lgkmcnt(0)
    s_barrier
    ds_read_b128 v[40:43], v4 offset:0
    ds_read_b128 v[44:47], v4 offset:1024
    ds_read_b128 v[48:51], v4 offset:2048
    ds_read_b128 v[52:55], v4 offset:3072
    ds_read_b128 v[56:59], v4 offset:4096
    ds_read_b128 v[60:63], v4 offset:5120
    ds_read_b128 v[64:67], v4 offset:6144
    ds_read_b128 v[68:71], v4 offset:7168
    ds_read_b128 v[72:75], v4 offset:8192
    ds_read_b128 v[76:79], v4 offset:9216
    ds_read_b128 v[80:83], v4 offset:10240
    ds_read_b128 v[84:87], v4 offset:11264
    s_waitcnt vmcnt(10) lgkmcnt(9)
    v_mfma_f32_16x16x32_bf16 v[96:99], a[0:3], v[40:43], 0
    ds_read_b128 v[40:43], v4 offset:12288
    buffer_load_dwordx4 a[40:43], v196, s[12:15], s45 offen offset:2048 sc1
    v_mfma_f32_16x16x32_bf16 v[100:103], a[0:3], v[44:47], 0
    ds_read_b128 v[44:47], v4 offset:13312
    v_mfma_f32_16x16x32_bf16 v[104:107], a[0:3], v[48:51], 0
    ds_read_b128 v[48:51], v4 offset:14336
    v_mfma_f32_16x16x32_bf16 v[120:123], a[0:3], v[212:215], 0
    buffer_load_dwordx4 a[44:47], v196, s[12:15], s45 offen offset:3072 sc1
    s_waitcnt vmcnt(11) lgkmcnt(9)
    v_mfma_f32_16x16x32_bf16 v[108:111], a[4:7], v[52:55], 0
    ds_read_b128 v[52:55], v4 offset:15360
    v_mfma_f32_16x16x32_bf16 v[96:99], a[4:7], v[200:203], v[96:99]
    v_mfma_f32_16x16x32_bf16 v[112:115], a[4:7], v[56:59], 0
    ds_read_b128 v[56:59], v4 offset:16384
    v_mfma_f32_16x16x32_bf16 v[100:103], a[4:7], v[200:203], v[100:103]
    s_add_u32 s45, s45, 4096
    buffer_load_dwordx4 a[48:51], v196, s[12:15], s45 offen offset:0 sc1
    v_mfma_f32_16x16x32_bf16 v[116:119], a[4:7], v[60:63], 0
    ds_read_b128 v[60:63], v4 offset:17408
    v_mfma_f32_16x16x32_bf16 v[104:107], a[4:7], v[200:203], v[104:107]
    v_mfma_f32_16x16x32_bf16 v[120:123], a[4:7], v[212:215], v[120:123]
    s_waitcnt vmcnt(11) lgkmcnt(9)
    v_mfma_f32_16x16x32_bf16 v[96:99], a[8:11], v[64:67], v[96:99]
    ds_read_b128 v[64:67], v4 offset:18432
    buffer_load_dwordx4 a[52:55], v196, s[12:15], s45 offen offset:1024 sc1
    v_mfma_f32_16x16x32_bf16 v[100:103], a[8:11], v[68:71], v[100:103]
    ds_read_b128 v[68:71], v4 offset:19456
    v_mfma_f32_16x16x32_bf16 v[104:107], a[8:11], v[72:75], v[104:107]
    ds_read_b128 v[72:75], v4 offset:20480
    buffer_load_dwordx4 a[56:59], v196, s[12:15], s45 offen offset:2048 sc1
    s_waitcnt vmcnt(12) lgkmcnt(9)
    v_mfma_f32_16x16x32_bf16 v[108:111], a[12:15], v[76:79], v[108:111]
    ds_read_b128 v[76:79], v4 offset:21504
    v_mfma_f32_16x16x32_bf16 v[112:115], a[12:15], v[80:83], v[112:115]
    ds_read_b128 v[80:83], v4 offset:22528
    buffer_load_dwordx4 a[60:63], v196, s[12:15], s45 offen offset:3072 sc1
    v_mfma_f32_16x16x32_bf16 v[116:119], a[12:15], v[84:87], v[116:119]
    ds_read_b128 v[84:87], v4 offset:23552
    s_waitcnt vmcnt(12) lgkmcnt(9)
    v_mfma_f32_16x16x32_bf16 v[96:99], a[16:19], v[40:43], v[96:99]
    ds_read_b128 v[40:43], v4 offset:24576
    s_add_u32 s45, s45, 4096
    buffer_load_dwordx2 a[64:65], v209, s[12:15], s45 offen offset:0 sc1
    buffer_load_dwordx2 a[66:67], v209, s[12:15], s45 offen offset:128 sc1
    v_mfma_f32_16x16x32_bf16 v[100:103], a[16:19], v[44:47], v[100:103]
    ds_read_b128 v[44:47], v4 offset:25600
    v_mfma_f32_16x16x32_bf16 v[104:107], a[16:19], v[48:51], v[104:107]
    ds_read_b128 v[48:51], v4 offset:26624
    buffer_load_dwordx2 a[68:69], v209, s[12:15], s45 offen offset:1024 sc1
    buffer_load_dwordx2 a[70:71], v209, s[12:15], s45 offen offset:1152 sc1
    s_waitcnt vmcnt(15) lgkmcnt(9)
    v_mfma_f32_16x16x32_bf16 v[108:111], a[20:23], v[52:55], v[108:111]
    ds_read_b128 v[52:55], v4 offset:27648
    v_mfma_f32_16x16x32_bf16 v[112:115], a[20:23], v[56:59], v[112:115]
    ds_read_b128 v[56:59], v4 offset:28672
    buffer_load_dwordx2 v[152:153], v210, s[12:15], s48 offen offset:0 sc1
    v_mfma_f32_16x16x32_bf16 v[116:119], a[20:23], v[60:63], v[116:119]
    ds_read_b128 v[60:63], v4 offset:29696
    s_waitcnt vmcnt(14) lgkmcnt(9)
    v_mfma_f32_16x16x32_bf16 v[96:99], a[24:27], v[64:67], v[96:99]
    ds_read_b128 v[64:67], v4 offset:30720
    buffer_load_dwordx2 v[154:155], v210, s[12:15], s48 offen offset:512 sc1
    v_mfma_f32_16x16x32_bf16 v[100:103], a[24:27], v[68:71], v[100:103]
    ds_read_b128 v[68:71], v4 offset:31744
    v_mfma_f32_16x16x32_bf16 v[104:107], a[24:27], v[72:75], v[104:107]
    ds_read_b128 v[72:75], v4 offset:32768
    buffer_load_dwordx2 v[156:157], v210, s[12:15], s48 offen offset:1024 sc1
    s_waitcnt vmcnt(15) lgkmcnt(9)
    v_mfma_f32_16x16x32_bf16 v[108:111], a[28:31], v[76:79], v[108:111]
    ds_read_b128 v[76:79], v4 offset:33792
    v_mfma_f32_16x16x32_bf16 v[112:115], a[28:31], v[80:83], v[112:115]
    ds_read_b128 v[80:83], v4 offset:34816
    buffer_load_dwordx2 v[158:159], v210, s[12:15], s48 offen offset:1536 sc1
    v_mfma_f32_16x16x32_bf16 v[116:119], a[28:31], v[84:87], v[116:119]
    ds_read_b128 v[84:87], v4 offset:35840
    s_waitcnt vmcnt(15) lgkmcnt(9)
    v_mfma_f32_16x16x32_bf16 v[96:99], a[32:35], v[40:43], v[96:99]
    ds_read_b128 v[40:43], v4 offset:36864
    buffer_load_dwordx2 v[160:161], v210, s[12:15], s48 offen offset:2048 sc1
    v_mfma_f32_16x16x32_bf16 v[100:103], a[32:35], v[44:47], v[100:103]
    ds_read_b128 v[44:47], v4 offset:37888
    v_mfma_f32_16x16x32_bf16 v[104:107], a[32:35], v[48:51], v[104:107]
    ds_read_b128 v[48:51], v4 offset:38912
    buffer_load_dwordx2 v[162:163], v210, s[12:15], s48 offen offset:2560 sc1
    s_waitcnt vmcnt(16) lgkmcnt(9)
    v_mfma_f32_16x16x32_bf16 v[108:111], a[36:39], v[52:55], v[108:111]
    ds_read_b128 v[52:55], v4 offset:39936
    v_mfma_f32_16x16x32_bf16 v[112:115], a[36:39], v[56:59], v[112:115]
    ds_read_b128 v[56:59], v4 offset:40960
    v_cmp_eq_u32 vcc, 0, v207
    s_nop 4
    s_cbranch_vccnz L_interleave_layers__spectral_fnet__mixer_gmlp__prompt_kernel_10
L_interleave_layers__spectral_fnet__mixer_gmlp__prompt_kernel_11:
    v_mfma_f32_16x16x32_bf16 v[116:119], a[36:39], v[60:63], v[116:119]
    ds_read_b128 v[60:63], v4 offset:41984
    s_waitcnt vmcnt(15) lgkmcnt(9)
    v_mfma_f32_16x16x32_bf16 v[96:99], a[40:43], v[64:67], v[96:99]
    ds_read_b128 v[64:67], v4 offset:43008
    s_add_u32 m0, s32, 73728
    s_add_u32 s41, s34, 0
    buffer_load_dwordx4 off, s[80:83], s41 offset:0 sc1 lds
    v_mfma_f32_16x16x32_bf16 v[100:103], a[40:43], v[68:71], v[100:103]
    ds_read_b128 v[68:71], v4 offset:44032
    v_mfma_f32_16x16x32_bf16 v[104:107], a[40:43], v[72:75], v[104:107]
    ds_read_b128 v[72:75], v4 offset:45056
    buffer_load_dwordx4 off, s[80:83], s41 offset:1024 sc1 lds
    s_waitcnt vmcnt(16) lgkmcnt(9)
    v_mfma_f32_16x16x32_bf16 v[108:111], a[44:47], v[76:79], v[108:111]
    ds_read_b128 v[76:79], v4 offset:46080
    v_mfma_f32_16x16x32_bf16 v[112:115], a[44:47], v[80:83], v[112:115]
    ds_read_b128 v[80:83], v4 offset:47104
    buffer_load_dwordx4 off, s[80:83], s41 offset:2048 sc1 lds
    v_mfma_f32_16x16x32_bf16 v[116:119], a[44:47], v[84:87], v[116:119]
    ds_read_b128 v[84:87], v4 offset:48128
    s_waitcnt vmcnt(16) lgkmcnt(9)
    v_mfma_f32_16x16x32_bf16 v[96:99], a[48:51], v[40:43], v[96:99]
    ds_read_b128 v[40:43], v4 offset:49152
    buffer_load_dwordx4 off, s[80:83], s41 offset:3072 sc1 lds
    v_mfma_f32_16x16x32_bf16 v[100:103], a[48:51], v[44:47], v[100:103]
    ds_read_b128 v[44:47], v4 offset:55296
    v_mfma_f32_16x16x32_bf16 v[104:107], a[48:51], v[48:51], v[104:107]
    ds_read_b128 v[48:51], v4 offset:50176
    s_add_u32 m0, s32, 77824
    s_add_u32 s41, s34, 4096
    buffer_load_dwordx4 off, s[80:83], s41 offset:0 sc1 lds
    s_waitcnt vmcnt(17) lgkmcnt(9)
    v_mfma_f32_16x16x32_bf16 v[108:111], a[52:55], v[52:55], v[108:111]
    ds_read_b128 v[52:55], v4 offset:56320
    v_mfma_f32_16x16x32_bf16 v[112:115], a[52:55], v[56:59], v[112:115]
    ds_read_b128 v[56:59], v4 offset:51200
    buffer_load_dwordx4 off, s[80:83], s41 offset:1024 sc1 lds
    v_mfma_f32_16x16x32_bf16 v[116:119], a[52:55], v[60:63], v[116:119]
    ds_read_b128 v[60:63], v4 offset:57344
    s_waitcnt vmcnt(17) lgkmcnt(9)
    v_mfma_f32_16x16x32_bf16 v[96:99], a[56:59], v[64:67], v[96:99]
    ds_read_b128 v[64:67], v4 offset:52224
    v_mfma_f32_16x16x32_bf16 v[100:103], a[56:59], v[68:71], v[100:103]
    ds_read_b128 v[68:71], v4 offset:58368
    v_mfma_f32_16x16x32_bf16 v[104:107], a[56:59], v[72:75], v[104:107]
    ds_read_b128 v[72:75], v4 offset:53248
    s_waitcnt vmcnt(16) lgkmcnt(9)
    v_mfma_f32_16x16x32_bf16 v[108:111], a[60:63], v[76:79], v[108:111]
    ds_read_b128 v[76:79], v4 offset:59392
    v_mfma_f32_16x16x32_bf16 v[112:115], a[60:63], v[80:83], v[112:115]
    ds_read_b128 v[80:83], v4 offset:54272
    v_mfma_f32_16x16x32_bf16 v[116:119], a[60:63], v[84:87], v[116:119]
    ds_read_b128 v[84:87], v4 offset:60416
    s_waitcnt vmcnt(12) lgkmcnt(9)
    v_mfma_f32_16x16x32_bf16 v[96:99], a[64:67], v[40:43], v[96:99]
    v_mfma_f32_16x16x32_bf16 v[96:99], a[68:71], v[44:47], v[96:99]
    v_cvt_pk_bf16_f32 v120, v120, v121
    v_cvt_pk_bf16_f32 v121, v122, v123
    ds_write_b64 v204, v[120:121] offset:12288
    v_mfma_f32_16x16x32_bf16 v[100:103], a[64:67], v[48:51], v[100:103]
    s_waitcnt lgkmcnt(7)
    v_mfma_f32_16x16x32_bf16 v[100:103], a[68:71], v[52:55], v[100:103]
    v_mfma_f32_16x16x32_bf16 v[104:107], a[64:67], v[56:59], v[104:107]
    v_mfma_f32_16x16x32_bf16 v[104:107], a[68:71], v[60:63], v[104:107]
    v_cvt_pk_bf16_f32 v96, v96, v97
    v_cvt_pk_bf16_f32 v97, v98, v99
    ds_write_b64 v204, v[96:97] offset:0
    s_waitcnt lgkmcnt(5)
    v_mfma_f32_16x16x32_bf16 v[108:111], a[64:67], v[64:67], v[108:111]
    v_mfma_f32_16x16x32_bf16 v[108:111], a[68:71], v[68:71], v[108:111]
    v_cvt_pk_bf16_f32 v100, v100, v101
    v_cvt_pk_bf16_f32 v101, v102, v103
    ds_write_b64 v204, v[100:101] offset:2048
    v_mfma_f32_16x16x32_bf16 v[112:115], a[64:67], v[72:75], v[112:115]
    s_waitcnt lgkmcnt(3)
    v_mfma_f32_16x16x32_bf16 v[112:115], a[68:71], v[76:79], v[112:115]
    v_cvt_pk_bf16_f32 v104, v104, v105
    v_cvt_pk_bf16_f32 v105, v106, v107
    ds_write_b64 v204, v[104:105] offset:4096
    v_mfma_f32_16x16x32_bf16 v[116:119], a[64:67], v[80:83], v[116:119]
    v_mfma_f32_16x16x32_bf16 v[116:119], a[68:71], v[84:87], v[116:119]
    v_cvt_pk_bf16_f32 v108, v108, v109
    v_cvt_pk_bf16_f32 v109, v110, v111
    ds_write_b64 v204, v[108:109] offset:6144
    s_waitcnt vmcnt(6)
    v_lshlrev_b32 v164, 16, v152
    v_and_b32 v165, 0xffff0000, v152
    v_lshlrev_b32 v166, 16, v153
    v_and_b32 v167, 0xffff0000, v153
    v_cvt_pk_bf16_f32 v112, v112, v113
    v_cvt_pk_bf16_f32 v113, v114, v115
    ds_write_b64 v204, v[112:113] offset:8192
    v_lshlrev_b32 v168, 16, v154
    v_and_b32 v169, 0xffff0000, v154
    v_lshlrev_b32 v170, 16, v155
    v_and_b32 v171, 0xffff0000, v155
    v_cvt_pk_bf16_f32 v116, v116, v117
    v_cvt_pk_bf16_f32 v117, v118, v119
    ds_write_b64 v204, v[116:117] offset:10240
    v_lshlrev_b32 v172, 16, v156
    v_and_b32 v173, 0xffff0000, v156
    v_lshlrev_b32 v174, 16, v157
    v_and_b32 v175, 0xffff0000, v157
    v_lshlrev_b32 v176, 16, v158
    v_and_b32 v177, 0xffff0000, v158
    v_lshlrev_b32 v178, 16, v159
    v_and_b32 v179, 0xffff0000, v159
    v_lshlrev_b32 v180, 16, v160
    v_and_b32 v181, 0xffff0000, v160
    v_lshlrev_b32 v182, 16, v161
    v_and_b32 v183, 0xffff0000, v161
    v_lshlrev_b32 v184, 16, v162
    v_and_b32 v185, 0xffff0000, v162
    v_lshlrev_b32 v186, 16, v163
    v_and_b32 v187, 0xffff0000, v163
    s_waitcnt lgkmcnt(0)
    s_barrier
    ds_read_b128 v[88:91], v205 offset:12288
    ds_read_b128 v[92:95], v205 offset:13312
    ds_read_b128 v[64:67], v205 offset:6144
    ds_read_b128 v[68:71], v205 offset:7168
    ds_read_b128 v[72:75], v205 offset:8192
    ds_read_b128 v[76:79], v205 offset:9216
    ds_read_b128 v[80:83], v205 offset:10240
    ds_read_b128 v[84:87], v205 offset:11264
    ds_read_b128 v[40:43], v205 offset:0
    ds_read_b128 v[44:47], v205 offset:1024
    ds_read_b128 v[48:51], v205 offset:2048
    ds_read_b128 v[52:55], v205 offset:3072
    ds_read_b128 v[56:59], v205 offset:4096
    ds_read_b128 v[60:63], v205 offset:5120
    buffer_load_dwordx4 off, s[80:83], s41 offset:2048 sc1 lds
    buffer_load_dwordx4 off, s[80:83], s41 offset:3072 sc1 lds
    s_add_u32 m0, s32, 81920
    s_add_u32 s41, s34, 8192
    buffer_load_dwordx4 off, s[80:83], s41 offset:0 sc1 lds
    s_cmp_eq_u32 s7, 0
    s_cselect_b32 s45, 0, -1
    v_cmp_eq_u32 vcc, s45, v3
    s_add_u32 s48, s48, 6291456
    s_waitcnt lgkmcnt(13)
    v_mfma_f32_16x16x32_bf16 v[148:151], v[88:91], v[224:227], 0
    s_waitcnt lgkmcnt(12)
    v_mfma_f32_16x16x32_bf16 v[148:151], v[92:95], v[228:231], v[148:151]
    s_add_u32 m0, s32, 110592
    s_add_u32 s41, s34, 36864
    buffer_load_dwordx4 off, s[80:83], s41 offset:0 sc1 lds
    s_waitcnt lgkmcnt(11)
    v_mfma_f32_16x16x32_bf16 v[136:139], v[64:67], v[232:235], 0
    s_waitcnt lgkmcnt(10)
    v_mfma_f32_16x16x32_bf16 v[136:139], v[68:71], v[236:239], v[136:139]
    buffer_load_dwordx4 off, s[80:83], s41 offset:1024 sc1 lds
    s_waitcnt lgkmcnt(9)
    v_mfma_f32_16x16x32_bf16 v[140:143], v[72:75], v[232:235], 0
    s_waitcnt lgkmcnt(8)
    v_mfma_f32_16x16x32_bf16 v[140:143], v[76:79], v[236:239], v[140:143]
    buffer_load_dwordx4 off, s[80:83], s41 offset:2048 sc1 lds
    s_waitcnt lgkmcnt(7)
    v_mfma_f32_16x16x32_bf16 v[144:147], v[80:83], v[232:235], 0
    s_waitcnt lgkmcnt(6)
    v_mfma_f32_16x16x32_bf16 v[144:147], v[84:87], v[236:239], v[144:147]
    s_waitcnt lgkmcnt(5)
    v_mfma_f32_16x16x32_bf16 v[124:127], v[40:43], v[224:227], v[148:151]
    s_waitcnt lgkmcnt(4)
    v_mfma_f32_16x16x32_bf16 v[124:127], v[44:47], v[228:231], v[124:127]
    s_waitcnt lgkmcnt(3)
    v_mfma_f32_16x16x32_bf16 v[128:131], v[48:51], v[224:227], v[148:151]
    s_waitcnt lgkmcnt(2)
    v_mfma_f32_16x16x32_bf16 v[128:131], v[52:55], v[228:231], v[128:131]
    s_waitcnt lgkmcnt(1)
    v_mfma_f32_16x16x32_bf16 v[132:135], v[56:59], v[224:227], v[148:151]
    s_waitcnt lgkmcnt(0)
    v_mfma_f32_16x16x32_bf16 v[132:135], v[60:63], v[228:231], v[132:135]
    v_pk_add_f32 v[188:189], v[124:125], v[136:137] neg_lo:[0,1] neg_hi:[0,1]
    v_pk_add_f32 v[190:191], v[126:127], v[138:139] neg_lo:[0,1] neg_hi:[0,1]
    v_pk_add_f32 v[192:193], v[124:125], v[136:137]
    v_pk_add_f32 v[194:195], v[126:127], v[138:139]
    v_cndmask_b32 v188, v188, v148, vcc
    v_pk_add_f32 v[188:189], v[188:189], v[164:165]
    v_pk_add_f32 v[190:191], v[190:191], v[166:167]
    v_pk_add_f32 v[192:193], v[192:193], v[168:169]
    v_pk_add_f32 v[194:195], v[194:195], v[170:171]
    v_cvt_pk_bf16_f32 v152, v188, v189
    v_cvt_pk_bf16_f32 v153, v190, v191
    v_cvt_pk_bf16_f32 v154, v192, v193
    v_cvt_pk_bf16_f32 v155, v194, v195
    buffer_store_dwordx4 v[152:155], v1, s[12:15], s48 offen offset:0 sc1
    v_pk_mul_f32 v[96:97], v[188:189], v[188:189]
    v_pk_mul_f32 v[98:99], v[190:191], v[190:191]
    v_pk_fma_f32 v[96:97], v[192:193], v[192:193], v[96:97]
    v_pk_fma_f32 v[98:99], v[194:195], v[194:195], v[98:99]
    v_pk_add_f32 v[188:189], v[128:129], v[140:141] neg_lo:[0,1] neg_hi:[0,1]
    v_pk_add_f32 v[190:191], v[130:131], v[142:143] neg_lo:[0,1] neg_hi:[0,1]
    v_pk_add_f32 v[192:193], v[128:129], v[140:141]
    v_pk_add_f32 v[194:195], v[130:131], v[142:143]
    v_pk_add_f32 v[188:189], v[188:189], v[172:173]
    v_pk_add_f32 v[190:191], v[190:191], v[174:175]
    v_pk_add_f32 v[192:193], v[192:193], v[176:177]
    v_pk_add_f32 v[194:195], v[194:195], v[178:179]
    v_cvt_pk_bf16_f32 v156, v188, v189
    v_cvt_pk_bf16_f32 v157, v190, v191
    v_cvt_pk_bf16_f32 v158, v192, v193
    v_cvt_pk_bf16_f32 v159, v194, v195
    buffer_store_dwordx4 v[156:159], v1, s[12:15], s48 offen offset:1024 sc1
    v_pk_fma_f32 v[96:97], v[188:189], v[188:189], v[96:97]
    v_pk_fma_f32 v[98:99], v[190:191], v[190:191], v[98:99]
    v_pk_fma_f32 v[96:97], v[192:193], v[192:193], v[96:97]
    v_pk_fma_f32 v[98:99], v[194:195], v[194:195], v[98:99]
    v_pk_add_f32 v[188:189], v[132:133], v[144:145] neg_lo:[0,1] neg_hi:[0,1]
    v_pk_add_f32 v[190:191], v[134:135], v[146:147] neg_lo:[0,1] neg_hi:[0,1]
    v_pk_add_f32 v[192:193], v[132:133], v[144:145]
    v_pk_add_f32 v[194:195], v[134:135], v[146:147]
    v_pk_add_f32 v[188:189], v[188:189], v[180:181]
    v_pk_add_f32 v[190:191], v[190:191], v[182:183]
    v_pk_add_f32 v[192:193], v[192:193], v[184:185]
    v_pk_add_f32 v[194:195], v[194:195], v[186:187]
    v_cvt_pk_bf16_f32 v160, v188, v189
    v_cvt_pk_bf16_f32 v161, v190, v191
    v_cvt_pk_bf16_f32 v162, v192, v193
    v_cvt_pk_bf16_f32 v163, v194, v195
    buffer_store_dwordx4 v[160:163], v1, s[12:15], s48 offen offset:2048 sc1
    v_pk_fma_f32 v[96:97], v[188:189], v[188:189], v[96:97]
    v_pk_fma_f32 v[98:99], v[190:191], v[190:191], v[98:99]
    v_pk_fma_f32 v[96:97], v[192:193], v[192:193], v[96:97]
    v_pk_fma_f32 v[98:99], v[194:195], v[194:195], v[98:99]
    v_pk_add_f32 v[96:97], v[96:97], v[98:99]
    v_add_f32 v96, v96, v97
    v_mov_b32 v97, v96
    v_lshrrev_b32 v98, 2, v1
    v_and_b32 v98, 127, v98
    v_permlane32_swap_b32 v96, v97
    v_add_f32 v96, v96, v97
    v_mul_f32 v148, 0.5, v148
    s_nop 1
    v_permlane16_swap_b32 v96, v148
    v_add_f32 v96, v96, v148
    buffer_store_dword v96, v98, s[12:15], s49 offen sc1
    s_lshr_b32 s45, s3, 1
    s_and_b32 s46, s3, 1
    s_xor_b32 s47, s45, s46
    s_cmp_eq_u32 s4, 0
    s_cselect_b32 s45, s45, s47
    s_lshl_b32 s47, s4, 1
    s_add_u32 s45, s45, s47
    s_lshl_b32 s45, s45, 16
    s_lshl_b32 s46, s46, 12
    s_add_u32 s45, s45, s46
    s_add_u32 s45, s45, s29
    v_lshrrev_b32 v200, 1, v2
    v_min_u32 v200, 5, v200
    v_lshlrev_b32 v200, 13, v200
    v_and_b32 v201, 1, v2
    v_lshl_add_u32 v200, v201, 11, v200
    s_mul_i32 s46, s31, 36864
    s_add_u32 s46, s46, s28
    s_add_u32 s46, s46, 6291456
    s_add_u32 s47, s46, 18432
    v_lshrrev_b32 v216, 1, v3
    v_lshlrev_b32 v216, 10, v216
    v_lshl_add_u32 v216, v2, 2, v216
    v_and_b32 v217, 1, v3
    v_lshl_add_u32 v216, v217, 7, v216
    s_lshl_b32 s48, s31, 11
    s_add_u32 s48, s48, s28
    s_add_u32 s48, s48, 2621440
    s_waitcnt vmcnt(0)
    v_lshlrev_b32 v188, 2, v2
    s_add_u32 s95, s37, s29
    s_mov_b64 exec, 0xffff
    buffer_store_dword v12, v188, s[12:15], s95 offen offset:128 sc1
    s_mov_b64 exec, -1
    buffer_load_dwordx4 off, s[80:83], s41 offset:3072 sc1 lds
    s_add_u32 m0, s32, 114688
    s_add_u32 s41, s34, 40960
    buffer_load_dwordx4 off, s[80:83], s41 offset:0 sc1 lds
    buffer_load_dwordx4 off, s[80:83], s41 offset:1024 sc1 lds
    buffer_load_dwordx4 off, s[80:83], s41 offset:2048 sc1 lds
    buffer_load_dwordx4 off, s[80:83], s41 offset:3072 sc1 lds
    s_add_u32 m0, s32, 118784
    s_add_u32 s41, s34, 45056
    buffer_load_dwordx4 off, s[80:83], s41 offset:0 sc1 lds
L_join_interleave_layers__spectral_fnet__mixer_gmlp__prompt_kernel:
    s_add_u32 m0, s32, 0
    s_add_u32 s41, s34, 73728
    buffer_load_dwordx4 off, s[80:83], s41 offset:0 sc1 lds
    buffer_load_dwordx4 off, s[80:83], s41 offset:1024 sc1 lds
    buffer_load_dword v201, v200, s[12:15], s45 offen offset:128 sc1
    buffer_load_dwordx4 off, s[80:83], s41 offset:2048 sc1 lds
    buffer_load_dwordx4 off, s[80:83], s41 offset:3072 sc1 lds
    s_add_u32 m0, s32, 4096
    s_add_u32 s41, s34, 77824
    buffer_load_dwordx4 off, s[80:83], s41 offset:0 sc1 lds
    buffer_load_dwordx4 off, s[80:83], s41 offset:1024 sc1 lds
    buffer_load_dwordx4 off, s[80:83], s41 offset:2048 sc1 lds
    buffer_load_dwordx4 off, s[80:83], s41 offset:3072 sc1 lds
    s_add_u32 m0, s32, 8192
    s_add_u32 s41, s34, 81920
    buffer_load_dwordx4 off, s[80:83], s41 offset:0 sc1 lds
    s_waitcnt vmcnt(7)
    v_cmp_eq_u32 vcc, 0, v201
    s_nop 3
    s_cbranch_vccz L_interleave_layers__spectral_fnet__mixer_gmlp__prompt_kernel_14
    s_mov_b32 s40, 0
L_interleave_layers__spectral_fnet__mixer_gmlp__prompt_kernel_16:
    s_mov_b64 exec, vcc
    buffer_load_dword v201, v200, s[12:15], s45 offen offset:128 sc1
    s_add_u32 s40, s40, 1
    s_cmp_gt_u32 s40, 2000000
    s_cbranch_scc1 L_interleave_layers__spectral_fnet__mixer_gmlp__prompt_kernel_15
    s_waitcnt vmcnt(0)
    v_cmp_eq_u32 vcc, 0, v201
    s_nop 3
    s_cbranch_vccnz L_interleave_layers__spectral_fnet__mixer_gmlp__prompt_kernel_16
    s_mov_b64 exec, -1
L_interleave_layers__spectral_fnet__mixer_gmlp__prompt_kernel_14:
    buffer_load_dwordx4 a[136:139], off, s[80:83], s46 offset:0 sc1
    buffer_load_dwordx4 a[140:143], off, s[80:83], s47 offset:0 sc1
    buffer_load_dwordx4 a[132:135], off, s[80:83], s47 offset:1024 sc1
    buffer_load_dwordx4 a[128:131], off, s[80:83], s46 offset:1024 sc1
    buffer_load_dword v217, v216, s[12:15], s48 offen offset:0 sc1
    buffer_load_dword v218, v216, s[12:15], s48 offen offset:256 sc1
    buffer_load_dword v219, v216, s[12:15], s48 offen offset:512 sc1
    buffer_load_dwordx4 a[120:123], off, s[80:83], s46 offset:2048 sc1
    buffer_load_dwordx4 a[124:127], off, s[80:83], s47 offset:2048 sc1
    buffer_load_dwordx4 a[116:119], off, s[80:83], s47 offset:3072 sc1
    buffer_load_dwordx4 a[112:115], off, s[80:83], s46 offset:3072 sc1
    s_add_u32 s46, s46, 4096
    buffer_load_dwordx4 a[104:107], off, s[80:83], s46 offset:0 sc1
    s_add_u32 s47, s47, 4096
    buffer_load_dwordx4 a[108:111], off, s[80:83], s47 offset:0 sc1
    s_barrier
    ds_read_b128 a[144:147], v6 offset:0
    ds_read_b128 a[148:151], v6 offset:18432
    ds_read_b128 a[152:155], v7 offset:0
    ds_read_b128 a[156:159], v7 offset:18432
    ds_read_b128 a[160:163], v6 offset:1024
    ds_read_b128 a[164:167], v6 offset:19456
    ds_read_b128 a[168:171], v7 offset:1024
    ds_read_b128 a[172:175], v7 offset:19456
    s_waitcnt lgkmcnt(4)
    s_waitcnt vmcnt(12)
    v_mfma_f32_16x16x32_bf16 v[40:43], a[144:147], a[136:139], 0
    ds_read_b128 a[176:179], v6 offset:2048
    ds_read_b128 a[180:183], v6 offset:20480
    v_mfma_f32_16x16x32_bf16 v[48:51], a[148:151], a[136:139], 0
    buffer_load_dwordx4 a[100:103], off, s[80:83], s47 offset:1024 sc1
    v_mfma_f32_16x16x32_bf16 v[56:59], a[152:155], a[136:139], 0
    ds_read_b128 a[184:187], v7 offset:2048
    ds_read_b128 a[188:191], v7 offset:20480
    v_mfma_f32_16x16x32_bf16 v[64:67], a[156:159], a[136:139], 0
    s_waitcnt vmcnt(12)
    v_mfma_f32_16x16x32_bf16 v[68:71], a[156:159], a[140:143], 0
    s_waitcnt lgkmcnt(4)
    v_mfma_f32_16x16x32_bf16 v[60:63], a[152:155], a[140:143], 0
    buffer_load_dwordx4 a[96:99], off, s[80:83], s46 offset:1024 sc1
    v_mfma_f32_16x16x32_bf16 v[52:55], a[148:151], a[140:143], 0
    v_mfma_f32_16x16x32_bf16 v[44:47], a[144:147], a[140:143], 0
    s_waitcnt vmcnt(12)
    v_mfma_f32_16x16x32_bf16 v[44:47], a[160:163], a[132:135], v[44:47]
    ds_read_b128 a[144:147], v6 offset:3072
    ds_read_b128 a[148:151], v6 offset:21504
    v_mfma_f32_16x16x32_bf16 v[52:55], a[164:167], a[132:135], v[52:55]
    buffer_load_dwordx4 a[88:91], off, s[80:83], s46 offset:2048 sc1
    v_mfma_f32_16x16x32_bf16 v[60:63], a[168:171], a[132:135], v[60:63]
    ds_read_b128 a[152:155], v7 offset:3072
    ds_read_b128 a[156:159], v7 offset:21504
    v_mfma_f32_16x16x32_bf16 v[68:71], a[172:175], a[132:135], v[68:71]
    s_waitcnt vmcnt(12)
    v_mfma_f32_16x16x32_bf16 v[64:67], a[172:175], a[128:131], v[64:67]
    s_waitcnt lgkmcnt(4)
    v_mfma_f32_16x16x32_bf16 v[56:59], a[168:171], a[128:131], v[56:59]
    buffer_load_dwordx4 a[92:95], off, s[80:83], s47 offset:2048 sc1
    v_mfma_f32_16x16x32_bf16 v[48:51], a[164:167], a[128:131], v[48:51]
    v_mfma_f32_16x16x32_bf16 v[40:43], a[160:163], a[128:131], v[40:43]
    s_waitcnt vmcnt(9)
    v_mfma_f32_16x16x32_bf16 v[40:43], a[176:179], a[120:123], v[40:43]
    ds_read_b128 a[160:163], v6 offset:4096
    ds_read_b128 a[164:167], v6 offset:22528
    v_mfma_f32_16x16x32_bf16 v[48:51], a[180:183], a[120:123], v[48:51]
    buffer_load_dwordx4 a[84:87], off, s[80:83], s47 offset:3072 sc1
    v_mfma_f32_16x16x32_bf16 v[56:59], a[184:187], a[120:123], v[56:59]
    ds_read_b128 a[168:171], v7 offset:4096
    ds_read_b128 a[172:175], v7 offset:22528
    v_mfma_f32_16x16x32_bf16 v[64:67], a[188:191], a[120:123], v[64:67]
    s_waitcnt vmcnt(9)
    v_mfma_f32_16x16x32_bf16 v[68:71], a[188:191], a[124:127], v[68:71]
    s_waitcnt lgkmcnt(4)
    v_mfma_f32_16x16x32_bf16 v[60:63], a[184:187], a[124:127], v[60:63]
    buffer_load_dwordx4 a[80:83], off, s[80:83], s46 offset:3072 sc1
    v_mfma_f32_16x16x32_bf16 v[52:55], a[180:183], a[124:127], v[52:55]
    v_mfma_f32_16x16x32_bf16 v[44:47], a[176:179], a[124:127], v[44:47]
    v_add_f32 v217, v217, v218
    s_waitcnt vmcnt(9)
    v_mfma_f32_16x16x32_bf16 v[44:47], a[144:147], a[116:119], v[44:47]
    ds_read_b128 a[176:179], v6 offset:5120
    ds_read_b128 a[180:183], v6 offset:23552
    v_mfma_f32_16x16x32_bf16 v[52:55], a[148:151], a[116:119], v[52:55]
    s_add_u32 s46, s46, 4096
    buffer_load_dwordx4 a[72:75], off, s[80:83], s46 offset:0 sc1
    v_mfma_f32_16x16x32_bf16 v[60:63], a[152:155], a[116:119], v[60:63]
    ds_read_b128 a[184:187], v7 offset:5120
    ds_read_b128 a[188:191], v7 offset:23552
    v_mfma_f32_16x16x32_bf16 v[68:71], a[156:159], a[116:119], v[68:71]
    v_add_f32 v217, v217, v219
    s_waitcnt vmcnt(9)
    v_mfma_f32_16x16x32_bf16 v[64:67], a[156:159], a[112:115], v[64:67]
    s_waitcnt lgkmcnt(4)
    v_mov_b32 v218, v217
    v_mfma_f32_16x16x32_bf16 v[56:59], a[152:155], a[112:115], v[56:59]
    s_add_u32 s47, s47, 4096
    buffer_load_dwordx4 a[76:79], off, s[80:83], s47 offset:0 sc1
    v_mfma_f32_16x16x32_bf16 v[48:51], a[148:151], a[112:115], v[48:51]
    v_permlane16_swap_b32 v217, v218
    v_mfma_f32_16x16x32_bf16 v[40:43], a[144:147], a[112:115], v[40:43]
    v_add_f32 v217, v217, v218
    s_waitcnt vmcnt(9)
    v_mfma_f32_16x16x32_bf16 v[40:43], a[160:163], a[104:107], v[40:43]
    ds_read_b128 a[144:147], v6 offset:6144
    ds_read_b128 a[148:151], v6 offset:24576
    v_mfma_f32_16x16x32_bf16 v[48:51], a[164:167], a[104:107], v[48:51]
    buffer_load_dwordx4 a[68:71], off, s[80:83], s47 offset:1024 sc1
    v_mov_b32 v219, 0x3727c5ac
    v_mfma_f32_16x16x32_bf16 v[56:59], a[168:171], a[104:107], v[56:59]
    ds_read_b128 a[152:155], v7 offset:6144
    ds_read_b128 a[156:159], v7 offset:24576
    v_mfma_f32_16x16x32_bf16 v[64:67], a[172:175], a[104:107], v[64:67]
    v_fmamk_f32 v217, v217, 0x3ae38e39, v219
    s_waitcnt vmcnt(9)
    v_mfma_f32_16x16x32_bf16 v[68:71], a[172:175], a[108:111], v[68:71]
    s_waitcnt lgkmcnt(4)
    v_mov_b32 v218, v217
    v_mfma_f32_16x16x32_bf16 v[60:63], a[168:171], a[108:111], v[60:63]
    buffer_load_dwordx4 a[64:67], off, s[80:83], s46 offset:1024 sc1
    v_permlane32_swap_b32 v217, v218
    v_mfma_f32_16x16x32_bf16 v[52:55], a[164:167], a[108:111], v[52:55]
    v_rsq_f32 v219, v217
    v_mfma_f32_16x16x32_bf16 v[44:47], a[160:163], a[108:111], v[44:47]
    v_rsq_f32 v220, v218
    s_waitcnt vmcnt(9)
    v_mfma_f32_16x16x32_bf16 v[44:47], a[176:179], a[100:103], v[44:47]
    ds_read_b128 a[160:163], v6 offset:7168
    ds_read_b128 a[164:167], v6 offset:25600
    v_mfma_f32_16x16x32_bf16 v[52:55], a[180:183], a[100:103], v[52:55]
    buffer_load_dwordx4 a[56:59], off, s[80:83], s46 offset:2048 sc1
    v_mul_f32 v190, 0x3727c5ac, v217
    v_mfma_f32_16x16x32_bf16 v[60:63], a[184:187], a[100:103], v[60:63]
    ds_read_b128 a[168:171], v7 offset:7168
    ds_read_b128 a[172:175], v7 offset:25600
    v_mfma_f32_16x16x32_bf16 v[68:71], a[188:191], a[100:103], v[68:71]
    v_mul_f32 v191, 0x3727c5ac, v218
    s_waitcnt vmcnt(9)
    v_mfma_f32_16x16x32_bf16 v[64:67], a[188:191], a[96:99], v[64:67]
    s_waitcnt lgkmcnt(4)
    v_mul_f32 v188, v217, v219
    v_mfma_f32_16x16x32_bf16 v[56:59], a[184:187], a[96:99], v[56:59]
    buffer_load_dwordx4 a[60:63], off, s[80:83], s47 offset:2048 sc1
    v_mul_f32 v184, 0xc0135761, v219
    v_mfma_f32_16x16x32_bf16 v[48:51], a[180:183], a[96:99], v[48:51]
    v_mul_f32 v189, v218, v220
    v_mfma_f32_16x16x32_bf16 v[40:43], a[176:179], a[96:99], v[40:43]
    v_mul_f32 v185, 0xc0135761, v220
    s_waitcnt vmcnt(9)
    v_mfma_f32_16x16x32_bf16 v[40:43], a[144:147], a[88:91], v[40:43]
    ds_read_b128 a[176:179], v6 offset:8192
    ds_read_b128 a[180:183], v6 offset:26624
    v_mfma_f32_16x16x32_bf16 v[48:51], a[148:151], a[88:91], v[48:51]
    buffer_load_dwordx4 a[52:55], off, s[80:83], s47 offset:3072 sc1
    v_mul_f32 v186, v219, v219
    v_mfma_f32_16x16x32_bf16 v[56:59], a[152:155], a[88:91], v[56:59]
    ds_read_b128 a[184:187], v7 offset:8192
    ds_read_b128 a[188:191], v7 offset:26624
    v_mfma_f32_16x16x32_bf16 v[64:67], a[156:159], a[88:91], v[64:67]
    v_mul_f32 v187, v220, v220
    s_waitcnt vmcnt(9)
    v_mfma_f32_16x16x32_bf16 v[68:71], a[156:159], a[92:95], v[68:71]
    s_waitcnt lgkmcnt(4)
    v_mul_f32 v186, v186, v184
    v_mfma_f32_16x16x32_bf16 v[60:63], a[152:155], a[92:95], v[60:63]
    buffer_load_dwordx4 a[48:51], off, s[80:83], s46 offset:3072 sc1
    v_mul_f32 v187, v187, v185
    v_mfma_f32_16x16x32_bf16 v[52:55], a[148:151], a[92:95], v[52:55]
    v_mul_f32 v186, 0x3d372713, v186
    v_mfma_f32_16x16x32_bf16 v[44:47], a[144:147], a[92:95], v[44:47]
    v_mul_f32 v187, 0x3d372713, v187
    s_waitcnt vmcnt(9)
    v_mfma_f32_16x16x32_bf16 v[44:47], a[160:163], a[84:87], v[44:47]
    ds_read_b128 a[144:147], v6 offset:9216
    ds_read_b128 a[148:151], v6 offset:27648
    v_mfma_f32_16x16x32_bf16 v[52:55], a[164:167], a[84:87], v[52:55]
    s_add_u32 s46, s46, 4096
    buffer_load_dwordx4 a[40:43], off, s[80:83], s46 offset:0 sc1
    v_mfma_f32_16x16x32_bf16 v[60:63], a[168:171], a[84:87], v[60:63]
    ds_read_b128 a[152:155], v7 offset:9216
    ds_read_b128 a[156:159], v7 offset:27648
    v_mfma_f32_16x16x32_bf16 v[68:71], a[172:175], a[84:87], v[68:71]
    v_mov_b32 v224, 0
    s_waitcnt vmcnt(9)
    v_mfma_f32_16x16x32_bf16 v[64:67], a[172:175], a[80:83], v[64:67]
    s_waitcnt lgkmcnt(4)
    v_mov_b32 v225, 0
    v_mfma_f32_16x16x32_bf16 v[56:59], a[168:171], a[80:83], v[56:59]
    s_add_u32 s47, s47, 4096
    buffer_load_dwordx4 a[44:47], off, s[80:83], s47 offset:0 sc1
    v_mfma_f32_16x16x32_bf16 v[48:51], a[164:167], a[80:83], v[48:51]
    v_mov_b32 v226, 0
    v_mfma_f32_16x16x32_bf16 v[40:43], a[160:163], a[80:83], v[40:43]
    v_mov_b32 v227, 0
    s_waitcnt vmcnt(9)
    v_mfma_f32_16x16x32_bf16 v[40:43], a[176:179], a[72:75], v[40:43]
    ds_read_b128 a[160:163], v6 offset:10240
    ds_read_b128 a[164:167], v6 offset:28672
    v_mfma_f32_16x16x32_bf16 v[48:51], a[180:183], a[72:75], v[48:51]
    buffer_load_dwordx4 a[36:39], off, s[80:83], s47 offset:1024 sc1
    v_mov_b32 v228, 0
    v_mfma_f32_16x16x32_bf16 v[56:59], a[184:187], a[72:75], v[56:59]
    ds_read_b128 a[168:171], v7 offset:10240
    ds_read_b128 a[172:175], v7 offset:28672
    v_mfma_f32_16x16x32_bf16 v[64:67], a[188:191], a[72:75], v[64:67]
    v_mov_b32 v229, 0
    s_waitcnt vmcnt(9)
    v_mfma_f32_16x16x32_bf16 v[68:71], a[188:191], a[76:79], v[68:71]
    s_waitcnt lgkmcnt(4)
    v_mov_b32 v230, 0
    v_mfma_f32_16x16x32_bf16 v[60:63], a[184:187], a[76:79], v[60:63]
    buffer_load_dwordx4 a[32:35], off, s[80:83], s46 offset:1024 sc1
    v_mov_b32 v231, 0
    v_mfma_f32_16x16x32_bf16 v[52:55], a[180:183], a[76:79], v[52:55]
    s_lshl_b32 s52, s6, 2
    v_mfma_f32_16x16x32_bf16 v[44:47], a[176:179], a[76:79], v[44:47]
    s_add_u32 s52, s52, s3
    s_waitcnt vmcnt(9)
    v_mfma_f32_16x16x32_bf16 v[44:47], a[144:147], a[68:71], v[44:47]
    ds_read_b128 a[176:179], v6 offset:11264
    ds_read_b128 a[180:183], v6 offset:29696
    v_mfma_f32_16x16x32_bf16 v[52:55], a[148:151], a[68:71], v[52:55]
    buffer_load_dwordx4 a[24:27], off, s[80:83], s46 offset:2048 sc1
    s_mul_i32 s52, s52, 9
    v_mfma_f32_16x16x32_bf16 v[60:63], a[152:155], a[68:71], v[60:63]
    ds_read_b128 a[184:187], v7 offset:11264
    ds_read_b128 a[188:191], v7 offset:29696
    v_mfma_f32_16x16x32_bf16 v[68:71], a[156:159], a[68:71], v[68:71]
    s_add_u32 s52, s52, 144
    s_waitcnt vmcnt(9)
    v_mfma_f32_16x16x32_bf16 v[64:67], a[156:159], a[64:67], v[64:67]
    s_waitcnt lgkmcnt(4)
    v_min_u32 v232, 8, v2
    v_mfma_f32_16x16x32_bf16 v[56:59], a[152:155], a[64:67], v[56:59]
    buffer_load_dwordx4 a[28:31], off, s[80:83], s47 offset:2048 sc1
    v_add_u32 v232, s52, v232
    v_mfma_f32_16x16x32_bf16 v[48:51], a[148:151], a[64:67], v[48:51]
    v_mov_b32 v20, 0
    v_mfma_f32_16x16x32_bf16 v[40:43], a[144:147], a[64:67], v[40:43]
    v_mov_b32 v21, 0
    s_waitcnt vmcnt(9)
    v_mfma_f32_16x16x32_bf16 v[40:43], a[160:163], a[56:59], v[40:43]
    ds_read_b128 a[144:147], v6 offset:12288
    ds_read_b128 a[148:151], v6 offset:30720
    v_mfma_f32_16x16x32_bf16 v[48:51], a[164:167], a[56:59], v[48:51]
    buffer_load_dwordx4 a[20:23], off, s[80:83], s47 offset:3072 sc1
    v_mov_b32 v22, 0
    v_mfma_f32_16x16x32_bf16 v[56:59], a[168:171], a[56:59], v[56:59]
    ds_read_b128 a[152:155], v7 offset:12288
    ds_read_b128 a[156:159], v7 offset:30720
    v_mfma_f32_16x16x32_bf16 v[64:67], a[172:175], a[56:59], v[64:67]
    v_mov_b32 v23, 0
    s_waitcnt vmcnt(9)
    v_mfma_f32_16x16x32_bf16 v[68:71], a[172:175], a[60:63], v[68:71]
    s_waitcnt lgkmcnt(4)
    s_lshr_b32 s58, s37, 11
    v_mfma_f32_16x16x32_bf16 v[60:63], a[168:171], a[60:63], v[60:63]
    buffer_load_dwordx4 a[16:19], off, s[80:83], s46 offset:3072 sc1
    s_mul_i32 s58, s58, 5120
    v_mfma_f32_16x16x32_bf16 v[52:55], a[164:167], a[60:63], v[52:55]
    s_lshl_b32 s59, s30, 28
    v_mfma_f32_16x16x32_bf16 v[44:47], a[160:163], a[60:63], v[44:47]
    s_add_u32 s58, s58, s59
    s_waitcnt vmcnt(9)
    v_mfma_f32_16x16x32_bf16 v[44:47], a[176:179], a[52:55], v[44:47]
    ds_read_b128 a[160:163], v6 offset:13312
    ds_read_b128 a[164:167], v6 offset:31744
    v_mfma_f32_16x16x32_bf16 v[52:55], a[180:183], a[52:55], v[52:55]
    s_add_u32 s46, s46, 4096
    buffer_load_dwordx4 a[8:11], off, s[80:83], s46 offset:0 sc1
    v_mfma_f32_16x16x32_bf16 v[60:63], a[184:187], a[52:55], v[60:63]
    ds_read_b128 a[168:171], v7 offset:13312
    ds_read_b128 a[172:175], v7 offset:31744
    v_mfma_f32_16x16x32_bf16 v[68:71], a[188:191], a[52:55], v[68:71]
    s_add_u32 s58, s58, 61865984
    s_waitcnt vmcnt(9)
    v_mfma_f32_16x16x32_bf16 v[64:67], a[188:191], a[48:51], v[64:67]
    s_waitcnt lgkmcnt(4)
    s_add_u32 s59, s58, 4096
    v_mfma_f32_16x16x32_bf16 v[56:59], a[184:187], a[48:51], v[56:59]
    s_add_u32 s47, s47, 4096
    buffer_load_dwordx4 a[12:15], off, s[80:83], s47 offset:0 sc1
    v_mfma_f32_16x16x32_bf16 v[48:51], a[180:183], a[48:51], v[48:51]
    v_lshrrev_b32 v233, 6, v232
    v_mfma_f32_16x16x32_bf16 v[40:43], a[176:179], a[48:51], v[40:43]
    v_add_u32 v233, 3, v233
    s_waitcnt vmcnt(9)
    v_mfma_f32_16x16x32_bf16 v[40:43], a[144:147], a[40:43], v[40:43]
    ds_read_b128 a[176:179], v6 offset:14336
    ds_read_b128 a[180:183], v6 offset:32768
    v_mfma_f32_16x16x32_bf16 v[48:51], a[148:151], a[40:43], v[48:51]
    buffer_load_dwordx4 a[4:7], off, s[80:83], s47 offset:1024 sc1
    v_and_b32 v233, 3, v233
    v_mfma_f32_16x16x32_bf16 v[56:59], a[152:155], a[40:43], v[56:59]
    ds_read_b128 a[184:187], v7 offset:14336
    ds_read_b128 a[188:191], v7 offset:32768
    v_mfma_f32_16x16x32_bf16 v[64:67], a[156:159], a[40:43], v[64:67]
    v_lshlrev_b32 v233, 1, v233
    s_waitcnt vmcnt(9)
    v_mfma_f32_16x16x32_bf16 v[68:71], a[156:159], a[44:47], v[68:71]
    s_waitcnt lgkmcnt(4)
    v_bfe_u32 v234, v232, 1, 5
    v_mfma_f32_16x16x32_bf16 v[60:63], a[152:155], a[44:47], v[60:63]
    buffer_load_dwordx4 a[0:3], off, s[80:83], s46 offset:1024 sc1
    v_lshl_add_u32 v233, v234, 3, v233
    v_mfma_f32_16x16x32_bf16 v[52:55], a[148:151], a[44:47], v[52:55]
    v_and_b32 v232, 1, v232
    v_mfma_f32_16x16x32_bf16 v[44:47], a[144:147], a[44:47], v[44:47]
    v_add_u32 v232, v232, v233
    s_waitcnt vmcnt(9)
    v_mfma_f32_16x16x32_bf16 v[44:47], a[160:163], a[36:39], v[44:47]
    ds_read_b128 a[144:147], v6 offset:15360
    ds_read_b128 a[148:151], v6 offset:33792
    v_mfma_f32_16x16x32_bf16 v[52:55], a[164:167], a[36:39], v[52:55]
    s_add_u32 m0, s32, 36864
    s_add_u32 s41, s34, 110592
    buffer_load_dwordx4 off, s[80:83], s41 offset:0 sc1 lds
    v_mfma_f32_16x16x32_bf16 v[60:63], a[168:171], a[36:39], v[60:63]
    ds_read_b128 a[152:155], v7 offset:15360
    ds_read_b128 a[156:159], v7 offset:33792
    v_mfma_f32_16x16x32_bf16 v[68:71], a[172:175], a[36:39], v[68:71]
    v_lshlrev_b32 v232, 13, v232
    s_waitcnt vmcnt(9)
    v_mfma_f32_16x16x32_bf16 v[64:67], a[172:175], a[32:35], v[64:67]
    s_waitcnt lgkmcnt(4)
    s_mov_b32 s52, 18874368
    v_mfma_f32_16x16x32_bf16 v[56:59], a[168:171], a[32:35], v[56:59]
    buffer_load_dwordx4 off, s[80:83], s41 offset:1024 sc1 lds
    v_mfma_f32_16x16x32_bf16 v[48:51], a[164:167], a[32:35], v[48:51]
    v_mfma_f32_16x16x32_bf16 v[40:43], a[160:163], a[32:35], v[40:43]
    s_waitcnt vmcnt(9)
    v_mfma_f32_16x16x32_bf16 v[40:43], a[176:179], a[24:27], v[40:43]
    ds_read_b128 a[160:163], v6 offset:16384
    ds_read_b128 a[164:167], v6 offset:34816
    v_mfma_f32_16x16x32_bf16 v[48:51], a[180:183], a[24:27], v[48:51]
    buffer_load_dwordx4 off, s[80:83], s41 offset:2048 sc1 lds
    v_mfma_f32_16x16x32_bf16 v[56:59], a[184:187], a[24:27], v[56:59]
    ds_read_b128 a[168:171], v7 offset:16384
    ds_read_b128 a[172:175], v7 offset:34816
    v_mfma_f32_16x16x32_bf16 v[64:67], a[188:191], a[24:27], v[64:67]
    s_waitcnt vmcnt(9)
    v_mfma_f32_16x16x32_bf16 v[68:71], a[188:191], a[28:31], v[68:71]
    s_waitcnt lgkmcnt(4)
    v_mfma_f32_16x16x32_bf16 v[60:63], a[184:187], a[28:31], v[60:63]
    buffer_load_dwordx4 off, s[80:83], s41 offset:3072 sc1 lds
    v_mfma_f32_16x16x32_bf16 v[52:55], a[180:183], a[28:31], v[52:55]
    v_mfma_f32_16x16x32_bf16 v[44:47], a[176:179], a[28:31], v[44:47]
    s_waitcnt vmcnt(9)
    v_mfma_f32_16x16x32_bf16 v[44:47], a[144:147], a[20:23], v[44:47]
    ds_read_b128 a[176:179], v6 offset:17408
    ds_read_b128 a[180:183], v6 offset:35840
    v_mfma_f32_16x16x32_bf16 v[52:55], a[148:151], a[20:23], v[52:55]
    s_add_u32 m0, s32, 40960
    s_add_u32 s41, s34, 114688
    buffer_load_dwordx4 off, s[80:83], s41 offset:0 sc1 lds
    v_mfma_f32_16x16x32_bf16 v[60:63], a[152:155], a[20:23], v[60:63]
    ds_read_b128 a[184:187], v7 offset:17408
    ds_read_b128 a[188:191], v7 offset:35840
    v_mfma_f32_16x16x32_bf16 v[68:71], a[156:159], a[20:23], v[68:71]
    s_waitcnt vmcnt(9)
    v_mfma_f32_16x16x32_bf16 v[64:67], a[156:159], a[16:19], v[64:67]
    s_waitcnt lgkmcnt(4)
    v_mfma_f32_16x16x32_bf16 v[56:59], a[152:155], a[16:19], v[56:59]
    buffer_load_dwordx4 off, s[80:83], s41 offset:1024 sc1 lds
    v_mfma_f32_16x16x32_bf16 v[48:51], a[148:151], a[16:19], v[48:51]
    v_mfma_f32_16x16x32_bf16 v[40:43], a[144:147], a[16:19], v[40:43]
    s_waitcnt vmcnt(9)
    v_mfma_f32_16x16x32_bf16 v[40:43], a[160:163], a[8:11], v[40:43]
    s_barrier
    v_mfma_f32_16x16x32_bf16 v[48:51], a[164:167], a[8:11], v[48:51]
    ds_read_b128 a[144:147], v4 offset:0
    ds_read_b128 a[148:151], v4 offset:1024
    buffer_load_dwordx4 off, s[80:83], s41 offset:2048 sc1 lds
    v_mfma_f32_16x16x32_bf16 v[56:59], a[168:171], a[8:11], v[56:59]
    ds_read_b128 a[152:155], v4 offset:2048
    v_mfma_f32_16x16x32_bf16 v[64:67], a[172:175], a[8:11], v[64:67]
    s_waitcnt vmcnt(9)
    v_mfma_f32_16x16x32_bf16 v[68:71], a[172:175], a[12:15], v[68:71]
    s_waitcnt lgkmcnt(3)
    v_mfma_f32_16x16x32_bf16 v[60:63], a[168:171], a[12:15], v[60:63]
    buffer_load_dwordx4 off, s[80:83], s41 offset:3072 sc1 lds
    v_mfma_f32_16x16x32_bf16 v[52:55], a[164:167], a[12:15], v[52:55]
    v_mfma_f32_16x16x32_bf16 v[44:47], a[160:163], a[12:15], v[44:47]
    s_waitcnt vmcnt(9)
    v_mfma_f32_16x16x32_bf16 v[44:47], a[176:179], a[4:7], v[44:47]
    ds_read_b128 a[160:163], v4 offset:3072
    ds_read_b128 a[164:167], v4 offset:4096
    v_mfma_f32_16x16x32_bf16 v[52:55], a[180:183], a[4:7], v[52:55]
    s_add_u32 m0, s32, 45056
    s_add_u32 s41, s34, 118784
    buffer_load_dwordx4 off, s[80:83], s41 offset:0 sc1 lds
    v_mfma_f32_16x16x32_bf16 v[60:63], a[184:187], a[4:7], v[60:63]
    ds_read_b128 a[168:171], v4 offset:5120
    v_mfma_f32_16x16x32_bf16 v[68:71], a[188:191], a[4:7], v[68:71]
    s_waitcnt vmcnt(9)
    v_mfma_f32_16x16x32_bf16 v[64:67], a[188:191], a[0:3], v[64:67]
    s_waitcnt lgkmcnt(3)
    v_mfma_f32_16x16x32_bf16 v[56:59], a[184:187], a[0:3], v[56:59]
    v_mfma_f32_16x16x32_bf16 v[48:51], a[180:183], a[0:3], v[48:51]
    v_mfma_f32_16x16x32_bf16 v[40:43], a[176:179], a[0:3], v[40:43]
    v_mfma_f32_16x16x32_bf16 v[72:75], a[144:147], a[136:139], 0
    s_barrier
    v_mfma_f32_16x16x32_bf16 v[72:75], a[148:151], a[128:131], v[72:75]
    ds_read_b128 a[176:179], v4 offset:6144
    ds_read_b128 a[180:183], v4 offset:7168
    v_mfma_f32_16x16x32_bf16 v[72:75], a[152:155], a[120:123], v[72:75]
    ds_read_b128 a[184:187], v4 offset:8192
    s_waitcnt lgkmcnt(3)
    buffer_store_dwordx4 v[20:23], v1, s[12:15], s58 offen offset:0 sc1
    v_mfma_f32_16x16x32_bf16 v[76:79], a[152:155], a[124:127], 0
    v_pk_mul_f32 v[200:201], v[40:41], v[40:41]
    v_pk_mul_f32 v[202:203], v[42:43], v[42:43]
    v_pk_mul_f32 v[204:205], v[44:45], v[44:45]
    v_pk_mul_f32 v[206:207], v[46:47], v[46:47]
    v_pk_fma_f32 v[200:201], v[200:201], v[186:187], v[184:185] op_sel:[0,0,0] op_sel_hi:[1,0,0]
    v_pk_fma_f32 v[202:203], v[202:203], v[186:187], v[184:185] op_sel:[0,0,0] op_sel_hi:[1,0,0]
    v_pk_fma_f32 v[204:205], v[204:205], v[186:187], v[184:185] op_sel:[0,1,1] op_sel_hi:[1,1,1]
    v_pk_fma_f32 v[206:207], v[206:207], v[186:187], v[184:185] op_sel:[0,1,1] op_sel_hi:[1,1,1]
    v_pk_mul_f32 v[200:201], v[200:201], v[40:41]
    v_pk_mul_f32 v[202:203], v[202:203], v[42:43]
    v_pk_mul_f32 v[204:205], v[204:205], v[44:45]
    v_pk_mul_f32 v[206:207], v[206:207], v[46:47]
    v_exp_f32 v200, v200
    v_exp_f32 v201, v201
    v_exp_f32 v202, v202
    v_exp_f32 v203, v203
    v_exp_f32 v204, v204
    v_exp_f32 v205, v205
    v_exp_f32 v206, v206
    v_exp_f32 v207, v207
    v_pk_add_f32 v[200:201], v[200:201], 1.0 op_sel_hi:[1,0]
    v_pk_add_f32 v[202:203], v[202:203], 1.0 op_sel_hi:[1,0]
    v_pk_add_f32 v[204:205], v[204:205], 1.0 op_sel_hi:[1,0]
    v_pk_add_f32 v[206:207], v[206:207], 1.0 op_sel_hi:[1,0]
    v_rcp_f32 v200, v200
    v_rcp_f32 v201, v201
    v_rcp_f32 v202, v202
    v_rcp_f32 v203, v203
    v_rcp_f32 v204, v204
    v_rcp_f32 v205, v205
    v_rcp_f32 v206, v206
    v_rcp_f32 v207, v207
    v_pk_mul_f32 v[40:41], v[40:41], v[200:201]
    v_pk_mul_f32 v[42:43], v[42:43], v[202:203]
    v_pk_mul_f32 v[44:45], v[44:45], v[204:205]
    v_pk_mul_f32 v[46:47], v[46:47], v[206:207]
    v_pk_add_f32 v[224:225], v[224:225], v[40:41]
    v_pk_fma_f32 v[226:227], v[40:41], v[40:41], v[226:227]
    v_pk_add_f32 v[228:229], v[228:229], v[44:45]
    v_pk_fma_f32 v[230:231], v[44:45], v[44:45], v[230:231]
    v_pk_add_f32 v[224:225], v[224:225], v[42:43]
    v_pk_fma_f32 v[226:227], v[42:43], v[42:43], v[226:227]
    v_pk_add_f32 v[228:229], v[228:229], v[46:47]
    v_pk_fma_f32 v[230:231], v[46:47], v[46:47], v[230:231]
    v_pk_mul_f32 v[208:209], v[48:49], v[48:49]
    v_pk_mul_f32 v[210:211], v[50:51], v[50:51]
    v_pk_mul_f32 v[212:213], v[52:53], v[52:53]
    v_pk_mul_f32 v[214:215], v[54:55], v[54:55]
    v_pk_fma_f32 v[208:209], v[208:209], v[186:187], v[184:185] op_sel:[0,0,0] op_sel_hi:[1,0,0]
    v_pk_fma_f32 v[210:211], v[210:211], v[186:187], v[184:185] op_sel:[0,0,0] op_sel_hi:[1,0,0]
    v_pk_fma_f32 v[212:213], v[212:213], v[186:187], v[184:185] op_sel:[0,1,1] op_sel_hi:[1,1,1]
    v_pk_fma_f32 v[214:215], v[214:215], v[186:187], v[184:185] op_sel:[0,1,1] op_sel_hi:[1,1,1]
    v_pk_mul_f32 v[208:209], v[208:209], v[48:49]
    v_pk_mul_f32 v[210:211], v[210:211], v[50:51]
    v_pk_mul_f32 v[212:213], v[212:213], v[52:53]
    v_pk_mul_f32 v[214:215], v[214:215], v[54:55]
    v_exp_f32 v208, v208
    v_exp_f32 v209, v209
    v_exp_f32 v210, v210
    v_exp_f32 v211, v211
    v_exp_f32 v212, v212
    v_exp_f32 v213, v213
    v_exp_f32 v214, v214
    v_exp_f32 v215, v215
    v_pk_add_f32 v[208:209], v[208:209], 1.0 op_sel_hi:[1,0]
    v_pk_add_f32 v[210:211], v[210:211], 1.0 op_sel_hi:[1,0]
    v_pk_add_f32 v[212:213], v[212:213], 1.0 op_sel_hi:[1,0]
    v_pk_add_f32 v[214:215], v[214:215], 1.0 op_sel_hi:[1,0]
    v_rcp_f32 v208, v208
    v_rcp_f32 v209, v209
    v_rcp_f32 v210, v210
    v_rcp_f32 v211, v211
    v_rcp_f32 v212, v212
    v_rcp_f32 v213, v213
    v_rcp_f32 v214, v214
    v_rcp_f32 v215, v215
    v_pk_mul_f32 v[48:49], v[48:49], v[208:209]
    v_pk_mul_f32 v[50:51], v[50:51], v[210:211]
    v_pk_mul_f32 v[52:53], v[52:53], v[212:213]
    v_pk_mul_f32 v[54:55], v[54:55], v[214:215]
    v_pk_add_f32 v[224:225], v[224:225], v[48:49]
    v_pk_fma_f32 v[226:227], v[48:49], v[48:49], v[226:227]
    v_pk_add_f32 v[228:229], v[228:229], v[52:53]
    v_pk_fma_f32 v[230:231], v[52:53], v[52:53], v[230:231]
    v_pk_add_f32 v[224:225], v[224:225], v[50:51]
    v_pk_fma_f32 v[226:227], v[50:51], v[50:51], v[226:227]
    v_pk_add_f32 v[228:229], v[228:229], v[54:55]
    v_pk_fma_f32 v[230:231], v[54:55], v[54:55], v[230:231]
    v_pk_mul_f32 v[200:201], v[56:57], v[56:57]
    v_pk_mul_f32 v[202:203], v[58:59], v[58:59]
    v_pk_mul_f32 v[204:205], v[60:61], v[60:61]
    v_pk_mul_f32 v[206:207], v[62:63], v[62:63]
    v_pk_fma_f32 v[200:201], v[200:201], v[186:187], v[184:185] op_sel:[0,0,0] op_sel_hi:[1,0,0]
    v_pk_fma_f32 v[202:203], v[202:203], v[186:187], v[184:185] op_sel:[0,0,0] op_sel_hi:[1,0,0]
    v_pk_fma_f32 v[204:205], v[204:205], v[186:187], v[184:185] op_sel:[0,1,1] op_sel_hi:[1,1,1]
    v_pk_fma_f32 v[206:207], v[206:207], v[186:187], v[184:185] op_sel:[0,1,1] op_sel_hi:[1,1,1]
    v_pk_mul_f32 v[200:201], v[200:201], v[56:57]
    v_pk_mul_f32 v[202:203], v[202:203], v[58:59]
    v_pk_mul_f32 v[204:205], v[204:205], v[60:61]
    v_pk_mul_f32 v[206:207], v[206:207], v[62:63]
    buffer_load_dword v233, v232, s[12:15], s52 offen offset:128 sc1
    v_exp_f32 v200, v200
    v_exp_f32 v201, v201
    v_exp_f32 v202, v202
    v_exp_f32 v203, v203
    v_exp_f32 v204, v204
    v_exp_f32 v205, v205
    v_exp_f32 v206, v206
    v_exp_f32 v207, v207
    v_pk_add_f32 v[200:201], v[200:201], 1.0 op_sel_hi:[1,0]
    v_pk_add_f32 v[202:203], v[202:203], 1.0 op_sel_hi:[1,0]
    v_pk_add_f32 v[204:205], v[204:205], 1.0 op_sel_hi:[1,0]
    v_pk_add_f32 v[206:207], v[206:207], 1.0 op_sel_hi:[1,0]
    v_rcp_f32 v200, v200
    v_rcp_f32 v201, v201
    v_rcp_f32 v202, v202
    v_rcp_f32 v203, v203
    v_rcp_f32 v204, v204
    v_rcp_f32 v205, v205
    v_rcp_f32 v206, v206
    v_rcp_f32 v207, v207
    v_pk_mul_f32 v[56:57], v[56:57], v[200:201]
    v_pk_mul_f32 v[58:59], v[58:59], v[202:203]
    v_pk_mul_f32 v[60:61], v[60:61], v[204:205]
    v_pk_mul_f32 v[62:63], v[62:63], v[206:207]
    v_pk_add_f32 v[224:225], v[224:225], v[56:57]
    v_pk_fma_f32 v[226:227], v[56:57], v[56:57], v[226:227]
    v_pk_add_f32 v[228:229], v[228:229], v[60:61]
    v_pk_fma_f32 v[230:231], v[60:61], v[60:61], v[230:231]
    v_pk_add_f32 v[224:225], v[224:225], v[58:59]
    v_pk_fma_f32 v[226:227], v[58:59], v[58:59], v[226:227]
    v_pk_add_f32 v[228:229], v[228:229], v[62:63]
    v_pk_fma_f32 v[230:231], v[62:63], v[62:63], v[230:231]
    v_pk_mul_f32 v[208:209], v[64:65], v[64:65]
    v_pk_mul_f32 v[210:211], v[66:67], v[66:67]
    v_pk_mul_f32 v[212:213], v[68:69], v[68:69]
    v_pk_mul_f32 v[214:215], v[70:71], v[70:71]
    v_pk_fma_f32 v[208:209], v[208:209], v[186:187], v[184:185] op_sel:[0,0,0] op_sel_hi:[1,0,0]
    v_pk_fma_f32 v[210:211], v[210:211], v[186:187], v[184:185] op_sel:[0,0,0] op_sel_hi:[1,0,0]
    v_pk_fma_f32 v[212:213], v[212:213], v[186:187], v[184:185] op_sel:[0,1,1] op_sel_hi:[1,1,1]
    v_pk_fma_f32 v[214:215], v[214:215], v[186:187], v[184:185] op_sel:[0,1,1] op_sel_hi:[1,1,1]
    v_pk_mul_f32 v[208:209], v[208:209], v[64:65]
    v_pk_mul_f32 v[210:211], v[210:211], v[66:67]
    v_pk_mul_f32 v[212:213], v[212:213], v[68:69]
    v_pk_mul_f32 v[214:215], v[214:215], v[70:71]
    v_exp_f32 v208, v208
    v_mfma_f32_16x16x32_bf16 v[76:79], a[148:151], a[132:135], v[76:79]
    s_add_u32 m0, s32, 73728
    s_add_u32 s41, s34, 147456
    v_mfma_f32_16x16x32_bf16 v[76:79], a[144:147], a[140:143], v[76:79]
    v_exp_f32 v209, v209
    v_mfma_f32_16x16x32_bf16 v[76:79], a[160:163], a[116:119], v[76:79]
    ds_read_b128 a[144:147], v4 offset:9216
    ds_read_b128 a[148:151], v4 offset:10240
    v_mfma_f32_16x16x32_bf16 v[76:79], a[164:167], a[108:111], v[76:79]
    v_exp_f32 v210, v210
    v_mfma_f32_16x16x32_bf16 v[76:79], a[168:171], a[100:103], v[76:79]
    ds_read_b128 a[152:155], v4 offset:11264
    s_waitcnt lgkmcnt(3)
    v_mfma_f32_16x16x32_bf16 v[72:75], a[168:171], a[96:99], v[72:75]
    v_exp_f32 v211, v211
    v_mfma_f32_16x16x32_bf16 v[72:75], a[164:167], a[104:107], v[72:75]
    buffer_load_dwordx4 off, s[80:83], s41 offset:0 sc1 lds
    v_exp_f32 v212, v212
    v_mfma_f32_16x16x32_bf16 v[72:75], a[160:163], a[112:115], v[72:75]
    v_exp_f32 v213, v213
    v_mfma_f32_16x16x32_bf16 v[72:75], a[176:179], a[88:91], v[72:75]
    ds_read_b128 a[160:163], v4 offset:12288
    ds_read_b128 a[164:167], v4 offset:13312
    v_mfma_f32_16x16x32_bf16 v[72:75], a[180:183], a[80:83], v[72:75]
    v_exp_f32 v214, v214
    v_mfma_f32_16x16x32_bf16 v[72:75], a[184:187], a[72:75], v[72:75]
    ds_read_b128 a[168:171], v4 offset:14336
    s_waitcnt lgkmcnt(3)
    buffer_store_dwordx4 v[20:23], v1, s[12:15], s58 offen offset:1024 sc1
    v_mfma_f32_16x16x32_bf16 v[76:79], a[184:187], a[76:79], v[76:79]
    v_exp_f32 v215, v215
    v_mfma_f32_16x16x32_bf16 v[76:79], a[180:183], a[84:87], v[76:79]
    buffer_load_dwordx4 off, s[80:83], s41 offset:1024 sc1 lds
    v_add_f32 v208, 1.0, v208
    v_mfma_f32_16x16x32_bf16 v[76:79], a[176:179], a[92:95], v[76:79]
    v_add_f32 v209, 1.0, v209
    v_add_f32 v210, 1.0, v210
    v_add_f32 v211, 1.0, v211
    v_mfma_f32_16x16x32_bf16 v[76:79], a[144:147], a[68:71], v[76:79]
    ds_read_b128 a[176:179], v4 offset:15360
    ds_read_b128 a[180:183], v4 offset:16384
    v_mfma_f32_16x16x32_bf16 v[76:79], a[148:151], a[60:63], v[76:79]
    v_add_f32 v212, 1.0, v212
    v_add_f32 v213, 1.0, v213
    v_mfma_f32_16x16x32_bf16 v[76:79], a[152:155], a[52:55], v[76:79]
    ds_read_b128 a[184:187], v4 offset:17408
    s_waitcnt lgkmcnt(3)
    v_mfma_f32_16x16x32_bf16 v[72:75], a[152:155], a[48:51], v[72:75]
    v_add_f32 v214, 1.0, v214
    v_add_f32 v215, 1.0, v215
    v_mfma_f32_16x16x32_bf16 v[72:75], a[148:151], a[56:59], v[72:75]
    buffer_load_dwordx4 off, s[80:83], s41 offset:2048 sc1 lds
    v_mfma_f32_16x16x32_bf16 v[72:75], a[144:147], a[64:67], v[72:75]
    v_rcp_f32 v208, v208
    v_mfma_f32_16x16x32_bf16 v[72:75], a[160:163], a[40:43], v[72:75]
    ds_read_b128 a[144:147], v4 offset:18432
    ds_read_b128 a[148:151], v4 offset:19456
    v_mfma_f32_16x16x32_bf16 v[72:75], a[164:167], a[32:35], v[72:75]
    v_rcp_f32 v209, v209
    v_mfma_f32_16x16x32_bf16 v[72:75], a[168:171], a[24:27], v[72:75]
    ds_read_b128 a[152:155], v4 offset:20480
    s_waitcnt lgkmcnt(3)
    buffer_store_dwordx4 v[20:23], v1, s[12:15], s58 offen offset:2048 sc1
    v_mfma_f32_16x16x32_bf16 v[76:79], a[168:171], a[28:31], v[76:79]
    v_rcp_f32 v210, v210
    v_mfma_f32_16x16x32_bf16 v[76:79], a[164:167], a[36:39], v[76:79]
    buffer_load_dwordx4 off, s[80:83], s41 offset:3072 sc1 lds
    v_rcp_f32 v211, v211
    v_mfma_f32_16x16x32_bf16 v[76:79], a[160:163], a[44:47], v[76:79]
    v_rcp_f32 v212, v212
    v_mfma_f32_16x16x32_bf16 v[76:79], a[176:179], a[20:23], v[76:79]
    ds_read_b128 a[160:163], v4 offset:21504
    ds_read_b128 a[164:167], v4 offset:22528
    v_mfma_f32_16x16x32_bf16 v[76:79], a[180:183], a[12:15], v[76:79]
    v_rcp_f32 v213, v213
    v_mfma_f32_16x16x32_bf16 v[76:79], a[184:187], a[4:7], v[76:79]
    ds_read_b128 a[168:171], v4 offset:23552
    s_waitcnt lgkmcnt(3)
    v_mfma_f32_16x16x32_bf16 v[72:75], a[184:187], a[0:3], v[72:75]
    v_rcp_f32 v214, v214
    v_mfma_f32_16x16x32_bf16 v[72:75], a[180:183], a[8:11], v[72:75]
    s_add_u32 m0, s32, 77824
    s_add_u32 s41, s34, 151552
    v_mfma_f32_16x16x32_bf16 v[72:75], a[176:179], a[16:19], v[72:75]
    v_rcp_f32 v215, v215
    v_mfma_f32_16x16x32_bf16 v[80:83], a[144:147], a[136:139], 0
    ds_read_b128 a[176:179], v4 offset:24576
    ds_read_b128 a[180:183], v4 offset:25600
    v_mfma_f32_16x16x32_bf16 v[80:83], a[148:151], a[128:131], v[80:83]
    v_mfma_f32_16x16x32_bf16 v[80:83], a[152:155], a[120:123], v[80:83]
    ds_read_b128 a[184:187], v4 offset:26624
    s_waitcnt lgkmcnt(3)
    buffer_store_dwordx4 v[20:23], v1, s[12:15], s58 offen offset:3072 sc1
    v_mfma_f32_16x16x32_bf16 v[84:87], a[152:155], a[124:127], 0
    v_pk_mul_f32 v[64:65], v[64:65], v[208:209]
    v_pk_mul_f32 v[66:67], v[66:67], v[210:211]
    v_pk_mul_f32 v[68:69], v[68:69], v[212:213]
    v_pk_mul_f32 v[70:71], v[70:71], v[214:215]
    v_pk_add_f32 v[224:225], v[224:225], v[64:65]
    v_pk_fma_f32 v[226:227], v[64:65], v[64:65], v[226:227]
    v_pk_add_f32 v[228:229], v[228:229], v[68:69]
    v_pk_fma_f32 v[230:231], v[68:69], v[68:69], v[230:231]
    v_pk_add_f32 v[224:225], v[224:225], v[66:67]
    v_pk_fma_f32 v[226:227], v[66:67], v[66:67], v[226:227]
    v_pk_add_f32 v[228:229], v[228:229], v[70:71]
    v_pk_fma_f32 v[230:231], v[70:71], v[70:71], v[230:231]
    v_pk_mul_f32 v[200:201], v[72:73], v[72:73]
    v_pk_mul_f32 v[202:203], v[74:75], v[74:75]
    v_pk_mul_f32 v[204:205], v[76:77], v[76:77]
    v_pk_mul_f32 v[206:207], v[78:79], v[78:79]
    v_pk_fma_f32 v[200:201], v[200:201], v[186:187], v[184:185] op_sel:[0,0,0] op_sel_hi:[1,0,0]
    v_pk_fma_f32 v[202:203], v[202:203], v[186:187], v[184:185] op_sel:[0,0,0] op_sel_hi:[1,0,0]
    v_pk_fma_f32 v[204:205], v[204:205], v[186:187], v[184:185] op_sel:[0,1,1] op_sel_hi:[1,1,1]
    v_pk_fma_f32 v[206:207], v[206:207], v[186:187], v[184:185] op_sel:[0,1,1] op_sel_hi:[1,1,1]
    v_pk_mul_f32 v[200:201], v[200:201], v[72:73]
    v_pk_mul_f32 v[202:203], v[202:203], v[74:75]
    v_pk_mul_f32 v[204:205], v[204:205], v[76:77]
    v_pk_mul_f32 v[206:207], v[206:207], v[78:79]
    s_waitcnt vmcnt(7)
    v_cmp_eq_u32 vcc, 0, v233
    s_nop 3
    s_cbranch_vccnz L_interleave_layers__spectral_fnet__mixer_gmlp__prompt_kernel_17
L_interleave_layers__spectral_fnet__mixer_gmlp__prompt_kernel_18:
    v_mfma_f32_16x16x32_bf16 v[84:87], a[148:151], a[132:135], v[84:87]
    buffer_load_dwordx4 off, s[80:83], s41 offset:0 sc1 lds
    v_mfma_f32_16x16x32_bf16 v[84:87], a[144:147], a[140:143], v[84:87]
    v_exp_f32 v200, v200
    v_mfma_f32_16x16x32_bf16 v[84:87], a[160:163], a[116:119], v[84:87]
    ds_read_b128 a[144:147], v4 offset:27648
    ds_read_b128 a[148:151], v4 offset:28672
    v_mfma_f32_16x16x32_bf16 v[84:87], a[164:167], a[108:111], v[84:87]
    v_exp_f32 v201, v201
    v_mfma_f32_16x16x32_bf16 v[84:87], a[168:171], a[100:103], v[84:87]
    ds_read_b128 a[152:155], v4 offset:29696
    s_waitcnt lgkmcnt(3)
    v_mfma_f32_16x16x32_bf16 v[80:83], a[168:171], a[96:99], v[80:83]
    v_exp_f32 v202, v202
    v_mfma_f32_16x16x32_bf16 v[80:83], a[164:167], a[104:107], v[80:83]
    buffer_load_dwordx4 off, s[80:83], s41 offset:1024 sc1 lds
    v_exp_f32 v203, v203
    v_mfma_f32_16x16x32_bf16 v[80:83], a[160:163], a[112:115], v[80:83]
    v_exp_f32 v204, v204
    v_mfma_f32_16x16x32_bf16 v[80:83], a[176:179], a[88:91], v[80:83]
    ds_read_b128 a[160:163], v4 offset:30720
    ds_read_b128 a[164:167], v4 offset:31744
    v_mfma_f32_16x16x32_bf16 v[80:83], a[180:183], a[80:83], v[80:83]
    v_exp_f32 v205, v205
    v_mfma_f32_16x16x32_bf16 v[80:83], a[184:187], a[72:75], v[80:83]
    ds_read_b128 a[168:171], v4 offset:32768
    s_waitcnt lgkmcnt(3)
    buffer_store_dwordx4 v[20:23], v1, s[12:15], s59 offen offset:0 sc1
    v_mfma_f32_16x16x32_bf16 v[84:87], a[184:187], a[76:79], v[84:87]
    v_exp_f32 v206, v206
    v_mfma_f32_16x16x32_bf16 v[84:87], a[180:183], a[84:87], v[84:87]
    buffer_load_dwordx4 off, s[80:83], s41 offset:2048 sc1 lds
    v_mfma_f32_16x16x32_bf16 v[84:87], a[176:179], a[92:95], v[84:87]
    v_exp_f32 v207, v207
    v_add_f32 v200, 1.0, v200
    v_mfma_f32_16x16x32_bf16 v[84:87], a[144:147], a[68:71], v[84:87]
    ds_read_b128 a[176:179], v4 offset:33792
    ds_read_b128 a[180:183], v4 offset:34816
    v_mfma_f32_16x16x32_bf16 v[84:87], a[148:151], a[60:63], v[84:87]
    v_add_f32 v201, 1.0, v201
    v_add_f32 v202, 1.0, v202
    v_mfma_f32_16x16x32_bf16 v[84:87], a[152:155], a[52:55], v[84:87]
    ds_read_b128 a[184:187], v4 offset:35840
    s_waitcnt lgkmcnt(3)
    s_add_u32 s51, s39, 0
    buffer_load_dwordx4 v[240:243], off, s[80:83], s51 offset:0 sc1
    v_mfma_f32_16x16x32_bf16 v[80:83], a[152:155], a[48:51], v[80:83]
    v_add_f32 v203, 1.0, v203
    v_add_f32 v204, 1.0, v204
    v_mfma_f32_16x16x32_bf16 v[80:83], a[148:151], a[56:59], v[80:83]
    buffer_load_dwordx4 off, s[80:83], s41 offset:3072 sc1 lds
    v_add_f32 v205, 1.0, v205
    v_mfma_f32_16x16x32_bf16 v[80:83], a[144:147], a[64:67], v[80:83]
    v_add_f32 v206, 1.0, v206
    v_add_f32 v207, 1.0, v207
    v_mfma_f32_16x16x32_bf16 v[80:83], a[160:163], a[40:43], v[80:83]
    s_barrier
    v_rcp_f32 v200, v200
    v_mfma_f32_16x16x32_bf16 v[80:83], a[164:167], a[32:35], v[80:83]
    ds_read_b128 a[144:147], v5 offset:0
    ds_read_b128 a[148:151], v5 offset:1024
    v_mfma_f32_16x16x32_bf16 v[80:83], a[168:171], a[24:27], v[80:83]
    ds_read_b128 a[152:155], v5 offset:2048
    s_waitcnt lgkmcnt(3)
    buffer_load_dwordx4 v[244:247], off, s[80:83], s51 offset:1024 sc1
    v_mfma_f32_16x16x32_bf16 v[84:87], a[168:171], a[28:31], v[84:87]
    v_rcp_f32 v201, v201
    v_mfma_f32_16x16x32_bf16 v[84:87], a[164:167], a[36:39], v[84:87]
    s_add_u32 m0, s32, 81920
    s_add_u32 s41, s34, 155648
    v_mfma_f32_16x16x32_bf16 v[84:87], a[160:163], a[44:47], v[84:87]
    v_rcp_f32 v202, v202
    v_mfma_f32_16x16x32_bf16 v[84:87], a[176:179], a[20:23], v[84:87]
    ds_read_b128 a[160:163], v5 offset:3072
    ds_read_b128 a[164:167], v5 offset:4096
    v_mfma_f32_16x16x32_bf16 v[84:87], a[180:183], a[12:15], v[84:87]
    v_rcp_f32 v203, v203
    v_mfma_f32_16x16x32_bf16 v[84:87], a[184:187], a[4:7], v[84:87]
    ds_read_b128 a[168:171], v5 offset:5120
    s_waitcnt lgkmcnt(3)
    buffer_load_dwordx4 v[248:251], off, s[80:83], s51 offset:2048 sc1
    v_mfma_f32_16x16x32_bf16 v[80:83], a[184:187], a[0:3], v[80:83]
    v_rcp_f32 v204, v204
    v_mfma_f32_16x16x32_bf16 v[80:83], a[180:183], a[8:11], v[80:83]
    buffer_load_dwordx4 off, s[80:83], s41 offset:0 sc1 lds
    v_rcp_f32 v205, v205
    v_mfma_f32_16x16x32_bf16 v[80:83], a[176:179], a[16:19], v[80:83]
    v_rcp_f32 v206, v206
    v_mfma_f32_16x16x32_bf16 v[88:91], a[144:147], a[136:139], 0
    ds_read_b128 a[176:179], v5 offset:6144
    ds_read_b128 a[180:183], v5 offset:7168
    v_mfma_f32_16x16x32_bf16 v[88:91], a[148:151], a[128:131], v[88:91]
    v_rcp_f32 v207, v207
    v_mfma_f32_16x16x32_bf16 v[88:91], a[152:155], a[120:123], v[88:91]
    ds_read_b128 a[184:187], v5 offset:8192
    s_waitcnt lgkmcnt(3)
    buffer_load_dwordx4 v[36:39], off, s[80:83], s51 offset:3072 sc1
    v_mfma_f32_16x16x32_bf16 v[92:95], a[152:155], a[124:127], 0
    v_pk_mul_f32 v[72:73], v[72:73], v[200:201]
    v_pk_mul_f32 v[74:75], v[74:75], v[202:203]
    v_pk_mul_f32 v[76:77], v[76:77], v[204:205]
    v_pk_mul_f32 v[78:79], v[78:79], v[206:207]
    v_pk_add_f32 v[224:225], v[224:225], v[72:73]
    v_pk_fma_f32 v[226:227], v[72:73], v[72:73], v[226:227]
    v_pk_add_f32 v[228:229], v[228:229], v[76:77]
    v_pk_fma_f32 v[230:231], v[76:77], v[76:77], v[230:231]
    v_pk_add_f32 v[224:225], v[224:225], v[74:75]
    v_pk_fma_f32 v[226:227], v[74:75], v[74:75], v[226:227]
    v_pk_add_f32 v[228:229], v[228:229], v[78:79]
    v_pk_fma_f32 v[230:231], v[78:79], v[78:79], v[230:231]
    v_pk_mul_f32 v[208:209], v[80:81], v[80:81]
    v_pk_mul_f32 v[210:211], v[82:83], v[82:83]
    v_pk_mul_f32 v[212:213], v[84:85], v[84:85]
    v_pk_mul_f32 v[214:215], v[86:87], v[86:87]
    v_pk_fma_f32 v[208:209], v[208:209], v[186:187], v[184:185] op_sel:[0,0,0] op_sel_hi:[1,0,0]
    v_pk_fma_f32 v[210:211], v[210:211], v[186:187], v[184:185] op_sel:[0,0,0] op_sel_hi:[1,0,0]
    v_pk_fma_f32 v[212:213], v[212:213], v[186:187], v[184:185] op_sel:[0,1,1] op_sel_hi:[1,1,1]
    v_pk_fma_f32 v[214:215], v[214:215], v[186:187], v[184:185] op_sel:[0,1,1] op_sel_hi:[1,1,1]
    v_pk_mul_f32 v[208:209], v[208:209], v[80:81]
    v_pk_mul_f32 v[210:211], v[210:211], v[82:83]
    v_pk_mul_f32 v[212:213], v[212:213], v[84:85]
    v_pk_mul_f32 v[214:215], v[214:215], v[86:87]
    s_nop 0
    v_mfma_f32_16x16x32_bf16 v[92:95], a[148:151], a[132:135], v[92:95]
    s_add_u32 m0, s32, 110592
    s_add_u32 s41, s34, 184320
    v_mfma_f32_16x16x32_bf16 v[92:95], a[144:147], a[140:143], v[92:95]
    v_exp_f32 v208, v208
    v_mfma_f32_16x16x32_bf16 v[92:95], a[160:163], a[116:119], v[92:95]
    ds_read_b128 a[144:147], v5 offset:9216
    ds_read_b128 a[148:151], v5 offset:10240
    v_mfma_f32_16x16x32_bf16 v[92:95], a[164:167], a[108:111], v[92:95]
    v_exp_f32 v209, v209
    v_mfma_f32_16x16x32_bf16 v[92:95], a[168:171], a[100:103], v[92:95]
    ds_read_b128 a[152:155], v5 offset:11264
    s_waitcnt lgkmcnt(3)
    buffer_load_dwordx4 v[32:35], v16, s[12:15], s51 offen sc1
    v_mfma_f32_16x16x32_bf16 v[88:91], a[168:171], a[96:99], v[88:91]
    v_exp_f32 v210, v210
    v_mfma_f32_16x16x32_bf16 v[88:91], a[164:167], a[104:107], v[88:91]
    buffer_load_dwordx4 off, s[80:83], s41 offset:0 sc1 lds
    v_exp_f32 v211, v211
    v_mfma_f32_16x16x32_bf16 v[88:91], a[160:163], a[112:115], v[88:91]
    v_exp_f32 v212, v212
    v_mfma_f32_16x16x32_bf16 v[88:91], a[176:179], a[88:91], v[88:91]
    ds_read_b128 a[160:163], v5 offset:12288
    ds_read_b128 a[164:167], v5 offset:13312
    v_mfma_f32_16x16x32_bf16 v[88:91], a[180:183], a[80:83], v[88:91]
    v_exp_f32 v213, v213
    v_mfma_f32_16x16x32_bf16 v[88:91], a[184:187], a[72:75], v[88:91]
    ds_read_b128 a[168:171], v5 offset:14336
    s_waitcnt lgkmcnt(3)
    s_add_u32 s51, s39, 36864
    buffer_load_dwordx4 v[28:31], off, s[80:83], s51 offset:0 sc1
    v_mfma_f32_16x16x32_bf16 v[92:95], a[184:187], a[76:79], v[92:95]
    v_exp_f32 v214, v214
    v_mfma_f32_16x16x32_bf16 v[92:95], a[180:183], a[84:87], v[92:95]
    buffer_load_dwordx4 off, s[80:83], s41 offset:1024 sc1 lds
    v_mfma_f32_16x16x32_bf16 v[92:95], a[176:179], a[92:95], v[92:95]
    v_exp_f32 v215, v215
    v_add_f32 v208, 1.0, v208
    v_mfma_f32_16x16x32_bf16 v[92:95], a[144:147], a[68:71], v[92:95]
    ds_read_b128 a[176:179], v5 offset:15360
    ds_read_b128 a[180:183], v5 offset:16384
    v_mfma_f32_16x16x32_bf16 v[92:95], a[148:151], a[60:63], v[92:95]
    v_add_f32 v209, 1.0, v209
    v_add_f32 v210, 1.0, v210
    v_mfma_f32_16x16x32_bf16 v[92:95], a[152:155], a[52:55], v[92:95]
    ds_read_b128 a[184:187], v5 offset:17408
    s_waitcnt lgkmcnt(3)
    buffer_load_dwordx4 v[24:27], off, s[80:83], s51 offset:1024 sc1
    v_mfma_f32_16x16x32_bf16 v[88:91], a[152:155], a[48:51], v[88:91]
    v_add_f32 v211, 1.0, v211
    v_add_f32 v212, 1.0, v212
    v_mfma_f32_16x16x32_bf16 v[88:91], a[148:151], a[56:59], v[88:91]
    buffer_load_dwordx4 off, s[80:83], s41 offset:2048 sc1 lds
    v_add_f32 v213, 1.0, v213
    v_mfma_f32_16x16x32_bf16 v[88:91], a[144:147], a[64:67], v[88:91]
    v_add_f32 v214, 1.0, v214
    v_add_f32 v215, 1.0, v215
    v_mfma_f32_16x16x32_bf16 v[88:91], a[160:163], a[40:43], v[88:91]
    ds_read_b128 a[144:147], v5 offset:18432
    ds_read_b128 a[148:151], v5 offset:19456
    v_mfma_f32_16x16x32_bf16 v[88:91], a[164:167], a[32:35], v[88:91]
    v_rcp_f32 v208, v208
    v_mfma_f32_16x16x32_bf16 v[88:91], a[168:171], a[24:27], v[88:91]
    ds_read_b128 a[152:155], v5 offset:20480
    s_waitcnt lgkmcnt(3)
    buffer_load_dwordx4 v[20:23], off, s[80:83], s51 offset:2048 sc1
    v_mfma_f32_16x16x32_bf16 v[92:95], a[168:171], a[28:31], v[92:95]
    v_rcp_f32 v209, v209
    v_mfma_f32_16x16x32_bf16 v[92:95], a[164:167], a[36:39], v[92:95]
    buffer_load_dwordx4 off, s[80:83], s41 offset:3072 sc1 lds
    v_rcp_f32 v210, v210
    v_mfma_f32_16x16x32_bf16 v[92:95], a[160:163], a[44:47], v[92:95]
    v_rcp_f32 v211, v211
    v_mfma_f32_16x16x32_bf16 v[92:95], a[176:179], a[20:23], v[92:95]
    ds_read_b128 a[160:163], v5 offset:21504
    ds_read_b128 a[164:167], v5 offset:22528
    v_mfma_f32_16x16x32_bf16 v[92:95], a[180:183], a[12:15], v[92:95]
    v_rcp_f32 v212, v212
    v_mfma_f32_16x16x32_bf16 v[92:95], a[184:187], a[4:7], v[92:95]
    ds_read_b128 a[168:171], v5 offset:23552
    s_waitcnt lgkmcnt(3)
    v_mfma_f32_16x16x32_bf16 v[88:91], a[184:187], a[0:3], v[88:91]
    v_rcp_f32 v213, v213
    v_mfma_f32_16x16x32_bf16 v[88:91], a[180:183], a[8:11], v[88:91]
    s_add_u32 m0, s32, 114688
    s_add_u32 s41, s34, 188416
    v_mfma_f32_16x16x32_bf16 v[88:91], a[176:179], a[16:19], v[88:91]
    v_rcp_f32 v214, v214
    v_mfma_f32_16x16x32_bf16 v[96:99], a[144:147], a[136:139], 0
    ds_read_b128 a[176:179], v5 offset:24576
    ds_read_b128 a[180:183], v5 offset:25600
    v_mfma_f32_16x16x32_bf16 v[96:99], a[148:151], a[128:131], v[96:99]
    v_rcp_f32 v215, v215
    v_mfma_f32_16x16x32_bf16 v[96:99], a[152:155], a[120:123], v[96:99]
    ds_read_b128 a[184:187], v5 offset:26624
    s_waitcnt lgkmcnt(3)
    v_mfma_f32_16x16x32_bf16 v[100:103], a[152:155], a[124:127], 0
    v_pk_mul_f32 v[80:81], v[80:81], v[208:209]
    v_pk_mul_f32 v[82:83], v[82:83], v[210:211]
    v_pk_mul_f32 v[84:85], v[84:85], v[212:213]
    v_pk_mul_f32 v[86:87], v[86:87], v[214:215]
    v_pk_add_f32 v[224:225], v[224:225], v[80:81]
    v_pk_fma_f32 v[226:227], v[80:81], v[80:81], v[226:227]
    v_pk_add_f32 v[228:229], v[228:229], v[84:85]
    v_pk_fma_f32 v[230:231], v[84:85], v[84:85], v[230:231]
    v_pk_add_f32 v[224:225], v[224:225], v[82:83]
    v_pk_fma_f32 v[226:227], v[82:83], v[82:83], v[226:227]
    v_pk_add_f32 v[228:229], v[228:229], v[86:87]
    v_pk_fma_f32 v[230:231], v[86:87], v[86:87], v[230:231]
    v_pk_mul_f32 v[200:201], v[88:89], v[88:89]
    v_pk_mul_f32 v[202:203], v[90:91], v[90:91]
    v_pk_mul_f32 v[204:205], v[92:93], v[92:93]
    v_pk_mul_f32 v[206:207], v[94:95], v[94:95]
    v_pk_fma_f32 v[200:201], v[200:201], v[186:187], v[184:185] op_sel:[0,0,0] op_sel_hi:[1,0,0]
    v_pk_fma_f32 v[202:203], v[202:203], v[186:187], v[184:185] op_sel:[0,0,0] op_sel_hi:[1,0,0]
    v_pk_fma_f32 v[204:205], v[204:205], v[186:187], v[184:185] op_sel:[0,1,1] op_sel_hi:[1,1,1]
    v_pk_fma_f32 v[206:207], v[206:207], v[186:187], v[184:185] op_sel:[0,1,1] op_sel_hi:[1,1,1]
    v_pk_mul_f32 v[200:201], v[200:201], v[88:89]
    v_pk_mul_f32 v[202:203], v[202:203], v[90:91]
    v_pk_mul_f32 v[204:205], v[204:205], v[92:93]
    v_pk_mul_f32 v[206:207], v[206:207], v[94:95]
    v_exp_f32 v200, v200
    v_mfma_f32_16x16x32_bf16 v[100:103], a[148:151], a[132:135], v[100:103]
    buffer_load_dwordx4 off, s[80:83], s41 offset:0 sc1 lds
    v_mfma_f32_16x16x32_bf16 v[100:103], a[144:147], a[140:143], v[100:103]
    v_exp_f32 v201, v201
    v_mfma_f32_16x16x32_bf16 v[100:103], a[160:163], a[116:119], v[100:103]
    ds_read_b128 a[144:147], v5 offset:27648
    ds_read_b128 a[148:151], v5 offset:28672
    v_mfma_f32_16x16x32_bf16 v[100:103], a[164:167], a[108:111], v[100:103]
    v_exp_f32 v202, v202
    v_mfma_f32_16x16x32_bf16 v[100:103], a[168:171], a[100:103], v[100:103]
    ds_read_b128 a[152:155], v5 offset:29696
    s_waitcnt lgkmcnt(3)
    v_mfma_f32_16x16x32_bf16 v[96:99], a[168:171], a[96:99], v[96:99]
    v_exp_f32 v203, v203
    v_mfma_f32_16x16x32_bf16 v[96:99], a[164:167], a[104:107], v[96:99]
    buffer_load_dwordx4 off, s[80:83], s41 offset:1024 sc1 lds
    v_exp_f32 v204, v204
    v_mfma_f32_16x16x32_bf16 v[96:99], a[160:163], a[112:115], v[96:99]
    v_exp_f32 v205, v205
    v_mfma_f32_16x16x32_bf16 v[96:99], a[176:179], a[88:91], v[96:99]
    ds_read_b128 a[160:163], v5 offset:30720
    ds_read_b128 a[164:167], v5 offset:31744
    v_mfma_f32_16x16x32_bf16 v[96:99], a[180:183], a[80:83], v[96:99]
    v_exp_f32 v206, v206
    v_mfma_f32_16x16x32_bf16 v[96:99], a[184:187], a[72:75], v[96:99]
    ds_read_b128 a[168:171], v5 offset:32768
    s_waitcnt lgkmcnt(3)
    v_mfma_f32_16x16x32_bf16 v[100:103], a[184:187], a[76:79], v[100:103]
    v_exp_f32 v207, v207
    v_mfma_f32_16x16x32_bf16 v[100:103], a[180:183], a[84:87], v[100:103]
    buffer_load_dwordx4 off, s[80:83], s41 offset:2048 sc1 lds
    v_add_f32 v200, 1.0, v200
    v_mfma_f32_16x16x32_bf16 v[100:103], a[176:179], a[92:95], v[100:103]
    v_add_f32 v201, 1.0, v201
    v_add_f32 v202, 1.0, v202
    v_add_f32 v203, 1.0, v203
    v_mfma_f32_16x16x32_bf16 v[100:103], a[144:147], a[68:71], v[100:103]
    ds_read_b128 a[176:179], v5 offset:33792
    ds_read_b128 a[180:183], v5 offset:34816
    v_mfma_f32_16x16x32_bf16 v[100:103], a[148:151], a[60:63], v[100:103]
    v_add_f32 v204, 1.0, v204
    v_add_f32 v205, 1.0, v205
    v_mfma_f32_16x16x32_bf16 v[100:103], a[152:155], a[52:55], v[100:103]
    ds_read_b128 a[184:187], v5 offset:35840
    s_waitcnt lgkmcnt(3)
    v_mfma_f32_16x16x32_bf16 v[96:99], a[152:155], a[48:51], v[96:99]
    v_add_f32 v206, 1.0, v206
    v_add_f32 v207, 1.0, v207
    v_mfma_f32_16x16x32_bf16 v[96:99], a[148:151], a[56:59], v[96:99]
    buffer_load_dwordx4 off, s[80:83], s41 offset:3072 sc1 lds
    v_mfma_f32_16x16x32_bf16 v[96:99], a[144:147], a[64:67], v[96:99]
    v_rcp_f32 v200, v200
    v_mfma_f32_16x16x32_bf16 v[96:99], a[160:163], a[40:43], v[96:99]
    s_waitcnt vmcnt(13)
    s_barrier
    v_mfma_f32_16x16x32_bf16 v[96:99], a[164:167], a[32:35], v[96:99]
    ds_read_b128 a[144:147], v6 offset:0
    ds_read_b128 a[148:151], v6 offset:1024
    v_mfma_f32_16x16x32_bf16 v[96:99], a[168:171], a[24:27], v[96:99]
    ds_read_b128 a[152:155], v6 offset:2048
    s_waitcnt lgkmcnt(3)
    v_mfma_f32_16x16x32_bf16 v[100:103], a[168:171], a[28:31], v[100:103]
    v_rcp_f32 v201, v201
    v_mfma_f32_16x16x32_bf16 v[100:103], a[164:167], a[36:39], v[100:103]
    s_add_u32 m0, s32, 118784
    s_add_u32 s41, s34, 192512
    v_mfma_f32_16x16x32_bf16 v[100:103], a[160:163], a[44:47], v[100:103]
    v_rcp_f32 v202, v202
    v_mfma_f32_16x16x32_bf16 v[100:103], a[176:179], a[20:23], v[100:103]
    ds_read_b128 a[160:163], v6 offset:3072
    ds_read_b128 a[164:167], v6 offset:4096
    v_rcp_f32 v203, v203
    v_mfma_f32_16x16x32_bf16 v[100:103], a[180:183], a[12:15], v[100:103]
    v_rcp_f32 v204, v204
    v_mfma_f32_16x16x32_bf16 v[100:103], a[184:187], a[4:7], v[100:103]
    ds_read_b128 a[168:171], v6 offset:5120
    s_waitcnt lgkmcnt(3)
    v_mfma_f32_16x16x32_bf16 v[96:99], a[184:187], a[0:3], v[96:99]
    v_rcp_f32 v205, v205
    v_mfma_f32_16x16x32_bf16 v[96:99], a[180:183], a[8:11], v[96:99]
    buffer_load_dwordx4 off, s[80:83], s41 offset:0 sc1 lds
    v_mfma_f32_16x16x32_bf16 v[96:99], a[176:179], a[16:19], v[96:99]
    v_rcp_f32 v206, v206
    v_mfma_f32_16x16x32_bf16 v[104:107], a[144:147], a[136:139], 0
    ds_read_b128 a[176:179], v6 offset:6144
    ds_read_b128 a[180:183], v6 offset:7168
    v_mfma_f32_16x16x32_bf16 v[104:107], a[148:151], a[128:131], v[104:107]
    v_rcp_f32 v207, v207
    v_mfma_f32_16x16x32_bf16 v[104:107], a[152:155], a[120:123], v[104:107]
    ds_read_b128 a[184:187], v6 offset:8192
    s_waitcnt lgkmcnt(3)
    v_mfma_f32_16x16x32_bf16 v[108:111], a[152:155], a[124:127], 0
    v_pk_mul_f32 v[88:89], v[88:89], v[200:201]
    v_pk_mul_f32 v[90:91], v[90:91], v[202:203]
    v_pk_mul_f32 v[92:93], v[92:93], v[204:205]
    v_pk_mul_f32 v[94:95], v[94:95], v[206:207]
    v_pk_add_f32 v[224:225], v[224:225], v[88:89]
    v_pk_fma_f32 v[226:227], v[88:89], v[88:89], v[226:227]
    v_pk_add_f32 v[228:229], v[228:229], v[92:93]
    v_pk_fma_f32 v[230:231], v[92:93], v[92:93], v[230:231]
    v_pk_add_f32 v[224:225], v[224:225], v[90:91]
    v_pk_fma_f32 v[226:227], v[90:91], v[90:91], v[226:227]
    v_pk_add_f32 v[228:229], v[228:229], v[94:95]
    v_pk_fma_f32 v[230:231], v[94:95], v[94:95], v[230:231]
    v_pk_mul_f32 v[208:209], v[96:97], v[96:97]
    v_pk_mul_f32 v[210:211], v[98:99], v[98:99]
    v_pk_mul_f32 v[212:213], v[100:101], v[100:101]
    v_pk_mul_f32 v[214:215], v[102:103], v[102:103]
    v_pk_fma_f32 v[208:209], v[208:209], v[186:187], v[184:185] op_sel:[0,0,0] op_sel_hi:[1,0,0]
    v_pk_fma_f32 v[210:211], v[210:211], v[186:187], v[184:185] op_sel:[0,0,0] op_sel_hi:[1,0,0]
    v_pk_fma_f32 v[212:213], v[212:213], v[186:187], v[184:185] op_sel:[0,1,1] op_sel_hi:[1,1,1]
    v_pk_fma_f32 v[214:215], v[214:215], v[186:187], v[184:185] op_sel:[0,1,1] op_sel_hi:[1,1,1]
    v_pk_mul_f32 v[208:209], v[208:209], v[96:97]
    v_pk_mul_f32 v[210:211], v[210:211], v[98:99]
    v_pk_mul_f32 v[212:213], v[212:213], v[100:101]
    v_pk_mul_f32 v[214:215], v[214:215], v[102:103]
    s_nop 0
    v_mfma_f32_16x16x32_bf16 v[108:111], a[148:151], a[132:135], v[108:111]
    s_add_u32 m0, s32, 0
    s_add_u32 s41, s34, 221184
    v_mfma_f32_16x16x32_bf16 v[108:111], a[144:147], a[140:143], v[108:111]
    v_exp_f32 v208, v208
    v_mfma_f32_16x16x32_bf16 v[108:111], a[160:163], a[116:119], v[108:111]
    ds_read_b128 a[144:147], v6 offset:9216
    ds_read_b128 a[148:151], v6 offset:10240
    v_mfma_f32_16x16x32_bf16 v[108:111], a[164:167], a[108:111], v[108:111]
    v_exp_f32 v209, v209
    v_mfma_f32_16x16x32_bf16 v[108:111], a[168:171], a[100:103], v[108:111]
    ds_read_b128 a[152:155], v6 offset:11264
    s_waitcnt lgkmcnt(3)
    v_mfma_f32_16x16x32_bf16 v[104:107], a[168:171], a[96:99], v[104:107]
    v_exp_f32 v210, v210
    v_mfma_f32_16x16x32_bf16 v[104:107], a[164:167], a[104:107], v[104:107]
    buffer_load_dwordx4 off, s[80:83], s41 offset:0 sc1 lds
    v_exp_f32 v211, v211
    v_mfma_f32_16x16x32_bf16 v[104:107], a[160:163], a[112:115], v[104:107]
    v_exp_f32 v212, v212
    v_mfma_f32_16x16x32_bf16 v[104:107], a[176:179], a[88:91], v[104:107]
    ds_read_b128 a[160:163], v6 offset:12288
    ds_read_b128 a[164:167], v6 offset:13312
    v_mfma_f32_16x16x32_bf16 v[104:107], a[180:183], a[80:83], v[104:107]
    v_exp_f32 v213, v213
    v_mfma_f32_16x16x32_bf16 v[104:107], a[184:187], a[72:75], v[104:107]
    ds_read_b128 a[168:171], v6 offset:14336
    s_waitcnt lgkmcnt(3)
    v_mfma_f32_16x16x32_bf16 v[108:111], a[184:187], a[76:79], v[108:111]
    v_exp_f32 v214, v214
    v_mfma_f32_16x16x32_bf16 v[108:111], a[180:183], a[84:87], v[108:111]
    buffer_load_dwordx4 off, s[80:83], s41 offset:1024 sc1 lds
    v_mfma_f32_16x16x32_bf16 v[108:111], a[176:179], a[92:95], v[108:111]
    v_exp_f32 v215, v215
    v_add_f32 v208, 1.0, v208
    v_mfma_f32_16x16x32_bf16 v[108:111], a[144:147], a[68:71], v[108:111]
    ds_read_b128 a[176:179], v6 offset:15360
    ds_read_b128 a[180:183], v6 offset:16384
    v_mfma_f32_16x16x32_bf16 v[108:111], a[148:151], a[60:63], v[108:111]
    v_add_f32 v209, 1.0, v209
    v_add_f32 v210, 1.0, v210
    v_mfma_f32_16x16x32_bf16 v[108:111], a[152:155], a[52:55], v[108:111]
    ds_read_b128 a[184:187], v6 offset:17408
    s_waitcnt lgkmcnt(3)
    v_mfma_f32_16x16x32_bf16 v[104:107], a[152:155], a[48:51], v[104:107]
    v_add_f32 v211, 1.0, v211
    v_add_f32 v212, 1.0, v212
    v_mfma_f32_16x16x32_bf16 v[104:107], a[148:151], a[56:59], v[104:107]
    buffer_load_dwordx4 off, s[80:83], s41 offset:2048 sc1 lds
    v_add_f32 v213, 1.0, v213
    v_mfma_f32_16x16x32_bf16 v[104:107], a[144:147], a[64:67], v[104:107]
    v_add_f32 v214, 1.0, v214
    v_add_f32 v215, 1.0, v215
    v_mfma_f32_16x16x32_bf16 v[104:107], a[160:163], a[40:43], v[104:107]
    ds_read_b128 a[144:147], v6 offset:18432
    ds_read_b128 a[148:151], v6 offset:19456
    v_mfma_f32_16x16x32_bf16 v[104:107], a[164:167], a[32:35], v[104:107]
    v_rcp_f32 v208, v208
    v_mfma_f32_16x16x32_bf16 v[104:107], a[168:171], a[24:27], v[104:107]
    ds_read_b128 a[152:155], v6 offset:20480
    s_waitcnt lgkmcnt(3)
    v_mfma_f32_16x16x32_bf16 v[108:111], a[168:171], a[28:31], v[108:111]
    v_rcp_f32 v209, v209
    v_mfma_f32_16x16x32_bf16 v[108:111], a[164:167], a[36:39], v[108:111]
    buffer_load_dwordx4 off, s[80:83], s41 offset:3072 sc1 lds
    v_rcp_f32 v210, v210
    v_mfma_f32_16x16x32_bf16 v[108:111], a[160:163], a[44:47], v[108:111]
    v_rcp_f32 v211, v211
    v_mfma_f32_16x16x32_bf16 v[108:111], a[176:179], a[20:23], v[108:111]
    ds_read_b128 a[160:163], v6 offset:21504
    ds_read_b128 a[164:167], v6 offset:22528
    v_mfma_f32_16x16x32_bf16 v[108:111], a[180:183], a[12:15], v[108:111]
    v_rcp_f32 v212, v212
    v_mfma_f32_16x16x32_bf16 v[108:111], a[184:187], a[4:7], v[108:111]
    ds_read_b128 a[168:171], v6 offset:23552
    s_waitcnt lgkmcnt(3)
    v_mfma_f32_16x16x32_bf16 v[104:107], a[184:187], a[0:3], v[104:107]
    v_rcp_f32 v213, v213
    v_mfma_f32_16x16x32_bf16 v[104:107], a[180:183], a[8:11], v[104:107]
    s_add_u32 m0, s32, 4096
    s_add_u32 s41, s34, 225280
    v_mfma_f32_16x16x32_bf16 v[104:107], a[176:179], a[16:19], v[104:107]
    v_rcp_f32 v214, v214
    v_mfma_f32_16x16x32_bf16 v[112:115], a[144:147], a[136:139], 0
    ds_read_b128 a[176:179], v6 offset:24576
    ds_read_b128 a[180:183], v6 offset:25600
    v_mfma_f32_16x16x32_bf16 v[112:115], a[148:151], a[128:131], v[112:115]
    v_rcp_f32 v215, v215
    v_mfma_f32_16x16x32_bf16 v[112:115], a[152:155], a[120:123], v[112:115]
    ds_read_b128 a[184:187], v6 offset:26624
    s_waitcnt lgkmcnt(3)
    v_mfma_f32_16x16x32_bf16 v[116:119], a[152:155], a[124:127], 0
    v_pk_mul_f32 v[96:97], v[96:97], v[208:209]
    v_pk_mul_f32 v[98:99], v[98:99], v[210:211]
    v_pk_mul_f32 v[100:101], v[100:101], v[212:213]
    v_pk_mul_f32 v[102:103], v[102:103], v[214:215]
    v_pk_add_f32 v[224:225], v[224:225], v[96:97]
    v_pk_fma_f32 v[226:227], v[96:97], v[96:97], v[226:227]
    v_pk_add_f32 v[228:229], v[228:229], v[100:101]
    v_pk_fma_f32 v[230:231], v[100:101], v[100:101], v[230:231]
    v_pk_add_f32 v[224:225], v[224:225], v[98:99]
    v_pk_fma_f32 v[226:227], v[98:99], v[98:99], v[226:227]
    v_pk_add_f32 v[228:229], v[228:229], v[102:103]
    v_pk_fma_f32 v[230:231], v[102:103], v[102:103], v[230:231]
    v_pk_mul_f32 v[200:201], v[104:105], v[104:105]
    v_pk_mul_f32 v[202:203], v[106:107], v[106:107]
    v_pk_mul_f32 v[204:205], v[108:109], v[108:109]
    v_pk_mul_f32 v[206:207], v[110:111], v[110:111]
    v_pk_fma_f32 v[200:201], v[200:201], v[186:187], v[184:185] op_sel:[0,0,0] op_sel_hi:[1,0,0]
    v_pk_fma_f32 v[202:203], v[202:203], v[186:187], v[184:185] op_sel:[0,0,0] op_sel_hi:[1,0,0]
    v_pk_fma_f32 v[204:205], v[204:205], v[186:187], v[184:185] op_sel:[0,1,1] op_sel_hi:[1,1,1]
    v_pk_fma_f32 v[206:207], v[206:207], v[186:187], v[184:185] op_sel:[0,1,1] op_sel_hi:[1,1,1]
    v_pk_mul_f32 v[200:201], v[200:201], v[104:105]
    v_pk_mul_f32 v[202:203], v[202:203], v[106:107]
    v_pk_mul_f32 v[204:205], v[204:205], v[108:109]
    v_pk_mul_f32 v[206:207], v[206:207], v[110:111]
    v_exp_f32 v200, v200
    v_exp_f32 v201, v201
    v_exp_f32 v202, v202
    v_exp_f32 v203, v203
    v_exp_f32 v204, v204
    v_exp_f32 v205, v205
    v_exp_f32 v206, v206
    v_exp_f32 v207, v207
    v_pk_add_f32 v[200:201], v[200:201], 1.0 op_sel_hi:[1,0]
    v_pk_add_f32 v[202:203], v[202:203], 1.0 op_sel_hi:[1,0]
    v_pk_add_f32 v[204:205], v[204:205], 1.0 op_sel_hi:[1,0]
    v_pk_add_f32 v[206:207], v[206:207], 1.0 op_sel_hi:[1,0]
    v_rcp_f32 v200, v200
    v_rcp_f32 v201, v201
    v_rcp_f32 v202, v202
    v_rcp_f32 v203, v203
    v_rcp_f32 v204, v204
    v_rcp_f32 v205, v205
    v_rcp_f32 v206, v206
    v_rcp_f32 v207, v207
    v_pk_mul_f32 v[104:105], v[104:105], v[200:201]
    v_pk_mul_f32 v[106:107], v[106:107], v[202:203]
    v_pk_mul_f32 v[108:109], v[108:109], v[204:205]
    v_pk_mul_f32 v[110:111], v[110:111], v[206:207]
    v_pk_add_f32 v[224:225], v[224:225], v[104:105]
    v_pk_fma_f32 v[226:227], v[104:105], v[104:105], v[226:227]
    v_pk_add_f32 v[228:229], v[228:229], v[108:109]
    v_pk_fma_f32 v[230:231], v[108:109], v[108:109], v[230:231]
    v_pk_add_f32 v[224:225], v[224:225], v[106:107]
    v_pk_fma_f32 v[226:227], v[106:107], v[106:107], v[226:227]
    v_pk_add_f32 v[228:229], v[228:229], v[110:111]
    v_pk_fma_f32 v[230:231], v[110:111], v[110:111], v[230:231]
    v_add_f32 v192, v224, v225
    v_add_f32 v193, v226, v227
    v_add_f32 v194, v228, v229
    v_add_f32 v195, v230, v231
    s_nop 0
    v_permlane32_swap_b32 v192, v194
    v_permlane32_swap_b32 v193, v195
    v_add_f32 v192, v192, v194
    v_add_f32 v193, v193, v195
    v_lshlrev_b32 v208, 4, v2
    v_lshl_add_u32 v209, v3, 2, v208
    v_lshl_add_u32 v208, v3, 15, v208
    v_permlane16_swap_b32 v192, v193
    v_add_f32 v192, v192, v193
    v_or_b32 v192, 1, v192
    s_lshl_b32 s48, s30, 8
    s_add_u32 s48, s48, 18875392
    s_add_u32 s49, s48, s37
    buffer_store_dword v192, v209, s[12:15], s49 offen sc1
    s_lshl_b32 s11, s5, 13
    s_sub_u32 s54, s49, s11
    s_add_u32 s55, s54, 8192
    s_add_u32 s56, s54, 16384
    s_add_u32 s57, s54, 24576
    s_lshl_b32 s53, s3, 12
    s_add_u32 s53, s53, 147456
    v_mfma_f32_16x16x32_bf16 v[116:119], a[148:151], a[132:135], v[116:119]
    buffer_load_dwordx4 off, s[80:83], s41 offset:0 sc1 lds
    v_mul_u32_u24 v213, 320, v3
    v_mfma_f32_16x16x32_bf16 v[116:119], a[144:147], a[140:143], v[116:119]
    v_lshl_add_u32 v213, v2, 3, v213
    v_add_u32 v213, s53, v213
    v_mfma_f32_16x16x32_bf16 v[116:119], a[160:163], a[116:119], v[116:119]
    ds_read_b128 a[144:147], v6 offset:27648
    ds_read_b128 a[148:151], v6 offset:28672
    v_mfma_f32_16x16x32_bf16 v[116:119], a[164:167], a[108:111], v[116:119]
    v_and_b32 v214, 3, v2
    v_mul_u32_u24 v214, 320, v214
    v_mfma_f32_16x16x32_bf16 v[116:119], a[168:171], a[100:103], v[116:119]
    ds_read_b128 a[152:155], v6 offset:29696
    s_waitcnt lgkmcnt(3)
    v_mfma_f32_16x16x32_bf16 v[112:115], a[168:171], a[96:99], v[112:115]
    v_lshl_add_u32 v214, v3, 5, v214
    v_lshrrev_b32 v215, 2, v2
    v_mfma_f32_16x16x32_bf16 v[112:115], a[164:167], a[104:107], v[112:115]
    buffer_load_dwordx4 off, s[80:83], s41 offset:1024 sc1 lds
    v_lshl_add_u32 v214, v215, 3, v214
    v_mfma_f32_16x16x32_bf16 v[112:115], a[160:163], a[112:115], v[112:115]
    v_add_u32 v214, s53, v214
    v_mfma_f32_16x16x32_bf16 v[112:115], a[176:179], a[88:91], v[112:115]
    ds_read_b128 a[160:163], v6 offset:30720
    ds_read_b128 a[164:167], v6 offset:31744
    v_mfma_f32_16x16x32_bf16 v[112:115], a[180:183], a[80:83], v[112:115]
    v_mfma_f32_16x16x32_bf16 v[112:115], a[184:187], a[72:75], v[112:115]
    ds_read_b128 a[168:171], v6 offset:32768
    s_waitcnt lgkmcnt(3)
    v_mfma_f32_16x16x32_bf16 v[116:119], a[184:187], a[76:79], v[116:119]
    v_mfma_f32_16x16x32_bf16 v[116:119], a[180:183], a[84:87], v[116:119]
    buffer_load_dwordx4 off, s[80:83], s41 offset:2048 sc1 lds
    v_mfma_f32_16x16x32_bf16 v[116:119], a[176:179], a[92:95], v[116:119]
    v_mfma_f32_16x16x32_bf16 v[116:119], a[144:147], a[68:71], v[116:119]
    ds_read_b128 a[176:179], v6 offset:33792
    ds_read_b128 a[180:183], v6 offset:34816
    v_mfma_f32_16x16x32_bf16 v[116:119], a[148:151], a[60:63], v[116:119]
    v_mfma_f32_16x16x32_bf16 v[116:119], a[152:155], a[52:55], v[116:119]
    ds_read_b128 a[184:187], v6 offset:35840
    s_waitcnt lgkmcnt(3)
    v_mfma_f32_16x16x32_bf16 v[112:115], a[152:155], a[48:51], v[112:115]
    v_mfma_f32_16x16x32_bf16 v[112:115], a[148:151], a[56:59], v[112:115]
    buffer_load_dwordx4 off, s[80:83], s41 offset:3072 sc1 lds
    v_mfma_f32_16x16x32_bf16 v[112:115], a[144:147], a[64:67], v[112:115]
    v_mfma_f32_16x16x32_bf16 v[112:115], a[160:163], a[40:43], v[112:115]
    s_waitcnt vmcnt(9)
    s_barrier
    v_mfma_f32_16x16x32_bf16 v[112:115], a[164:167], a[32:35], v[112:115]
    ds_read_b128 a[144:147], v7 offset:0
    ds_read_b128 a[148:151], v7 offset:1024
    v_mfma_f32_16x16x32_bf16 v[112:115], a[168:171], a[24:27], v[112:115]
    ds_read_b128 a[152:155], v7 offset:2048
    s_waitcnt lgkmcnt(3)
    v_mfma_f32_16x16x32_bf16 v[116:119], a[168:171], a[28:31], v[116:119]
    v_mfma_f32_16x16x32_bf16 v[116:119], a[164:167], a[36:39], v[116:119]
    s_add_u32 m0, s32, 8192
    s_add_u32 s41, s34, 229376
    v_mfma_f32_16x16x32_bf16 v[116:119], a[160:163], a[44:47], v[116:119]
    v_mfma_f32_16x16x32_bf16 v[116:119], a[176:179], a[20:23], v[116:119]
    ds_read_b128 a[160:163], v7 offset:3072
    ds_read_b128 a[164:167], v7 offset:4096
    v_mfma_f32_16x16x32_bf16 v[116:119], a[180:183], a[12:15], v[116:119]
    v_mfma_f32_16x16x32_bf16 v[116:119], a[184:187], a[4:7], v[116:119]
    ds_read_b128 a[168:171], v7 offset:5120
    s_waitcnt lgkmcnt(3)
    v_mfma_f32_16x16x32_bf16 v[112:115], a[184:187], a[0:3], v[112:115]
    v_mfma_f32_16x16x32_bf16 v[112:115], a[180:183], a[8:11], v[112:115]
    buffer_load_dwordx4 off, s[80:83], s41 offset:0 sc1 lds
    v_mfma_f32_16x16x32_bf16 v[112:115], a[176:179], a[16:19], v[112:115]
    v_mfma_f32_16x16x32_bf16 v[120:123], a[144:147], a[136:139], 0
    ds_read_b128 a[176:179], v7 offset:6144
    ds_read_b128 a[180:183], v7 offset:7168
    v_mfma_f32_16x16x32_bf16 v[120:123], a[148:151], a[128:131], v[120:123]
    v_mfma_f32_16x16x32_bf16 v[120:123], a[152:155], a[120:123], v[120:123]
    ds_read_b128 a[184:187], v7 offset:8192
    s_waitcnt lgkmcnt(3)
    v_mfma_f32_16x16x32_bf16 v[124:127], a[152:155], a[124:127], 0
    v_mul_f32 v232, v112, v112
    v_mul_f32 v233, v113, v113
    v_mfma_f32_16x16x32_bf16 v[124:127], a[148:151], a[132:135], v[124:127]
    s_add_u32 m0, s32, 36864
    s_add_u32 s41, s34, 258048
    v_mfma_f32_16x16x32_bf16 v[124:127], a[144:147], a[140:143], v[124:127]
    v_mul_f32 v234, v114, v114
    v_mul_f32 v235, v115, v115
    v_mfma_f32_16x16x32_bf16 v[124:127], a[160:163], a[116:119], v[124:127]
    ds_read_b128 a[144:147], v7 offset:9216
    ds_read_b128 a[148:151], v7 offset:10240
    v_mfma_f32_16x16x32_bf16 v[124:127], a[164:167], a[108:111], v[124:127]
    buffer_load_dwordx4 v[216:219], v208, s[12:15], s54 offen sc1
    buffer_load_dwordx4 v[220:223], v208, s[12:15], s55 offen sc1
    v_mfma_f32_16x16x32_bf16 v[124:127], a[168:171], a[100:103], v[124:127]
    ds_read_b128 a[152:155], v7 offset:11264
    s_waitcnt lgkmcnt(3)
    v_mfma_f32_16x16x32_bf16 v[120:123], a[168:171], a[96:99], v[120:123]
    buffer_load_dwordx4 v[224:227], v208, s[12:15], s56 offen sc1
    buffer_load_dwordx4 v[228:231], v208, s[12:15], s57 offen sc1
    v_mfma_f32_16x16x32_bf16 v[120:123], a[164:167], a[104:107], v[120:123]
    buffer_load_dwordx4 off, s[80:83], s41 offset:0 sc1 lds
    v_fma_f32 v232, v232, v186, v184
    v_mfma_f32_16x16x32_bf16 v[120:123], a[160:163], a[112:115], v[120:123]
    v_fma_f32 v233, v233, v186, v184
    v_fma_f32 v234, v234, v186, v184
    v_mfma_f32_16x16x32_bf16 v[120:123], a[176:179], a[88:91], v[120:123]
    ds_read_b128 a[160:163], v7 offset:12288
    ds_read_b128 a[164:167], v7 offset:13312
    v_mfma_f32_16x16x32_bf16 v[120:123], a[180:183], a[80:83], v[120:123]
    v_fma_f32 v235, v235, v186, v184
    v_mul_f32 v232, v232, v112
    v_mfma_f32_16x16x32_bf16 v[120:123], a[184:187], a[72:75], v[120:123]
    ds_read_b128 a[168:171], v7 offset:14336
    s_waitcnt lgkmcnt(3)
    v_mfma_f32_16x16x32_bf16 v[124:127], a[184:187], a[76:79], v[124:127]
    v_mul_f32 v233, v233, v113
    v_mul_f32 v234, v234, v114
    v_mfma_f32_16x16x32_bf16 v[124:127], a[180:183], a[84:87], v[124:127]
    buffer_load_dwordx4 off, s[80:83], s41 offset:1024 sc1 lds
    v_mul_f32 v235, v235, v115
    v_mfma_f32_16x16x32_bf16 v[124:127], a[176:179], a[92:95], v[124:127]
    v_exp_f32 v232, v232
    v_mfma_f32_16x16x32_bf16 v[124:127], a[144:147], a[68:71], v[124:127]
    ds_read_b128 a[176:179], v7 offset:15360
    ds_read_b128 a[180:183], v7 offset:16384
    v_mfma_f32_16x16x32_bf16 v[124:127], a[148:151], a[60:63], v[124:127]
    v_exp_f32 v233, v233
    v_mfma_f32_16x16x32_bf16 v[124:127], a[152:155], a[52:55], v[124:127]
    ds_read_b128 a[184:187], v7 offset:17408
    s_waitcnt lgkmcnt(3)
    v_mfma_f32_16x16x32_bf16 v[120:123], a[152:155], a[48:51], v[120:123]
    v_exp_f32 v234, v234
    v_mfma_f32_16x16x32_bf16 v[120:123], a[148:151], a[56:59], v[120:123]
    buffer_load_dwordx4 off, s[80:83], s41 offset:2048 sc1 lds
    v_mfma_f32_16x16x32_bf16 v[120:123], a[144:147], a[64:67], v[120:123]
    v_exp_f32 v235, v235
    v_mfma_f32_16x16x32_bf16 v[120:123], a[160:163], a[40:43], v[120:123]
    ds_read_b128 a[144:147], v7 offset:18432
    ds_read_b128 a[148:151], v7 offset:19456
    v_mfma_f32_16x16x32_bf16 v[120:123], a[164:167], a[32:35], v[120:123]
    v_fma_f32 v232, v232, v188, v188
    v_fma_f32 v233, v233, v188, v188
    v_mfma_f32_16x16x32_bf16 v[120:123], a[168:171], a[24:27], v[120:123]
    ds_read_b128 a[152:155], v7 offset:20480
    s_waitcnt lgkmcnt(3)
    v_mfma_f32_16x16x32_bf16 v[124:127], a[168:171], a[28:31], v[124:127]
    v_fma_f32 v234, v234, v188, v188
    v_fma_f32 v235, v235, v188, v188
    v_mfma_f32_16x16x32_bf16 v[124:127], a[164:167], a[36:39], v[124:127]
    buffer_load_dwordx4 off, s[80:83], s41 offset:3072 sc1 lds
    v_mfma_f32_16x16x32_bf16 v[124:127], a[160:163], a[44:47], v[124:127]
    v_rcp_f32 v232, v232
    v_mfma_f32_16x16x32_bf16 v[124:127], a[176:179], a[20:23], v[124:127]
    ds_read_b128 a[160:163], v7 offset:21504
    ds_read_b128 a[164:167], v7 offset:22528
    v_mfma_f32_16x16x32_bf16 v[124:127], a[180:183], a[12:15], v[124:127]
    v_rcp_f32 v233, v233
    v_mfma_f32_16x16x32_bf16 v[124:127], a[184:187], a[4:7], v[124:127]
    ds_read_b128 a[168:171], v7 offset:23552
    s_waitcnt lgkmcnt(3)
    v_mfma_f32_16x16x32_bf16 v[120:123], a[184:187], a[0:3], v[120:123]
    v_rcp_f32 v234, v234
    v_mfma_f32_16x16x32_bf16 v[120:123], a[180:183], a[8:11], v[120:123]
    s_add_u32 m0, s32, 40960
    s_add_u32 s41, s34, 262144
    v_mfma_f32_16x16x32_bf16 v[120:123], a[176:179], a[16:19], v[120:123]
    v_rcp_f32 v235, v235
    v_mfma_f32_16x16x32_bf16 v[128:131], a[144:147], a[136:139], 0
    ds_read_b128 a[176:179], v7 offset:24576
    ds_read_b128 a[180:183], v7 offset:25600
    v_mfma_f32_16x16x32_bf16 v[128:131], a[148:151], a[128:131], v[128:131]
    v_mul_f32 v112, v112, v232
    v_mul_f32 v113, v113, v233
    v_mfma_f32_16x16x32_bf16 v[128:131], a[152:155], a[120:123], v[128:131]
    ds_read_b128 a[184:187], v7 offset:26624
    s_waitcnt lgkmcnt(3)
    v_mfma_f32_16x16x32_bf16 v[132:135], a[152:155], a[124:127], 0
    v_mul_f32 v114, v114, v234
    v_mul_f32 v115, v115, v235
    v_mfma_f32_16x16x32_bf16 v[132:135], a[148:151], a[132:135], v[132:135]
    buffer_load_dwordx4 off, s[80:83], s41 offset:0 sc1 lds
    v_mul_f32 v236, v116, v116
    v_mfma_f32_16x16x32_bf16 v[132:135], a[144:147], a[140:143], v[132:135]
    s_waitcnt vmcnt(5)
    v_and_b32 v210, v216, v217
    v_bitop3_b32 v210, v210, v218, v219 bitop3:0x80
    v_bitop3_b32 v210, v210, v220, v221 bitop3:0x80
    v_bitop3_b32 v210, v210, v222, v223 bitop3:0x80
    v_bitop3_b32 v210, v210, v224, v225 bitop3:0x80
    v_bitop3_b32 v210, v210, v226, v227 bitop3:0x80
    v_bitop3_b32 v210, v210, v228, v229 bitop3:0x80
    v_bitop3_b32 v210, v210, v230, v231 bitop3:0x80
    v_and_b32 v210, 1, v210
    v_cmp_eq_u32 vcc, 0, v210
    s_nop 3
    s_cbranch_vccz L_interleave_layers__spectral_fnet__mixer_gmlp__prompt_kernel_21
    s_mov_b32 s40, 0
L_interleave_layers__spectral_fnet__mixer_gmlp__prompt_kernel_23:
    buffer_load_dwordx4 v[216:219], v208, s[12:15], s54 offen sc1
    buffer_load_dwordx4 v[220:223], v208, s[12:15], s55 offen sc1
    buffer_load_dwordx4 v[224:227], v208, s[12:15], s56 offen sc1
    buffer_load_dwordx4 v[228:231], v208, s[12:15], s57 offen sc1
    s_add_u32 s40, s40, 1
    s_cmp_gt_u32 s40, 2000000
    s_cbranch_scc1 L_interleave_layers__spectral_fnet__mixer_gmlp__prompt_kernel_22
    s_waitcnt vmcnt(0)
    v_and_b32 v210, v216, v217
    v_bitop3_b32 v210, v210, v218, v219 bitop3:0x80
    v_bitop3_b32 v210, v210, v220, v221 bitop3:0x80
    v_bitop3_b32 v210, v210, v222, v223 bitop3:0x80
    v_bitop3_b32 v210, v210, v224, v225 bitop3:0x80
    v_bitop3_b32 v210, v210, v226, v227 bitop3:0x80
    v_bitop3_b32 v210, v210, v228, v229 bitop3:0x80
    v_bitop3_b32 v210, v210, v230, v231 bitop3:0x80
    v_and_b32 v210, 1, v210
    v_cmp_eq_u32 vcc, 0, v210
    s_nop 3
    s_cbranch_vccnz L_interleave_layers__spectral_fnet__mixer_gmlp__prompt_kernel_23
    s_mov_b64 exec, -1
L_interleave_layers__spectral_fnet__mixer_gmlp__prompt_kernel_21:
    v_add_f32 v216, v216, v220
    v_add_f32 v224, v224, v228
    v_add_f32 v217, v217, v221
    v_add_f32 v225, v225, v229
    v_add_f32 v218, v218, v222
    v_add_f32 v226, v226, v230
    v_add_f32 v219, v219, v223
    v_add_f32 v227, v227, v231
    v_add_f32 v216, v216, v224
    v_add_f32 v217, v217, v225
    v_add_f32 v218, v218, v226
    v_add_f32 v219, v219, v227
    v_permlane32_swap_b32 v216, v217
    v_add_f32 v216, v216, v217
    v_mov_b32 v217, v216
    s_nop 1
    v_permlane16_swap_b32 v216, v217
    v_add_f32 v216, v216, v217
    v_mov_b32 v217, v216
    s_nop 1
    v_permlane32_swap_b32 v216, v217
    v_permlane32_swap_b32 v218, v219
    v_add_f32 v218, v218, v219
    v_mov_b32 v219, v218
    s_nop 1
    v_permlane16_swap_b32 v218, v219
    v_add_f32 v218, v218, v219
    v_mov_b32 v219, v218
    s_nop 1
    v_permlane32_swap_b32 v218, v219
    v_mul_f32 v216, 0x39e38e39, v216
    v_mul_f32 v217, 0x39e38e39, v217
    v_mul_f32 v218, 0x39e38e39, v218
    v_mul_f32 v219, 0x39e38e39, v219
    v_fma_f32 v217, -v216, v216, v217
    v_fma_f32 v219, -v218, v218, v219
    v_max_f32 v217, 0, v217
    v_max_f32 v219, 0, v219
    v_add_f32 v217, v217, v190
    v_add_f32 v219, v219, v191
    v_rsq_f32 v196, v217
    v_rsq_f32 v197, v219
    s_mul_i32 s49, s4, 36864
    s_add_u32 s49, s49, s35
    v_mul_f32 v198, v216, v196
    v_mul_f32 v199, v218, v197
    v_fma_f32 v40, v40, v196, -v198
    v_fma_f32 v41, v41, v196, -v198
    v_fma_f32 v42, v42, v196, -v198
    v_fma_f32 v43, v43, v196, -v198
    v_fma_f32 v44, v44, v197, -v199
    v_fma_f32 v45, v45, v197, -v199
    v_fma_f32 v46, v46, v197, -v199
    v_fma_f32 v47, v47, v197, -v199
    v_cvt_pk_bf16_f32 v200, v40, v41
    v_cvt_pk_bf16_f32 v201, v42, v43
    ds_write_b64 v213, v[200:201] offset:0
    v_cvt_pk_bf16_f32 v202, v44, v45
    v_cvt_pk_bf16_f32 v203, v46, v47
    ds_write_b64 v213, v[202:203] offset:128
    ds_read_b64_tr_b16 v[40:41], v214 offset:0
    ds_read_b64_tr_b16 v[42:43], v214 offset:128
    v_fma_f32 v48, v48, v196, -v198
    v_fma_f32 v49, v49, v196, -v198
    v_mfma_f32_16x16x32_bf16 v[132:135], a[160:163], a[116:119], v[132:135]
    ds_read_b128 a[144:147], v7 offset:27648
    ds_read_b128 a[148:151], v7 offset:28672
    v_mfma_f32_16x16x32_bf16 v[132:135], a[164:167], a[108:111], v[132:135]
    v_fma_f32 v50, v50, v196, -v198
    v_fma_f32 v51, v51, v196, -v198
    v_mfma_f32_16x16x32_bf16 v[132:135], a[168:171], a[100:103], v[132:135]
    ds_read_b128 a[152:155], v7 offset:29696
    s_waitcnt lgkmcnt(7)
    v_mfma_f32_16x16x32_bf16 v[128:131], a[168:171], a[96:99], v[128:131]
    v_fma_f32 v52, v52, v197, -v199
    v_fma_f32 v53, v53, v197, -v199
    v_fma_f32 v54, v54, v197, -v199
    v_mfma_f32_16x16x32_bf16 v[128:131], a[164:167], a[104:107], v[128:131]
    buffer_load_dwordx4 off, s[80:83], s41 offset:1024 sc1 lds
    v_fma_f32 v55, v55, v197, -v199
    v_mfma_f32_16x16x32_bf16 v[128:131], a[160:163], a[112:115], v[128:131]
    v_cvt_pk_bf16_f32 v204, v48, v49
    v_cvt_pk_bf16_f32 v205, v50, v51
    v_mfma_f32_16x16x32_bf16 v[128:131], a[176:179], a[88:91], v[128:131]
    ds_read_b128 a[160:163], v7 offset:30720
    ds_read_b128 a[164:167], v7 offset:31744
    ds_write_b64 v213, v[204:205] offset:1280
    v_mfma_f32_16x16x32_bf16 v[128:131], a[180:183], a[80:83], v[128:131]
    v_cvt_pk_bf16_f32 v206, v52, v53
    v_cvt_pk_bf16_f32 v207, v54, v55
    v_mfma_f32_16x16x32_bf16 v[128:131], a[184:187], a[72:75], v[128:131]
    ds_read_b128 a[168:171], v7 offset:32768
    s_waitcnt lgkmcnt(4)
    v_mfma_f32_16x16x32_bf16 v[132:135], a[184:187], a[76:79], v[132:135]
    ds_write_b64 v213, v[206:207] offset:1408
    ds_read_b64_tr_b16 v[48:49], v214 offset:1280
    ds_read_b64_tr_b16 v[50:51], v214 offset:1408
    v_mfma_f32_16x16x32_bf16 v[132:135], a[180:183], a[84:87], v[132:135]
    buffer_load_dwordx4 off, s[80:83], s41 offset:2048 sc1 lds
    buffer_store_dwordx4 v[40:43], off, s[80:83], s49 offset:0 sc1
    v_mfma_f32_16x16x32_bf16 v[132:135], a[176:179], a[92:95], v[132:135]
    v_fma_f32 v56, v56, v196, -v198
    v_fma_f32 v57, v57, v196, -v198
    v_mfma_f32_16x16x32_bf16 v[132:135], a[144:147], a[68:71], v[132:135]
    ds_read_b128 a[176:179], v7 offset:33792
    ds_read_b128 a[180:183], v7 offset:34816
    v_mfma_f32_16x16x32_bf16 v[132:135], a[148:151], a[60:63], v[132:135]
    v_fma_f32 v58, v58, v196, -v198
    v_fma_f32 v59, v59, v196, -v198
    v_fma_f32 v60, v60, v197, -v199
    v_mfma_f32_16x16x32_bf16 v[132:135], a[152:155], a[52:55], v[132:135]
    ds_read_b128 a[184:187], v7 offset:35840
    s_waitcnt lgkmcnt(6)
    v_mfma_f32_16x16x32_bf16 v[128:131], a[152:155], a[48:51], v[128:131]
    v_fma_f32 v61, v61, v197, -v199
    v_fma_f32 v62, v62, v197, -v199
    v_mfma_f32_16x16x32_bf16 v[128:131], a[148:151], a[56:59], v[128:131]
    buffer_load_dwordx4 off, s[80:83], s41 offset:3072 sc1 lds
    v_fma_f32 v63, v63, v197, -v199
    v_cvt_pk_bf16_f32 v200, v56, v57
    v_mfma_f32_16x16x32_bf16 v[128:131], a[144:147], a[64:67], v[128:131]
    v_cvt_pk_bf16_f32 v201, v58, v59
    ds_write_b64 v213, v[200:201] offset:2560
    v_mfma_f32_16x16x32_bf16 v[128:131], a[160:163], a[40:43], v[128:131]
    s_barrier
    v_cvt_pk_bf16_f32 v202, v60, v61
    v_mfma_f32_16x16x32_bf16 v[128:131], a[164:167], a[32:35], v[128:131]
    ds_read_b128 a[144:147], v4 offset:0
    ds_read_b128 a[148:151], v4 offset:1024
    v_cvt_pk_bf16_f32 v203, v62, v63
    v_mfma_f32_16x16x32_bf16 v[128:131], a[168:171], a[24:27], v[128:131]
    ds_read_b128 a[152:155], v4 offset:2048
    s_waitcnt lgkmcnt(4)
    v_mfma_f32_16x16x32_bf16 v[132:135], a[168:171], a[28:31], v[132:135]
    ds_write_b64 v213, v[202:203] offset:2688
    ds_read_b64_tr_b16 v[56:57], v214 offset:2560
    v_mfma_f32_16x16x32_bf16 v[132:135], a[164:167], a[36:39], v[132:135]
    s_add_u32 m0, s32, 45056
    s_add_u32 s41, s34, 266240
    v_mfma_f32_16x16x32_bf16 v[132:135], a[160:163], a[44:47], v[132:135]
    ds_read_b64_tr_b16 v[58:59], v214 offset:2688
    buffer_store_dwordx4 v[48:51], off, s[80:83], s49 offset:1024 sc1
    v_fma_f32 v64, v64, v196, -v198
    v_mfma_f32_16x16x32_bf16 v[132:135], a[176:179], a[20:23], v[132:135]
    ds_read_b128 a[160:163], v4 offset:3072
    ds_read_b128 a[164:167], v4 offset:4096
    v_mfma_f32_16x16x32_bf16 v[132:135], a[180:183], a[12:15], v[132:135]
    v_fma_f32 v65, v65, v196, -v198
    v_fma_f32 v66, v66, v196, -v198
    v_mfma_f32_16x16x32_bf16 v[132:135], a[184:187], a[4:7], v[132:135]
    ds_read_b128 a[168:171], v4 offset:5120
    s_waitcnt lgkmcnt(6)
    v_fma_f32 v67, v67, v196, -v198
    v_mfma_f32_16x16x32_bf16 v[128:131], a[184:187], a[0:3], v[128:131]
    v_fma_f32 v68, v68, v197, -v199
    v_fma_f32 v69, v69, v197, -v199
    v_mfma_f32_16x16x32_bf16 v[128:131], a[180:183], a[8:11], v[128:131]
    buffer_load_dwordx4 off, s[80:83], s41 offset:0 sc1 lds
    v_fma_f32 v70, v70, v197, -v199
    v_mfma_f32_16x16x32_bf16 v[128:131], a[176:179], a[16:19], v[128:131]
    v_fma_f32 v71, v71, v197, -v199
    v_cvt_pk_bf16_f32 v204, v64, v65
    v_cvt_pk_bf16_f32 v205, v66, v67
    v_mfma_f32_16x16x32_bf16 v[136:139], a[144:147], a[136:139], 0
    ds_read_b128 a[176:179], v4 offset:6144
    ds_read_b128 a[180:183], v4 offset:7168
    v_mfma_f32_16x16x32_bf16 v[136:139], a[148:151], a[128:131], v[136:139]
    ds_write_b64 v213, v[204:205] offset:0
    v_cvt_pk_bf16_f32 v206, v68, v69
    v_mfma_f32_16x16x32_bf16 v[136:139], a[152:155], a[120:123], v[136:139]
    ds_read_b128 a[184:187], v4 offset:8192
    s_waitcnt lgkmcnt(4)
    v_mfma_f32_16x16x32_bf16 v[140:143], a[152:155], a[124:127], 0
    v_cvt_pk_bf16_f32 v207, v70, v71
    ds_write_b64 v213, v[206:207] offset:128
    ds_read_b64_tr_b16 v[64:65], v214 offset:0
    v_mfma_f32_16x16x32_bf16 v[140:143], a[148:151], a[132:135], v[140:143]
    s_add_u32 m0, s32, 73728
    s_add_u32 s41, s34, 294912
    v_mfma_f32_16x16x32_bf16 v[140:143], a[144:147], a[140:143], v[140:143]
    ds_read_b64_tr_b16 v[66:67], v214 offset:128
    buffer_store_dwordx4 v[56:59], off, s[80:83], s49 offset:2048 sc1
    v_mfma_f32_16x16x32_bf16 v[140:143], a[160:163], a[116:119], v[140:143]
    ds_read_b128 a[144:147], v4 offset:9216
    ds_read_b128 a[148:151], v4 offset:10240
    v_fma_f32 v72, v72, v196, -v198
    v_mfma_f32_16x16x32_bf16 v[140:143], a[164:167], a[108:111], v[140:143]
    v_fma_f32 v73, v73, v196, -v198
    v_fma_f32 v74, v74, v196, -v198
    v_mfma_f32_16x16x32_bf16 v[140:143], a[168:171], a[100:103], v[140:143]
    ds_read_b128 a[152:155], v4 offset:11264
    s_waitcnt lgkmcnt(6)
    v_mfma_f32_16x16x32_bf16 v[136:139], a[168:171], a[96:99], v[136:139]
    v_fma_f32 v75, v75, v196, -v198
    v_fma_f32 v76, v76, v197, -v199
    v_fma_f32 v77, v77, v197, -v199
    v_mfma_f32_16x16x32_bf16 v[136:139], a[164:167], a[104:107], v[136:139]
    buffer_load_dwordx4 off, s[80:83], s41 offset:0 sc1 lds
    v_fma_f32 v78, v78, v197, -v199
    v_mfma_f32_16x16x32_bf16 v[136:139], a[160:163], a[112:115], v[136:139]
    v_fma_f32 v79, v79, v197, -v199
    v_cvt_pk_bf16_f32 v200, v72, v73
    v_mfma_f32_16x16x32_bf16 v[136:139], a[176:179], a[88:91], v[136:139]
    ds_read_b128 a[160:163], v4 offset:12288
    ds_read_b128 a[164:167], v4 offset:13312
    v_mfma_f32_16x16x32_bf16 v[136:139], a[180:183], a[80:83], v[136:139]
    v_cvt_pk_bf16_f32 v201, v74, v75
    ds_write_b64 v213, v[200:201] offset:1280
    v_cvt_pk_bf16_f32 v202, v76, v77
    v_mfma_f32_16x16x32_bf16 v[136:139], a[184:187], a[72:75], v[136:139]
    ds_read_b128 a[168:171], v4 offset:14336
    s_waitcnt lgkmcnt(4)
    v_mfma_f32_16x16x32_bf16 v[140:143], a[184:187], a[76:79], v[140:143]
    v_cvt_pk_bf16_f32 v203, v78, v79
    ds_write_b64 v213, v[202:203] offset:1408
    v_mfma_f32_16x16x32_bf16 v[140:143], a[180:183], a[84:87], v[140:143]
    buffer_load_dwordx4 off, s[80:83], s41 offset:1024 sc1 lds
    ds_read_b64_tr_b16 v[72:73], v214 offset:1280
    ds_read_b64_tr_b16 v[74:75], v214 offset:1408
    v_mfma_f32_16x16x32_bf16 v[140:143], a[176:179], a[92:95], v[140:143]
    buffer_store_dwordx4 v[64:67], off, s[80:83], s49 offset:3072 sc1
    v_fma_f32 v80, v80, v196, -v198
    v_mfma_f32_16x16x32_bf16 v[140:143], a[144:147], a[68:71], v[140:143]
    ds_read_b128 a[176:179], v4 offset:15360
    ds_read_b128 a[180:183], v4 offset:16384
    v_mfma_f32_16x16x32_bf16 v[140:143], a[148:151], a[60:63], v[140:143]
    v_fma_f32 v81, v81, v196, -v198
    v_fma_f32 v82, v82, v196, -v198
    v_fma_f32 v83, v83, v196, -v198
    v_mfma_f32_16x16x32_bf16 v[140:143], a[152:155], a[52:55], v[140:143]
    ds_read_b128 a[184:187], v4 offset:17408
    s_waitcnt lgkmcnt(6)
    v_mfma_f32_16x16x32_bf16 v[136:139], a[152:155], a[48:51], v[136:139]
    v_fma_f32 v84, v84, v197, -v199
    v_fma_f32 v85, v85, v197, -v199
    v_mfma_f32_16x16x32_bf16 v[136:139], a[148:151], a[56:59], v[136:139]
    buffer_load_dwordx4 off, s[80:83], s41 offset:2048 sc1 lds
    v_fma_f32 v86, v86, v197, -v199
    v_mfma_f32_16x16x32_bf16 v[136:139], a[144:147], a[64:67], v[136:139]
    v_fma_f32 v87, v87, v197, -v199
    v_cvt_pk_bf16_f32 v204, v80, v81
    v_cvt_pk_bf16_f32 v205, v82, v83
    v_mfma_f32_16x16x32_bf16 v[136:139], a[160:163], a[40:43], v[136:139]
    ds_read_b128 a[144:147], v4 offset:18432
    ds_read_b128 a[148:151], v4 offset:19456
    v_mfma_f32_16x16x32_bf16 v[136:139], a[164:167], a[32:35], v[136:139]
    ds_write_b64 v213, v[204:205] offset:2560
    v_cvt_pk_bf16_f32 v206, v84, v85
    v_mfma_f32_16x16x32_bf16 v[136:139], a[168:171], a[24:27], v[136:139]
    ds_read_b128 a[152:155], v4 offset:20480
    s_waitcnt lgkmcnt(4)
    v_cvt_pk_bf16_f32 v207, v86, v87
    v_mfma_f32_16x16x32_bf16 v[140:143], a[168:171], a[28:31], v[140:143]
    ds_write_b64 v213, v[206:207] offset:2688
    ds_read_b64_tr_b16 v[80:81], v214 offset:2560
    v_mfma_f32_16x16x32_bf16 v[140:143], a[164:167], a[36:39], v[140:143]
    buffer_load_dwordx4 off, s[80:83], s41 offset:3072 sc1 lds
    ds_read_b64_tr_b16 v[82:83], v214 offset:2688
    v_mfma_f32_16x16x32_bf16 v[140:143], a[160:163], a[44:47], v[140:143]
    s_add_u32 s49, s49, 4096
    buffer_store_dwordx4 v[72:75], off, s[80:83], s49 offset:0 sc1
    v_fma_f32 v88, v88, v196, -v198
    v_mfma_f32_16x16x32_bf16 v[140:143], a[176:179], a[20:23], v[140:143]
    ds_read_b128 a[160:163], v4 offset:21504
    ds_read_b128 a[164:167], v4 offset:22528
    v_mfma_f32_16x16x32_bf16 v[140:143], a[180:183], a[12:15], v[140:143]
    v_fma_f32 v89, v89, v196, -v198
    v_fma_f32 v90, v90, v196, -v198
    v_mfma_f32_16x16x32_bf16 v[140:143], a[184:187], a[4:7], v[140:143]
    ds_read_b128 a[168:171], v4 offset:23552
    s_waitcnt lgkmcnt(6)
    v_mfma_f32_16x16x32_bf16 v[136:139], a[184:187], a[0:3], v[136:139]
    v_fma_f32 v91, v91, v196, -v198
    v_fma_f32 v92, v92, v197, -v199
    v_fma_f32 v93, v93, v197, -v199
    v_mfma_f32_16x16x32_bf16 v[136:139], a[180:183], a[8:11], v[136:139]
    s_add_u32 m0, s32, 77824
    s_add_u32 s41, s34, 299008
    v_mfma_f32_16x16x32_bf16 v[136:139], a[176:179], a[16:19], v[136:139]
    v_fma_f32 v94, v94, v197, -v199
    v_fma_f32 v95, v95, v197, -v199
    v_mfma_f32_16x16x32_bf16 v[144:147], a[144:147], a[136:139], 0
    ds_read_b128 a[176:179], v4 offset:24576
    ds_read_b128 a[180:183], v4 offset:25600
    v_cvt_pk_bf16_f32 v200, v88, v89
    v_mfma_f32_16x16x32_bf16 v[144:147], a[148:151], a[128:131], v[144:147]
    v_cvt_pk_bf16_f32 v201, v90, v91
    ds_write_b64 v213, v[200:201] offset:0
    v_mfma_f32_16x16x32_bf16 v[144:147], a[152:155], a[120:123], v[144:147]
    ds_read_b128 a[184:187], v4 offset:26624
    s_waitcnt lgkmcnt(4)
    v_mfma_f32_16x16x32_bf16 v[148:151], a[152:155], a[124:127], 0
    v_cvt_pk_bf16_f32 v202, v92, v93
    v_cvt_pk_bf16_f32 v203, v94, v95
    ds_write_b64 v213, v[202:203] offset:128
    v_mfma_f32_16x16x32_bf16 v[148:151], a[148:151], a[132:135], v[148:151]
    buffer_load_dwordx4 off, s[80:83], s41 offset:0 sc1 lds
    ds_read_b64_tr_b16 v[88:89], v214 offset:0
    v_mfma_f32_16x16x32_bf16 v[148:151], a[144:147], a[140:143], v[148:151]
    ds_read_b64_tr_b16 v[90:91], v214 offset:128
    buffer_store_dwordx4 v[80:83], off, s[80:83], s49 offset:1024 sc1
    v_mfma_f32_16x16x32_bf16 v[148:151], a[160:163], a[116:119], v[148:151]
    ds_read_b128 a[144:147], v4 offset:27648
    ds_read_b128 a[148:151], v4 offset:28672
    v_mfma_f32_16x16x32_bf16 v[148:151], a[164:167], a[108:111], v[148:151]
    v_fma_f32 v96, v96, v196, -v198
    v_fma_f32 v97, v97, v196, -v198
    v_fma_f32 v98, v98, v196, -v198
    v_mfma_f32_16x16x32_bf16 v[148:151], a[168:171], a[100:103], v[148:151]
    ds_read_b128 a[152:155], v4 offset:29696
    s_waitcnt lgkmcnt(6)
    v_mfma_f32_16x16x32_bf16 v[144:147], a[168:171], a[96:99], v[144:147]
    v_fma_f32 v99, v99, v196, -v198
    v_fma_f32 v100, v100, v197, -v199
    v_mfma_f32_16x16x32_bf16 v[144:147], a[164:167], a[104:107], v[144:147]
    buffer_load_dwordx4 off, s[80:83], s41 offset:1024 sc1 lds
    v_fma_f32 v101, v101, v197, -v199
    v_fma_f32 v102, v102, v197, -v199
    v_mfma_f32_16x16x32_bf16 v[144:147], a[160:163], a[112:115], v[144:147]
    v_fma_f32 v103, v103, v197, -v199
    v_cvt_pk_bf16_f32 v204, v96, v97
    v_mfma_f32_16x16x32_bf16 v[144:147], a[176:179], a[88:91], v[144:147]
    ds_read_b128 a[160:163], v4 offset:30720
    ds_read_b128 a[164:167], v4 offset:31744
    v_mfma_f32_16x16x32_bf16 v[144:147], a[180:183], a[80:83], v[144:147]
    v_cvt_pk_bf16_f32 v205, v98, v99
    ds_write_b64 v213, v[204:205] offset:1280
    v_cvt_pk_bf16_f32 v206, v100, v101
    v_mfma_f32_16x16x32_bf16 v[144:147], a[184:187], a[72:75], v[144:147]
    ds_read_b128 a[168:171], v4 offset:32768
    s_waitcnt lgkmcnt(4)
    v_mfma_f32_16x16x32_bf16 v[148:151], a[184:187], a[76:79], v[148:151]
    v_cvt_pk_bf16_f32 v207, v102, v103
    ds_write_b64 v213, v[206:207] offset:1408
    v_mfma_f32_16x16x32_bf16 v[148:151], a[180:183], a[84:87], v[148:151]
    buffer_load_dwordx4 off, s[80:83], s41 offset:2048 sc1 lds
    ds_read_b64_tr_b16 v[96:97], v214 offset:1280
    v_mfma_f32_16x16x32_bf16 v[148:151], a[176:179], a[92:95], v[148:151]
    ds_read_b64_tr_b16 v[98:99], v214 offset:1408
    buffer_store_dwordx4 v[88:91], off, s[80:83], s49 offset:2048 sc1
    v_fma_f32 v104, v104, v196, -v198
    v_mfma_f32_16x16x32_bf16 v[148:151], a[144:147], a[68:71], v[148:151]
    ds_read_b128 a[176:179], v4 offset:33792
    ds_read_b128 a[180:183], v4 offset:34816
    v_mfma_f32_16x16x32_bf16 v[148:151], a[148:151], a[60:63], v[148:151]
    v_fma_f32 v105, v105, v196, -v198
    v_fma_f32 v106, v106, v196, -v198
    v_mfma_f32_16x16x32_bf16 v[148:151], a[152:155], a[52:55], v[148:151]
    ds_read_b128 a[184:187], v4 offset:35840
    s_waitcnt lgkmcnt(6)
    v_fma_f32 v107, v107, v196, -v198
    v_mfma_f32_16x16x32_bf16 v[144:147], a[152:155], a[48:51], v[144:147]
    v_fma_f32 v108, v108, v197, -v199
    v_fma_f32 v109, v109, v197, -v199
    v_mfma_f32_16x16x32_bf16 v[144:147], a[148:151], a[56:59], v[144:147]
    buffer_load_dwordx4 off, s[80:83], s41 offset:3072 sc1 lds
    v_fma_f32 v110, v110, v197, -v199
    v_mfma_f32_16x16x32_bf16 v[144:147], a[144:147], a[64:67], v[144:147]
    v_fma_f32 v111, v111, v197, -v199
    v_cvt_pk_bf16_f32 v200, v104, v105
    v_cvt_pk_bf16_f32 v201, v106, v107
    v_mfma_f32_16x16x32_bf16 v[144:147], a[160:163], a[40:43], v[144:147]
    s_waitcnt vmcnt(13)
    s_barrier
    v_mfma_f32_16x16x32_bf16 v[144:147], a[164:167], a[32:35], v[144:147]
    ds_read_b128 a[144:147], v5 offset:0
    ds_read_b128 a[148:151], v5 offset:1024
    v_mfma_f32_16x16x32_bf16 v[144:147], a[168:171], a[24:27], v[144:147]
    ds_read_b128 a[152:155], v5 offset:2048
    s_waitcnt lgkmcnt(3)
    v_mfma_f32_16x16x32_bf16 v[148:151], a[168:171], a[28:31], v[148:151]
    ds_write_b64 v213, v[200:201] offset:2560
    v_cvt_pk_bf16_f32 v202, v108, v109
    v_cvt_pk_bf16_f32 v203, v110, v111
    v_mfma_f32_16x16x32_bf16 v[148:151], a[164:167], a[36:39], v[148:151]
    s_add_u32 m0, s32, 81920
    s_add_u32 s41, s34, 303104
    v_mfma_f32_16x16x32_bf16 v[148:151], a[160:163], a[44:47], v[148:151]
    ds_write_b64 v213, v[202:203] offset:2688
    ds_read_b64_tr_b16 v[104:105], v214 offset:2560
    v_mfma_f32_16x16x32_bf16 v[148:151], a[176:179], a[20:23], v[148:151]
    ds_read_b128 a[160:163], v5 offset:3072
    ds_read_b128 a[164:167], v5 offset:4096
    ds_read_b64_tr_b16 v[106:107], v214 offset:2688
    v_mfma_f32_16x16x32_bf16 v[148:151], a[180:183], a[12:15], v[148:151]
    buffer_store_dwordx4 v[96:99], off, s[80:83], s49 offset:3072 sc1
    v_mul_f32 v237, v117, v117
    v_mfma_f32_16x16x32_bf16 v[148:151], a[184:187], a[4:7], v[148:151]
    ds_read_b128 a[168:171], v5 offset:5120
    s_waitcnt lgkmcnt(7)
    v_mfma_f32_16x16x32_bf16 v[144:147], a[184:187], a[0:3], v[144:147]
    v_mul_f32 v238, v118, v118
    v_mul_f32 v239, v119, v119
    v_mfma_f32_16x16x32_bf16 v[144:147], a[180:183], a[8:11], v[144:147]
    buffer_load_dwordx4 off, s[80:83], s41 offset:0 sc1 lds
    v_fma_f32 v236, v236, v187, v185
    v_mfma_f32_16x16x32_bf16 v[144:147], a[176:179], a[16:19], v[144:147]
    v_fma_f32 v237, v237, v187, v185
    v_fma_f32 v238, v238, v187, v185
    v_mfma_f32_16x16x32_bf16 v[152:155], a[144:147], a[136:139], 0
    ds_read_b128 a[176:179], v5 offset:6144
    ds_read_b128 a[180:183], v5 offset:7168
    v_mfma_f32_16x16x32_bf16 v[152:155], a[148:151], a[128:131], v[152:155]
    v_fma_f32 v239, v239, v187, v185
    v_mul_f32 v236, v236, v116
    v_mfma_f32_16x16x32_bf16 v[152:155], a[152:155], a[120:123], v[152:155]
    ds_read_b128 a[184:187], v5 offset:8192
    s_waitcnt lgkmcnt(3)
    v_mfma_f32_16x16x32_bf16 v[156:159], a[152:155], a[124:127], 0
    s_add_u32 s49, s49, 4096
    buffer_store_dwordx4 v[104:107], off, s[80:83], s49 offset:0 sc1
    s_lshl_b32 s93, s4, 13
    s_add_u32 s93, s93, s36
    s_add_u32 s91, s35, 36864
    s_add_u32 s90, s36, 8192
    v_mfma_f32_16x16x32_bf16 v[156:159], a[148:151], a[132:135], v[156:159]
    s_add_u32 s50, s93, 0
    buffer_load_dwordx4 a[192:195], off, s[80:83], s50 offset:0 sc1
    v_mfma_f32_16x16x32_bf16 v[156:159], a[144:147], a[140:143], v[156:159]
    v_add_u32 v212, s32, v7
    v_mul_f32 v237, v237, v117
    v_mfma_f32_16x16x32_bf16 v[156:159], a[160:163], a[116:119], v[156:159]
    ds_read_b128 a[144:147], v5 offset:9216
    ds_read_b128 a[148:151], v5 offset:10240
    v_mfma_f32_16x16x32_bf16 v[156:159], a[164:167], a[108:111], v[156:159]
    ds_write_b128 v212, v[40:43] offset:0
    v_mfma_f32_16x16x32_bf16 v[156:159], a[168:171], a[100:103], v[156:159]
    ds_read_b128 a[152:155], v5 offset:11264
    s_waitcnt lgkmcnt(4)
    v_mfma_f32_16x16x32_bf16 v[152:155], a[168:171], a[96:99], v[152:155]
    buffer_load_dwordx4 a[196:199], off, s[80:83], s50 offset:1024 sc1
    v_mul_f32 v238, v238, v118
    v_mfma_f32_16x16x32_bf16 v[152:155], a[164:167], a[104:107], v[152:155]
    v_mul_f32 v239, v239, v119
    v_mfma_f32_16x16x32_bf16 v[152:155], a[160:163], a[112:115], v[152:155]
    v_exp_f32 v236, v236
    v_mfma_f32_16x16x32_bf16 v[152:155], a[176:179], a[88:91], v[152:155]
    ds_read_b128 a[160:163], v5 offset:12288
    ds_read_b128 a[164:167], v5 offset:13312
    v_mfma_f32_16x16x32_bf16 v[152:155], a[180:183], a[80:83], v[152:155]
    buffer_load_dwordx4 a[200:203], off, s[80:83], s50 offset:2048 sc1
    v_mfma_f32_16x16x32_bf16 v[152:155], a[184:187], a[72:75], v[152:155]
    ds_read_b128 a[168:171], v5 offset:14336
    s_waitcnt lgkmcnt(3)
    v_mfma_f32_16x16x32_bf16 v[156:159], a[184:187], a[76:79], v[156:159]
    ds_write_b128 v212, v[48:51] offset:1024
    v_mfma_f32_16x16x32_bf16 v[156:159], a[180:183], a[84:87], v[156:159]
    v_exp_f32 v237, v237
    v_mfma_f32_16x16x32_bf16 v[156:159], a[176:179], a[92:95], v[156:159]
    buffer_load_dwordx4 a[204:207], off, s[80:83], s50 offset:3072 sc1
    v_mfma_f32_16x16x32_bf16 v[156:159], a[144:147], a[68:71], v[156:159]
    ds_read_b128 a[176:179], v5 offset:15360
    ds_read_b128 a[180:183], v5 offset:16384
    v_mfma_f32_16x16x32_bf16 v[156:159], a[148:151], a[60:63], v[156:159]
    v_exp_f32 v238, v238
    v_mfma_f32_16x16x32_bf16 v[156:159], a[152:155], a[52:55], v[156:159]
    ds_read_b128 a[184:187], v5 offset:17408
    s_waitcnt lgkmcnt(4)
    v_mfma_f32_16x16x32_bf16 v[152:155], a[152:155], a[48:51], v[152:155]
    s_add_u32 s50, s93, 4096
    buffer_load_dwordx4 a[208:211], off, s[80:83], s50 offset:0 sc1
    v_mfma_f32_16x16x32_bf16 v[152:155], a[148:151], a[56:59], v[152:155]
    v_exp_f32 v239, v239
    v_mfma_f32_16x16x32_bf16 v[152:155], a[144:147], a[64:67], v[152:155]
    ds_write_b128 v212, v[56:59] offset:2048
    v_mfma_f32_16x16x32_bf16 v[152:155], a[160:163], a[40:43], v[152:155]
    s_waitcnt vmcnt(6)
    s_barrier
    v_mfma_f32_16x16x32_bf16 v[152:155], a[164:167], a[32:35], v[152:155]
    ds_read_b128 a[144:147], v5 offset:18432
    ds_read_b128 a[148:151], v6 offset:0
    v_mfma_f32_16x16x32_bf16 v[152:155], a[168:171], a[24:27], v[152:155]
    ds_read_b128 a[152:155], v6 offset:18432
    s_waitcnt lgkmcnt(4)
    v_mfma_f32_16x16x32_bf16 v[156:159], a[168:171], a[28:31], v[156:159]
    buffer_load_dwordx4 a[212:215], off, s[80:83], s50 offset:1024 sc1
    v_fma_f32 v236, v236, v189, v189
    v_mfma_f32_16x16x32_bf16 v[156:159], a[164:167], a[36:39], v[156:159]
    v_fma_f32 v237, v237, v189, v189
    v_fma_f32 v238, v238, v189, v189
    v_mfma_f32_16x16x32_bf16 v[156:159], a[160:163], a[44:47], v[156:159]
    v_fma_f32 v239, v239, v189, v189
    v_mfma_f32_16x16x32_bf16 v[156:159], a[176:179], a[20:23], v[156:159]
    ds_read_b128 a[160:163], v5 offset:19456
    ds_read_b128 a[164:167], v6 offset:1024
    v_mfma_f32_16x16x32_bf16 v[156:159], a[180:183], a[12:15], v[156:159]
    buffer_load_dwordx4 a[216:219], off, s[80:83], s50 offset:2048 sc1
    v_mfma_f32_16x16x32_bf16 v[156:159], a[184:187], a[4:7], v[156:159]
    ds_read_b128 a[168:171], v6 offset:19456
    s_waitcnt lgkmcnt(3)
    v_mfma_f32_16x16x32_bf16 v[152:155], a[184:187], a[0:3], v[152:155]
    ds_write_b128 v212, v[64:67] offset:3072
    v_mfma_f32_16x16x32_bf16 v[152:155], a[180:183], a[8:11], v[152:155]
    v_rcp_f32 v236, v236
    v_mfma_f32_16x16x32_bf16 v[152:155], a[176:179], a[16:19], v[152:155]
    buffer_load_dwordx4 a[220:223], off, s[80:83], s50 offset:3072 sc1
    v_mfma_f32_16x16x32_bf16 v[160:163], a[144:147], a[136:139], 0
    ds_read_b128 a[176:179], v5 offset:20480
    ds_read_b128 a[180:183], v6 offset:2048
    v_mfma_f32_16x16x32_bf16 v[168:171], a[148:151], a[136:139], 0
    v_rcp_f32 v237, v237
    v_mfma_f32_16x16x32_bf16 v[176:179], a[152:155], a[136:139], 0
    ds_read_b128 a[184:187], v6 offset:20480
    s_waitcnt lgkmcnt(4)
    v_mfma_f32_16x16x32_bf16 v[180:183], a[152:155], a[140:143], 0
    v_rcp_f32 v238, v238
    v_mfma_f32_16x16x32_bf16 v[172:175], a[148:151], a[140:143], 0
    v_rcp_f32 v239, v239
    v_mfma_f32_16x16x32_bf16 v[164:167], a[144:147], a[140:143], 0
    ds_write_b128 v212, v[72:75] offset:4096
    v_mfma_f32_16x16x32_bf16 v[164:167], a[160:163], a[132:135], v[164:167]
    ds_read_b128 a[144:147], v5 offset:21504
    ds_read_b128 a[148:151], v6 offset:3072
    v_mfma_f32_16x16x32_bf16 v[172:175], a[164:167], a[132:135], v[172:175]
    buffer_load_dwordx4 a[140:143], off, s[80:83], s51 offset:3072 sc1
    v_mul_f32 v116, v116, v236
    v_mfma_f32_16x16x32_bf16 v[180:183], a[168:171], a[132:135], v[180:183]
    ds_read_b128 a[152:155], v6 offset:21504
    s_waitcnt lgkmcnt(4)
    v_mfma_f32_16x16x32_bf16 v[176:179], a[168:171], a[128:131], v[176:179]
    v_mul_f32 v117, v117, v237
    v_mul_f32 v118, v118, v238
    v_mfma_f32_16x16x32_bf16 v[168:171], a[164:167], a[128:131], v[168:171]
    buffer_load_dwordx4 a[136:139], v16, s[12:15], s51 offen sc1
    v_mul_f32 v119, v119, v239
    v_mfma_f32_16x16x32_bf16 v[160:163], a[160:163], a[128:131], v[160:163]
    s_and_b32 s45, s37, 0x1ffff
    s_add_u32 s45, s45, s29
    s_waitcnt vmcnt(10)
    v_lshlrev_b32 v210, 2, v2
    s_add_u32 s95, s37, s29
    s_mov_b64 exec, 0xffff
    buffer_store_dword v12, v210, s[12:15], s95 offen offset:256 sc1
    s_mov_b64 exec, -1
    v_lshlrev_b32 v211, 17, v2
    v_mfma_f32_16x16x32_bf16 v[160:163], a[176:179], a[120:123], v[160:163]
    ds_read_b128 a[160:163], v5 offset:22528
    ds_read_b128 a[164:167], v6 offset:4096
    v_mfma_f32_16x16x32_bf16 v[168:171], a[180:183], a[120:123], v[168:171]
    v_mov_b32 v216, v10
    v_mov_b32 v217, v10
    v_mfma_f32_16x16x32_bf16 v[176:179], a[184:187], a[120:123], v[176:179]
    ds_read_b128 a[168:171], v6 offset:22528
    s_waitcnt lgkmcnt(3)
    v_mfma_f32_16x16x32_bf16 v[180:183], a[184:187], a[124:127], v[180:183]
    v_mov_b32 v218, v10
    v_mov_b32 v219, v10
    v_mfma_f32_16x16x32_bf16 v[172:175], a[180:183], a[124:127], v[172:175]
    v_mov_b32 v220, v11
    v_mov_b32 v221, v11
    v_mfma_f32_16x16x32_bf16 v[164:167], a[176:179], a[124:127], v[164:167]
    v_mov_b32 v222, v11
    v_mov_b32 v223, v11
    v_mfma_f32_16x16x32_bf16 v[164:167], a[144:147], a[116:119], v[164:167]
    ds_read_b128 a[176:179], v5 offset:23552
    ds_read_b128 a[180:183], v6 offset:5120
    v_mfma_f32_16x16x32_bf16 v[172:175], a[148:151], a[116:119], v[172:175]
    s_add_u32 s51, s39, 147456
    buffer_load_dwordx4 a[132:135], off, s[80:83], s51 offset:0 sc1
    v_mfma_f32_16x16x32_bf16 v[180:183], a[152:155], a[116:119], v[180:183]
    ds_read_b128 a[184:187], v6 offset:23552
    s_waitcnt lgkmcnt(3)
    v_mfma_f32_16x16x32_bf16 v[176:179], a[152:155], a[112:115], v[176:179]
    ds_write_b128 v212, v[80:83] offset:5120
    v_mfma_f32_16x16x32_bf16 v[168:171], a[148:151], a[112:115], v[168:171]
    buffer_load_dwordx4 a[128:131], off, s[80:83], s51 offset:1024 sc1
    v_mul_f32 v232, v120, v120
    v_mfma_f32_16x16x32_bf16 v[160:163], a[144:147], a[112:115], v[160:163]
    v_mul_f32 v233, v121, v121
    v_mul_f32 v234, v122, v122
    v_mfma_f32_16x16x32_bf16 v[160:163], a[160:163], a[104:107], v[160:163]
    ds_read_b128 a[144:147], v5 offset:24576
    ds_read_b128 a[148:151], v6 offset:6144
    v_mfma_f32_16x16x32_bf16 v[168:171], a[164:167], a[104:107], v[168:171]
    buffer_load_dwordx4 a[124:127], off, s[80:83], s51 offset:2048 sc1
    v_mul_f32 v235, v123, v123
    v_mfma_f32_16x16x32_bf16 v[176:179], a[168:171], a[104:107], v[176:179]
    ds_read_b128 a[152:155], v6 offset:24576
    s_waitcnt lgkmcnt(4)
    v_mfma_f32_16x16x32_bf16 v[180:183], a[168:171], a[108:111], v[180:183]
    v_fma_f32 v232, v232, v186, v184
    v_fma_f32 v233, v233, v186, v184
    v_mfma_f32_16x16x32_bf16 v[172:175], a[164:167], a[108:111], v[172:175]
    buffer_load_dwordx4 a[120:123], off, s[80:83], s51 offset:3072 sc1
    v_fma_f32 v234, v234, v186, v184
    v_mfma_f32_16x16x32_bf16 v[164:167], a[160:163], a[108:111], v[164:167]
    ds_write_b128 v212, v[88:91] offset:6144
    v_mfma_f32_16x16x32_bf16 v[164:167], a[176:179], a[100:103], v[164:167]
    ds_read_b128 a[160:163], v5 offset:25600
    ds_read_b128 a[164:167], v6 offset:7168
    v_mfma_f32_16x16x32_bf16 v[172:175], a[180:183], a[100:103], v[172:175]
    buffer_load_dwordx4 a[116:119], v16, s[12:15], s51 offen sc1
    v_fma_f32 v235, v235, v186, v184
    v_mfma_f32_16x16x32_bf16 v[180:183], a[184:187], a[100:103], v[180:183]
    ds_read_b128 a[168:171], v6 offset:25600
    s_waitcnt lgkmcnt(4)
    v_mfma_f32_16x16x32_bf16 v[176:179], a[184:187], a[96:99], v[176:179]
    v_mul_f32 v232, v232, v120
    v_mul_f32 v233, v233, v121
    v_mfma_f32_16x16x32_bf16 v[168:171], a[180:183], a[96:99], v[168:171]
    s_add_u32 s51, s39, 184320
    buffer_load_dwordx4 a[112:115], off, s[80:83], s51 offset:0 sc1
    v_mfma_f32_16x16x32_bf16 v[160:163], a[176:179], a[96:99], v[160:163]
    v_mul_f32 v234, v234, v122
    v_mul_f32 v235, v235, v123
    v_mfma_f32_16x16x32_bf16 v[160:163], a[144:147], a[88:91], v[160:163]
    ds_read_b128 a[176:179], v5 offset:26624
    ds_read_b128 a[180:183], v6 offset:8192
    v_mfma_f32_16x16x32_bf16 v[168:171], a[148:151], a[88:91], v[168:171]
    buffer_load_dwordx4 a[108:111], off, s[80:83], s51 offset:1024 sc1
    v_mfma_f32_16x16x32_bf16 v[176:179], a[152:155], a[88:91], v[176:179]
    ds_read_b128 a[184:187], v6 offset:26624
    s_waitcnt lgkmcnt(3)
    v_mfma_f32_16x16x32_bf16 v[180:183], a[152:155], a[92:95], v[180:183]
    ds_write_b128 v212, v[96:99] offset:7168
    v_mfma_f32_16x16x32_bf16 v[172:175], a[148:151], a[92:95], v[172:175]
    buffer_load_dwordx4 a[104:107], off, s[80:83], s51 offset:2048 sc1
    v_mfma_f32_16x16x32_bf16 v[164:167], a[144:147], a[92:95], v[164:167]
    v_exp_f32 v232, v232
    v_mfma_f32_16x16x32_bf16 v[164:167], a[160:163], a[84:87], v[164:167]
    ds_read_b128 a[144:147], v5 offset:27648
    ds_read_b128 a[148:151], v6 offset:9216
    v_mfma_f32_16x16x32_bf16 v[172:175], a[164:167], a[84:87], v[172:175]
    buffer_load_dwordx4 a[100:103], off, s[80:83], s51 offset:3072 sc1
    v_mfma_f32_16x16x32_bf16 v[180:183], a[168:171], a[84:87], v[180:183]
    ds_read_b128 a[152:155], v6 offset:27648
    s_waitcnt lgkmcnt(4)
    v_mfma_f32_16x16x32_bf16 v[176:179], a[168:171], a[80:83], v[176:179]
    v_exp_f32 v233, v233
    v_mfma_f32_16x16x32_bf16 v[168:171], a[164:167], a[80:83], v[168:171]
    buffer_load_dwordx4 a[96:99], v16, s[12:15], s51 offen sc1
    v_mfma_f32_16x16x32_bf16 v[160:163], a[160:163], a[80:83], v[160:163]
    ds_write_b128 v212, v[104:107] offset:8192
    v_mfma_f32_16x16x32_bf16 v[160:163], a[176:179], a[72:75], v[160:163]
    ds_read_b128 a[160:163], v5 offset:28672
    ds_read_b128 a[164:167], v6 offset:10240
    v_mfma_f32_16x16x32_bf16 v[168:171], a[180:183], a[72:75], v[168:171]
    s_add_u32 s51, s39, 294912
    buffer_load_dwordx4 a[92:95], off, s[80:83], s51 offset:0 sc1
    v_mfma_f32_16x16x32_bf16 v[176:179], a[184:187], a[72:75], v[176:179]
    ds_read_b128 a[168:171], v6 offset:28672
    s_waitcnt lgkmcnt(4)
    v_mfma_f32_16x16x32_bf16 v[180:183], a[184:187], a[76:79], v[180:183]
    v_exp_f32 v234, v234
    v_mfma_f32_16x16x32_bf16 v[172:175], a[180:183], a[76:79], v[172:175]
    buffer_load_dwordx4 a[88:91], off, s[80:83], s51 offset:1024 sc1
    v_mfma_f32_16x16x32_bf16 v[164:167], a[176:179], a[76:79], v[164:167]
    v_exp_f32 v235, v235
    v_mfma_f32_16x16x32_bf16 v[164:167], a[144:147], a[68:71], v[164:167]
    ds_read_b128 a[176:179], v5 offset:29696
    ds_read_b128 a[180:183], v6 offset:11264
    v_mfma_f32_16x16x32_bf16 v[172:175], a[148:151], a[68:71], v[172:175]
    buffer_load_dwordx4 a[84:87], off, s[80:83], s51 offset:2048 sc1
    v_fma_f32 v232, v232, v188, v188
    v_mfma_f32_16x16x32_bf16 v[180:183], a[152:155], a[68:71], v[180:183]
    ds_read_b128 a[184:187], v6 offset:29696
    s_waitcnt lgkmcnt(3)
    v_mfma_f32_16x16x32_bf16 v[176:179], a[152:155], a[64:67], v[176:179]
    v_fma_f32 v233, v233, v188, v188
    v_fma_f32 v234, v234, v188, v188
    v_mfma_f32_16x16x32_bf16 v[168:171], a[148:151], a[64:67], v[168:171]
    buffer_load_dwordx4 a[80:83], off, s[80:83], s51 offset:3072 sc1
    v_fma_f32 v235, v235, v188, v188
    v_mfma_f32_16x16x32_bf16 v[160:163], a[144:147], a[64:67], v[160:163]
    v_rcp_f32 v232, v232
    v_mfma_f32_16x16x32_bf16 v[160:163], a[160:163], a[56:59], v[160:163]
    ds_read_b128 a[144:147], v5 offset:30720
    ds_read_b128 a[148:151], v6 offset:12288
    v_mfma_f32_16x16x32_bf16 v[168:171], a[164:167], a[56:59], v[168:171]
    buffer_load_dwordx4 a[76:79], v16, s[12:15], s51 offen sc1
    v_mfma_f32_16x16x32_bf16 v[176:179], a[168:171], a[56:59], v[176:179]
    ds_read_b128 a[152:155], v6 offset:30720
    s_waitcnt lgkmcnt(3)
    v_mfma_f32_16x16x32_bf16 v[180:183], a[168:171], a[60:63], v[180:183]
    v_rcp_f32 v233, v233
    v_mfma_f32_16x16x32_bf16 v[172:175], a[164:167], a[60:63], v[172:175]
    s_add_u32 s51, s39, 73728
    buffer_load_dwordx4 a[72:75], off, s[80:83], s51 offset:0 sc1
    v_mfma_f32_16x16x32_bf16 v[164:167], a[160:163], a[60:63], v[164:167]
    v_rcp_f32 v234, v234
    v_mfma_f32_16x16x32_bf16 v[164:167], a[176:179], a[52:55], v[164:167]
    ds_read_b128 a[160:163], v5 offset:31744
    ds_read_b128 a[164:167], v6 offset:13312
    v_mfma_f32_16x16x32_bf16 v[172:175], a[180:183], a[52:55], v[172:175]
    buffer_load_dwordx4 a[68:71], off, s[80:83], s51 offset:1024 sc1
    v_mfma_f32_16x16x32_bf16 v[180:183], a[184:187], a[52:55], v[180:183]
    ds_read_b128 a[168:171], v6 offset:31744
    s_waitcnt lgkmcnt(3)
    v_mfma_f32_16x16x32_bf16 v[176:179], a[184:187], a[48:51], v[176:179]
    v_rcp_f32 v235, v235
    v_mfma_f32_16x16x32_bf16 v[168:171], a[180:183], a[48:51], v[168:171]
    buffer_load_dwordx4 a[64:67], off, s[80:83], s51 offset:2048 sc1
    v_mul_f32 v120, v120, v232
    v_mfma_f32_16x16x32_bf16 v[160:163], a[176:179], a[48:51], v[160:163]
    v_mul_f32 v121, v121, v233
    v_mul_f32 v122, v122, v234
    v_mfma_f32_16x16x32_bf16 v[160:163], a[144:147], a[40:43], v[160:163]
    ds_read_b128 a[176:179], v5 offset:32768
    ds_read_b128 a[180:183], v6 offset:14336
    v_mfma_f32_16x16x32_bf16 v[168:171], a[148:151], a[40:43], v[168:171]
    buffer_load_dwordx4 a[60:63], off, s[80:83], s51 offset:3072 sc1
    v_mul_f32 v123, v123, v235
    v_mfma_f32_16x16x32_bf16 v[176:179], a[152:155], a[40:43], v[176:179]
    ds_read_b128 a[184:187], v6 offset:32768
    s_waitcnt lgkmcnt(3)
    v_mfma_f32_16x16x32_bf16 v[180:183], a[152:155], a[44:47], v[180:183]
    v_mul_f32 v236, v124, v124
    v_mul_f32 v237, v125, v125
    v_mfma_f32_16x16x32_bf16 v[172:175], a[148:151], a[44:47], v[172:175]
    buffer_load_dwordx4 a[56:59], v16, s[12:15], s51 offen sc1
    v_mul_f32 v238, v126, v126
    v_mfma_f32_16x16x32_bf16 v[164:167], a[144:147], a[44:47], v[164:167]
    v_mul_f32 v239, v127, v127
    v_fma_f32 v236, v236, v187, v185
    v_mfma_f32_16x16x32_bf16 v[164:167], a[160:163], a[36:39], v[164:167]
    ds_read_b128 a[144:147], v5 offset:33792
    ds_read_b128 a[148:151], v6 offset:15360
    v_mfma_f32_16x16x32_bf16 v[172:175], a[164:167], a[36:39], v[172:175]
    s_add_u32 s51, s39, 110592
    buffer_load_dwordx4 a[52:55], off, s[80:83], s51 offset:0 sc1
    v_mfma_f32_16x16x32_bf16 v[180:183], a[168:171], a[36:39], v[180:183]
    ds_read_b128 a[152:155], v6 offset:33792
    s_waitcnt lgkmcnt(3)
    v_mfma_f32_16x16x32_bf16 v[176:179], a[168:171], a[32:35], v[176:179]
    v_fma_f32 v237, v237, v187, v185
    v_fma_f32 v238, v238, v187, v185
    v_mfma_f32_16x16x32_bf16 v[168:171], a[164:167], a[32:35], v[168:171]
    buffer_load_dwordx4 a[48:51], off, s[80:83], s51 offset:1024 sc1
    v_fma_f32 v239, v239, v187, v185
    v_mfma_f32_16x16x32_bf16 v[160:163], a[160:163], a[32:35], v[160:163]
    buffer_load_dword v210, v211, s[12:15], s45 offen offset:256 sc1
    v_mul_f32 v236, v236, v124
    v_mfma_f32_16x16x32_bf16 v[160:163], a[176:179], a[24:27], v[160:163]
    ds_read_b128 a[160:163], v5 offset:34816
    ds_read_b128 a[164:167], v6 offset:16384
    v_mfma_f32_16x16x32_bf16 v[168:171], a[180:183], a[24:27], v[168:171]
    s_cmp_le_u32 s4, 0
    s_cselect_b32 s93, s90, s36
    v_mfma_f32_16x16x32_bf16 v[176:179], a[184:187], a[24:27], v[176:179]
    ds_read_b128 a[168:171], v6 offset:34816
    s_waitcnt lgkmcnt(3)
    v_mfma_f32_16x16x32_bf16 v[180:183], a[184:187], a[28:31], v[180:183]
    s_add_u32 s50, s93, 0
    buffer_load_dwordx4 a[224:227], off, s[80:83], s50 offset:0 sc1
    v_mfma_f32_16x16x32_bf16 v[172:175], a[180:183], a[28:31], v[172:175]
    buffer_load_dwordx4 a[44:47], off, s[80:83], s51 offset:2048 sc1
    v_mul_f32 v237, v237, v125
    v_mfma_f32_16x16x32_bf16 v[164:167], a[176:179], a[28:31], v[164:167]
    v_mul_f32 v238, v238, v126
    v_mul_f32 v239, v239, v127
    v_mfma_f32_16x16x32_bf16 v[164:167], a[144:147], a[20:23], v[164:167]
    ds_read_b128 a[176:179], v5 offset:35840
    ds_read_b128 a[180:183], v6 offset:17408
    v_mfma_f32_16x16x32_bf16 v[172:175], a[148:151], a[20:23], v[172:175]
    buffer_load_dwordx4 a[228:231], off, s[80:83], s50 offset:1024 sc1
    v_mfma_f32_16x16x32_bf16 v[180:183], a[152:155], a[20:23], v[180:183]
    ds_read_b128 a[184:187], v6 offset:35840
    s_waitcnt lgkmcnt(3)
    v_mfma_f32_16x16x32_bf16 v[176:179], a[152:155], a[16:19], v[176:179]
    buffer_load_dwordx4 a[40:43], off, s[80:83], s51 offset:3072 sc1
    v_mfma_f32_16x16x32_bf16 v[168:171], a[148:151], a[16:19], v[168:171]
    v_exp_f32 v236, v236
    v_mfma_f32_16x16x32_bf16 v[160:163], a[144:147], a[16:19], v[160:163]
    buffer_load_dwordx4 a[232:235], off, s[80:83], s50 offset:2048 sc1
    v_mfma_f32_16x16x32_bf16 v[160:163], a[160:163], a[8:11], v[160:163]
    buffer_load_dwordx4 a[36:39], v16, s[12:15], s51 offen sc1
    v_mfma_f32_16x16x32_bf16 v[168:171], a[164:167], a[8:11], v[168:171]
    v_exp_f32 v237, v237
    v_mfma_f32_16x16x32_bf16 v[176:179], a[168:171], a[8:11], v[176:179]
    s_waitcnt lgkmcnt(0)
    v_mfma_f32_16x16x32_bf16 v[180:183], a[168:171], a[12:15], v[180:183]
    buffer_load_dwordx4 a[236:239], off, s[80:83], s50 offset:3072 sc1
    v_mfma_f32_16x16x32_bf16 v[172:175], a[164:167], a[12:15], v[172:175]
    s_add_u32 s51, s39, 221184
    buffer_load_dwordx4 a[32:35], off, s[80:83], s51 offset:0 sc1
    v_mfma_f32_16x16x32_bf16 v[164:167], a[160:163], a[12:15], v[164:167]
    v_exp_f32 v238, v238
    v_mfma_f32_16x16x32_bf16 v[164:167], a[176:179], a[4:7], v[164:167]
    v_exp_f32 v239, v239
    v_mfma_f32_16x16x32_bf16 v[172:175], a[180:183], a[4:7], v[172:175]
    s_add_u32 s50, s93, 4096
    buffer_load_dwordx4 a[240:243], off, s[80:83], s50 offset:0 sc1
    v_mfma_f32_16x16x32_bf16 v[180:183], a[184:187], a[4:7], v[180:183]
    v_fma_f32 v236, v236, v189, v189
    v_fma_f32 v237, v237, v189, v189
    v_mfma_f32_16x16x32_bf16 v[176:179], a[184:187], a[0:3], v[176:179]
    v_fma_f32 v238, v238, v189, v189
    v_fma_f32 v239, v239, v189, v189
    v_mfma_f32_16x16x32_bf16 v[168:171], a[180:183], a[0:3], v[168:171]
    v_rcp_f32 v236, v236
    v_mfma_f32_16x16x32_bf16 v[160:163], a[176:179], a[0:3], v[160:163]
    buffer_load_dwordx4 a[244:247], off, s[80:83], s50 offset:1024 sc1
    s_barrier
    ds_read_b128 a[144:147], v7 offset:0
    ds_read_b128 a[148:151], v7 offset:9216
    ds_read_b128 a[152:155], v7 offset:18432
    ds_read_b128 a[156:159], v7 offset:27648
    ds_read_b128 a[160:163], v7 offset:1024
    ds_read_b128 a[164:167], v7 offset:10240
    ds_read_b128 a[168:171], v7 offset:19456
    ds_read_b128 a[172:175], v7 offset:28672
    s_waitcnt vmcnt(36) lgkmcnt(4)
    v_mfma_f32_16x16x32_bf16 v[40:43], a[144:147], a[192:195], v[216:219]
    ds_read_b128 a[176:179], v7 offset:2048
    ds_read_b128 a[180:183], v7 offset:11264
    v_mfma_f32_16x16x32_bf16 v[40:43], a[148:151], a[200:203], v[40:43]
    v_rcp_f32 v237, v237
    v_mfma_f32_16x16x32_bf16 v[40:43], a[152:155], a[208:211], v[40:43]
    ds_read_b128 a[184:187], v7 offset:20480
    ds_read_b128 a[188:191], v7 offset:29696
    v_mfma_f32_16x16x32_bf16 v[40:43], a[156:159], a[216:219], v[40:43]
    buffer_load_dwordx4 a[248:251], off, s[80:83], s50 offset:2048 sc1
    v_mfma_f32_16x16x32_bf16 v[44:47], a[156:159], a[220:223], v[220:223]
    v_rcp_f32 v238, v238
    v_mfma_f32_16x16x32_bf16 v[44:47], a[152:155], a[212:215], v[44:47]
    v_rcp_f32 v239, v239
    v_mfma_f32_16x16x32_bf16 v[44:47], a[148:151], a[204:207], v[44:47]
    s_waitcnt lgkmcnt(4)
    v_mul_f32 v124, v124, v236
    v_mfma_f32_16x16x32_bf16 v[44:47], a[144:147], a[196:199], v[44:47]
    buffer_load_dwordx4 a[252:255], off, s[80:83], s50 offset:3072 sc1
    v_mul_f32 v125, v125, v237
    v_mfma_f32_16x16x32_bf16 v[52:55], a[160:163], a[196:199], v[220:223]
    ds_read_b128 a[144:147], v7 offset:3072
    ds_read_b128 a[148:151], v7 offset:12288
    v_mfma_f32_16x16x32_bf16 v[52:55], a[164:167], a[204:207], v[52:55]
    v_mul_f32 v126, v126, v238
    v_mul_f32 v127, v127, v239
    v_mfma_f32_16x16x32_bf16 v[52:55], a[168:171], a[212:215], v[52:55]
    ds_read_b128 a[152:155], v7 offset:21504
    ds_read_b128 a[156:159], v7 offset:30720
    v_mfma_f32_16x16x32_bf16 v[52:55], a[172:175], a[220:223], v[52:55]
    v_mul_f32 v232, v128, v128
    v_mul_f32 v233, v129, v129
    v_mfma_f32_16x16x32_bf16 v[48:51], a[172:175], a[216:219], v[216:219]
    v_mul_f32 v234, v130, v130
    v_mul_f32 v235, v131, v131
    v_mfma_f32_16x16x32_bf16 v[48:51], a[168:171], a[208:211], v[48:51]
    v_fma_f32 v232, v232, v186, v184
    v_fma_f32 v233, v233, v186, v184
    v_mfma_f32_16x16x32_bf16 v[48:51], a[164:167], a[200:203], v[48:51]
    s_waitcnt lgkmcnt(4)
    v_fma_f32 v234, v234, v186, v184
    v_mfma_f32_16x16x32_bf16 v[48:51], a[160:163], a[192:195], v[48:51]
    s_waitcnt vmcnt(12)
    v_cmp_eq_u32 vcc, 0, v210
    s_nop 4
    s_cbranch_vccnz L_interleave_layers__spectral_fnet__mixer_gmlp__prompt_kernel_24
L_interleave_layers__spectral_fnet__mixer_gmlp__prompt_kernel_25:
    v_mfma_f32_16x16x32_bf16 v[56:59], a[176:179], a[192:195], v[216:219]
    ds_read_b128 a[160:163], v7 offset:4096
    ds_read_b128 a[164:167], v7 offset:13312
    v_mfma_f32_16x16x32_bf16 v[56:59], a[180:183], a[200:203], v[56:59]
    s_cmp_le_u32 s4, 0
    s_cselect_b32 s92, s91, s35
    v_mfma_f32_16x16x32_bf16 v[56:59], a[184:187], a[208:211], v[56:59]
    ds_read_b128 a[168:171], v7 offset:22528
    ds_read_b128 a[172:175], v7 offset:31744
    v_mfma_f32_16x16x32_bf16 v[56:59], a[188:191], a[216:219], v[56:59]
    s_add_u32 m0, s32, 0
    s_add_u32 s41, s92, 0
    v_mfma_f32_16x16x32_bf16 v[60:63], a[188:191], a[220:223], v[220:223]
    v_fma_f32 v235, v235, v186, v184
    v_mul_f32 v232, v232, v128
    v_mfma_f32_16x16x32_bf16 v[60:63], a[184:187], a[212:215], v[60:63]
    buffer_load_dwordx4 off, s[80:83], s41 offset:0 sc1 lds
    v_mul_f32 v233, v233, v129
    v_mfma_f32_16x16x32_bf16 v[60:63], a[180:183], a[204:207], v[60:63]
    s_waitcnt lgkmcnt(4)
    v_mul_f32 v234, v234, v130
    v_mfma_f32_16x16x32_bf16 v[60:63], a[176:179], a[196:199], v[60:63]
    buffer_load_dwordx4 off, s[80:83], s41 offset:1024 sc1 lds
    v_mul_f32 v235, v235, v131
    v_mfma_f32_16x16x32_bf16 v[68:71], a[144:147], a[196:199], v[220:223]
    ds_read_b128 a[176:179], v7 offset:5120
    ds_read_b128 a[180:183], v7 offset:14336
    v_mfma_f32_16x16x32_bf16 v[68:71], a[148:151], a[204:207], v[68:71]
    buffer_load_dwordx4 off, s[80:83], s41 offset:2048 sc1 lds
    v_mfma_f32_16x16x32_bf16 v[68:71], a[152:155], a[212:215], v[68:71]
    ds_read_b128 a[184:187], v7 offset:23552
    ds_read_b128 a[188:191], v7 offset:32768
    v_mfma_f32_16x16x32_bf16 v[68:71], a[156:159], a[220:223], v[68:71]
    buffer_load_dwordx4 off, s[80:83], s41 offset:3072 sc1 lds
    v_mfma_f32_16x16x32_bf16 v[64:67], a[156:159], a[216:219], v[216:219]
    v_exp_f32 v232, v232
    v_mfma_f32_16x16x32_bf16 v[64:67], a[152:155], a[208:211], v[64:67]
    s_add_u32 m0, s32, 4096
    s_add_u32 s41, s92, 4096
    v_mfma_f32_16x16x32_bf16 v[64:67], a[148:151], a[200:203], v[64:67]
    s_waitcnt lgkmcnt(4)
    v_mfma_f32_16x16x32_bf16 v[64:67], a[144:147], a[192:195], v[64:67]
    buffer_load_dwordx4 off, s[80:83], s41 offset:0 sc1 lds
    v_mfma_f32_16x16x32_bf16 v[72:75], a[160:163], a[192:195], v[216:219]
    ds_read_b128 a[144:147], v7 offset:6144
    ds_read_b128 a[148:151], v7 offset:15360
    v_mfma_f32_16x16x32_bf16 v[72:75], a[164:167], a[200:203], v[72:75]
    buffer_load_dwordx4 off, s[80:83], s41 offset:1024 sc1 lds
    v_mfma_f32_16x16x32_bf16 v[72:75], a[168:171], a[208:211], v[72:75]
    ds_read_b128 a[152:155], v7 offset:24576
    ds_read_b128 a[156:159], v7 offset:33792
    v_mfma_f32_16x16x32_bf16 v[72:75], a[172:175], a[216:219], v[72:75]
    buffer_load_dwordx4 off, s[80:83], s41 offset:2048 sc1 lds
    v_mfma_f32_16x16x32_bf16 v[76:79], a[172:175], a[220:223], v[220:223]
    v_exp_f32 v233, v233
    v_mfma_f32_16x16x32_bf16 v[76:79], a[168:171], a[212:215], v[76:79]
    buffer_load_dwordx4 off, s[80:83], s41 offset:3072 sc1 lds
    v_mfma_f32_16x16x32_bf16 v[76:79], a[164:167], a[204:207], v[76:79]
    s_waitcnt lgkmcnt(4)
    v_mfma_f32_16x16x32_bf16 v[76:79], a[160:163], a[196:199], v[76:79]
    s_add_u32 m0, s32, 8192
    s_add_u32 s41, s92, 8192
    v_mfma_f32_16x16x32_bf16 v[84:87], a[176:179], a[196:199], v[220:223]
    ds_read_b128 a[160:163], v7 offset:7168
    ds_read_b128 a[164:167], v7 offset:16384
    v_mfma_f32_16x16x32_bf16 v[84:87], a[180:183], a[204:207], v[84:87]
    buffer_load_dwordx4 off, s[80:83], s41 offset:0 sc1 lds
    v_mfma_f32_16x16x32_bf16 v[84:87], a[184:187], a[212:215], v[84:87]
    ds_read_b128 a[168:171], v7 offset:25600
    ds_read_b128 a[172:175], v7 offset:34816
    v_mfma_f32_16x16x32_bf16 v[84:87], a[188:191], a[220:223], v[84:87]
    s_cmp_le_u32 s4, 1
    s_cselect_b32 s92, s91, s35
    v_mfma_f32_16x16x32_bf16 v[80:83], a[188:191], a[216:219], v[216:219]
    s_cmp_le_u32 s4, 1
    s_cselect_b32 s93, s90, s36
    v_mfma_f32_16x16x32_bf16 v[80:83], a[184:187], a[208:211], v[80:83]
    s_add_u32 m0, s32, 36864
    s_add_u32 s41, s92, 36864
    v_mfma_f32_16x16x32_bf16 v[80:83], a[180:183], a[200:203], v[80:83]
    s_waitcnt lgkmcnt(4)
    v_mfma_f32_16x16x32_bf16 v[80:83], a[176:179], a[192:195], v[80:83]
    v_exp_f32 v234, v234
    v_mfma_f32_16x16x32_bf16 v[88:91], a[144:147], a[192:195], v[216:219]
    ds_read_b128 a[176:179], v7 offset:8192
    ds_read_b128 a[180:183], v7 offset:17408
    v_mfma_f32_16x16x32_bf16 v[88:91], a[148:151], a[200:203], v[88:91]
    s_add_u32 s50, s93, 8192
    buffer_load_dwordx4 a[0:3], off, s[80:83], s50 offset:0 sc1
    v_mfma_f32_16x16x32_bf16 v[88:91], a[152:155], a[208:211], v[88:91]
    ds_read_b128 a[184:187], v7 offset:26624
    ds_read_b128 a[188:191], v7 offset:35840
    v_mfma_f32_16x16x32_bf16 v[88:91], a[156:159], a[216:219], v[88:91]
    v_exp_f32 v235, v235
    v_mfma_f32_16x16x32_bf16 v[92:95], a[156:159], a[220:223], v[220:223]
    buffer_load_dwordx4 off, s[80:83], s41 offset:0 sc1 lds
    v_fma_f32 v232, v232, v188, v188
    v_mfma_f32_16x16x32_bf16 v[92:95], a[152:155], a[212:215], v[92:95]
    v_fma_f32 v233, v233, v188, v188
    v_fma_f32 v234, v234, v188, v188
    v_mfma_f32_16x16x32_bf16 v[92:95], a[148:151], a[204:207], v[92:95]
    s_waitcnt lgkmcnt(4)
    v_fma_f32 v235, v235, v188, v188
    v_mfma_f32_16x16x32_bf16 v[92:95], a[144:147], a[196:199], v[92:95]
    buffer_load_dwordx4 a[4:7], off, s[80:83], s50 offset:1024 sc1
    v_mfma_f32_16x16x32_bf16 v[100:103], a[160:163], a[196:199], v[220:223]
    v_rcp_f32 v232, v232
    v_rcp_f32 v233, v233
    v_rcp_f32 v234, v234
    v_rcp_f32 v235, v235
    buffer_load_dwordx4 off, s[80:83], s41 offset:1024 sc1 lds
    v_mul_f32 v128, v128, v232
    v_mul_f32 v129, v129, v233
    v_mul_f32 v130, v130, v234
    v_mul_f32 v131, v131, v235
    v_mul_f32 v236, v132, v132
    v_mul_f32 v237, v133, v133
    v_mul_f32 v238, v134, v134
    v_mul_f32 v239, v135, v135
    v_fma_f32 v236, v236, v187, v185
    v_fma_f32 v237, v237, v187, v185
    v_fma_f32 v238, v238, v187, v185
    buffer_load_dwordx4 a[8:11], off, s[80:83], s50 offset:2048 sc1
    v_fma_f32 v239, v239, v187, v185
    v_mul_f32 v236, v236, v132
    v_mul_f32 v237, v237, v133
    v_mul_f32 v238, v238, v134
    v_mul_f32 v239, v239, v135
    v_exp_f32 v236, v236
    v_exp_f32 v237, v237
    v_exp_f32 v238, v238
    buffer_load_dwordx4 off, s[80:83], s41 offset:2048 sc1 lds
    v_exp_f32 v239, v239
    v_fma_f32 v236, v236, v189, v189
    v_fma_f32 v237, v237, v189, v189
    v_fma_f32 v238, v238, v189, v189
    v_fma_f32 v239, v239, v189, v189
    v_rcp_f32 v236, v236
    v_rcp_f32 v237, v237
    v_rcp_f32 v238, v238
    buffer_load_dwordx4 a[12:15], off, s[80:83], s50 offset:3072 sc1
    v_rcp_f32 v239, v239
    v_mul_f32 v132, v132, v236
    s_waitcnt vmcnt(7)
    s_barrier
    v_mfma_f32_16x16x32_bf16 v[100:103], a[164:167], a[204:207], v[100:103]
    v_mul_f32 v133, v133, v237
    v_mul_f32 v134, v134, v238
    v_mfma_f32_16x16x32_bf16 v[100:103], a[168:171], a[212:215], v[100:103]
    ds_read_b128 a[144:147], v4 offset:0
    ds_read_b128 a[148:151], v4 offset:9216
    v_mfma_f32_16x16x32_bf16 v[100:103], a[172:175], a[220:223], v[100:103]
    buffer_load_dwordx4 off, s[80:83], s41 offset:3072 sc1 lds
    v_mul_f32 v135, v135, v239
    v_mfma_f32_16x16x32_bf16 v[96:99], a[172:175], a[216:219], v[216:219]
    ds_read_b128 a[152:155], v4 offset:18432
    ds_read_b128 a[156:159], v4 offset:27648
    v_mfma_f32_16x16x32_bf16 v[96:99], a[168:171], a[208:211], v[96:99]
    v_mul_f32 v232, v136, v136
    v_mul_f32 v233, v137, v137
    v_mfma_f32_16x16x32_bf16 v[96:99], a[164:167], a[200:203], v[96:99]
    s_waitcnt lgkmcnt(4)
    s_add_u32 s50, s93, 12288
    buffer_load_dwordx4 a[16:19], off, s[80:83], s50 offset:0 sc1
    v_mfma_f32_16x16x32_bf16 v[96:99], a[160:163], a[192:195], v[96:99]
    v_mul_f32 v234, v138, v138
    v_mul_f32 v235, v139, v139
    v_mfma_f32_16x16x32_bf16 v[104:107], a[176:179], a[192:195], v[216:219]
    ds_read_b128 a[160:163], v4 offset:1024
    ds_read_b128 a[164:167], v4 offset:10240
    v_mfma_f32_16x16x32_bf16 v[104:107], a[180:183], a[200:203], v[104:107]
    s_add_u32 m0, s32, 40960
    s_add_u32 s41, s92, 40960
    v_mfma_f32_16x16x32_bf16 v[104:107], a[184:187], a[208:211], v[104:107]
    ds_read_b128 a[168:171], v4 offset:19456
    ds_read_b128 a[172:175], v4 offset:28672
    v_mfma_f32_16x16x32_bf16 v[104:107], a[188:191], a[216:219], v[104:107]
    v_fma_f32 v232, v232, v186, v184
    v_fma_f32 v233, v233, v186, v184
    v_mfma_f32_16x16x32_bf16 v[108:111], a[188:191], a[220:223], v[220:223]
    buffer_load_dwordx4 a[20:23], off, s[80:83], s50 offset:1024 sc1
    v_fma_f32 v234, v234, v186, v184
    v_mfma_f32_16x16x32_bf16 v[108:111], a[184:187], a[212:215], v[108:111]
    v_fma_f32 v235, v235, v186, v184
    v_mul_f32 v232, v232, v136
    v_mfma_f32_16x16x32_bf16 v[108:111], a[180:183], a[204:207], v[108:111]
    buffer_load_dwordx4 off, s[80:83], s41 offset:0 sc1 lds
    buffer_load_dwordx4 a[24:27], off, s[80:83], s50 offset:2048 sc1
    buffer_load_dwordx4 off, s[80:83], s41 offset:1024 sc1 lds
    buffer_load_dwordx4 a[28:31], off, s[80:83], s50 offset:3072 sc1
    buffer_load_dwordx4 off, s[80:83], s41 offset:2048 sc1 lds
    buffer_load_dwordx4 off, s[80:83], s41 offset:3072 sc1 lds
    s_add_u32 m0, s32, 45056
    s_add_u32 s41, s92, 45056
    buffer_load_dwordx4 off, s[80:83], s41 offset:0 sc1 lds
    s_waitcnt lgkmcnt(4)
    v_mfma_f32_16x16x32_bf16 v[108:111], a[176:179], a[196:199], v[108:111]
    v_mul_f32 v233, v233, v137
    v_mul_f32 v234, v234, v138
    v_mfma_f32_16x16x32_bf16 v[44:47], a[144:147], a[228:231], v[44:47]
    ds_read_b128 a[176:179], v4 offset:2048
    ds_read_b128 a[180:183], v4 offset:11264
    v_mfma_f32_16x16x32_bf16 v[44:47], a[148:151], a[236:239], v[44:47]
    s_cmp_le_u32 s4, 2
    s_cselect_b32 s92, s91, s35
    v_mfma_f32_16x16x32_bf16 v[44:47], a[152:155], a[244:247], v[44:47]
    ds_read_b128 a[184:187], v4 offset:20480
    ds_read_b128 a[188:191], v4 offset:29696
    v_mfma_f32_16x16x32_bf16 v[44:47], a[156:159], a[252:255], v[44:47]
    s_cmp_le_u32 s4, 2
    s_cselect_b32 s93, s90, s36
    v_mfma_f32_16x16x32_bf16 v[40:43], a[156:159], a[248:251], v[40:43]
    v_mul_f32 v235, v235, v139
    v_mfma_f32_16x16x32_bf16 v[40:43], a[152:155], a[240:243], v[40:43]
    s_add_u32 m0, s32, 73728
    s_add_u32 s41, s92, 73728
    v_mfma_f32_16x16x32_bf16 v[40:43], a[148:151], a[232:235], v[40:43]
    s_waitcnt lgkmcnt(4)
    v_mfma_f32_16x16x32_bf16 v[40:43], a[144:147], a[224:227], v[40:43]
    v_exp_f32 v232, v232
    v_mfma_f32_16x16x32_bf16 v[48:51], a[160:163], a[224:227], v[48:51]
    ds_read_b128 a[144:147], v4 offset:3072
    ds_read_b128 a[148:151], v4 offset:12288
    v_mfma_f32_16x16x32_bf16 v[48:51], a[164:167], a[232:235], v[48:51]
    s_add_u32 s50, s93, 16384
    buffer_load_dwordx4 a[192:195], off, s[80:83], s50 offset:0 sc1
    v_mfma_f32_16x16x32_bf16 v[48:51], a[168:171], a[240:243], v[48:51]
    ds_read_b128 a[152:155], v4 offset:21504
    ds_read_b128 a[156:159], v4 offset:30720
    v_mfma_f32_16x16x32_bf16 v[48:51], a[172:175], a[248:251], v[48:51]
    v_exp_f32 v233, v233
    v_mfma_f32_16x16x32_bf16 v[52:55], a[172:175], a[252:255], v[52:55]
    v_exp_f32 v234, v234
    v_mfma_f32_16x16x32_bf16 v[52:55], a[168:171], a[244:247], v[52:55]
    buffer_load_dwordx4 off, s[80:83], s41 offset:0 sc1 lds
    v_mfma_f32_16x16x32_bf16 v[52:55], a[164:167], a[236:239], v[52:55]
    s_waitcnt lgkmcnt(4)
    v_mfma_f32_16x16x32_bf16 v[52:55], a[160:163], a[228:231], v[52:55]
    v_exp_f32 v235, v235
    v_mfma_f32_16x16x32_bf16 v[60:63], a[176:179], a[228:231], v[60:63]
    ds_read_b128 a[160:163], v4 offset:4096
    ds_read_b128 a[164:167], v4 offset:13312
    v_mfma_f32_16x16x32_bf16 v[60:63], a[180:183], a[236:239], v[60:63]
    buffer_load_dwordx4 a[196:199], off, s[80:83], s50 offset:1024 sc1
    v_fma_f32 v232, v232, v188, v188
    v_mfma_f32_16x16x32_bf16 v[60:63], a[184:187], a[244:247], v[60:63]
    ds_read_b128 a[168:171], v4 offset:22528
    ds_read_b128 a[172:175], v4 offset:31744
    v_mfma_f32_16x16x32_bf16 v[60:63], a[188:191], a[252:255], v[60:63]
    buffer_load_dwordx4 off, s[80:83], s41 offset:1024 sc1 lds
    v_fma_f32 v233, v233, v188, v188
    v_mfma_f32_16x16x32_bf16 v[56:59], a[188:191], a[248:251], v[56:59]
    v_fma_f32 v234, v234, v188, v188
    v_fma_f32 v235, v235, v188, v188
    v_mfma_f32_16x16x32_bf16 v[56:59], a[184:187], a[240:243], v[56:59]
    buffer_load_dwordx4 a[200:203], off, s[80:83], s50 offset:2048 sc1
    v_mfma_f32_16x16x32_bf16 v[56:59], a[180:183], a[232:235], v[56:59]
    s_waitcnt lgkmcnt(4)
    v_mfma_f32_16x16x32_bf16 v[56:59], a[176:179], a[224:227], v[56:59]
    v_rcp_f32 v232, v232
    v_mfma_f32_16x16x32_bf16 v[64:67], a[144:147], a[224:227], v[64:67]
    ds_read_b128 a[176:179], v4 offset:5120
    ds_read_b128 a[180:183], v4 offset:14336
    v_mfma_f32_16x16x32_bf16 v[64:67], a[148:151], a[232:235], v[64:67]
    buffer_load_dwordx4 off, s[80:83], s41 offset:2048 sc1 lds
    v_mfma_f32_16x16x32_bf16 v[64:67], a[152:155], a[240:243], v[64:67]
    ds_read_b128 a[184:187], v4 offset:23552
    ds_read_b128 a[188:191], v4 offset:32768
    v_mfma_f32_16x16x32_bf16 v[64:67], a[156:159], a[248:251], v[64:67]
    v_rcp_f32 v233, v233
    v_mfma_f32_16x16x32_bf16 v[68:71], a[156:159], a[252:255], v[68:71]
    v_rcp_f32 v234, v234
    v_mfma_f32_16x16x32_bf16 v[68:71], a[152:155], a[244:247], v[68:71]
    buffer_load_dwordx4 a[204:207], off, s[80:83], s50 offset:3072 sc1
    v_mfma_f32_16x16x32_bf16 v[68:71], a[148:151], a[236:239], v[68:71]
    s_waitcnt lgkmcnt(4)
    v_mfma_f32_16x16x32_bf16 v[68:71], a[144:147], a[228:231], v[68:71]
    v_rcp_f32 v235, v235
    v_mfma_f32_16x16x32_bf16 v[76:79], a[160:163], a[228:231], v[76:79]
    ds_read_b128 a[144:147], v4 offset:6144
    ds_read_b128 a[148:151], v4 offset:15360
    v_mfma_f32_16x16x32_bf16 v[76:79], a[164:167], a[236:239], v[76:79]
    buffer_load_dwordx4 off, s[80:83], s41 offset:3072 sc1 lds
    v_mul_f32 v136, v136, v232
    v_mfma_f32_16x16x32_bf16 v[76:79], a[168:171], a[244:247], v[76:79]
    ds_read_b128 a[152:155], v4 offset:24576
    ds_read_b128 a[156:159], v4 offset:33792
    v_mfma_f32_16x16x32_bf16 v[76:79], a[172:175], a[252:255], v[76:79]
    s_add_u32 s50, s93, 20480
    buffer_load_dwordx4 a[208:211], off, s[80:83], s50 offset:0 sc1
    v_mfma_f32_16x16x32_bf16 v[72:75], a[172:175], a[248:251], v[72:75]
    v_mul_f32 v137, v137, v233
    v_mul_f32 v138, v138, v234
    v_mfma_f32_16x16x32_bf16 v[72:75], a[168:171], a[240:243], v[72:75]
    s_add_u32 m0, s32, 77824
    s_add_u32 s41, s92, 77824
    v_mfma_f32_16x16x32_bf16 v[72:75], a[164:167], a[232:235], v[72:75]
    s_waitcnt lgkmcnt(4)
    v_mul_f32 v139, v139, v235
    v_mfma_f32_16x16x32_bf16 v[72:75], a[160:163], a[224:227], v[72:75]
    v_mul_f32 v236, v140, v140
    v_mul_f32 v237, v141, v141
    v_mfma_f32_16x16x32_bf16 v[80:83], a[176:179], a[224:227], v[80:83]
    ds_read_b128 a[160:163], v4 offset:7168
    ds_read_b128 a[164:167], v4 offset:16384
    v_mfma_f32_16x16x32_bf16 v[80:83], a[180:183], a[232:235], v[80:83]
    buffer_load_dwordx4 a[212:215], off, s[80:83], s50 offset:1024 sc1
    v_mul_f32 v238, v142, v142
    v_mfma_f32_16x16x32_bf16 v[80:83], a[184:187], a[240:243], v[80:83]
    ds_read_b128 a[168:171], v4 offset:25600
    ds_read_b128 a[172:175], v4 offset:34816
    v_mfma_f32_16x16x32_bf16 v[80:83], a[188:191], a[248:251], v[80:83]
    v_mul_f32 v239, v143, v143
    v_fma_f32 v236, v236, v187, v185
    v_mfma_f32_16x16x32_bf16 v[84:87], a[188:191], a[252:255], v[84:87]
    v_fma_f32 v237, v237, v187, v185
    v_fma_f32 v238, v238, v187, v185
    v_mfma_f32_16x16x32_bf16 v[84:87], a[184:187], a[244:247], v[84:87]
    buffer_load_dwordx4 off, s[80:83], s41 offset:0 sc1 lds
    v_fma_f32 v239, v239, v187, v185
    v_mfma_f32_16x16x32_bf16 v[84:87], a[180:183], a[236:239], v[84:87]
    s_waitcnt lgkmcnt(4)
    v_mul_f32 v236, v236, v140
    v_mfma_f32_16x16x32_bf16 v[84:87], a[176:179], a[228:231], v[84:87]
    v_mul_f32 v237, v237, v141
    v_mul_f32 v238, v238, v142
    v_mfma_f32_16x16x32_bf16 v[92:95], a[144:147], a[228:231], v[92:95]
    ds_read_b128 a[176:179], v4 offset:8192
    ds_read_b128 a[180:183], v4 offset:17408
    v_mfma_f32_16x16x32_bf16 v[92:95], a[148:151], a[236:239], v[92:95]
    buffer_load_dwordx4 a[216:219], off, s[80:83], s50 offset:2048 sc1
    v_mul_f32 v239, v239, v143
    v_mfma_f32_16x16x32_bf16 v[92:95], a[152:155], a[244:247], v[92:95]
    ds_read_b128 a[184:187], v4 offset:26624
    ds_read_b128 a[188:191], v4 offset:35840
    v_mfma_f32_16x16x32_bf16 v[92:95], a[156:159], a[252:255], v[92:95]
    buffer_load_dwordx4 off, s[80:83], s41 offset:1024 sc1 lds
    v_mfma_f32_16x16x32_bf16 v[88:91], a[156:159], a[248:251], v[88:91]
    v_exp_f32 v236, v236
    v_mfma_f32_16x16x32_bf16 v[88:91], a[152:155], a[240:243], v[88:91]
    buffer_load_dwordx4 a[220:223], off, s[80:83], s50 offset:3072 sc1
    v_mfma_f32_16x16x32_bf16 v[88:91], a[148:151], a[232:235], v[88:91]
    s_waitcnt lgkmcnt(4)
    v_mfma_f32_16x16x32_bf16 v[88:91], a[144:147], a[224:227], v[88:91]
    v_exp_f32 v237, v237
    v_mfma_f32_16x16x32_bf16 v[96:99], a[160:163], a[224:227], v[96:99]
    s_waitcnt vmcnt(14)
    s_barrier
    v_mfma_f32_16x16x32_bf16 v[96:99], a[164:167], a[232:235], v[96:99]
    buffer_load_dwordx4 off, s[80:83], s41 offset:2048 sc1 lds
    v_mfma_f32_16x16x32_bf16 v[96:99], a[168:171], a[240:243], v[96:99]
    ds_read_b128 a[144:147], v5 offset:0
    ds_read_b128 a[148:151], v5 offset:9216
    v_mfma_f32_16x16x32_bf16 v[96:99], a[172:175], a[248:251], v[96:99]
    v_exp_f32 v238, v238
    v_mfma_f32_16x16x32_bf16 v[100:103], a[172:175], a[252:255], v[100:103]
    ds_read_b128 a[152:155], v5 offset:18432
    ds_read_b128 a[156:159], v5 offset:27648
    v_mfma_f32_16x16x32_bf16 v[100:103], a[168:171], a[244:247], v[100:103]
    buffer_load_dwordx4 off, s[80:83], s41 offset:3072 sc1 lds
    v_mfma_f32_16x16x32_bf16 v[100:103], a[164:167], a[236:239], v[100:103]
    s_waitcnt lgkmcnt(4)
    v_mfma_f32_16x16x32_bf16 v[100:103], a[160:163], a[228:231], v[100:103]
    v_exp_f32 v239, v239
    v_mfma_f32_16x16x32_bf16 v[108:111], a[176:179], a[228:231], v[108:111]
    ds_read_b128 a[160:163], v5 offset:1024
    ds_read_b128 a[164:167], v5 offset:10240
    v_mfma_f32_16x16x32_bf16 v[108:111], a[180:183], a[236:239], v[108:111]
    s_add_u32 m0, s32, 81920
    s_add_u32 s41, s92, 81920
    v_mfma_f32_16x16x32_bf16 v[108:111], a[184:187], a[244:247], v[108:111]
    ds_read_b128 a[168:171], v5 offset:19456
    ds_read_b128 a[172:175], v5 offset:28672
    v_mfma_f32_16x16x32_bf16 v[108:111], a[188:191], a[252:255], v[108:111]
    buffer_load_dwordx4 off, s[80:83], s41 offset:0 sc1 lds
    v_fma_f32 v236, v236, v189, v189
    v_mfma_f32_16x16x32_bf16 v[104:107], a[188:191], a[248:251], v[104:107]
    v_fma_f32 v237, v237, v189, v189
    v_fma_f32 v238, v238, v189, v189
    v_mfma_f32_16x16x32_bf16 v[104:107], a[184:187], a[240:243], v[104:107]
    v_fma_f32 v239, v239, v189, v189
    v_mfma_f32_16x16x32_bf16 v[104:107], a[180:183], a[232:235], v[104:107]
    s_waitcnt lgkmcnt(4)
    v_mfma_f32_16x16x32_bf16 v[104:107], a[176:179], a[224:227], v[104:107]
    v_rcp_f32 v236, v236
    v_mfma_f32_16x16x32_bf16 v[40:43], a[144:147], a[0:3], v[40:43]
    ds_read_b128 a[176:179], v5 offset:2048
    ds_read_b128 a[180:183], v5 offset:11264
    v_mfma_f32_16x16x32_bf16 v[40:43], a[148:151], a[8:11], v[40:43]
    s_cmp_le_u32 s4, 3
    s_cselect_b32 s92, s91, s35
    v_mfma_f32_16x16x32_bf16 v[40:43], a[152:155], a[16:19], v[40:43]
    ds_read_b128 a[184:187], v5 offset:20480
    ds_read_b128 a[188:191], v5 offset:29696
    v_mfma_f32_16x16x32_bf16 v[40:43], a[156:159], a[24:27], v[40:43]
    s_cmp_le_u32 s4, 3
    s_cselect_b32 s93, s90, s36
    v_mfma_f32_16x16x32_bf16 v[44:47], a[156:159], a[28:31], v[44:47]
    v_rcp_f32 v237, v237
    v_mfma_f32_16x16x32_bf16 v[44:47], a[152:155], a[20:23], v[44:47]
    s_add_u32 m0, s32, 110592
    s_add_u32 s41, s92, 110592
    v_mfma_f32_16x16x32_bf16 v[44:47], a[148:151], a[12:15], v[44:47]
    s_waitcnt lgkmcnt(4)
    v_mfma_f32_16x16x32_bf16 v[44:47], a[144:147], a[4:7], v[44:47]
    v_rcp_f32 v238, v238
    v_mfma_f32_16x16x32_bf16 v[52:55], a[160:163], a[4:7], v[52:55]
    ds_read_b128 a[144:147], v5 offset:3072
    ds_read_b128 a[148:151], v5 offset:12288
    v_mfma_f32_16x16x32_bf16 v[52:55], a[164:167], a[12:15], v[52:55]
    s_add_u32 s50, s93, 24576
    buffer_load_dwordx4 a[224:227], off, s[80:83], s50 offset:0 sc1
    v_mfma_f32_16x16x32_bf16 v[52:55], a[168:171], a[20:23], v[52:55]
    ds_read_b128 a[152:155], v5 offset:21504
    ds_read_b128 a[156:159], v5 offset:30720
    v_mfma_f32_16x16x32_bf16 v[52:55], a[172:175], a[28:31], v[52:55]
    v_rcp_f32 v239, v239
    v_mfma_f32_16x16x32_bf16 v[48:51], a[172:175], a[24:27], v[48:51]
    v_mul_f32 v140, v140, v236
    v_mul_f32 v141, v141, v237
    v_mfma_f32_16x16x32_bf16 v[48:51], a[168:171], a[16:19], v[48:51]
    buffer_load_dwordx4 off, s[80:83], s41 offset:0 sc1 lds
    v_mul_f32 v142, v142, v238
    v_mfma_f32_16x16x32_bf16 v[48:51], a[164:167], a[8:11], v[48:51]
    s_waitcnt lgkmcnt(4)
    v_mul_f32 v143, v143, v239
    v_mfma_f32_16x16x32_bf16 v[48:51], a[160:163], a[0:3], v[48:51]
    v_mul_f32 v232, v144, v144
    v_mul_f32 v233, v145, v145
    v_mfma_f32_16x16x32_bf16 v[56:59], a[176:179], a[0:3], v[56:59]
    ds_read_b128 a[160:163], v5 offset:4096
    ds_read_b128 a[164:167], v5 offset:13312
    v_mfma_f32_16x16x32_bf16 v[56:59], a[180:183], a[8:11], v[56:59]
    buffer_load_dwordx4 a[228:231], off, s[80:83], s50 offset:1024 sc1
    v_mul_f32 v234, v146, v146
    v_mfma_f32_16x16x32_bf16 v[56:59], a[184:187], a[16:19], v[56:59]
    ds_read_b128 a[168:171], v5 offset:22528
    ds_read_b128 a[172:175], v5 offset:31744
    v_mfma_f32_16x16x32_bf16 v[56:59], a[188:191], a[24:27], v[56:59]
    buffer_load_dwordx4 off, s[80:83], s41 offset:1024 sc1 lds
    v_mul_f32 v235, v147, v147
    v_mfma_f32_16x16x32_bf16 v[60:63], a[188:191], a[28:31], v[60:63]
    v_fma_f32 v232, v232, v186, v184
    v_fma_f32 v233, v233, v186, v184
    v_mfma_f32_16x16x32_bf16 v[60:63], a[184:187], a[20:23], v[60:63]
    buffer_load_dwordx4 a[232:235], off, s[80:83], s50 offset:2048 sc1
    v_fma_f32 v234, v234, v186, v184
    v_mfma_f32_16x16x32_bf16 v[60:63], a[180:183], a[12:15], v[60:63]
    s_waitcnt lgkmcnt(4)
    v_fma_f32 v235, v235, v186, v184
    v_mfma_f32_16x16x32_bf16 v[60:63], a[176:179], a[4:7], v[60:63]
    v_mul_f32 v232, v232, v144
    v_mul_f32 v233, v233, v145
    v_mfma_f32_16x16x32_bf16 v[68:71], a[144:147], a[4:7], v[68:71]
    ds_read_b128 a[176:179], v5 offset:5120
    ds_read_b128 a[180:183], v5 offset:14336
    v_mfma_f32_16x16x32_bf16 v[68:71], a[148:151], a[12:15], v[68:71]
    buffer_load_dwordx4 off, s[80:83], s41 offset:2048 sc1 lds
    v_mul_f32 v234, v234, v146
    v_mfma_f32_16x16x32_bf16 v[68:71], a[152:155], a[20:23], v[68:71]
    ds_read_b128 a[184:187], v5 offset:23552
    ds_read_b128 a[188:191], v5 offset:32768
    v_mfma_f32_16x16x32_bf16 v[68:71], a[156:159], a[28:31], v[68:71]
    v_mul_f32 v235, v235, v147
    v_mfma_f32_16x16x32_bf16 v[64:67], a[156:159], a[24:27], v[64:67]
    v_exp_f32 v232, v232
    v_mfma_f32_16x16x32_bf16 v[64:67], a[152:155], a[16:19], v[64:67]
    buffer_load_dwordx4 a[236:239], off, s[80:83], s50 offset:3072 sc1
    v_mfma_f32_16x16x32_bf16 v[64:67], a[148:151], a[8:11], v[64:67]
    s_waitcnt lgkmcnt(4)
    v_mfma_f32_16x16x32_bf16 v[64:67], a[144:147], a[0:3], v[64:67]
    v_exp_f32 v233, v233
    v_mfma_f32_16x16x32_bf16 v[72:75], a[160:163], a[0:3], v[72:75]
    ds_read_b128 a[144:147], v5 offset:6144
    ds_read_b128 a[148:151], v5 offset:15360
    v_mfma_f32_16x16x32_bf16 v[72:75], a[164:167], a[8:11], v[72:75]
    buffer_load_dwordx4 off, s[80:83], s41 offset:3072 sc1 lds
    v_mfma_f32_16x16x32_bf16 v[72:75], a[168:171], a[16:19], v[72:75]
    ds_read_b128 a[152:155], v5 offset:24576
    ds_read_b128 a[156:159], v5 offset:33792
    v_mfma_f32_16x16x32_bf16 v[72:75], a[172:175], a[24:27], v[72:75]
    s_add_u32 s50, s93, 28672
    buffer_load_dwordx4 a[240:243], off, s[80:83], s50 offset:0 sc1
    v_mfma_f32_16x16x32_bf16 v[76:79], a[172:175], a[28:31], v[76:79]
    v_exp_f32 v234, v234
    v_mfma_f32_16x16x32_bf16 v[76:79], a[168:171], a[20:23], v[76:79]
    s_add_u32 m0, s32, 114688
    s_add_u32 s41, s92, 114688
    v_mfma_f32_16x16x32_bf16 v[76:79], a[164:167], a[12:15], v[76:79]
    s_waitcnt lgkmcnt(4)
    v_mfma_f32_16x16x32_bf16 v[76:79], a[160:163], a[4:7], v[76:79]
    v_exp_f32 v235, v235
    v_mfma_f32_16x16x32_bf16 v[84:87], a[176:179], a[4:7], v[84:87]
    ds_read_b128 a[160:163], v5 offset:7168
    ds_read_b128 a[164:167], v5 offset:16384
    v_mfma_f32_16x16x32_bf16 v[84:87], a[180:183], a[12:15], v[84:87]
    buffer_load_dwordx4 a[244:247], off, s[80:83], s50 offset:1024 sc1
    v_fma_f32 v232, v232, v188, v188
    v_mfma_f32_16x16x32_bf16 v[84:87], a[184:187], a[20:23], v[84:87]
    ds_read_b128 a[168:171], v5 offset:25600
    ds_read_b128 a[172:175], v5 offset:34816
    v_mfma_f32_16x16x32_bf16 v[84:87], a[188:191], a[28:31], v[84:87]
    v_fma_f32 v233, v233, v188, v188
    v_fma_f32 v234, v234, v188, v188
    v_mfma_f32_16x16x32_bf16 v[80:83], a[188:191], a[24:27], v[80:83]
    v_fma_f32 v235, v235, v188, v188
    v_mfma_f32_16x16x32_bf16 v[80:83], a[184:187], a[16:19], v[80:83]
    buffer_load_dwordx4 off, s[80:83], s41 offset:0 sc1 lds
    v_mfma_f32_16x16x32_bf16 v[80:83], a[180:183], a[8:11], v[80:83]
    s_waitcnt lgkmcnt(4)
    v_mfma_f32_16x16x32_bf16 v[80:83], a[176:179], a[0:3], v[80:83]
    v_rcp_f32 v232, v232
    v_mfma_f32_16x16x32_bf16 v[88:91], a[144:147], a[0:3], v[88:91]
    ds_read_b128 a[176:179], v5 offset:8192
    ds_read_b128 a[180:183], v5 offset:17408
    v_mfma_f32_16x16x32_bf16 v[88:91], a[148:151], a[8:11], v[88:91]
    buffer_load_dwordx4 a[248:251], off, s[80:83], s50 offset:2048 sc1
    v_mfma_f32_16x16x32_bf16 v[88:91], a[152:155], a[16:19], v[88:91]
    ds_read_b128 a[184:187], v5 offset:26624
    ds_read_b128 a[188:191], v5 offset:35840
    v_mfma_f32_16x16x32_bf16 v[88:91], a[156:159], a[24:27], v[88:91]
    buffer_load_dwordx4 off, s[80:83], s41 offset:1024 sc1 lds
    v_mfma_f32_16x16x32_bf16 v[92:95], a[156:159], a[28:31], v[92:95]
    v_rcp_f32 v233, v233
    v_mfma_f32_16x16x32_bf16 v[92:95], a[152:155], a[20:23], v[92:95]
    buffer_load_dwordx4 a[252:255], off, s[80:83], s50 offset:3072 sc1
    v_mfma_f32_16x16x32_bf16 v[92:95], a[148:151], a[12:15], v[92:95]
    s_waitcnt lgkmcnt(4)
    v_mfma_f32_16x16x32_bf16 v[92:95], a[144:147], a[4:7], v[92:95]
    v_rcp_f32 v234, v234
    v_mfma_f32_16x16x32_bf16 v[100:103], a[160:163], a[4:7], v[100:103]
    s_waitcnt vmcnt(14)
    s_barrier
    v_mfma_f32_16x16x32_bf16 v[100:103], a[164:167], a[12:15], v[100:103]
    buffer_load_dwordx4 off, s[80:83], s41 offset:2048 sc1 lds
    v_mfma_f32_16x16x32_bf16 v[100:103], a[168:171], a[20:23], v[100:103]
    ds_read_b128 a[144:147], v6 offset:0
    ds_read_b128 a[148:151], v6 offset:9216
    v_mfma_f32_16x16x32_bf16 v[100:103], a[172:175], a[28:31], v[100:103]
    v_rcp_f32 v235, v235
    v_mfma_f32_16x16x32_bf16 v[96:99], a[172:175], a[24:27], v[96:99]
    ds_read_b128 a[152:155], v6 offset:18432
    ds_read_b128 a[156:159], v6 offset:27648
    v_mfma_f32_16x16x32_bf16 v[96:99], a[168:171], a[16:19], v[96:99]
    buffer_load_dwordx4 off, s[80:83], s41 offset:3072 sc1 lds
    v_mul_f32 v144, v144, v232
    v_mfma_f32_16x16x32_bf16 v[96:99], a[164:167], a[8:11], v[96:99]
    s_waitcnt lgkmcnt(4)
    v_mul_f32 v145, v145, v233
    v_mfma_f32_16x16x32_bf16 v[96:99], a[160:163], a[0:3], v[96:99]
    v_mul_f32 v146, v146, v234
    v_mul_f32 v147, v147, v235
    v_mfma_f32_16x16x32_bf16 v[104:107], a[176:179], a[0:3], v[104:107]
    ds_read_b128 a[160:163], v6 offset:1024
    ds_read_b128 a[164:167], v6 offset:10240
    v_mfma_f32_16x16x32_bf16 v[104:107], a[180:183], a[8:11], v[104:107]
    s_add_u32 m0, s32, 118784
    s_add_u32 s41, s92, 118784
    v_mfma_f32_16x16x32_bf16 v[104:107], a[184:187], a[16:19], v[104:107]
    ds_read_b128 a[168:171], v6 offset:19456
    ds_read_b128 a[172:175], v6 offset:28672
    v_mfma_f32_16x16x32_bf16 v[104:107], a[188:191], a[24:27], v[104:107]
    buffer_load_dwordx4 off, s[80:83], s41 offset:0 sc1 lds
    v_mul_f32 v236, v148, v148
    v_mfma_f32_16x16x32_bf16 v[108:111], a[188:191], a[28:31], v[108:111]
    v_mul_f32 v237, v149, v149
    v_mul_f32 v238, v150, v150
    v_mfma_f32_16x16x32_bf16 v[108:111], a[184:187], a[20:23], v[108:111]
    v_mul_f32 v239, v151, v151
    v_fma_f32 v236, v236, v187, v185
    v_mfma_f32_16x16x32_bf16 v[108:111], a[180:183], a[12:15], v[108:111]
    s_waitcnt lgkmcnt(4)
    v_fma_f32 v237, v237, v187, v185
    v_mfma_f32_16x16x32_bf16 v[108:111], a[176:179], a[4:7], v[108:111]
    v_fma_f32 v238, v238, v187, v185
    v_fma_f32 v239, v239, v187, v185
    v_mfma_f32_16x16x32_bf16 v[44:47], a[144:147], a[196:199], v[44:47]
    ds_read_b128 a[176:179], v6 offset:2048
    ds_read_b128 a[180:183], v6 offset:11264
    v_mfma_f32_16x16x32_bf16 v[44:47], a[148:151], a[204:207], v[44:47]
    s_cmp_le_u32 s4, 4
    s_cselect_b32 s92, s91, s35
    v_mfma_f32_16x16x32_bf16 v[44:47], a[152:155], a[212:215], v[44:47]
    ds_read_b128 a[184:187], v6 offset:20480
    ds_read_b128 a[188:191], v6 offset:29696
    v_mfma_f32_16x16x32_bf16 v[44:47], a[156:159], a[220:223], v[44:47]
    s_cmp_le_u32 s4, 4
    s_cselect_b32 s93, s90, s36
    v_mfma_f32_16x16x32_bf16 v[40:43], a[156:159], a[216:219], v[40:43]
    v_mul_f32 v236, v236, v148
    v_mul_f32 v237, v237, v149
    v_mfma_f32_16x16x32_bf16 v[40:43], a[152:155], a[208:211], v[40:43]
    s_add_u32 m0, s32, 0
    s_add_u32 s41, s92, 147456
    v_mfma_f32_16x16x32_bf16 v[40:43], a[148:151], a[200:203], v[40:43]
    s_waitcnt lgkmcnt(4)
    v_mul_f32 v238, v238, v150
    v_mfma_f32_16x16x32_bf16 v[40:43], a[144:147], a[192:195], v[40:43]
    v_mul_f32 v239, v239, v151
    v_mfma_f32_16x16x32_bf16 v[48:51], a[160:163], a[192:195], v[48:51]
    ds_read_b128 a[144:147], v6 offset:3072
    ds_read_b128 a[148:151], v6 offset:12288
    v_mfma_f32_16x16x32_bf16 v[48:51], a[164:167], a[200:203], v[48:51]
    s_add_u32 s50, s93, 32768
    buffer_load_dwordx4 a[0:3], off, s[80:83], s50 offset:0 sc1
    v_mfma_f32_16x16x32_bf16 v[48:51], a[168:171], a[208:211], v[48:51]
    ds_read_b128 a[152:155], v6 offset:21504
    ds_read_b128 a[156:159], v6 offset:30720
    v_mfma_f32_16x16x32_bf16 v[48:51], a[172:175], a[216:219], v[48:51]
    v_exp_f32 v236, v236
    v_mfma_f32_16x16x32_bf16 v[52:55], a[172:175], a[220:223], v[52:55]
    v_exp_f32 v237, v237
    v_mfma_f32_16x16x32_bf16 v[52:55], a[168:171], a[212:215], v[52:55]
    buffer_load_dwordx4 off, s[80:83], s41 offset:0 sc1 lds
    v_mfma_f32_16x16x32_bf16 v[52:55], a[164:167], a[204:207], v[52:55]
    s_waitcnt lgkmcnt(4)
    v_mfma_f32_16x16x32_bf16 v[52:55], a[160:163], a[196:199], v[52:55]
    v_exp_f32 v238, v238
    v_mfma_f32_16x16x32_bf16 v[60:63], a[176:179], a[196:199], v[60:63]
    ds_read_b128 a[160:163], v6 offset:4096
    ds_read_b128 a[164:167], v6 offset:13312
    v_mfma_f32_16x16x32_bf16 v[60:63], a[180:183], a[204:207], v[60:63]
    buffer_load_dwordx4 a[4:7], off, s[80:83], s50 offset:1024 sc1
    v_mfma_f32_16x16x32_bf16 v[60:63], a[184:187], a[212:215], v[60:63]
    ds_read_b128 a[168:171], v6 offset:22528
    ds_read_b128 a[172:175], v6 offset:31744
    v_mfma_f32_16x16x32_bf16 v[60:63], a[188:191], a[220:223], v[60:63]
    buffer_load_dwordx4 off, s[80:83], s41 offset:1024 sc1 lds
    v_mfma_f32_16x16x32_bf16 v[56:59], a[188:191], a[216:219], v[56:59]
    v_exp_f32 v239, v239
    v_mfma_f32_16x16x32_bf16 v[56:59], a[184:187], a[208:211], v[56:59]
    buffer_load_dwordx4 a[8:11], off, s[80:83], s50 offset:2048 sc1
    v_fma_f32 v236, v236, v189, v189
    v_mfma_f32_16x16x32_bf16 v[56:59], a[180:183], a[200:203], v[56:59]
    s_waitcnt lgkmcnt(4)
    v_fma_f32 v237, v237, v189, v189
    v_mfma_f32_16x16x32_bf16 v[56:59], a[176:179], a[192:195], v[56:59]
    v_fma_f32 v238, v238, v189, v189
    v_fma_f32 v239, v239, v189, v189
    v_mfma_f32_16x16x32_bf16 v[64:67], a[144:147], a[192:195], v[64:67]
    ds_read_b128 a[176:179], v6 offset:5120
    ds_read_b128 a[180:183], v6 offset:14336
    v_mfma_f32_16x16x32_bf16 v[64:67], a[148:151], a[200:203], v[64:67]
    buffer_load_dwordx4 off, s[80:83], s41 offset:2048 sc1 lds
    v_mfma_f32_16x16x32_bf16 v[64:67], a[152:155], a[208:211], v[64:67]
    ds_read_b128 a[184:187], v6 offset:23552
    ds_read_b128 a[188:191], v6 offset:32768
    v_mfma_f32_16x16x32_bf16 v[64:67], a[156:159], a[216:219], v[64:67]
    v_rcp_f32 v236, v236
    v_mfma_f32_16x16x32_bf16 v[68:71], a[156:159], a[220:223], v[68:71]
    v_rcp_f32 v237, v237
    v_mfma_f32_16x16x32_bf16 v[68:71], a[152:155], a[212:215], v[68:71]
    buffer_load_dwordx4 a[12:15], off, s[80:83], s50 offset:3072 sc1
    v_mfma_f32_16x16x32_bf16 v[68:71], a[148:151], a[204:207], v[68:71]
    s_waitcnt lgkmcnt(4)
    v_mfma_f32_16x16x32_bf16 v[68:71], a[144:147], a[196:199], v[68:71]
    v_rcp_f32 v238, v238
    v_mfma_f32_16x16x32_bf16 v[76:79], a[160:163], a[196:199], v[76:79]
    ds_read_b128 a[144:147], v6 offset:6144
    ds_read_b128 a[148:151], v6 offset:15360
    v_mfma_f32_16x16x32_bf16 v[76:79], a[164:167], a[204:207], v[76:79]
    buffer_load_dwordx4 off, s[80:83], s41 offset:3072 sc1 lds
    v_mfma_f32_16x16x32_bf16 v[76:79], a[168:171], a[212:215], v[76:79]
    ds_read_b128 a[152:155], v6 offset:24576
    ds_read_b128 a[156:159], v6 offset:33792
    v_mfma_f32_16x16x32_bf16 v[76:79], a[172:175], a[220:223], v[76:79]
    s_add_u32 s50, s93, 36864
    buffer_load_dwordx4 a[16:19], off, s[80:83], s50 offset:0 sc1
    v_mfma_f32_16x16x32_bf16 v[72:75], a[172:175], a[216:219], v[72:75]
    v_rcp_f32 v239, v239
    v_mfma_f32_16x16x32_bf16 v[72:75], a[168:171], a[208:211], v[72:75]
    s_add_u32 m0, s32, 4096
    s_add_u32 s41, s92, 151552
    v_mfma_f32_16x16x32_bf16 v[72:75], a[164:167], a[200:203], v[72:75]
    s_waitcnt lgkmcnt(4)
    v_mul_f32 v148, v148, v236
    v_mfma_f32_16x16x32_bf16 v[72:75], a[160:163], a[192:195], v[72:75]
    v_mul_f32 v149, v149, v237
    v_mul_f32 v150, v150, v238
    v_mfma_f32_16x16x32_bf16 v[80:83], a[176:179], a[192:195], v[80:83]
    ds_read_b128 a[160:163], v6 offset:7168
    ds_read_b128 a[164:167], v6 offset:16384
    v_mfma_f32_16x16x32_bf16 v[80:83], a[180:183], a[200:203], v[80:83]
    buffer_load_dwordx4 a[20:23], off, s[80:83], s50 offset:1024 sc1
    v_mul_f32 v151, v151, v239
    v_mfma_f32_16x16x32_bf16 v[80:83], a[184:187], a[208:211], v[80:83]
    ds_read_b128 a[168:171], v6 offset:25600
    ds_read_b128 a[172:175], v6 offset:34816
    v_mfma_f32_16x16x32_bf16 v[80:83], a[188:191], a[216:219], v[80:83]
    v_mul_f32 v232, v152, v152
    v_mul_f32 v233, v153, v153
    v_mfma_f32_16x16x32_bf16 v[84:87], a[188:191], a[220:223], v[84:87]
    v_mul_f32 v234, v154, v154
    v_mul_f32 v235, v155, v155
    v_mfma_f32_16x16x32_bf16 v[84:87], a[184:187], a[212:215], v[84:87]
    buffer_load_dwordx4 off, s[80:83], s41 offset:0 sc1 lds
    v_fma_f32 v232, v232, v186, v184
    v_mfma_f32_16x16x32_bf16 v[84:87], a[180:183], a[204:207], v[84:87]
    s_waitcnt lgkmcnt(4)
    v_fma_f32 v233, v233, v186, v184
    v_mfma_f32_16x16x32_bf16 v[84:87], a[176:179], a[196:199], v[84:87]
    v_fma_f32 v234, v234, v186, v184
    v_fma_f32 v235, v235, v186, v184
    v_mfma_f32_16x16x32_bf16 v[92:95], a[144:147], a[196:199], v[92:95]
    ds_read_b128 a[176:179], v6 offset:8192
    ds_read_b128 a[180:183], v6 offset:17408
    v_mfma_f32_16x16x32_bf16 v[92:95], a[148:151], a[204:207], v[92:95]
    buffer_load_dwordx4 a[24:27], off, s[80:83], s50 offset:2048 sc1
    v_mul_f32 v232, v232, v152
    v_mfma_f32_16x16x32_bf16 v[92:95], a[152:155], a[212:215], v[92:95]
    ds_read_b128 a[184:187], v6 offset:26624
    ds_read_b128 a[188:191], v6 offset:35840
    v_mfma_f32_16x16x32_bf16 v[92:95], a[156:159], a[220:223], v[92:95]
    buffer_load_dwordx4 off, s[80:83], s41 offset:1024 sc1 lds
    v_mul_f32 v233, v233, v153
    v_mfma_f32_16x16x32_bf16 v[88:91], a[156:159], a[216:219], v[88:91]
    v_mul_f32 v234, v234, v154
    v_mul_f32 v235, v235, v155
    v_mfma_f32_16x16x32_bf16 v[88:91], a[152:155], a[208:211], v[88:91]
    buffer_load_dwordx4 a[28:31], off, s[80:83], s50 offset:3072 sc1
    v_mfma_f32_16x16x32_bf16 v[88:91], a[148:151], a[200:203], v[88:91]
    s_waitcnt lgkmcnt(4)
    v_mfma_f32_16x16x32_bf16 v[88:91], a[144:147], a[192:195], v[88:91]
    v_exp_f32 v232, v232
    v_mfma_f32_16x16x32_bf16 v[96:99], a[160:163], a[192:195], v[96:99]
    s_waitcnt vmcnt(14)
    s_barrier
    v_mfma_f32_16x16x32_bf16 v[96:99], a[164:167], a[200:203], v[96:99]
    buffer_load_dwordx4 off, s[80:83], s41 offset:2048 sc1 lds
    v_mfma_f32_16x16x32_bf16 v[96:99], a[168:171], a[208:211], v[96:99]
    ds_read_b128 a[144:147], v7 offset:0
    ds_read_b128 a[148:151], v7 offset:9216
    v_mfma_f32_16x16x32_bf16 v[96:99], a[172:175], a[216:219], v[96:99]
    v_exp_f32 v233, v233
    v_mfma_f32_16x16x32_bf16 v[100:103], a[172:175], a[220:223], v[100:103]
    ds_read_b128 a[152:155], v7 offset:18432
    ds_read_b128 a[156:159], v7 offset:27648
    v_mfma_f32_16x16x32_bf16 v[100:103], a[168:171], a[212:215], v[100:103]
    buffer_load_dwordx4 off, s[80:83], s41 offset:3072 sc1 lds
    v_mfma_f32_16x16x32_bf16 v[100:103], a[164:167], a[204:207], v[100:103]
    s_waitcnt lgkmcnt(4)
    v_mfma_f32_16x16x32_bf16 v[100:103], a[160:163], a[196:199], v[100:103]
    v_exp_f32 v234, v234
    v_mfma_f32_16x16x32_bf16 v[108:111], a[176:179], a[196:199], v[108:111]
    ds_read_b128 a[160:163], v7 offset:1024
    ds_read_b128 a[164:167], v7 offset:10240
    v_mfma_f32_16x16x32_bf16 v[108:111], a[180:183], a[204:207], v[108:111]
    s_add_u32 m0, s32, 8192
    s_add_u32 s41, s92, 155648
    v_mfma_f32_16x16x32_bf16 v[108:111], a[184:187], a[212:215], v[108:111]
    ds_read_b128 a[168:171], v7 offset:19456
    ds_read_b128 a[172:175], v7 offset:28672
    v_mfma_f32_16x16x32_bf16 v[108:111], a[188:191], a[220:223], v[108:111]
    buffer_load_dwordx4 off, s[80:83], s41 offset:0 sc1 lds
    v_mfma_f32_16x16x32_bf16 v[104:107], a[188:191], a[216:219], v[104:107]
    v_exp_f32 v235, v235
    v_mfma_f32_16x16x32_bf16 v[104:107], a[184:187], a[208:211], v[104:107]
    v_fma_f32 v232, v232, v188, v188
    v_fma_f32 v233, v233, v188, v188
    v_mfma_f32_16x16x32_bf16 v[104:107], a[180:183], a[200:203], v[104:107]
    s_waitcnt lgkmcnt(4)
    v_fma_f32 v234, v234, v188, v188
    v_mfma_f32_16x16x32_bf16 v[104:107], a[176:179], a[192:195], v[104:107]
    v_fma_f32 v235, v235, v188, v188
    v_mfma_f32_16x16x32_bf16 v[40:43], a[144:147], a[224:227], v[40:43]
    ds_read_b128 a[176:179], v7 offset:2048
    ds_read_b128 a[180:183], v7 offset:11264
    v_mfma_f32_16x16x32_bf16 v[40:43], a[148:151], a[232:235], v[40:43]
    s_cmp_le_u32 s4, 5
    s_cselect_b32 s92, s91, s35
    v_mfma_f32_16x16x32_bf16 v[40:43], a[152:155], a[240:243], v[40:43]
    ds_read_b128 a[184:187], v7 offset:20480
    ds_read_b128 a[188:191], v7 offset:29696
    v_mfma_f32_16x16x32_bf16 v[40:43], a[156:159], a[248:251], v[40:43]
    s_cmp_le_u32 s4, 5
    s_cselect_b32 s93, s90, s36
    v_mfma_f32_16x16x32_bf16 v[44:47], a[156:159], a[252:255], v[44:47]
    v_rcp_f32 v232, v232
    v_mfma_f32_16x16x32_bf16 v[44:47], a[152:155], a[244:247], v[44:47]
    s_add_u32 m0, s32, 36864
    s_add_u32 s41, s92, 184320
    v_mfma_f32_16x16x32_bf16 v[44:47], a[148:151], a[236:239], v[44:47]
    s_waitcnt lgkmcnt(4)
    v_mfma_f32_16x16x32_bf16 v[44:47], a[144:147], a[228:231], v[44:47]
    v_rcp_f32 v233, v233
    v_mfma_f32_16x16x32_bf16 v[52:55], a[160:163], a[228:231], v[52:55]
    ds_read_b128 a[144:147], v7 offset:3072
    ds_read_b128 a[148:151], v7 offset:12288
    v_mfma_f32_16x16x32_bf16 v[52:55], a[164:167], a[236:239], v[52:55]
    s_add_u32 s50, s93, 40960
    buffer_load_dwordx4 a[192:195], off, s[80:83], s50 offset:0 sc1
    v_mfma_f32_16x16x32_bf16 v[52:55], a[168:171], a[244:247], v[52:55]
    ds_read_b128 a[152:155], v7 offset:21504
    ds_read_b128 a[156:159], v7 offset:30720
    v_mfma_f32_16x16x32_bf16 v[52:55], a[172:175], a[252:255], v[52:55]
    v_rcp_f32 v234, v234
    v_mfma_f32_16x16x32_bf16 v[48:51], a[172:175], a[248:251], v[48:51]
    v_rcp_f32 v235, v235
    v_mfma_f32_16x16x32_bf16 v[48:51], a[168:171], a[240:243], v[48:51]
    buffer_load_dwordx4 off, s[80:83], s41 offset:0 sc1 lds
    v_mul_f32 v152, v152, v232
    v_mfma_f32_16x16x32_bf16 v[48:51], a[164:167], a[232:235], v[48:51]
    s_waitcnt lgkmcnt(4)
    v_mul_f32 v153, v153, v233
    v_mfma_f32_16x16x32_bf16 v[48:51], a[160:163], a[224:227], v[48:51]
    v_mul_f32 v154, v154, v234
    v_mul_f32 v155, v155, v235
    v_mfma_f32_16x16x32_bf16 v[56:59], a[176:179], a[224:227], v[56:59]
    ds_read_b128 a[160:163], v7 offset:4096
    ds_read_b128 a[164:167], v7 offset:13312
    v_mfma_f32_16x16x32_bf16 v[56:59], a[180:183], a[232:235], v[56:59]
    buffer_load_dwordx4 a[196:199], off, s[80:83], s50 offset:1024 sc1
    v_mul_f32 v236, v156, v156
    v_mfma_f32_16x16x32_bf16 v[56:59], a[184:187], a[240:243], v[56:59]
    ds_read_b128 a[168:171], v7 offset:22528
    ds_read_b128 a[172:175], v7 offset:31744
    v_mfma_f32_16x16x32_bf16 v[56:59], a[188:191], a[248:251], v[56:59]
    buffer_load_dwordx4 off, s[80:83], s41 offset:1024 sc1 lds
    v_mul_f32 v237, v157, v157
    v_mfma_f32_16x16x32_bf16 v[60:63], a[188:191], a[252:255], v[60:63]
    v_mul_f32 v238, v158, v158
    v_mul_f32 v239, v159, v159
    v_mfma_f32_16x16x32_bf16 v[60:63], a[184:187], a[244:247], v[60:63]
    buffer_load_dwordx4 a[200:203], off, s[80:83], s50 offset:2048 sc1
    v_fma_f32 v236, v236, v187, v185
    v_mfma_f32_16x16x32_bf16 v[60:63], a[180:183], a[236:239], v[60:63]
    s_waitcnt lgkmcnt(4)
    v_fma_f32 v237, v237, v187, v185
    v_mfma_f32_16x16x32_bf16 v[60:63], a[176:179], a[228:231], v[60:63]
    v_fma_f32 v238, v238, v187, v185
    v_fma_f32 v239, v239, v187, v185
    v_mfma_f32_16x16x32_bf16 v[68:71], a[144:147], a[228:231], v[68:71]
    ds_read_b128 a[176:179], v7 offset:5120
    ds_read_b128 a[180:183], v7 offset:14336
    v_mfma_f32_16x16x32_bf16 v[68:71], a[148:151], a[236:239], v[68:71]
    buffer_load_dwordx4 off, s[80:83], s41 offset:2048 sc1 lds
    v_mul_f32 v236, v236, v156
    v_mfma_f32_16x16x32_bf16 v[68:71], a[152:155], a[244:247], v[68:71]
    ds_read_b128 a[184:187], v7 offset:23552
    ds_read_b128 a[188:191], v7 offset:32768
    v_mfma_f32_16x16x32_bf16 v[68:71], a[156:159], a[252:255], v[68:71]
    v_mul_f32 v237, v237, v157
    v_mul_f32 v238, v238, v158
    v_mfma_f32_16x16x32_bf16 v[64:67], a[156:159], a[248:251], v[64:67]
    v_mul_f32 v239, v239, v159
    v_mfma_f32_16x16x32_bf16 v[64:67], a[152:155], a[240:243], v[64:67]
    buffer_load_dwordx4 a[204:207], off, s[80:83], s50 offset:3072 sc1
    v_mfma_f32_16x16x32_bf16 v[64:67], a[148:151], a[232:235], v[64:67]
    s_waitcnt lgkmcnt(4)
    v_mfma_f32_16x16x32_bf16 v[64:67], a[144:147], a[224:227], v[64:67]
    v_exp_f32 v236, v236
    v_mfma_f32_16x16x32_bf16 v[72:75], a[160:163], a[224:227], v[72:75]
    ds_read_b128 a[144:147], v7 offset:6144
    ds_read_b128 a[148:151], v7 offset:15360
    v_mfma_f32_16x16x32_bf16 v[72:75], a[164:167], a[232:235], v[72:75]
    buffer_load_dwordx4 off, s[80:83], s41 offset:3072 sc1 lds
    v_mfma_f32_16x16x32_bf16 v[72:75], a[168:171], a[240:243], v[72:75]
    ds_read_b128 a[152:155], v7 offset:24576
    ds_read_b128 a[156:159], v7 offset:33792
    v_mfma_f32_16x16x32_bf16 v[72:75], a[172:175], a[248:251], v[72:75]
    s_add_u32 s50, s93, 45056
    buffer_load_dwordx4 a[208:211], off, s[80:83], s50 offset:0 sc1
    v_mfma_f32_16x16x32_bf16 v[76:79], a[172:175], a[252:255], v[76:79]
    v_exp_f32 v237, v237
    v_mfma_f32_16x16x32_bf16 v[76:79], a[168:171], a[244:247], v[76:79]
    s_add_u32 m0, s32, 40960
    s_add_u32 s41, s92, 188416
    v_mfma_f32_16x16x32_bf16 v[76:79], a[164:167], a[236:239], v[76:79]
    s_waitcnt lgkmcnt(4)
    v_mfma_f32_16x16x32_bf16 v[76:79], a[160:163], a[228:231], v[76:79]
    v_exp_f32 v238, v238
    v_mfma_f32_16x16x32_bf16 v[84:87], a[176:179], a[228:231], v[84:87]
    ds_read_b128 a[160:163], v7 offset:7168
    ds_read_b128 a[164:167], v7 offset:16384
    v_mfma_f32_16x16x32_bf16 v[84:87], a[180:183], a[236:239], v[84:87]
    buffer_load_dwordx4 a[212:215], off, s[80:83], s50 offset:1024 sc1
    v_mfma_f32_16x16x32_bf16 v[84:87], a[184:187], a[244:247], v[84:87]
    ds_read_b128 a[168:171], v7 offset:25600
    ds_read_b128 a[172:175], v7 offset:34816
    v_mfma_f32_16x16x32_bf16 v[84:87], a[188:191], a[252:255], v[84:87]
    v_exp_f32 v239, v239
    v_mfma_f32_16x16x32_bf16 v[80:83], a[188:191], a[248:251], v[80:83]
    v_fma_f32 v236, v236, v189, v189
    v_fma_f32 v237, v237, v189, v189
    v_mfma_f32_16x16x32_bf16 v[80:83], a[184:187], a[240:243], v[80:83]
    buffer_load_dwordx4 off, s[80:83], s41 offset:0 sc1 lds
    v_fma_f32 v238, v238, v189, v189
    v_mfma_f32_16x16x32_bf16 v[80:83], a[180:183], a[232:235], v[80:83]
    s_waitcnt lgkmcnt(4)
    v_fma_f32 v239, v239, v189, v189
    v_mfma_f32_16x16x32_bf16 v[80:83], a[176:179], a[224:227], v[80:83]
    v_rcp_f32 v236, v236
    v_mfma_f32_16x16x32_bf16 v[88:91], a[144:147], a[224:227], v[88:91]
    ds_read_b128 a[176:179], v7 offset:8192
    ds_read_b128 a[180:183], v7 offset:17408
    v_mfma_f32_16x16x32_bf16 v[88:91], a[148:151], a[232:235], v[88:91]
    buffer_load_dwordx4 a[216:219], off, s[80:83], s50 offset:2048 sc1
    v_mfma_f32_16x16x32_bf16 v[88:91], a[152:155], a[240:243], v[88:91]
    ds_read_b128 a[184:187], v7 offset:26624
    ds_read_b128 a[188:191], v7 offset:35840
    v_mfma_f32_16x16x32_bf16 v[88:91], a[156:159], a[248:251], v[88:91]
    buffer_load_dwordx4 off, s[80:83], s41 offset:1024 sc1 lds
    v_mfma_f32_16x16x32_bf16 v[92:95], a[156:159], a[252:255], v[92:95]
    v_rcp_f32 v237, v237
    v_mfma_f32_16x16x32_bf16 v[92:95], a[152:155], a[244:247], v[92:95]
    buffer_load_dwordx4 a[220:223], off, s[80:83], s50 offset:3072 sc1
    v_mfma_f32_16x16x32_bf16 v[92:95], a[148:151], a[236:239], v[92:95]
    s_waitcnt lgkmcnt(4)
    v_mfma_f32_16x16x32_bf16 v[92:95], a[144:147], a[228:231], v[92:95]
    v_rcp_f32 v238, v238
    v_mfma_f32_16x16x32_bf16 v[100:103], a[160:163], a[228:231], v[100:103]
    s_waitcnt vmcnt(14)
    s_barrier
    v_mfma_f32_16x16x32_bf16 v[100:103], a[164:167], a[236:239], v[100:103]
    buffer_load_dwordx4 off, s[80:83], s41 offset:2048 sc1 lds
    v_mfma_f32_16x16x32_bf16 v[100:103], a[168:171], a[244:247], v[100:103]
    ds_read_b128 a[144:147], v4 offset:0
    ds_read_b128 a[148:151], v4 offset:9216
    v_mfma_f32_16x16x32_bf16 v[100:103], a[172:175], a[252:255], v[100:103]
    v_rcp_f32 v239, v239
    v_mfma_f32_16x16x32_bf16 v[96:99], a[172:175], a[248:251], v[96:99]
    ds_read_b128 a[152:155], v4 offset:18432
    ds_read_b128 a[156:159], v4 offset:27648
    v_mfma_f32_16x16x32_bf16 v[96:99], a[168:171], a[240:243], v[96:99]
    buffer_load_dwordx4 off, s[80:83], s41 offset:3072 sc1 lds
    v_mul_f32 v156, v156, v236
    v_mfma_f32_16x16x32_bf16 v[96:99], a[164:167], a[232:235], v[96:99]
    s_waitcnt lgkmcnt(4)
    v_mul_f32 v157, v157, v237
    v_mfma_f32_16x16x32_bf16 v[96:99], a[160:163], a[224:227], v[96:99]
    v_mul_f32 v158, v158, v238
    v_mul_f32 v159, v159, v239
    v_mfma_f32_16x16x32_bf16 v[104:107], a[176:179], a[224:227], v[104:107]
    ds_read_b128 a[160:163], v4 offset:1024
    ds_read_b128 a[164:167], v4 offset:10240
    v_mfma_f32_16x16x32_bf16 v[104:107], a[180:183], a[232:235], v[104:107]
    s_add_u32 m0, s32, 45056
    s_add_u32 s41, s92, 192512
    v_mfma_f32_16x16x32_bf16 v[104:107], a[184:187], a[240:243], v[104:107]
    ds_read_b128 a[168:171], v4 offset:19456
    ds_read_b128 a[172:175], v4 offset:28672
    v_mfma_f32_16x16x32_bf16 v[104:107], a[188:191], a[248:251], v[104:107]
    buffer_load_dwordx4 off, s[80:83], s41 offset:0 sc1 lds
    v_mul_f32 v232, v160, v160
    v_mfma_f32_16x16x32_bf16 v[108:111], a[188:191], a[252:255], v[108:111]
    v_mul_f32 v233, v161, v161
    v_mul_f32 v234, v162, v162
    v_mfma_f32_16x16x32_bf16 v[108:111], a[184:187], a[244:247], v[108:111]
    v_mul_f32 v235, v163, v163
    v_fma_f32 v232, v232, v186, v184
    v_mfma_f32_16x16x32_bf16 v[108:111], a[180:183], a[236:239], v[108:111]
    s_waitcnt lgkmcnt(4)
    v_fma_f32 v233, v233, v186, v184
    v_mfma_f32_16x16x32_bf16 v[108:111], a[176:179], a[228:231], v[108:111]
    v_fma_f32 v234, v234, v186, v184
    v_fma_f32 v235, v235, v186, v184
    v_mfma_f32_16x16x32_bf16 v[44:47], a[144:147], a[4:7], v[44:47]
    ds_read_b128 a[176:179], v4 offset:2048
    ds_read_b128 a[180:183], v4 offset:11264
    v_mfma_f32_16x16x32_bf16 v[44:47], a[148:151], a[12:15], v[44:47]
    s_cmp_le_u32 s4, 6
    s_cselect_b32 s92, s91, s35
    v_mfma_f32_16x16x32_bf16 v[44:47], a[152:155], a[20:23], v[44:47]
    ds_read_b128 a[184:187], v4 offset:20480
    ds_read_b128 a[188:191], v4 offset:29696
    v_mfma_f32_16x16x32_bf16 v[44:47], a[156:159], a[28:31], v[44:47]
    s_cmp_le_u32 s4, 6
    s_cselect_b32 s93, s90, s36
    v_mfma_f32_16x16x32_bf16 v[40:43], a[156:159], a[24:27], v[40:43]
    v_mul_f32 v232, v232, v160
    v_mul_f32 v233, v233, v161
    v_mfma_f32_16x16x32_bf16 v[40:43], a[152:155], a[16:19], v[40:43]
    s_add_u32 m0, s32, 73728
    s_add_u32 s41, s92, 221184
    v_mfma_f32_16x16x32_bf16 v[40:43], a[148:151], a[8:11], v[40:43]
    s_waitcnt lgkmcnt(4)
    v_mul_f32 v234, v234, v162
    v_mfma_f32_16x16x32_bf16 v[40:43], a[144:147], a[0:3], v[40:43]
    v_mul_f32 v235, v235, v163
    v_mfma_f32_16x16x32_bf16 v[48:51], a[160:163], a[0:3], v[48:51]
    ds_read_b128 a[144:147], v4 offset:3072
    ds_read_b128 a[148:151], v4 offset:12288
    v_mfma_f32_16x16x32_bf16 v[48:51], a[164:167], a[8:11], v[48:51]
    s_add_u32 s50, s93, 49152
    buffer_load_dwordx4 a[224:227], off, s[80:83], s50 offset:0 sc1
    v_mfma_f32_16x16x32_bf16 v[48:51], a[168:171], a[16:19], v[48:51]
    ds_read_b128 a[152:155], v4 offset:21504
    ds_read_b128 a[156:159], v4 offset:30720
    v_mfma_f32_16x16x32_bf16 v[48:51], a[172:175], a[24:27], v[48:51]
    v_exp_f32 v232, v232
    v_mfma_f32_16x16x32_bf16 v[52:55], a[172:175], a[28:31], v[52:55]
    v_exp_f32 v233, v233
    v_mfma_f32_16x16x32_bf16 v[52:55], a[168:171], a[20:23], v[52:55]
    buffer_load_dwordx4 off, s[80:83], s41 offset:0 sc1 lds
    v_mfma_f32_16x16x32_bf16 v[52:55], a[164:167], a[12:15], v[52:55]
    s_waitcnt lgkmcnt(4)
    v_mfma_f32_16x16x32_bf16 v[52:55], a[160:163], a[4:7], v[52:55]
    v_exp_f32 v234, v234
    v_mfma_f32_16x16x32_bf16 v[60:63], a[176:179], a[4:7], v[60:63]
    ds_read_b128 a[160:163], v4 offset:4096
    ds_read_b128 a[164:167], v4 offset:13312
    v_mfma_f32_16x16x32_bf16 v[60:63], a[180:183], a[12:15], v[60:63]
    buffer_load_dwordx4 a[228:231], off, s[80:83], s50 offset:1024 sc1
    v_mfma_f32_16x16x32_bf16 v[60:63], a[184:187], a[20:23], v[60:63]
    ds_read_b128 a[168:171], v4 offset:22528
    ds_read_b128 a[172:175], v4 offset:31744
    v_mfma_f32_16x16x32_bf16 v[60:63], a[188:191], a[28:31], v[60:63]
    buffer_load_dwordx4 off, s[80:83], s41 offset:1024 sc1 lds
    v_mfma_f32_16x16x32_bf16 v[56:59], a[188:191], a[24:27], v[56:59]
    v_exp_f32 v235, v235
    v_mfma_f32_16x16x32_bf16 v[56:59], a[184:187], a[16:19], v[56:59]
    buffer_load_dwordx4 a[232:235], off, s[80:83], s50 offset:2048 sc1
    v_fma_f32 v232, v232, v188, v188
    v_mfma_f32_16x16x32_bf16 v[56:59], a[180:183], a[8:11], v[56:59]
    s_waitcnt lgkmcnt(4)
    v_fma_f32 v233, v233, v188, v188
    v_mfma_f32_16x16x32_bf16 v[56:59], a[176:179], a[0:3], v[56:59]
    v_fma_f32 v234, v234, v188, v188
    v_fma_f32 v235, v235, v188, v188
    v_mfma_f32_16x16x32_bf16 v[64:67], a[144:147], a[0:3], v[64:67]
    ds_read_b128 a[176:179], v4 offset:5120
    ds_read_b128 a[180:183], v4 offset:14336
    v_mfma_f32_16x16x32_bf16 v[64:67], a[148:151], a[8:11], v[64:67]
    buffer_load_dwordx4 off, s[80:83], s41 offset:2048 sc1 lds
    v_mfma_f32_16x16x32_bf16 v[64:67], a[152:155], a[16:19], v[64:67]
    ds_read_b128 a[184:187], v4 offset:23552
    ds_read_b128 a[188:191], v4 offset:32768
    v_mfma_f32_16x16x32_bf16 v[64:67], a[156:159], a[24:27], v[64:67]
    v_rcp_f32 v232, v232
    v_mfma_f32_16x16x32_bf16 v[68:71], a[156:159], a[28:31], v[68:71]
    v_rcp_f32 v233, v233
    v_mfma_f32_16x16x32_bf16 v[68:71], a[152:155], a[20:23], v[68:71]
    buffer_load_dwordx4 a[236:239], off, s[80:83], s50 offset:3072 sc1
    v_mfma_f32_16x16x32_bf16 v[68:71], a[148:151], a[12:15], v[68:71]
    s_waitcnt lgkmcnt(4)
    v_mfma_f32_16x16x32_bf16 v[68:71], a[144:147], a[4:7], v[68:71]
    v_rcp_f32 v234, v234
    v_mfma_f32_16x16x32_bf16 v[76:79], a[160:163], a[4:7], v[76:79]
    ds_read_b128 a[144:147], v4 offset:6144
    ds_read_b128 a[148:151], v4 offset:15360
    v_mfma_f32_16x16x32_bf16 v[76:79], a[164:167], a[12:15], v[76:79]
    buffer_load_dwordx4 off, s[80:83], s41 offset:3072 sc1 lds
    v_mfma_f32_16x16x32_bf16 v[76:79], a[168:171], a[20:23], v[76:79]
    ds_read_b128 a[152:155], v4 offset:24576
    ds_read_b128 a[156:159], v4 offset:33792
    v_mfma_f32_16x16x32_bf16 v[76:79], a[172:175], a[28:31], v[76:79]
    s_add_u32 s50, s93, 53248
    buffer_load_dwordx4 a[240:243], off, s[80:83], s50 offset:0 sc1
    v_mfma_f32_16x16x32_bf16 v[72:75], a[172:175], a[24:27], v[72:75]
    v_rcp_f32 v235, v235
    v_mfma_f32_16x16x32_bf16 v[72:75], a[168:171], a[16:19], v[72:75]
    s_add_u32 m0, s32, 77824
    s_add_u32 s41, s92, 225280
    v_mfma_f32_16x16x32_bf16 v[72:75], a[164:167], a[8:11], v[72:75]
    s_waitcnt lgkmcnt(4)
    v_mul_f32 v160, v160, v232
    v_mfma_f32_16x16x32_bf16 v[72:75], a[160:163], a[0:3], v[72:75]
    v_mul_f32 v161, v161, v233
    v_mul_f32 v162, v162, v234
    v_mfma_f32_16x16x32_bf16 v[80:83], a[176:179], a[0:3], v[80:83]
    ds_read_b128 a[160:163], v4 offset:7168
    ds_read_b128 a[164:167], v4 offset:16384
    v_mfma_f32_16x16x32_bf16 v[80:83], a[180:183], a[8:11], v[80:83]
    buffer_load_dwordx4 a[244:247], off, s[80:83], s50 offset:1024 sc1
    v_mul_f32 v163, v163, v235
    v_mfma_f32_16x16x32_bf16 v[80:83], a[184:187], a[16:19], v[80:83]
    ds_read_b128 a[168:171], v4 offset:25600
    ds_read_b128 a[172:175], v4 offset:34816
    v_mfma_f32_16x16x32_bf16 v[80:83], a[188:191], a[24:27], v[80:83]
    v_mul_f32 v236, v164, v164
    v_mul_f32 v237, v165, v165
    v_mfma_f32_16x16x32_bf16 v[84:87], a[188:191], a[28:31], v[84:87]
    v_mul_f32 v238, v166, v166
    v_mul_f32 v239, v167, v167
    v_mfma_f32_16x16x32_bf16 v[84:87], a[184:187], a[20:23], v[84:87]
    buffer_load_dwordx4 off, s[80:83], s41 offset:0 sc1 lds
    v_fma_f32 v236, v236, v187, v185
    v_mfma_f32_16x16x32_bf16 v[84:87], a[180:183], a[12:15], v[84:87]
    s_waitcnt lgkmcnt(4)
    v_fma_f32 v237, v237, v187, v185
    v_mfma_f32_16x16x32_bf16 v[84:87], a[176:179], a[4:7], v[84:87]
    v_fma_f32 v238, v238, v187, v185
    v_fma_f32 v239, v239, v187, v185
    v_mfma_f32_16x16x32_bf16 v[92:95], a[144:147], a[4:7], v[92:95]
    ds_read_b128 a[176:179], v4 offset:8192
    ds_read_b128 a[180:183], v4 offset:17408
    v_mfma_f32_16x16x32_bf16 v[92:95], a[148:151], a[12:15], v[92:95]
    buffer_load_dwordx4 a[248:251], off, s[80:83], s50 offset:2048 sc1
    v_mul_f32 v236, v236, v164
    v_mfma_f32_16x16x32_bf16 v[92:95], a[152:155], a[20:23], v[92:95]
    ds_read_b128 a[184:187], v4 offset:26624
    ds_read_b128 a[188:191], v4 offset:35840
    v_mfma_f32_16x16x32_bf16 v[92:95], a[156:159], a[28:31], v[92:95]
    buffer_load_dwordx4 off, s[80:83], s41 offset:1024 sc1 lds
    v_mul_f32 v237, v237, v165
    v_mfma_f32_16x16x32_bf16 v[88:91], a[156:159], a[24:27], v[88:91]
    v_mul_f32 v238, v238, v166
    v_mul_f32 v239, v239, v167
    v_mfma_f32_16x16x32_bf16 v[88:91], a[152:155], a[16:19], v[88:91]
    buffer_load_dwordx4 a[252:255], off, s[80:83], s50 offset:3072 sc1
    v_mfma_f32_16x16x32_bf16 v[88:91], a[148:151], a[8:11], v[88:91]
    s_waitcnt lgkmcnt(4)
    v_mfma_f32_16x16x32_bf16 v[88:91], a[144:147], a[0:3], v[88:91]
    v_exp_f32 v236, v236
    v_mfma_f32_16x16x32_bf16 v[96:99], a[160:163], a[0:3], v[96:99]
    s_waitcnt vmcnt(14)
    s_barrier
    v_mfma_f32_16x16x32_bf16 v[96:99], a[164:167], a[8:11], v[96:99]
    buffer_load_dwordx4 off, s[80:83], s41 offset:2048 sc1 lds
    v_mfma_f32_16x16x32_bf16 v[96:99], a[168:171], a[16:19], v[96:99]
    ds_read_b128 a[144:147], v5 offset:0
    ds_read_b128 a[148:151], v5 offset:9216
    v_mfma_f32_16x16x32_bf16 v[96:99], a[172:175], a[24:27], v[96:99]
    v_exp_f32 v237, v237
    v_mfma_f32_16x16x32_bf16 v[100:103], a[172:175], a[28:31], v[100:103]
    ds_read_b128 a[152:155], v5 offset:18432
    ds_read_b128 a[156:159], v5 offset:27648
    v_mfma_f32_16x16x32_bf16 v[100:103], a[168:171], a[20:23], v[100:103]
    buffer_load_dwordx4 off, s[80:83], s41 offset:3072 sc1 lds
    v_mfma_f32_16x16x32_bf16 v[100:103], a[164:167], a[12:15], v[100:103]
    s_waitcnt lgkmcnt(4)
    v_mfma_f32_16x16x32_bf16 v[100:103], a[160:163], a[4:7], v[100:103]
    v_exp_f32 v238, v238
    v_mfma_f32_16x16x32_bf16 v[108:111], a[176:179], a[4:7], v[108:111]
    ds_read_b128 a[160:163], v5 offset:1024
    ds_read_b128 a[164:167], v5 offset:10240
    v_mfma_f32_16x16x32_bf16 v[108:111], a[180:183], a[12:15], v[108:111]
    s_add_u32 m0, s32, 81920
    s_add_u32 s41, s92, 229376
    v_mfma_f32_16x16x32_bf16 v[108:111], a[184:187], a[20:23], v[108:111]
    ds_read_b128 a[168:171], v5 offset:19456
    ds_read_b128 a[172:175], v5 offset:28672
    v_mfma_f32_16x16x32_bf16 v[108:111], a[188:191], a[28:31], v[108:111]
    buffer_load_dwordx4 off, s[80:83], s41 offset:0 sc1 lds
    v_mfma_f32_16x16x32_bf16 v[104:107], a[188:191], a[24:27], v[104:107]
    v_exp_f32 v239, v239
    v_mfma_f32_16x16x32_bf16 v[104:107], a[184:187], a[16:19], v[104:107]
    v_fma_f32 v236, v236, v189, v189
    v_fma_f32 v237, v237, v189, v189
    v_mfma_f32_16x16x32_bf16 v[104:107], a[180:183], a[8:11], v[104:107]
    s_waitcnt lgkmcnt(4)
    v_fma_f32 v238, v238, v189, v189
    v_mfma_f32_16x16x32_bf16 v[104:107], a[176:179], a[0:3], v[104:107]
    v_fma_f32 v239, v239, v189, v189
    v_mfma_f32_16x16x32_bf16 v[40:43], a[144:147], a[192:195], v[40:43]
    ds_read_b128 a[176:179], v5 offset:2048
    ds_read_b128 a[180:183], v5 offset:11264
    v_mfma_f32_16x16x32_bf16 v[40:43], a[148:151], a[200:203], v[40:43]
    s_cmp_le_u32 s4, 7
    s_cselect_b32 s92, s91, s35
    v_mfma_f32_16x16x32_bf16 v[40:43], a[152:155], a[208:211], v[40:43]
    ds_read_b128 a[184:187], v5 offset:20480
    ds_read_b128 a[188:191], v5 offset:29696
    v_mfma_f32_16x16x32_bf16 v[40:43], a[156:159], a[216:219], v[40:43]
    s_cmp_le_u32 s4, 7
    s_cselect_b32 s93, s90, s36
    v_mfma_f32_16x16x32_bf16 v[44:47], a[156:159], a[220:223], v[44:47]
    v_rcp_f32 v236, v236
    v_mfma_f32_16x16x32_bf16 v[44:47], a[152:155], a[212:215], v[44:47]
    s_add_u32 m0, s32, 110592
    s_add_u32 s41, s92, 258048
    v_mfma_f32_16x16x32_bf16 v[44:47], a[148:151], a[204:207], v[44:47]
    s_waitcnt lgkmcnt(4)
    v_mfma_f32_16x16x32_bf16 v[44:47], a[144:147], a[196:199], v[44:47]
    v_rcp_f32 v237, v237
    v_mfma_f32_16x16x32_bf16 v[52:55], a[160:163], a[196:199], v[52:55]
    ds_read_b128 a[144:147], v5 offset:3072
    ds_read_b128 a[148:151], v5 offset:12288
    v_mfma_f32_16x16x32_bf16 v[52:55], a[164:167], a[204:207], v[52:55]
    s_add_u32 s50, s93, 57344
    buffer_load_dwordx4 a[0:3], off, s[80:83], s50 offset:0 sc1
    v_mfma_f32_16x16x32_bf16 v[52:55], a[168:171], a[212:215], v[52:55]
    ds_read_b128 a[152:155], v5 offset:21504
    ds_read_b128 a[156:159], v5 offset:30720
    v_mfma_f32_16x16x32_bf16 v[52:55], a[172:175], a[220:223], v[52:55]
    v_rcp_f32 v238, v238
    v_mfma_f32_16x16x32_bf16 v[48:51], a[172:175], a[216:219], v[48:51]
    v_rcp_f32 v239, v239
    v_mfma_f32_16x16x32_bf16 v[48:51], a[168:171], a[208:211], v[48:51]
    buffer_load_dwordx4 off, s[80:83], s41 offset:0 sc1 lds
    v_mul_f32 v164, v164, v236
    v_mfma_f32_16x16x32_bf16 v[48:51], a[164:167], a[200:203], v[48:51]
    s_waitcnt lgkmcnt(4)
    v_mul_f32 v165, v165, v237
    v_mfma_f32_16x16x32_bf16 v[48:51], a[160:163], a[192:195], v[48:51]
    v_mul_f32 v166, v166, v238
    v_mul_f32 v167, v167, v239
    v_mfma_f32_16x16x32_bf16 v[56:59], a[176:179], a[192:195], v[56:59]
    ds_read_b128 a[160:163], v5 offset:4096
    ds_read_b128 a[164:167], v5 offset:13312
    v_mfma_f32_16x16x32_bf16 v[56:59], a[180:183], a[200:203], v[56:59]
    buffer_load_dwordx4 a[4:7], off, s[80:83], s50 offset:1024 sc1
    v_mul_f32 v232, v168, v168
    v_mfma_f32_16x16x32_bf16 v[56:59], a[184:187], a[208:211], v[56:59]
    ds_read_b128 a[168:171], v5 offset:22528
    ds_read_b128 a[172:175], v5 offset:31744
    v_mfma_f32_16x16x32_bf16 v[56:59], a[188:191], a[216:219], v[56:59]
    buffer_load_dwordx4 off, s[80:83], s41 offset:1024 sc1 lds
    v_mul_f32 v233, v169, v169
    v_mfma_f32_16x16x32_bf16 v[60:63], a[188:191], a[220:223], v[60:63]
    v_mul_f32 v234, v170, v170
    v_mul_f32 v235, v171, v171
    v_mfma_f32_16x16x32_bf16 v[60:63], a[184:187], a[212:215], v[60:63]
    buffer_load_dwordx4 a[8:11], off, s[80:83], s50 offset:2048 sc1
    v_fma_f32 v232, v232, v186, v184
    v_mfma_f32_16x16x32_bf16 v[60:63], a[180:183], a[204:207], v[60:63]
    s_waitcnt lgkmcnt(4)
    v_fma_f32 v233, v233, v186, v184
    v_mfma_f32_16x16x32_bf16 v[60:63], a[176:179], a[196:199], v[60:63]
    v_fma_f32 v234, v234, v186, v184
    v_fma_f32 v235, v235, v186, v184
    v_mfma_f32_16x16x32_bf16 v[68:71], a[144:147], a[196:199], v[68:71]
    ds_read_b128 a[176:179], v5 offset:5120
    ds_read_b128 a[180:183], v5 offset:14336
    v_mfma_f32_16x16x32_bf16 v[68:71], a[148:151], a[204:207], v[68:71]
    buffer_load_dwordx4 off, s[80:83], s41 offset:2048 sc1 lds
    v_mul_f32 v232, v232, v168
    v_mfma_f32_16x16x32_bf16 v[68:71], a[152:155], a[212:215], v[68:71]
    ds_read_b128 a[184:187], v5 offset:23552
    ds_read_b128 a[188:191], v5 offset:32768
    v_mfma_f32_16x16x32_bf16 v[68:71], a[156:159], a[220:223], v[68:71]
    v_mul_f32 v233, v233, v169
    v_mul_f32 v234, v234, v170
    v_mfma_f32_16x16x32_bf16 v[64:67], a[156:159], a[216:219], v[64:67]
    v_mul_f32 v235, v235, v171
    v_mfma_f32_16x16x32_bf16 v[64:67], a[152:155], a[208:211], v[64:67]
    buffer_load_dwordx4 a[12:15], off, s[80:83], s50 offset:3072 sc1
    v_mfma_f32_16x16x32_bf16 v[64:67], a[148:151], a[200:203], v[64:67]
    s_waitcnt lgkmcnt(4)
    v_mfma_f32_16x16x32_bf16 v[64:67], a[144:147], a[192:195], v[64:67]
    v_exp_f32 v232, v232
    v_mfma_f32_16x16x32_bf16 v[72:75], a[160:163], a[192:195], v[72:75]
    ds_read_b128 a[144:147], v5 offset:6144
    ds_read_b128 a[148:151], v5 offset:15360
    v_mfma_f32_16x16x32_bf16 v[72:75], a[164:167], a[200:203], v[72:75]
    buffer_load_dwordx4 off, s[80:83], s41 offset:3072 sc1 lds
    v_mfma_f32_16x16x32_bf16 v[72:75], a[168:171], a[208:211], v[72:75]
    ds_read_b128 a[152:155], v5 offset:24576
    ds_read_b128 a[156:159], v5 offset:33792
    v_mfma_f32_16x16x32_bf16 v[72:75], a[172:175], a[216:219], v[72:75]
    s_add_u32 s50, s93, 61440
    buffer_load_dwordx4 a[16:19], off, s[80:83], s50 offset:0 sc1
    v_mfma_f32_16x16x32_bf16 v[76:79], a[172:175], a[220:223], v[76:79]
    v_exp_f32 v233, v233
    v_mfma_f32_16x16x32_bf16 v[76:79], a[168:171], a[212:215], v[76:79]
    s_add_u32 m0, s32, 114688
    s_add_u32 s41, s92, 262144
    v_mfma_f32_16x16x32_bf16 v[76:79], a[164:167], a[204:207], v[76:79]
    s_waitcnt lgkmcnt(4)
    v_mfma_f32_16x16x32_bf16 v[76:79], a[160:163], a[196:199], v[76:79]
    v_exp_f32 v234, v234
    v_mfma_f32_16x16x32_bf16 v[84:87], a[176:179], a[196:199], v[84:87]
    ds_read_b128 a[160:163], v5 offset:7168
    ds_read_b128 a[164:167], v5 offset:16384
    v_mfma_f32_16x16x32_bf16 v[84:87], a[180:183], a[204:207], v[84:87]
    buffer_load_dwordx4 a[20:23], off, s[80:83], s50 offset:1024 sc1
    v_mfma_f32_16x16x32_bf16 v[84:87], a[184:187], a[212:215], v[84:87]
    ds_read_b128 a[168:171], v5 offset:25600
    ds_read_b128 a[172:175], v5 offset:34816
    v_mfma_f32_16x16x32_bf16 v[84:87], a[188:191], a[220:223], v[84:87]
    v_exp_f32 v235, v235
    v_mfma_f32_16x16x32_bf16 v[80:83], a[188:191], a[216:219], v[80:83]
    v_fma_f32 v232, v232, v188, v188
    v_fma_f32 v233, v233, v188, v188
    v_mfma_f32_16x16x32_bf16 v[80:83], a[184:187], a[208:211], v[80:83]
    buffer_load_dwordx4 off, s[80:83], s41 offset:0 sc1 lds
    v_fma_f32 v234, v234, v188, v188
    v_mfma_f32_16x16x32_bf16 v[80:83], a[180:183], a[200:203], v[80:83]
    s_waitcnt lgkmcnt(4)
    v_fma_f32 v235, v235, v188, v188
    v_mfma_f32_16x16x32_bf16 v[80:83], a[176:179], a[192:195], v[80:83]
    v_rcp_f32 v232, v232
    v_mfma_f32_16x16x32_bf16 v[88:91], a[144:147], a[192:195], v[88:91]
    ds_read_b128 a[176:179], v5 offset:8192
    ds_read_b128 a[180:183], v5 offset:17408
    v_mfma_f32_16x16x32_bf16 v[88:91], a[148:151], a[200:203], v[88:91]
    buffer_load_dwordx4 a[24:27], off, s[80:83], s50 offset:2048 sc1
    v_mfma_f32_16x16x32_bf16 v[88:91], a[152:155], a[208:211], v[88:91]
    ds_read_b128 a[184:187], v5 offset:26624
    ds_read_b128 a[188:191], v5 offset:35840
    v_mfma_f32_16x16x32_bf16 v[88:91], a[156:159], a[216:219], v[88:91]
    buffer_load_dwordx4 off, s[80:83], s41 offset:1024 sc1 lds
    v_mfma_f32_16x16x32_bf16 v[92:95], a[156:159], a[220:223], v[92:95]
    v_rcp_f32 v233, v233
    v_mfma_f32_16x16x32_bf16 v[92:95], a[152:155], a[212:215], v[92:95]
    buffer_load_dwordx4 a[28:31], off, s[80:83], s50 offset:3072 sc1
    v_mfma_f32_16x16x32_bf16 v[92:95], a[148:151], a[204:207], v[92:95]
    s_waitcnt lgkmcnt(4)
    v_mfma_f32_16x16x32_bf16 v[92:95], a[144:147], a[196:199], v[92:95]
    v_rcp_f32 v234, v234
    v_mfma_f32_16x16x32_bf16 v[100:103], a[160:163], a[196:199], v[100:103]
    s_waitcnt vmcnt(14)
    s_barrier
    v_mfma_f32_16x16x32_bf16 v[100:103], a[164:167], a[204:207], v[100:103]
    buffer_load_dwordx4 off, s[80:83], s41 offset:2048 sc1 lds
    v_mfma_f32_16x16x32_bf16 v[100:103], a[168:171], a[212:215], v[100:103]
    ds_read_b128 a[144:147], v6 offset:0
    ds_read_b128 a[148:151], v6 offset:9216
    v_mfma_f32_16x16x32_bf16 v[100:103], a[172:175], a[220:223], v[100:103]
    v_rcp_f32 v235, v235
    v_mfma_f32_16x16x32_bf16 v[96:99], a[172:175], a[216:219], v[96:99]
    ds_read_b128 a[152:155], v6 offset:18432
    ds_read_b128 a[156:159], v6 offset:27648
    v_mfma_f32_16x16x32_bf16 v[96:99], a[168:171], a[208:211], v[96:99]
    buffer_load_dwordx4 off, s[80:83], s41 offset:3072 sc1 lds
    v_mul_f32 v168, v168, v232
    v_mfma_f32_16x16x32_bf16 v[96:99], a[164:167], a[200:203], v[96:99]
    s_waitcnt lgkmcnt(4)
    v_mul_f32 v169, v169, v233
    v_mfma_f32_16x16x32_bf16 v[96:99], a[160:163], a[192:195], v[96:99]
    v_mul_f32 v170, v170, v234
    v_mul_f32 v171, v171, v235
    v_mfma_f32_16x16x32_bf16 v[104:107], a[176:179], a[192:195], v[104:107]
    ds_read_b128 a[160:163], v6 offset:1024
    ds_read_b128 a[164:167], v6 offset:10240
    v_mfma_f32_16x16x32_bf16 v[104:107], a[180:183], a[200:203], v[104:107]
    s_add_u32 m0, s32, 118784
    s_add_u32 s41, s92, 266240
    v_mfma_f32_16x16x32_bf16 v[104:107], a[184:187], a[208:211], v[104:107]
    ds_read_b128 a[168:171], v6 offset:19456
    ds_read_b128 a[172:175], v6 offset:28672
    v_mfma_f32_16x16x32_bf16 v[104:107], a[188:191], a[216:219], v[104:107]
    buffer_load_dwordx4 off, s[80:83], s41 offset:0 sc1 lds
    v_mul_f32 v236, v172, v172
    v_mfma_f32_16x16x32_bf16 v[108:111], a[188:191], a[220:223], v[108:111]
    v_mul_f32 v237, v173, v173
    v_mul_f32 v238, v174, v174
    v_mfma_f32_16x16x32_bf16 v[108:111], a[184:187], a[212:215], v[108:111]
    v_mul_f32 v239, v175, v175
    v_fma_f32 v236, v236, v187, v185
    v_mfma_f32_16x16x32_bf16 v[108:111], a[180:183], a[204:207], v[108:111]
    s_waitcnt lgkmcnt(4)
    v_fma_f32 v237, v237, v187, v185
    v_mfma_f32_16x16x32_bf16 v[108:111], a[176:179], a[196:199], v[108:111]
    v_fma_f32 v238, v238, v187, v185
    v_fma_f32 v239, v239, v187, v185
    v_mfma_f32_16x16x32_bf16 v[44:47], a[144:147], a[228:231], v[44:47]
    ds_read_b128 a[176:179], v6 offset:2048
    ds_read_b128 a[180:183], v6 offset:11264
    v_mfma_f32_16x16x32_bf16 v[44:47], a[148:151], a[236:239], v[44:47]
    s_cmp_le_u32 s4, 8
    s_cselect_b32 s92, s91, s35
    v_mfma_f32_16x16x32_bf16 v[44:47], a[152:155], a[244:247], v[44:47]
    ds_read_b128 a[184:187], v6 offset:20480
    ds_read_b128 a[188:191], v6 offset:29696
    v_mfma_f32_16x16x32_bf16 v[44:47], a[156:159], a[252:255], v[44:47]
    s_cmp_le_u32 s4, 8
    s_cselect_b32 s93, s90, s36
    v_mfma_f32_16x16x32_bf16 v[40:43], a[156:159], a[248:251], v[40:43]
    v_mul_f32 v236, v236, v172
    v_mul_f32 v237, v237, v173
    v_mfma_f32_16x16x32_bf16 v[40:43], a[152:155], a[240:243], v[40:43]
    s_add_u32 m0, s32, 0
    s_add_u32 s41, s92, 294912
    v_mfma_f32_16x16x32_bf16 v[40:43], a[148:151], a[232:235], v[40:43]
    s_waitcnt lgkmcnt(4)
    v_mul_f32 v238, v238, v174
    v_mfma_f32_16x16x32_bf16 v[40:43], a[144:147], a[224:227], v[40:43]
    v_mul_f32 v239, v239, v175
    v_mfma_f32_16x16x32_bf16 v[48:51], a[160:163], a[224:227], v[48:51]
    ds_read_b128 a[144:147], v6 offset:3072
    ds_read_b128 a[148:151], v6 offset:12288
    v_mfma_f32_16x16x32_bf16 v[48:51], a[164:167], a[232:235], v[48:51]
    s_add_u32 s50, s93, 65536
    buffer_load_dwordx4 a[192:195], off, s[80:83], s50 offset:0 sc1
    v_mfma_f32_16x16x32_bf16 v[48:51], a[168:171], a[240:243], v[48:51]
    ds_read_b128 a[152:155], v6 offset:21504
    ds_read_b128 a[156:159], v6 offset:30720
    v_mfma_f32_16x16x32_bf16 v[48:51], a[172:175], a[248:251], v[48:51]
    v_exp_f32 v236, v236
    v_mfma_f32_16x16x32_bf16 v[52:55], a[172:175], a[252:255], v[52:55]
    v_exp_f32 v237, v237
    v_mfma_f32_16x16x32_bf16 v[52:55], a[168:171], a[244:247], v[52:55]
    buffer_load_dwordx4 off, s[80:83], s41 offset:0 sc1 lds
    v_mfma_f32_16x16x32_bf16 v[52:55], a[164:167], a[236:239], v[52:55]
    s_waitcnt lgkmcnt(4)
    v_mfma_f32_16x16x32_bf16 v[52:55], a[160:163], a[228:231], v[52:55]
    v_exp_f32 v238, v238
    v_mfma_f32_16x16x32_bf16 v[60:63], a[176:179], a[228:231], v[60:63]
    ds_read_b128 a[160:163], v6 offset:4096
    ds_read_b128 a[164:167], v6 offset:13312
    v_mfma_f32_16x16x32_bf16 v[60:63], a[180:183], a[236:239], v[60:63]
    buffer_load_dwordx4 a[196:199], off, s[80:83], s50 offset:1024 sc1
    v_mfma_f32_16x16x32_bf16 v[60:63], a[184:187], a[244:247], v[60:63]
    ds_read_b128 a[168:171], v6 offset:22528
    ds_read_b128 a[172:175], v6 offset:31744
    v_mfma_f32_16x16x32_bf16 v[60:63], a[188:191], a[252:255], v[60:63]
    buffer_load_dwordx4 off, s[80:83], s41 offset:1024 sc1 lds
    v_mfma_f32_16x16x32_bf16 v[56:59], a[188:191], a[248:251], v[56:59]
    v_exp_f32 v239, v239
    v_mfma_f32_16x16x32_bf16 v[56:59], a[184:187], a[240:243], v[56:59]
    buffer_load_dwordx4 a[200:203], off, s[80:83], s50 offset:2048 sc1
    v_fma_f32 v236, v236, v189, v189
    v_mfma_f32_16x16x32_bf16 v[56:59], a[180:183], a[232:235], v[56:59]
    s_waitcnt lgkmcnt(4)
    v_fma_f32 v237, v237, v189, v189
    v_mfma_f32_16x16x32_bf16 v[56:59], a[176:179], a[224:227], v[56:59]
    v_fma_f32 v238, v238, v189, v189
    v_fma_f32 v239, v239, v189, v189
    v_mfma_f32_16x16x32_bf16 v[64:67], a[144:147], a[224:227], v[64:67]
    ds_read_b128 a[176:179], v6 offset:5120
    ds_read_b128 a[180:183], v6 offset:14336
    v_mfma_f32_16x16x32_bf16 v[64:67], a[148:151], a[232:235], v[64:67]
    buffer_load_dwordx4 off, s[80:83], s41 offset:2048 sc1 lds
    v_mfma_f32_16x16x32_bf16 v[64:67], a[152:155], a[240:243], v[64:67]
    ds_read_b128 a[184:187], v6 offset:23552
    ds_read_b128 a[188:191], v6 offset:32768
    v_mfma_f32_16x16x32_bf16 v[64:67], a[156:159], a[248:251], v[64:67]
    v_rcp_f32 v236, v236
    v_mfma_f32_16x16x32_bf16 v[68:71], a[156:159], a[252:255], v[68:71]
    v_rcp_f32 v237, v237
    v_mfma_f32_16x16x32_bf16 v[68:71], a[152:155], a[244:247], v[68:71]
    buffer_load_dwordx4 a[204:207], off, s[80:83], s50 offset:3072 sc1
    v_mfma_f32_16x16x32_bf16 v[68:71], a[148:151], a[236:239], v[68:71]
    s_waitcnt lgkmcnt(4)
    v_mfma_f32_16x16x32_bf16 v[68:71], a[144:147], a[228:231], v[68:71]
    v_rcp_f32 v238, v238
    v_mfma_f32_16x16x32_bf16 v[76:79], a[160:163], a[228:231], v[76:79]
    ds_read_b128 a[144:147], v6 offset:6144
    ds_read_b128 a[148:151], v6 offset:15360
    v_mfma_f32_16x16x32_bf16 v[76:79], a[164:167], a[236:239], v[76:79]
    buffer_load_dwordx4 off, s[80:83], s41 offset:3072 sc1 lds
    v_mfma_f32_16x16x32_bf16 v[76:79], a[168:171], a[244:247], v[76:79]
    ds_read_b128 a[152:155], v6 offset:24576
    ds_read_b128 a[156:159], v6 offset:33792
    v_mfma_f32_16x16x32_bf16 v[76:79], a[172:175], a[252:255], v[76:79]
    s_add_u32 s50, s93, 69632
    buffer_load_dwordx4 a[208:211], off, s[80:83], s50 offset:0 sc1
    v_mfma_f32_16x16x32_bf16 v[72:75], a[172:175], a[248:251], v[72:75]
    v_rcp_f32 v239, v239
    v_mfma_f32_16x16x32_bf16 v[72:75], a[168:171], a[240:243], v[72:75]
    s_add_u32 m0, s32, 4096
    s_add_u32 s41, s92, 299008
    v_mfma_f32_16x16x32_bf16 v[72:75], a[164:167], a[232:235], v[72:75]
    s_waitcnt lgkmcnt(4)
    v_mul_f32 v172, v172, v236
    v_mfma_f32_16x16x32_bf16 v[72:75], a[160:163], a[224:227], v[72:75]
    v_mul_f32 v173, v173, v237
    v_mul_f32 v174, v174, v238
    v_mfma_f32_16x16x32_bf16 v[80:83], a[176:179], a[224:227], v[80:83]
    ds_read_b128 a[160:163], v6 offset:7168
    ds_read_b128 a[164:167], v6 offset:16384
    v_mfma_f32_16x16x32_bf16 v[80:83], a[180:183], a[232:235], v[80:83]
    buffer_load_dwordx4 a[212:215], off, s[80:83], s50 offset:1024 sc1
    v_mul_f32 v175, v175, v239
    v_mfma_f32_16x16x32_bf16 v[80:83], a[184:187], a[240:243], v[80:83]
    ds_read_b128 a[168:171], v6 offset:25600
    ds_read_b128 a[172:175], v6 offset:34816
    v_mfma_f32_16x16x32_bf16 v[80:83], a[188:191], a[248:251], v[80:83]
    v_mul_f32 v232, v176, v176
    v_mul_f32 v233, v177, v177
    v_mfma_f32_16x16x32_bf16 v[84:87], a[188:191], a[252:255], v[84:87]
    v_mul_f32 v234, v178, v178
    v_mul_f32 v235, v179, v179
    v_mfma_f32_16x16x32_bf16 v[84:87], a[184:187], a[244:247], v[84:87]
    buffer_load_dwordx4 off, s[80:83], s41 offset:0 sc1 lds
    v_fma_f32 v232, v232, v186, v184
    v_mfma_f32_16x16x32_bf16 v[84:87], a[180:183], a[236:239], v[84:87]
    s_waitcnt lgkmcnt(4)
    v_fma_f32 v233, v233, v186, v184
    v_mfma_f32_16x16x32_bf16 v[84:87], a[176:179], a[228:231], v[84:87]
    v_fma_f32 v234, v234, v186, v184
    v_fma_f32 v235, v235, v186, v184
    v_mfma_f32_16x16x32_bf16 v[92:95], a[144:147], a[228:231], v[92:95]
    ds_read_b128 a[176:179], v6 offset:8192
    ds_read_b128 a[180:183], v6 offset:17408
    v_mfma_f32_16x16x32_bf16 v[92:95], a[148:151], a[236:239], v[92:95]
    buffer_load_dwordx4 a[216:219], off, s[80:83], s50 offset:2048 sc1
    v_mul_f32 v232, v232, v176
    v_mfma_f32_16x16x32_bf16 v[92:95], a[152:155], a[244:247], v[92:95]
    ds_read_b128 a[184:187], v6 offset:26624
    ds_read_b128 a[188:191], v6 offset:35840
    v_mfma_f32_16x16x32_bf16 v[92:95], a[156:159], a[252:255], v[92:95]
    buffer_load_dwordx4 off, s[80:83], s41 offset:1024 sc1 lds
    v_mul_f32 v233, v233, v177
    v_mfma_f32_16x16x32_bf16 v[88:91], a[156:159], a[248:251], v[88:91]
    v_mul_f32 v234, v234, v178
    v_mul_f32 v235, v235, v179
    v_mfma_f32_16x16x32_bf16 v[88:91], a[152:155], a[240:243], v[88:91]
    buffer_load_dwordx4 a[220:223], off, s[80:83], s50 offset:3072 sc1
    v_mfma_f32_16x16x32_bf16 v[88:91], a[148:151], a[232:235], v[88:91]
    s_waitcnt lgkmcnt(4)
    v_mfma_f32_16x16x32_bf16 v[88:91], a[144:147], a[224:227], v[88:91]
    v_exp_f32 v232, v232
    v_mfma_f32_16x16x32_bf16 v[96:99], a[160:163], a[224:227], v[96:99]
    s_waitcnt vmcnt(14)
    s_barrier
    v_mfma_f32_16x16x32_bf16 v[96:99], a[164:167], a[232:235], v[96:99]
    buffer_load_dwordx4 off, s[80:83], s41 offset:2048 sc1 lds
    v_mfma_f32_16x16x32_bf16 v[96:99], a[168:171], a[240:243], v[96:99]
    ds_read_b128 a[144:147], v7 offset:0
    ds_read_b128 a[148:151], v7 offset:9216
    v_mfma_f32_16x16x32_bf16 v[96:99], a[172:175], a[248:251], v[96:99]
    v_exp_f32 v233, v233
    v_mfma_f32_16x16x32_bf16 v[100:103], a[172:175], a[252:255], v[100:103]
    ds_read_b128 a[152:155], v7 offset:18432
    ds_read_b128 a[156:159], v7 offset:27648
    v_mfma_f32_16x16x32_bf16 v[100:103], a[168:171], a[244:247], v[100:103]
    buffer_load_dwordx4 off, s[80:83], s41 offset:3072 sc1 lds
    v_mfma_f32_16x16x32_bf16 v[100:103], a[164:167], a[236:239], v[100:103]
    s_waitcnt lgkmcnt(4)
    v_mfma_f32_16x16x32_bf16 v[100:103], a[160:163], a[228:231], v[100:103]
    v_exp_f32 v234, v234
    v_mfma_f32_16x16x32_bf16 v[108:111], a[176:179], a[228:231], v[108:111]
    ds_read_b128 a[160:163], v7 offset:1024
    ds_read_b128 a[164:167], v7 offset:10240
    v_mfma_f32_16x16x32_bf16 v[108:111], a[180:183], a[236:239], v[108:111]
    s_add_u32 m0, s32, 8192
    s_add_u32 s41, s92, 303104
    v_mfma_f32_16x16x32_bf16 v[108:111], a[184:187], a[244:247], v[108:111]
    ds_read_b128 a[168:171], v7 offset:19456
    ds_read_b128 a[172:175], v7 offset:28672
    v_mfma_f32_16x16x32_bf16 v[108:111], a[188:191], a[252:255], v[108:111]
    buffer_load_dwordx4 off, s[80:83], s41 offset:0 sc1 lds
    v_mfma_f32_16x16x32_bf16 v[104:107], a[188:191], a[248:251], v[104:107]
    v_exp_f32 v235, v235
    v_mfma_f32_16x16x32_bf16 v[104:107], a[184:187], a[240:243], v[104:107]
    v_fma_f32 v232, v232, v188, v188
    v_fma_f32 v233, v233, v188, v188
    v_mfma_f32_16x16x32_bf16 v[104:107], a[180:183], a[232:235], v[104:107]
    s_waitcnt lgkmcnt(4)
    v_fma_f32 v234, v234, v188, v188
    v_mfma_f32_16x16x32_bf16 v[104:107], a[176:179], a[224:227], v[104:107]
    v_fma_f32 v235, v235, v188, v188
    v_mfma_f32_16x16x32_bf16 v[40:43], a[144:147], a[0:3], v[40:43]
    ds_read_b128 a[176:179], v7 offset:2048
    ds_read_b128 a[180:183], v7 offset:11264
    v_mfma_f32_16x16x32_bf16 v[40:43], a[148:151], a[8:11], v[40:43]
    s_cmp_le_u32 s4, 9
    s_cselect_b32 s92, s91, s35
    v_mfma_f32_16x16x32_bf16 v[40:43], a[152:155], a[16:19], v[40:43]
    ds_read_b128 a[184:187], v7 offset:20480
    ds_read_b128 a[188:191], v7 offset:29696
    v_mfma_f32_16x16x32_bf16 v[40:43], a[156:159], a[24:27], v[40:43]
    s_cmp_le_u32 s4, 9
    s_cselect_b32 s93, s90, s36
    v_mfma_f32_16x16x32_bf16 v[44:47], a[156:159], a[28:31], v[44:47]
    v_rcp_f32 v232, v232
    v_mfma_f32_16x16x32_bf16 v[44:47], a[152:155], a[20:23], v[44:47]
    s_add_u32 m0, s32, 36864
    s_add_u32 s41, s92, 331776
    v_mfma_f32_16x16x32_bf16 v[44:47], a[148:151], a[12:15], v[44:47]
    s_waitcnt lgkmcnt(4)
    v_mfma_f32_16x16x32_bf16 v[44:47], a[144:147], a[4:7], v[44:47]
    v_rcp_f32 v233, v233
    v_mfma_f32_16x16x32_bf16 v[52:55], a[160:163], a[4:7], v[52:55]
    ds_read_b128 a[144:147], v7 offset:3072
    ds_read_b128 a[148:151], v7 offset:12288
    v_mfma_f32_16x16x32_bf16 v[52:55], a[164:167], a[12:15], v[52:55]
    s_add_u32 s50, s93, 73728
    buffer_load_dwordx4 a[224:227], off, s[80:83], s50 offset:0 sc1
    v_mfma_f32_16x16x32_bf16 v[52:55], a[168:171], a[20:23], v[52:55]
    ds_read_b128 a[152:155], v7 offset:21504
    ds_read_b128 a[156:159], v7 offset:30720
    v_mfma_f32_16x16x32_bf16 v[52:55], a[172:175], a[28:31], v[52:55]
    v_rcp_f32 v234, v234
    v_mfma_f32_16x16x32_bf16 v[48:51], a[172:175], a[24:27], v[48:51]
    v_rcp_f32 v235, v235
    v_mfma_f32_16x16x32_bf16 v[48:51], a[168:171], a[16:19], v[48:51]
    buffer_load_dwordx4 off, s[80:83], s41 offset:0 sc1 lds
    v_mul_f32 v176, v176, v232
    v_mfma_f32_16x16x32_bf16 v[48:51], a[164:167], a[8:11], v[48:51]
    s_waitcnt lgkmcnt(4)
    v_mul_f32 v177, v177, v233
    v_mfma_f32_16x16x32_bf16 v[48:51], a[160:163], a[0:3], v[48:51]
    v_mul_f32 v178, v178, v234
    v_mul_f32 v179, v179, v235
    v_mfma_f32_16x16x32_bf16 v[56:59], a[176:179], a[0:3], v[56:59]
    ds_read_b128 a[160:163], v7 offset:4096
    ds_read_b128 a[164:167], v7 offset:13312
    v_mfma_f32_16x16x32_bf16 v[56:59], a[180:183], a[8:11], v[56:59]
    buffer_load_dwordx4 a[228:231], off, s[80:83], s50 offset:1024 sc1
    v_mul_f32 v236, v180, v180
    v_mfma_f32_16x16x32_bf16 v[56:59], a[184:187], a[16:19], v[56:59]
    ds_read_b128 a[168:171], v7 offset:22528
    ds_read_b128 a[172:175], v7 offset:31744
    v_mfma_f32_16x16x32_bf16 v[56:59], a[188:191], a[24:27], v[56:59]
    buffer_load_dwordx4 off, s[80:83], s41 offset:1024 sc1 lds
    v_mul_f32 v237, v181, v181
    v_mfma_f32_16x16x32_bf16 v[60:63], a[188:191], a[28:31], v[60:63]
    v_mul_f32 v238, v182, v182
    v_mul_f32 v239, v183, v183
    v_mfma_f32_16x16x32_bf16 v[60:63], a[184:187], a[20:23], v[60:63]
    buffer_load_dwordx4 a[232:235], off, s[80:83], s50 offset:2048 sc1
    v_fma_f32 v236, v236, v187, v185
    v_mfma_f32_16x16x32_bf16 v[60:63], a[180:183], a[12:15], v[60:63]
    s_waitcnt lgkmcnt(4)
    v_fma_f32 v237, v237, v187, v185
    v_mfma_f32_16x16x32_bf16 v[60:63], a[176:179], a[4:7], v[60:63]
    v_fma_f32 v238, v238, v187, v185
    v_fma_f32 v239, v239, v187, v185
    v_mfma_f32_16x16x32_bf16 v[68:71], a[144:147], a[4:7], v[68:71]
    ds_read_b128 a[176:179], v7 offset:5120
    ds_read_b128 a[180:183], v7 offset:14336
    v_mfma_f32_16x16x32_bf16 v[68:71], a[148:151], a[12:15], v[68:71]
    buffer_load_dwordx4 off, s[80:83], s41 offset:2048 sc1 lds
    v_mul_f32 v236, v236, v180
    v_mfma_f32_16x16x32_bf16 v[68:71], a[152:155], a[20:23], v[68:71]
    ds_read_b128 a[184:187], v7 offset:23552
    ds_read_b128 a[188:191], v7 offset:32768
    v_mfma_f32_16x16x32_bf16 v[68:71], a[156:159], a[28:31], v[68:71]
    v_mul_f32 v237, v237, v181
    v_mul_f32 v238, v238, v182
    v_mfma_f32_16x16x32_bf16 v[64:67], a[156:159], a[24:27], v[64:67]
    v_mul_f32 v239, v239, v183
    v_mfma_f32_16x16x32_bf16 v[64:67], a[152:155], a[16:19], v[64:67]
    buffer_load_dwordx4 a[236:239], off, s[80:83], s50 offset:3072 sc1
    v_mfma_f32_16x16x32_bf16 v[64:67], a[148:151], a[8:11], v[64:67]
    s_waitcnt lgkmcnt(4)
    v_mfma_f32_16x16x32_bf16 v[64:67], a[144:147], a[0:3], v[64:67]
    v_exp_f32 v236, v236
    v_mfma_f32_16x16x32_bf16 v[72:75], a[160:163], a[0:3], v[72:75]
    ds_read_b128 a[144:147], v7 offset:6144
    ds_read_b128 a[148:151], v7 offset:15360
    v_mfma_f32_16x16x32_bf16 v[72:75], a[164:167], a[8:11], v[72:75]
    buffer_load_dwordx4 off, s[80:83], s41 offset:3072 sc1 lds
    v_mfma_f32_16x16x32_bf16 v[72:75], a[168:171], a[16:19], v[72:75]
    ds_read_b128 a[152:155], v7 offset:24576
    ds_read_b128 a[156:159], v7 offset:33792
    v_mfma_f32_16x16x32_bf16 v[72:75], a[172:175], a[24:27], v[72:75]
    s_add_u32 s50, s93, 77824
    buffer_load_dwordx4 a[240:243], off, s[80:83], s50 offset:0 sc1
    v_mfma_f32_16x16x32_bf16 v[76:79], a[172:175], a[28:31], v[76:79]
    v_exp_f32 v237, v237
    v_mfma_f32_16x16x32_bf16 v[76:79], a[168:171], a[20:23], v[76:79]
    s_add_u32 m0, s32, 40960
    s_add_u32 s41, s92, 335872
    v_mfma_f32_16x16x32_bf16 v[76:79], a[164:167], a[12:15], v[76:79]
    s_waitcnt lgkmcnt(4)
    v_mfma_f32_16x16x32_bf16 v[76:79], a[160:163], a[4:7], v[76:79]
    v_exp_f32 v238, v238
    v_mfma_f32_16x16x32_bf16 v[84:87], a[176:179], a[4:7], v[84:87]
    ds_read_b128 a[160:163], v7 offset:7168
    ds_read_b128 a[164:167], v7 offset:16384
    v_mfma_f32_16x16x32_bf16 v[84:87], a[180:183], a[12:15], v[84:87]
    buffer_load_dwordx4 a[244:247], off, s[80:83], s50 offset:1024 sc1
    v_mfma_f32_16x16x32_bf16 v[84:87], a[184:187], a[20:23], v[84:87]
    ds_read_b128 a[168:171], v7 offset:25600
    ds_read_b128 a[172:175], v7 offset:34816
    v_mfma_f32_16x16x32_bf16 v[84:87], a[188:191], a[28:31], v[84:87]
    v_exp_f32 v239, v239
    v_mfma_f32_16x16x32_bf16 v[80:83], a[188:191], a[24:27], v[80:83]
    v_fma_f32 v236, v236, v189, v189
    v_fma_f32 v237, v237, v189, v189
    v_mfma_f32_16x16x32_bf16 v[80:83], a[184:187], a[16:19], v[80:83]
    buffer_load_dwordx4 off, s[80:83], s41 offset:0 sc1 lds
    v_fma_f32 v238, v238, v189, v189
    v_mfma_f32_16x16x32_bf16 v[80:83], a[180:183], a[8:11], v[80:83]
    s_waitcnt lgkmcnt(4)
    v_fma_f32 v239, v239, v189, v189
    v_mfma_f32_16x16x32_bf16 v[80:83], a[176:179], a[0:3], v[80:83]
    v_rcp_f32 v236, v236
    v_mfma_f32_16x16x32_bf16 v[88:91], a[144:147], a[0:3], v[88:91]
    ds_read_b128 a[176:179], v7 offset:8192
    ds_read_b128 a[180:183], v7 offset:17408
    v_mfma_f32_16x16x32_bf16 v[88:91], a[148:151], a[8:11], v[88:91]
    buffer_load_dwordx4 a[248:251], off, s[80:83], s50 offset:2048 sc1
    v_mfma_f32_16x16x32_bf16 v[88:91], a[152:155], a[16:19], v[88:91]
    ds_read_b128 a[184:187], v7 offset:26624
    ds_read_b128 a[188:191], v7 offset:35840
    v_mfma_f32_16x16x32_bf16 v[88:91], a[156:159], a[24:27], v[88:91]
    buffer_load_dwordx4 off, s[80:83], s41 offset:1024 sc1 lds
    v_mfma_f32_16x16x32_bf16 v[92:95], a[156:159], a[28:31], v[92:95]
    v_rcp_f32 v237, v237
    v_mfma_f32_16x16x32_bf16 v[92:95], a[152:155], a[20:23], v[92:95]
    buffer_load_dwordx4 a[252:255], off, s[80:83], s50 offset:3072 sc1
    v_mfma_f32_16x16x32_bf16 v[92:95], a[148:151], a[12:15], v[92:95]
    s_waitcnt lgkmcnt(4)
    v_mfma_f32_16x16x32_bf16 v[92:95], a[144:147], a[4:7], v[92:95]
    v_rcp_f32 v238, v238
    v_mfma_f32_16x16x32_bf16 v[100:103], a[160:163], a[4:7], v[100:103]
    s_waitcnt vmcnt(14)
    s_barrier
    v_mfma_f32_16x16x32_bf16 v[100:103], a[164:167], a[12:15], v[100:103]
    buffer_load_dwordx4 off, s[80:83], s41 offset:2048 sc1 lds
    v_mfma_f32_16x16x32_bf16 v[100:103], a[168:171], a[20:23], v[100:103]
    ds_read_b128 a[144:147], v4 offset:0
    ds_read_b128 a[148:151], v4 offset:9216
    v_mfma_f32_16x16x32_bf16 v[100:103], a[172:175], a[28:31], v[100:103]
    v_rcp_f32 v239, v239
    v_mfma_f32_16x16x32_bf16 v[96:99], a[172:175], a[24:27], v[96:99]
    ds_read_b128 a[152:155], v4 offset:18432
    ds_read_b128 a[156:159], v4 offset:27648
    v_mfma_f32_16x16x32_bf16 v[96:99], a[168:171], a[16:19], v[96:99]
    buffer_load_dwordx4 off, s[80:83], s41 offset:3072 sc1 lds
    v_mul_f32 v180, v180, v236
    v_mfma_f32_16x16x32_bf16 v[96:99], a[164:167], a[8:11], v[96:99]
    s_waitcnt lgkmcnt(4)
    v_mul_f32 v181, v181, v237
    v_mfma_f32_16x16x32_bf16 v[96:99], a[160:163], a[0:3], v[96:99]
    v_mul_f32 v182, v182, v238
    v_mul_f32 v183, v183, v239
    v_mfma_f32_16x16x32_bf16 v[104:107], a[176:179], a[0:3], v[104:107]
    ds_read_b128 a[160:163], v4 offset:1024
    ds_read_b128 a[164:167], v4 offset:10240
    v_mfma_f32_16x16x32_bf16 v[104:107], a[180:183], a[8:11], v[104:107]
    s_add_u32 m0, s32, 45056
    s_add_u32 s41, s92, 339968
    v_mfma_f32_16x16x32_bf16 v[104:107], a[184:187], a[16:19], v[104:107]
    ds_read_b128 a[168:171], v4 offset:19456
    ds_read_b128 a[172:175], v4 offset:28672
    v_mfma_f32_16x16x32_bf16 v[104:107], a[188:191], a[24:27], v[104:107]
    buffer_load_dwordx4 off, s[80:83], s41 offset:0 sc1 lds
    v_mfma_f32_16x16x32_bf16 v[108:111], a[188:191], a[28:31], v[108:111]
    v_mfma_f32_16x16x32_bf16 v[108:111], a[184:187], a[20:23], v[108:111]
    v_mfma_f32_16x16x32_bf16 v[108:111], a[180:183], a[12:15], v[108:111]
    s_waitcnt lgkmcnt(4)
    v_mfma_f32_16x16x32_bf16 v[108:111], a[176:179], a[4:7], v[108:111]
    v_mfma_f32_16x16x32_bf16 v[44:47], a[144:147], a[196:199], v[44:47]
    ds_read_b128 a[176:179], v4 offset:2048
    ds_read_b128 a[180:183], v4 offset:11264
    v_mfma_f32_16x16x32_bf16 v[44:47], a[148:151], a[204:207], v[44:47]
    s_cmp_le_u32 s4, 10
    s_cselect_b32 s92, s91, s35
    v_mfma_f32_16x16x32_bf16 v[44:47], a[152:155], a[212:215], v[44:47]
    ds_read_b128 a[184:187], v4 offset:20480
    ds_read_b128 a[188:191], v4 offset:29696
    v_mfma_f32_16x16x32_bf16 v[44:47], a[156:159], a[220:223], v[44:47]
    s_cmp_le_u32 s4, 10
    s_cselect_b32 s93, s90, s36
    v_mfma_f32_16x16x32_bf16 v[40:43], a[156:159], a[216:219], v[40:43]
    v_mfma_f32_16x16x32_bf16 v[40:43], a[152:155], a[208:211], v[40:43]
    s_add_u32 m0, s32, 73728
    s_add_u32 s41, s92, 368640
    v_mfma_f32_16x16x32_bf16 v[40:43], a[148:151], a[200:203], v[40:43]
    s_waitcnt lgkmcnt(4)
    v_mfma_f32_16x16x32_bf16 v[40:43], a[144:147], a[192:195], v[40:43]
    v_mfma_f32_16x16x32_bf16 v[48:51], a[160:163], a[192:195], v[48:51]
    ds_read_b128 a[144:147], v4 offset:3072
    ds_read_b128 a[148:151], v4 offset:12288
    v_mfma_f32_16x16x32_bf16 v[48:51], a[164:167], a[200:203], v[48:51]
    s_add_u32 s50, s93, 81920
    buffer_load_dwordx4 a[0:3], off, s[80:83], s50 offset:0 sc1
    v_mfma_f32_16x16x32_bf16 v[48:51], a[168:171], a[208:211], v[48:51]
    ds_read_b128 a[152:155], v4 offset:21504
    ds_read_b128 a[156:159], v4 offset:30720
    v_mfma_f32_16x16x32_bf16 v[48:51], a[172:175], a[216:219], v[48:51]
    v_mfma_f32_16x16x32_bf16 v[52:55], a[172:175], a[220:223], v[52:55]
    v_mfma_f32_16x16x32_bf16 v[52:55], a[168:171], a[212:215], v[52:55]
    buffer_load_dwordx4 off, s[80:83], s41 offset:0 sc1 lds
    v_mfma_f32_16x16x32_bf16 v[52:55], a[164:167], a[204:207], v[52:55]
    s_waitcnt lgkmcnt(4)
    v_mfma_f32_16x16x32_bf16 v[52:55], a[160:163], a[196:199], v[52:55]
    v_mfma_f32_16x16x32_bf16 v[60:63], a[176:179], a[196:199], v[60:63]
    ds_read_b128 a[160:163], v4 offset:4096
    ds_read_b128 a[164:167], v4 offset:13312
    v_mfma_f32_16x16x32_bf16 v[60:63], a[180:183], a[204:207], v[60:63]
    buffer_load_dwordx4 a[4:7], off, s[80:83], s50 offset:1024 sc1
    v_mfma_f32_16x16x32_bf16 v[60:63], a[184:187], a[212:215], v[60:63]
    ds_read_b128 a[168:171], v4 offset:22528
    ds_read_b128 a[172:175], v4 offset:31744
    v_mfma_f32_16x16x32_bf16 v[60:63], a[188:191], a[220:223], v[60:63]
    buffer_load_dwordx4 off, s[80:83], s41 offset:1024 sc1 lds
    v_mfma_f32_16x16x32_bf16 v[56:59], a[188:191], a[216:219], v[56:59]
    v_mfma_f32_16x16x32_bf16 v[56:59], a[184:187], a[208:211], v[56:59]
    buffer_load_dwordx4 a[8:11], off, s[80:83], s50 offset:2048 sc1
    v_mfma_f32_16x16x32_bf16 v[56:59], a[180:183], a[200:203], v[56:59]
    s_waitcnt lgkmcnt(4)
    v_mfma_f32_16x16x32_bf16 v[56:59], a[176:179], a[192:195], v[56:59]
    v_mfma_f32_16x16x32_bf16 v[64:67], a[144:147], a[192:195], v[64:67]
    ds_read_b128 a[176:179], v4 offset:5120
    ds_read_b128 a[180:183], v4 offset:14336
    v_mfma_f32_16x16x32_bf16 v[64:67], a[148:151], a[200:203], v[64:67]
    buffer_load_dwordx4 off, s[80:83], s41 offset:2048 sc1 lds
    v_mfma_f32_16x16x32_bf16 v[64:67], a[152:155], a[208:211], v[64:67]
    ds_read_b128 a[184:187], v4 offset:23552
    ds_read_b128 a[188:191], v4 offset:32768
    v_mfma_f32_16x16x32_bf16 v[64:67], a[156:159], a[216:219], v[64:67]
    v_mfma_f32_16x16x32_bf16 v[68:71], a[156:159], a[220:223], v[68:71]
    v_mfma_f32_16x16x32_bf16 v[68:71], a[152:155], a[212:215], v[68:71]
    buffer_load_dwordx4 a[12:15], off, s[80:83], s50 offset:3072 sc1
    v_mfma_f32_16x16x32_bf16 v[68:71], a[148:151], a[204:207], v[68:71]
    s_waitcnt lgkmcnt(4)
    v_mfma_f32_16x16x32_bf16 v[68:71], a[144:147], a[196:199], v[68:71]
    v_mfma_f32_16x16x32_bf16 v[76:79], a[160:163], a[196:199], v[76:79]
    ds_read_b128 a[144:147], v4 offset:6144
    ds_read_b128 a[148:151], v4 offset:15360
    v_mfma_f32_16x16x32_bf16 v[76:79], a[164:167], a[204:207], v[76:79]
    buffer_load_dwordx4 off, s[80:83], s41 offset:3072 sc1 lds
    v_mfma_f32_16x16x32_bf16 v[76:79], a[168:171], a[212:215], v[76:79]
    ds_read_b128 a[152:155], v4 offset:24576
    ds_read_b128 a[156:159], v4 offset:33792
    v_mfma_f32_16x16x32_bf16 v[76:79], a[172:175], a[220:223], v[76:79]
    s_add_u32 s50, s93, 86016
    buffer_load_dwordx4 a[16:19], off, s[80:83], s50 offset:0 sc1
    v_mfma_f32_16x16x32_bf16 v[72:75], a[172:175], a[216:219], v[72:75]
    v_mfma_f32_16x16x32_bf16 v[72:75], a[168:171], a[208:211], v[72:75]
    s_add_u32 m0, s32, 77824
    s_add_u32 s41, s92, 372736
    v_mfma_f32_16x16x32_bf16 v[72:75], a[164:167], a[200:203], v[72:75]
    s_waitcnt lgkmcnt(4)
    v_mfma_f32_16x16x32_bf16 v[72:75], a[160:163], a[192:195], v[72:75]
    v_mfma_f32_16x16x32_bf16 v[80:83], a[176:179], a[192:195], v[80:83]
    ds_read_b128 a[160:163], v4 offset:7168
    ds_read_b128 a[164:167], v4 offset:16384
    v_mfma_f32_16x16x32_bf16 v[80:83], a[180:183], a[200:203], v[80:83]
    buffer_load_dwordx4 a[20:23], off, s[80:83], s50 offset:1024 sc1
    v_mfma_f32_16x16x32_bf16 v[80:83], a[184:187], a[208:211], v[80:83]
    ds_read_b128 a[168:171], v4 offset:25600
    ds_read_b128 a[172:175], v4 offset:34816
    v_mfma_f32_16x16x32_bf16 v[80:83], a[188:191], a[216:219], v[80:83]
    v_mfma_f32_16x16x32_bf16 v[84:87], a[188:191], a[220:223], v[84:87]
    v_mfma_f32_16x16x32_bf16 v[84:87], a[184:187], a[212:215], v[84:87]
    buffer_load_dwordx4 off, s[80:83], s41 offset:0 sc1 lds
    v_mfma_f32_16x16x32_bf16 v[84:87], a[180:183], a[204:207], v[84:87]
    s_waitcnt lgkmcnt(4)
    v_mfma_f32_16x16x32_bf16 v[84:87], a[176:179], a[196:199], v[84:87]
    v_mfma_f32_16x16x32_bf16 v[92:95], a[144:147], a[196:199], v[92:95]
    ds_read_b128 a[176:179], v4 offset:8192
    ds_read_b128 a[180:183], v4 offset:17408
    v_mfma_f32_16x16x32_bf16 v[92:95], a[148:151], a[204:207], v[92:95]
    buffer_load_dwordx4 a[24:27], off, s[80:83], s50 offset:2048 sc1
    v_mfma_f32_16x16x32_bf16 v[92:95], a[152:155], a[212:215], v[92:95]
    ds_read_b128 a[184:187], v4 offset:26624
    ds_read_b128 a[188:191], v4 offset:35840
    v_mfma_f32_16x16x32_bf16 v[92:95], a[156:159], a[220:223], v[92:95]
    buffer_load_dwordx4 off, s[80:83], s41 offset:1024 sc1 lds
    v_mfma_f32_16x16x32_bf16 v[88:91], a[156:159], a[216:219], v[88:91]
    v_mfma_f32_16x16x32_bf16 v[88:91], a[152:155], a[208:211], v[88:91]
    buffer_load_dwordx4 a[28:31], off, s[80:83], s50 offset:3072 sc1
    v_mfma_f32_16x16x32_bf16 v[88:91], a[148:151], a[200:203], v[88:91]
    s_waitcnt lgkmcnt(4)
    v_mfma_f32_16x16x32_bf16 v[88:91], a[144:147], a[192:195], v[88:91]
    v_mfma_f32_16x16x32_bf16 v[96:99], a[160:163], a[192:195], v[96:99]
    s_waitcnt vmcnt(14)
    s_barrier
    v_mfma_f32_16x16x32_bf16 v[96:99], a[164:167], a[200:203], v[96:99]
    buffer_load_dwordx4 off, s[80:83], s41 offset:2048 sc1 lds
    v_mfma_f32_16x16x32_bf16 v[96:99], a[168:171], a[208:211], v[96:99]
    ds_read_b128 a[144:147], v5 offset:0
    ds_read_b128 a[148:151], v5 offset:9216
    v_mfma_f32_16x16x32_bf16 v[96:99], a[172:175], a[216:219], v[96:99]
    v_mfma_f32_16x16x32_bf16 v[100:103], a[172:175], a[220:223], v[100:103]
    ds_read_b128 a[152:155], v5 offset:18432
    ds_read_b128 a[156:159], v5 offset:27648
    v_mfma_f32_16x16x32_bf16 v[100:103], a[168:171], a[212:215], v[100:103]
    buffer_load_dwordx4 off, s[80:83], s41 offset:3072 sc1 lds
    v_mfma_f32_16x16x32_bf16 v[100:103], a[164:167], a[204:207], v[100:103]
    s_waitcnt lgkmcnt(4)
    v_mfma_f32_16x16x32_bf16 v[100:103], a[160:163], a[196:199], v[100:103]
    v_mfma_f32_16x16x32_bf16 v[108:111], a[176:179], a[196:199], v[108:111]
    ds_read_b128 a[160:163], v5 offset:1024
    ds_read_b128 a[164:167], v5 offset:10240
    v_mfma_f32_16x16x32_bf16 v[108:111], a[180:183], a[204:207], v[108:111]
    s_add_u32 m0, s32, 81920
    s_add_u32 s41, s92, 376832
    v_mfma_f32_16x16x32_bf16 v[108:111], a[184:187], a[212:215], v[108:111]
    ds_read_b128 a[168:171], v5 offset:19456
    ds_read_b128 a[172:175], v5 offset:28672
    v_mfma_f32_16x16x32_bf16 v[108:111], a[188:191], a[220:223], v[108:111]
    buffer_load_dwordx4 off, s[80:83], s41 offset:0 sc1 lds
    v_mfma_f32_16x16x32_bf16 v[104:107], a[188:191], a[216:219], v[104:107]
    v_mfma_f32_16x16x32_bf16 v[104:107], a[184:187], a[208:211], v[104:107]
    v_mfma_f32_16x16x32_bf16 v[104:107], a[180:183], a[200:203], v[104:107]
    s_waitcnt lgkmcnt(4)
    v_mfma_f32_16x16x32_bf16 v[104:107], a[176:179], a[192:195], v[104:107]
    v_mfma_f32_16x16x32_bf16 v[40:43], a[144:147], a[224:227], v[40:43]
    ds_read_b128 a[176:179], v5 offset:2048
    ds_read_b128 a[180:183], v5 offset:11264
    v_mfma_f32_16x16x32_bf16 v[40:43], a[148:151], a[232:235], v[40:43]
    s_cmp_le_u32 s4, 11
    s_cselect_b32 s92, s91, s35
    v_mfma_f32_16x16x32_bf16 v[40:43], a[152:155], a[240:243], v[40:43]
    ds_read_b128 a[184:187], v5 offset:20480
    ds_read_b128 a[188:191], v5 offset:29696
    v_mfma_f32_16x16x32_bf16 v[40:43], a[156:159], a[248:251], v[40:43]
    s_cmp_le_u32 s4, 11
    s_cselect_b32 s93, s90, s36
    v_mfma_f32_16x16x32_bf16 v[44:47], a[156:159], a[252:255], v[44:47]
    v_mfma_f32_16x16x32_bf16 v[44:47], a[152:155], a[244:247], v[44:47]
    s_add_u32 m0, s32, 110592
    s_add_u32 s41, s92, 405504
    v_mfma_f32_16x16x32_bf16 v[44:47], a[148:151], a[236:239], v[44:47]
    s_waitcnt lgkmcnt(4)
    v_mfma_f32_16x16x32_bf16 v[44:47], a[144:147], a[228:231], v[44:47]
    v_mfma_f32_16x16x32_bf16 v[52:55], a[160:163], a[228:231], v[52:55]
    ds_read_b128 a[144:147], v5 offset:3072
    ds_read_b128 a[148:151], v5 offset:12288
    v_mfma_f32_16x16x32_bf16 v[52:55], a[164:167], a[236:239], v[52:55]
    s_add_u32 s50, s93, 90112
    buffer_load_dwordx4 a[192:195], off, s[80:83], s50 offset:0 sc1
    v_mfma_f32_16x16x32_bf16 v[52:55], a[168:171], a[244:247], v[52:55]
    ds_read_b128 a[152:155], v5 offset:21504
    ds_read_b128 a[156:159], v5 offset:30720
    v_mfma_f32_16x16x32_bf16 v[52:55], a[172:175], a[252:255], v[52:55]
    v_mfma_f32_16x16x32_bf16 v[48:51], a[172:175], a[248:251], v[48:51]
    v_mfma_f32_16x16x32_bf16 v[48:51], a[168:171], a[240:243], v[48:51]
    buffer_load_dwordx4 off, s[80:83], s41 offset:0 sc1 lds
    v_mfma_f32_16x16x32_bf16 v[48:51], a[164:167], a[232:235], v[48:51]
    s_waitcnt lgkmcnt(4)
    v_mfma_f32_16x16x32_bf16 v[48:51], a[160:163], a[224:227], v[48:51]
    v_mfma_f32_16x16x32_bf16 v[56:59], a[176:179], a[224:227], v[56:59]
    ds_read_b128 a[160:163], v5 offset:4096
    ds_read_b128 a[164:167], v5 offset:13312
    v_mfma_f32_16x16x32_bf16 v[56:59], a[180:183], a[232:235], v[56:59]
    buffer_load_dwordx4 a[196:199], off, s[80:83], s50 offset:1024 sc1
    v_mfma_f32_16x16x32_bf16 v[56:59], a[184:187], a[240:243], v[56:59]
    ds_read_b128 a[168:171], v5 offset:22528
    ds_read_b128 a[172:175], v5 offset:31744
    v_mfma_f32_16x16x32_bf16 v[56:59], a[188:191], a[248:251], v[56:59]
    buffer_load_dwordx4 off, s[80:83], s41 offset:1024 sc1 lds
    v_mfma_f32_16x16x32_bf16 v[60:63], a[188:191], a[252:255], v[60:63]
    v_mfma_f32_16x16x32_bf16 v[60:63], a[184:187], a[244:247], v[60:63]
    buffer_load_dwordx4 a[200:203], off, s[80:83], s50 offset:2048 sc1
    v_mfma_f32_16x16x32_bf16 v[60:63], a[180:183], a[236:239], v[60:63]
    s_waitcnt lgkmcnt(4)
    v_mfma_f32_16x16x32_bf16 v[60:63], a[176:179], a[228:231], v[60:63]
    v_mfma_f32_16x16x32_bf16 v[68:71], a[144:147], a[228:231], v[68:71]
    ds_read_b128 a[176:179], v5 offset:5120
    ds_read_b128 a[180:183], v5 offset:14336
    v_mfma_f32_16x16x32_bf16 v[68:71], a[148:151], a[236:239], v[68:71]
    buffer_load_dwordx4 off, s[80:83], s41 offset:2048 sc1 lds
    v_mfma_f32_16x16x32_bf16 v[68:71], a[152:155], a[244:247], v[68:71]
    ds_read_b128 a[184:187], v5 offset:23552
    ds_read_b128 a[188:191], v5 offset:32768
    v_mfma_f32_16x16x32_bf16 v[68:71], a[156:159], a[252:255], v[68:71]
    v_mfma_f32_16x16x32_bf16 v[64:67], a[156:159], a[248:251], v[64:67]
    v_mfma_f32_16x16x32_bf16 v[64:67], a[152:155], a[240:243], v[64:67]
    buffer_load_dwordx4 a[204:207], off, s[80:83], s50 offset:3072 sc1
    v_mfma_f32_16x16x32_bf16 v[64:67], a[148:151], a[232:235], v[64:67]
    s_waitcnt lgkmcnt(4)
    v_mfma_f32_16x16x32_bf16 v[64:67], a[144:147], a[224:227], v[64:67]
    v_mfma_f32_16x16x32_bf16 v[72:75], a[160:163], a[224:227], v[72:75]
    ds_read_b128 a[144:147], v5 offset:6144
    ds_read_b128 a[148:151], v5 offset:15360
    v_mfma_f32_16x16x32_bf16 v[72:75], a[164:167], a[232:235], v[72:75]
    buffer_load_dwordx4 off, s[80:83], s41 offset:3072 sc1 lds
    v_mfma_f32_16x16x32_bf16 v[72:75], a[168:171], a[240:243], v[72:75]
    ds_read_b128 a[152:155], v5 offset:24576
    ds_read_b128 a[156:159], v5 offset:33792
    v_mfma_f32_16x16x32_bf16 v[72:75], a[172:175], a[248:251], v[72:75]
    s_add_u32 s50, s93, 94208
    buffer_load_dwordx4 a[208:211], off, s[80:83], s50 offset:0 sc1
    v_mfma_f32_16x16x32_bf16 v[76:79], a[172:175], a[252:255], v[76:79]
    v_mfma_f32_16x16x32_bf16 v[76:79], a[168:171], a[244:247], v[76:79]
    s_add_u32 m0, s32, 114688
    s_add_u32 s41, s92, 409600
    v_mfma_f32_16x16x32_bf16 v[76:79], a[164:167], a[236:239], v[76:79]
    s_waitcnt lgkmcnt(4)
    v_mfma_f32_16x16x32_bf16 v[76:79], a[160:163], a[228:231], v[76:79]
    v_mfma_f32_16x16x32_bf16 v[84:87], a[176:179], a[228:231], v[84:87]
    ds_read_b128 a[160:163], v5 offset:7168
    ds_read_b128 a[164:167], v5 offset:16384
    v_mfma_f32_16x16x32_bf16 v[84:87], a[180:183], a[236:239], v[84:87]
    buffer_load_dwordx4 a[212:215], off, s[80:83], s50 offset:1024 sc1
    v_mfma_f32_16x16x32_bf16 v[84:87], a[184:187], a[244:247], v[84:87]
    ds_read_b128 a[168:171], v5 offset:25600
    ds_read_b128 a[172:175], v5 offset:34816
    v_mfma_f32_16x16x32_bf16 v[84:87], a[188:191], a[252:255], v[84:87]
    v_mfma_f32_16x16x32_bf16 v[80:83], a[188:191], a[248:251], v[80:83]
    v_mfma_f32_16x16x32_bf16 v[80:83], a[184:187], a[240:243], v[80:83]
    buffer_load_dwordx4 off, s[80:83], s41 offset:0 sc1 lds
    v_mfma_f32_16x16x32_bf16 v[80:83], a[180:183], a[232:235], v[80:83]
    s_waitcnt lgkmcnt(4)
    v_mfma_f32_16x16x32_bf16 v[80:83], a[176:179], a[224:227], v[80:83]
    v_mfma_f32_16x16x32_bf16 v[88:91], a[144:147], a[224:227], v[88:91]
    ds_read_b128 a[176:179], v5 offset:8192
    ds_read_b128 a[180:183], v5 offset:17408
    v_mfma_f32_16x16x32_bf16 v[88:91], a[148:151], a[232:235], v[88:91]
    buffer_load_dwordx4 a[216:219], off, s[80:83], s50 offset:2048 sc1
    v_mfma_f32_16x16x32_bf16 v[88:91], a[152:155], a[240:243], v[88:91]
    ds_read_b128 a[184:187], v5 offset:26624
    ds_read_b128 a[188:191], v5 offset:35840
    v_mfma_f32_16x16x32_bf16 v[88:91], a[156:159], a[248:251], v[88:91]
    buffer_load_dwordx4 off, s[80:83], s41 offset:1024 sc1 lds
    v_mfma_f32_16x16x32_bf16 v[92:95], a[156:159], a[252:255], v[92:95]
    v_mfma_f32_16x16x32_bf16 v[92:95], a[152:155], a[244:247], v[92:95]
    buffer_load_dwordx4 a[220:223], off, s[80:83], s50 offset:3072 sc1
    v_mfma_f32_16x16x32_bf16 v[92:95], a[148:151], a[236:239], v[92:95]
    s_waitcnt lgkmcnt(4)
    v_mfma_f32_16x16x32_bf16 v[92:95], a[144:147], a[228:231], v[92:95]
    v_mfma_f32_16x16x32_bf16 v[100:103], a[160:163], a[228:231], v[100:103]
    s_waitcnt vmcnt(14)
    s_barrier
    v_mfma_f32_16x16x32_bf16 v[100:103], a[164:167], a[236:239], v[100:103]
    buffer_load_dwordx4 off, s[80:83], s41 offset:2048 sc1 lds
    v_mfma_f32_16x16x32_bf16 v[100:103], a[168:171], a[244:247], v[100:103]
    ds_read_b128 a[144:147], v6 offset:0
    ds_read_b128 a[148:151], v6 offset:9216
    v_mfma_f32_16x16x32_bf16 v[100:103], a[172:175], a[252:255], v[100:103]
    v_mfma_f32_16x16x32_bf16 v[96:99], a[172:175], a[248:251], v[96:99]
    ds_read_b128 a[152:155], v6 offset:18432
    ds_read_b128 a[156:159], v6 offset:27648
    v_mfma_f32_16x16x32_bf16 v[96:99], a[168:171], a[240:243], v[96:99]
    buffer_load_dwordx4 off, s[80:83], s41 offset:3072 sc1 lds
    v_mfma_f32_16x16x32_bf16 v[96:99], a[164:167], a[232:235], v[96:99]
    s_waitcnt lgkmcnt(4)
    v_mfma_f32_16x16x32_bf16 v[96:99], a[160:163], a[224:227], v[96:99]
    v_mfma_f32_16x16x32_bf16 v[104:107], a[176:179], a[224:227], v[104:107]
    ds_read_b128 a[160:163], v6 offset:1024
    ds_read_b128 a[164:167], v6 offset:10240
    v_mfma_f32_16x16x32_bf16 v[104:107], a[180:183], a[232:235], v[104:107]
    s_add_u32 m0, s32, 118784
    s_add_u32 s41, s92, 413696
    v_mfma_f32_16x16x32_bf16 v[104:107], a[184:187], a[240:243], v[104:107]
    ds_read_b128 a[168:171], v6 offset:19456
    ds_read_b128 a[172:175], v6 offset:28672
    v_mfma_f32_16x16x32_bf16 v[104:107], a[188:191], a[248:251], v[104:107]
    buffer_load_dwordx4 off, s[80:83], s41 offset:0 sc1 lds
    v_mfma_f32_16x16x32_bf16 v[108:111], a[188:191], a[252:255], v[108:111]
    v_mfma_f32_16x16x32_bf16 v[108:111], a[184:187], a[244:247], v[108:111]
    v_mfma_f32_16x16x32_bf16 v[108:111], a[180:183], a[236:239], v[108:111]
    s_waitcnt lgkmcnt(4)
    v_mfma_f32_16x16x32_bf16 v[108:111], a[176:179], a[228:231], v[108:111]
    v_mfma_f32_16x16x32_bf16 v[44:47], a[144:147], a[4:7], v[44:47]
    ds_read_b128 a[176:179], v6 offset:2048
    ds_read_b128 a[180:183], v6 offset:11264
    v_mfma_f32_16x16x32_bf16 v[44:47], a[148:151], a[12:15], v[44:47]
    s_cmp_le_u32 s4, 12
    s_cselect_b32 s92, s91, s35
    v_mfma_f32_16x16x32_bf16 v[44:47], a[152:155], a[20:23], v[44:47]
    ds_read_b128 a[184:187], v6 offset:20480
    ds_read_b128 a[188:191], v6 offset:29696
    v_mfma_f32_16x16x32_bf16 v[44:47], a[156:159], a[28:31], v[44:47]
    s_cmp_le_u32 s4, 12
    s_cselect_b32 s93, s90, s36
    v_mfma_f32_16x16x32_bf16 v[40:43], a[156:159], a[24:27], v[40:43]
    v_mfma_f32_16x16x32_bf16 v[40:43], a[152:155], a[16:19], v[40:43]
    s_add_u32 m0, s32, 0
    s_add_u32 s41, s92, 442368
    v_mfma_f32_16x16x32_bf16 v[40:43], a[148:151], a[8:11], v[40:43]
    s_waitcnt lgkmcnt(4)
    v_mfma_f32_16x16x32_bf16 v[40:43], a[144:147], a[0:3], v[40:43]
    v_mfma_f32_16x16x32_bf16 v[48:51], a[160:163], a[0:3], v[48:51]
    ds_read_b128 a[144:147], v6 offset:3072
    ds_read_b128 a[148:151], v6 offset:12288
    v_mfma_f32_16x16x32_bf16 v[48:51], a[164:167], a[8:11], v[48:51]
    s_add_u32 s50, s93, 98304
    buffer_load_dwordx4 a[224:227], off, s[80:83], s50 offset:0 sc1
    v_mfma_f32_16x16x32_bf16 v[48:51], a[168:171], a[16:19], v[48:51]
    ds_read_b128 a[152:155], v6 offset:21504
    ds_read_b128 a[156:159], v6 offset:30720
    v_mfma_f32_16x16x32_bf16 v[48:51], a[172:175], a[24:27], v[48:51]
    v_mfma_f32_16x16x32_bf16 v[52:55], a[172:175], a[28:31], v[52:55]
    v_mfma_f32_16x16x32_bf16 v[52:55], a[168:171], a[20:23], v[52:55]
    buffer_load_dwordx4 off, s[80:83], s41 offset:0 sc1 lds
    v_mfma_f32_16x16x32_bf16 v[52:55], a[164:167], a[12:15], v[52:55]
    s_waitcnt lgkmcnt(4)
    v_mfma_f32_16x16x32_bf16 v[52:55], a[160:163], a[4:7], v[52:55]
    v_mfma_f32_16x16x32_bf16 v[60:63], a[176:179], a[4:7], v[60:63]
    ds_read_b128 a[160:163], v6 offset:4096
    ds_read_b128 a[164:167], v6 offset:13312
    v_mfma_f32_16x16x32_bf16 v[60:63], a[180:183], a[12:15], v[60:63]
    buffer_load_dwordx4 a[228:231], off, s[80:83], s50 offset:1024 sc1
    v_mfma_f32_16x16x32_bf16 v[60:63], a[184:187], a[20:23], v[60:63]
    ds_read_b128 a[168:171], v6 offset:22528
    ds_read_b128 a[172:175], v6 offset:31744
    v_mfma_f32_16x16x32_bf16 v[60:63], a[188:191], a[28:31], v[60:63]
    buffer_load_dwordx4 off, s[80:83], s41 offset:1024 sc1 lds
    v_mfma_f32_16x16x32_bf16 v[56:59], a[188:191], a[24:27], v[56:59]
    v_mfma_f32_16x16x32_bf16 v[56:59], a[184:187], a[16:19], v[56:59]
    buffer_load_dwordx4 a[232:235], off, s[80:83], s50 offset:2048 sc1
    v_mfma_f32_16x16x32_bf16 v[56:59], a[180:183], a[8:11], v[56:59]
    s_waitcnt lgkmcnt(4)
    v_mfma_f32_16x16x32_bf16 v[56:59], a[176:179], a[0:3], v[56:59]
    v_mfma_f32_16x16x32_bf16 v[64:67], a[144:147], a[0:3], v[64:67]
    ds_read_b128 a[176:179], v6 offset:5120
    ds_read_b128 a[180:183], v6 offset:14336
    v_mfma_f32_16x16x32_bf16 v[64:67], a[148:151], a[8:11], v[64:67]
    buffer_load_dwordx4 off, s[80:83], s41 offset:2048 sc1 lds
    v_mfma_f32_16x16x32_bf16 v[64:67], a[152:155], a[16:19], v[64:67]
    ds_read_b128 a[184:187], v6 offset:23552
    ds_read_b128 a[188:191], v6 offset:32768
    v_mfma_f32_16x16x32_bf16 v[64:67], a[156:159], a[24:27], v[64:67]
    v_mfma_f32_16x16x32_bf16 v[68:71], a[156:159], a[28:31], v[68:71]
    v_mfma_f32_16x16x32_bf16 v[68:71], a[152:155], a[20:23], v[68:71]
    buffer_load_dwordx4 a[236:239], off, s[80:83], s50 offset:3072 sc1
    v_mfma_f32_16x16x32_bf16 v[68:71], a[148:151], a[12:15], v[68:71]
    s_waitcnt lgkmcnt(4)
    v_mfma_f32_16x16x32_bf16 v[68:71], a[144:147], a[4:7], v[68:71]
    v_mfma_f32_16x16x32_bf16 v[76:79], a[160:163], a[4:7], v[76:79]
    ds_read_b128 a[144:147], v6 offset:6144
    ds_read_b128 a[148:151], v6 offset:15360
    v_mfma_f32_16x16x32_bf16 v[76:79], a[164:167], a[12:15], v[76:79]
    buffer_load_dwordx4 off, s[80:83], s41 offset:3072 sc1 lds
    v_mfma_f32_16x16x32_bf16 v[76:79], a[168:171], a[20:23], v[76:79]
    ds_read_b128 a[152:155], v6 offset:24576
    ds_read_b128 a[156:159], v6 offset:33792
    v_mfma_f32_16x16x32_bf16 v[76:79], a[172:175], a[28:31], v[76:79]
    s_add_u32 s50, s93, 102400
    buffer_load_dwordx4 a[240:243], off, s[80:83], s50 offset:0 sc1
    v_mfma_f32_16x16x32_bf16 v[72:75], a[172:175], a[24:27], v[72:75]
    v_mfma_f32_16x16x32_bf16 v[72:75], a[168:171], a[16:19], v[72:75]
    s_add_u32 m0, s32, 4096
    s_add_u32 s41, s92, 446464
    v_mfma_f32_16x16x32_bf16 v[72:75], a[164:167], a[8:11], v[72:75]
    s_waitcnt lgkmcnt(4)
    v_mfma_f32_16x16x32_bf16 v[72:75], a[160:163], a[0:3], v[72:75]
    v_mfma_f32_16x16x32_bf16 v[80:83], a[176:179], a[0:3], v[80:83]
    ds_read_b128 a[160:163], v6 offset:7168
    ds_read_b128 a[164:167], v6 offset:16384
    v_mfma_f32_16x16x32_bf16 v[80:83], a[180:183], a[8:11], v[80:83]
    buffer_load_dwordx4 a[244:247], off, s[80:83], s50 offset:1024 sc1
    v_mfma_f32_16x16x32_bf16 v[80:83], a[184:187], a[16:19], v[80:83]
    ds_read_b128 a[168:171], v6 offset:25600
    ds_read_b128 a[172:175], v6 offset:34816
    v_mfma_f32_16x16x32_bf16 v[80:83], a[188:191], a[24:27], v[80:83]
    v_mfma_f32_16x16x32_bf16 v[84:87], a[188:191], a[28:31], v[84:87]
    v_mfma_f32_16x16x32_bf16 v[84:87], a[184:187], a[20:23], v[84:87]
    buffer_load_dwordx4 off, s[80:83], s41 offset:0 sc1 lds
    v_mfma_f32_16x16x32_bf16 v[84:87], a[180:183], a[12:15], v[84:87]
    s_waitcnt lgkmcnt(4)
    v_mfma_f32_16x16x32_bf16 v[84:87], a[176:179], a[4:7], v[84:87]
    v_mfma_f32_16x16x32_bf16 v[92:95], a[144:147], a[4:7], v[92:95]
    ds_read_b128 a[176:179], v6 offset:8192
    ds_read_b128 a[180:183], v6 offset:17408
    v_mfma_f32_16x16x32_bf16 v[92:95], a[148:151], a[12:15], v[92:95]
    buffer_load_dwordx4 a[248:251], off, s[80:83], s50 offset:2048 sc1
    v_mfma_f32_16x16x32_bf16 v[92:95], a[152:155], a[20:23], v[92:95]
    ds_read_b128 a[184:187], v6 offset:26624
    ds_read_b128 a[188:191], v6 offset:35840
    v_mfma_f32_16x16x32_bf16 v[92:95], a[156:159], a[28:31], v[92:95]
    buffer_load_dwordx4 off, s[80:83], s41 offset:1024 sc1 lds
    v_mfma_f32_16x16x32_bf16 v[88:91], a[156:159], a[24:27], v[88:91]
    v_mfma_f32_16x16x32_bf16 v[88:91], a[152:155], a[16:19], v[88:91]
    buffer_load_dwordx4 a[252:255], off, s[80:83], s50 offset:3072 sc1
    v_mfma_f32_16x16x32_bf16 v[88:91], a[148:151], a[8:11], v[88:91]
    s_waitcnt lgkmcnt(4)
    v_mfma_f32_16x16x32_bf16 v[88:91], a[144:147], a[0:3], v[88:91]
    v_mfma_f32_16x16x32_bf16 v[96:99], a[160:163], a[0:3], v[96:99]
    s_waitcnt vmcnt(14)
    s_barrier
    v_mfma_f32_16x16x32_bf16 v[96:99], a[164:167], a[8:11], v[96:99]
    buffer_load_dwordx4 off, s[80:83], s41 offset:2048 sc1 lds
    v_mfma_f32_16x16x32_bf16 v[96:99], a[168:171], a[16:19], v[96:99]
    ds_read_b128 a[144:147], v7 offset:0
    ds_read_b128 a[148:151], v7 offset:9216
    v_mfma_f32_16x16x32_bf16 v[96:99], a[172:175], a[24:27], v[96:99]
    v_mfma_f32_16x16x32_bf16 v[100:103], a[172:175], a[28:31], v[100:103]
    ds_read_b128 a[152:155], v7 offset:18432
    ds_read_b128 a[156:159], v7 offset:27648
    v_mfma_f32_16x16x32_bf16 v[100:103], a[168:171], a[20:23], v[100:103]
    buffer_load_dwordx4 off, s[80:83], s41 offset:3072 sc1 lds
    v_mfma_f32_16x16x32_bf16 v[100:103], a[164:167], a[12:15], v[100:103]
    s_waitcnt lgkmcnt(4)
    v_mfma_f32_16x16x32_bf16 v[100:103], a[160:163], a[4:7], v[100:103]
    v_mfma_f32_16x16x32_bf16 v[108:111], a[176:179], a[4:7], v[108:111]
    ds_read_b128 a[160:163], v7 offset:1024
    ds_read_b128 a[164:167], v7 offset:10240
    v_mfma_f32_16x16x32_bf16 v[108:111], a[180:183], a[12:15], v[108:111]
    s_add_u32 m0, s32, 8192
    s_add_u32 s41, s92, 450560
    v_mfma_f32_16x16x32_bf16 v[108:111], a[184:187], a[20:23], v[108:111]
    ds_read_b128 a[168:171], v7 offset:19456
    ds_read_b128 a[172:175], v7 offset:28672
    v_mfma_f32_16x16x32_bf16 v[108:111], a[188:191], a[28:31], v[108:111]
    buffer_load_dwordx4 off, s[80:83], s41 offset:0 sc1 lds
    v_mfma_f32_16x16x32_bf16 v[104:107], a[188:191], a[24:27], v[104:107]
    v_mfma_f32_16x16x32_bf16 v[104:107], a[184:187], a[16:19], v[104:107]
    s_getpc_b64 s[88:89]
.set L_interleave_layers__spectral_fnet__mixer_gmlp__prompt_kernel_27, .
    s_lshr_b32 s11, s2, 3
    s_lshl_b32 s11, s11, 10
    v_lshl_add_u32 v18, v0, 2, s11
    v_min_u32 v18, L_last_interleave_layers__spectral_fnet__mixer_gmlp__prompt_kernel-L_interleave_layers__spectral_fnet__mixer_gmlp__prompt_kernel_27-16, v18
    v_add_co_u32 v18, vcc, s88, v18
    v_mov_b32 v19, s89
    s_nop 0
    v_addc_co_u32 v19, vcc, 0, v19, vcc
    global_load_dword v18, v[18:19], off
    v_mfma_f32_16x16x32_bf16 v[104:107], a[180:183], a[8:11], v[104:107]
    s_waitcnt lgkmcnt(4)
    v_mfma_f32_16x16x32_bf16 v[104:107], a[176:179], a[0:3], v[104:107]
    v_mfma_f32_16x16x32_bf16 v[40:43], a[144:147], a[192:195], v[40:43]
    ds_read_b128 a[176:179], v7 offset:2048
    ds_read_b128 a[180:183], v7 offset:11264
    v_mfma_f32_16x16x32_bf16 v[40:43], a[148:151], a[200:203], v[40:43]
    s_cmp_le_u32 s4, 13
    s_cselect_b32 s92, s91, s35
    v_mfma_f32_16x16x32_bf16 v[40:43], a[152:155], a[208:211], v[40:43]
    ds_read_b128 a[184:187], v7 offset:20480
    ds_read_b128 a[188:191], v7 offset:29696
    v_mfma_f32_16x16x32_bf16 v[40:43], a[156:159], a[216:219], v[40:43]
    s_cmp_le_u32 s4, 13
    s_cselect_b32 s93, s90, s36
    v_mfma_f32_16x16x32_bf16 v[44:47], a[156:159], a[220:223], v[44:47]
    v_mfma_f32_16x16x32_bf16 v[44:47], a[152:155], a[212:215], v[44:47]
    s_add_u32 m0, s32, 45056
    s_add_u32 s41, s92, 487424
    v_mfma_f32_16x16x32_bf16 v[44:47], a[148:151], a[204:207], v[44:47]
    s_waitcnt lgkmcnt(4)
    v_mfma_f32_16x16x32_bf16 v[44:47], a[144:147], a[196:199], v[44:47]
    v_mfma_f32_16x16x32_bf16 v[52:55], a[160:163], a[196:199], v[52:55]
    ds_read_b128 a[144:147], v7 offset:3072
    ds_read_b128 a[148:151], v7 offset:12288
    v_mfma_f32_16x16x32_bf16 v[52:55], a[164:167], a[204:207], v[52:55]
    s_add_u32 s50, s93, 106496
    buffer_load_dwordx4 a[0:3], off, s[80:83], s50 offset:0 sc1
    v_mfma_f32_16x16x32_bf16 v[52:55], a[168:171], a[212:215], v[52:55]
    ds_read_b128 a[152:155], v7 offset:21504
    ds_read_b128 a[156:159], v7 offset:30720
    v_mfma_f32_16x16x32_bf16 v[52:55], a[172:175], a[220:223], v[52:55]
    v_mfma_f32_16x16x32_bf16 v[48:51], a[172:175], a[216:219], v[48:51]
    v_mfma_f32_16x16x32_bf16 v[48:51], a[168:171], a[208:211], v[48:51]
    buffer_load_dwordx4 off, s[80:83], s41 offset:0 sc1 lds
    v_mfma_f32_16x16x32_bf16 v[48:51], a[164:167], a[200:203], v[48:51]
    s_waitcnt lgkmcnt(4)
    v_mfma_f32_16x16x32_bf16 v[48:51], a[160:163], a[192:195], v[48:51]
    v_mfma_f32_16x16x32_bf16 v[56:59], a[176:179], a[192:195], v[56:59]
    ds_read_b128 a[160:163], v7 offset:4096
    ds_read_b128 a[164:167], v7 offset:13312
    v_mfma_f32_16x16x32_bf16 v[56:59], a[180:183], a[200:203], v[56:59]
    buffer_load_dwordx4 a[4:7], off, s[80:83], s50 offset:1024 sc1
    v_mfma_f32_16x16x32_bf16 v[56:59], a[184:187], a[208:211], v[56:59]
    ds_read_b128 a[168:171], v7 offset:22528
    ds_read_b128 a[172:175], v7 offset:31744
    v_mfma_f32_16x16x32_bf16 v[56:59], a[188:191], a[216:219], v[56:59]
    s_add_u32 m0, s32, 36864
    s_add_u32 s41, s92, 479232
    v_mfma_f32_16x16x32_bf16 v[60:63], a[188:191], a[220:223], v[60:63]
    v_mfma_f32_16x16x32_bf16 v[60:63], a[184:187], a[212:215], v[60:63]
    buffer_load_dwordx4 a[8:11], off, s[80:83], s50 offset:2048 sc1
    v_mfma_f32_16x16x32_bf16 v[60:63], a[180:183], a[204:207], v[60:63]
    s_waitcnt lgkmcnt(4)
    v_mfma_f32_16x16x32_bf16 v[60:63], a[176:179], a[196:199], v[60:63]
    v_mfma_f32_16x16x32_bf16 v[68:71], a[144:147], a[196:199], v[68:71]
    ds_read_b128 a[176:179], v7 offset:5120
    ds_read_b128 a[180:183], v7 offset:14336
    v_mfma_f32_16x16x32_bf16 v[68:71], a[148:151], a[204:207], v[68:71]
    buffer_load_dwordx4 off, s[80:83], s41 offset:0 sc1 lds
    v_mfma_f32_16x16x32_bf16 v[68:71], a[152:155], a[212:215], v[68:71]
    ds_read_b128 a[184:187], v7 offset:23552
    ds_read_b128 a[188:191], v7 offset:32768
    v_mfma_f32_16x16x32_bf16 v[68:71], a[156:159], a[220:223], v[68:71]
    v_mfma_f32_16x16x32_bf16 v[64:67], a[156:159], a[216:219], v[64:67]
    v_mfma_f32_16x16x32_bf16 v[64:67], a[152:155], a[208:211], v[64:67]
    buffer_load_dwordx4 a[12:15], off, s[80:83], s50 offset:3072 sc1
    v_mfma_f32_16x16x32_bf16 v[64:67], a[148:151], a[200:203], v[64:67]
    s_waitcnt lgkmcnt(4)
    v_mfma_f32_16x16x32_bf16 v[64:67], a[144:147], a[192:195], v[64:67]
    v_mfma_f32_16x16x32_bf16 v[72:75], a[160:163], a[192:195], v[72:75]
    ds_read_b128 a[144:147], v7 offset:6144
    ds_read_b128 a[148:151], v7 offset:15360
    v_mfma_f32_16x16x32_bf16 v[72:75], a[164:167], a[200:203], v[72:75]
    buffer_load_dwordx4 off, s[80:83], s41 offset:1024 sc1 lds
    v_mfma_f32_16x16x32_bf16 v[72:75], a[168:171], a[208:211], v[72:75]
    ds_read_b128 a[152:155], v7 offset:24576
    ds_read_b128 a[156:159], v7 offset:33792
    v_mfma_f32_16x16x32_bf16 v[72:75], a[172:175], a[216:219], v[72:75]
    s_add_u32 s50, s93, 110592
    buffer_load_dwordx4 a[16:19], off, s[80:83], s50 offset:0 sc1
    v_mfma_f32_16x16x32_bf16 v[76:79], a[172:175], a[220:223], v[76:79]
    v_mfma_f32_16x16x32_bf16 v[76:79], a[168:171], a[212:215], v[76:79]
    buffer_load_dwordx4 off, s[80:83], s41 offset:2048 sc1 lds
    v_mfma_f32_16x16x32_bf16 v[76:79], a[164:167], a[204:207], v[76:79]
    s_waitcnt lgkmcnt(4)
    v_mfma_f32_16x16x32_bf16 v[76:79], a[160:163], a[196:199], v[76:79]
    v_mfma_f32_16x16x32_bf16 v[84:87], a[176:179], a[196:199], v[84:87]
    ds_read_b128 a[160:163], v7 offset:7168
    ds_read_b128 a[164:167], v7 offset:16384
    v_mfma_f32_16x16x32_bf16 v[84:87], a[180:183], a[204:207], v[84:87]
    buffer_load_dwordx4 a[20:23], off, s[80:83], s50 offset:1024 sc1
    v_mfma_f32_16x16x32_bf16 v[84:87], a[184:187], a[212:215], v[84:87]
    ds_read_b128 a[168:171], v7 offset:25600
    ds_read_b128 a[172:175], v7 offset:34816
    v_mfma_f32_16x16x32_bf16 v[84:87], a[188:191], a[220:223], v[84:87]
    v_mfma_f32_16x16x32_bf16 v[80:83], a[188:191], a[216:219], v[80:83]
    v_mfma_f32_16x16x32_bf16 v[80:83], a[184:187], a[208:211], v[80:83]
    buffer_load_dwordx4 off, s[80:83], s41 offset:3072 sc1 lds
    v_mfma_f32_16x16x32_bf16 v[80:83], a[180:183], a[200:203], v[80:83]
    s_waitcnt lgkmcnt(4)
    v_mfma_f32_16x16x32_bf16 v[80:83], a[176:179], a[192:195], v[80:83]
    v_mfma_f32_16x16x32_bf16 v[88:91], a[144:147], a[192:195], v[88:91]
    ds_read_b128 a[176:179], v7 offset:8192
    ds_read_b128 a[180:183], v7 offset:17408
    v_mfma_f32_16x16x32_bf16 v[88:91], a[148:151], a[200:203], v[88:91]
    buffer_load_dwordx4 a[24:27], off, s[80:83], s50 offset:2048 sc1
    v_mfma_f32_16x16x32_bf16 v[88:91], a[152:155], a[208:211], v[88:91]
    ds_read_b128 a[184:187], v7 offset:26624
    ds_read_b128 a[188:191], v7 offset:35840
    v_mfma_f32_16x16x32_bf16 v[88:91], a[156:159], a[216:219], v[88:91]
    s_add_u32 m0, s32, 40960
    s_add_u32 s41, s92, 483328
    v_mfma_f32_16x16x32_bf16 v[92:95], a[156:159], a[220:223], v[92:95]
    v_mfma_f32_16x16x32_bf16 v[92:95], a[152:155], a[212:215], v[92:95]
    buffer_load_dwordx4 a[28:31], off, s[80:83], s50 offset:3072 sc1
    v_mfma_f32_16x16x32_bf16 v[92:95], a[148:151], a[204:207], v[92:95]
    s_waitcnt lgkmcnt(4)
    v_mfma_f32_16x16x32_bf16 v[92:95], a[144:147], a[196:199], v[92:95]
    v_mfma_f32_16x16x32_bf16 v[100:103], a[160:163], a[196:199], v[100:103]
    s_waitcnt vmcnt(14)
    s_barrier
    v_mfma_f32_16x16x32_bf16 v[100:103], a[164:167], a[204:207], v[100:103]
    buffer_load_dwordx4 off, s[80:83], s41 offset:0 sc1 lds
    v_mfma_f32_16x16x32_bf16 v[100:103], a[168:171], a[212:215], v[100:103]
    ds_read_b128 a[144:147], v4 offset:8192
    ds_read_b128 a[148:151], v4 offset:17408
    v_mfma_f32_16x16x32_bf16 v[100:103], a[172:175], a[220:223], v[100:103]
    v_mfma_f32_16x16x32_bf16 v[96:99], a[172:175], a[216:219], v[96:99]
    ds_read_b128 a[152:155], v4 offset:26624
    ds_read_b128 a[156:159], v4 offset:35840
    v_mfma_f32_16x16x32_bf16 v[96:99], a[168:171], a[208:211], v[96:99]
    buffer_load_dwordx4 off, s[80:83], s41 offset:1024 sc1 lds
    v_mfma_f32_16x16x32_bf16 v[96:99], a[164:167], a[200:203], v[96:99]
    s_waitcnt lgkmcnt(4)
    v_mfma_f32_16x16x32_bf16 v[96:99], a[160:163], a[192:195], v[96:99]
    v_mfma_f32_16x16x32_bf16 v[104:107], a[176:179], a[192:195], v[104:107]
    ds_read_b128 a[160:163], v4 offset:0
    ds_read_b128 a[164:167], v4 offset:9216
    v_mfma_f32_16x16x32_bf16 v[104:107], a[180:183], a[200:203], v[104:107]
    buffer_load_dwordx4 off, s[80:83], s41 offset:2048 sc1 lds
    v_mfma_f32_16x16x32_bf16 v[104:107], a[184:187], a[208:211], v[104:107]
    ds_read_b128 a[168:171], v4 offset:18432
    ds_read_b128 a[172:175], v4 offset:27648
    v_mfma_f32_16x16x32_bf16 v[104:107], a[188:191], a[216:219], v[104:107]
    buffer_load_dwordx4 off, s[80:83], s41 offset:3072 sc1 lds
    v_mfma_f32_16x16x32_bf16 v[108:111], a[188:191], a[220:223], v[108:111]
    v_mfma_f32_16x16x32_bf16 v[108:111], a[184:187], a[212:215], v[108:111]
    v_mfma_f32_16x16x32_bf16 v[108:111], a[180:183], a[204:207], v[108:111]
    s_waitcnt lgkmcnt(4)
    v_mfma_f32_16x16x32_bf16 v[108:111], a[176:179], a[196:199], v[108:111]
    v_mfma_f32_16x16x32_bf16 v[108:111], a[144:147], a[228:231], v[108:111]
    ds_read_b128 a[176:179], v4 offset:1024
    ds_read_b128 a[180:183], v4 offset:10240
    s_mul_i32 s45, s31, 147456
    s_lshr_b32 s46, s5, 1
    s_mul_i32 s46, s46, 9216
    s_add_u32 s45, s45, s46
    s_add_u32 s45, s45, s28
    s_add_u32 s45, s45, 18874368
    s_and_b32 s49, s5, 1
    s_bfe_u32 s48, s5, 0x10001
    s_xor_b32 s48, s48, s49
    s_mul_i32 s47, s48, 73728
    s_add_u32 s47, s47, s45
    s_add_u32 s47, s47, 8192
    s_cmp_eq_u32 s48, 1
    s_cselect_b64 s[58:59], -1, 0
    s_lshl_b32 s49, s49, 12
    s_add_u32 s45, s45, s49
    s_add_u32 s46, s45, 73728
    v_mfma_f32_16x16x32_bf16 v[108:111], a[148:151], a[236:239], v[108:111]
    s_cmp_le_u32 s4, 14
    s_cselect_b32 s92, s91, s35
    v_mfma_f32_16x16x32_bf16 v[108:111], a[152:155], a[244:247], v[108:111]
    ds_read_b128 a[184:187], v4 offset:19456
    ds_read_b128 a[188:191], v4 offset:28672
    v_mfma_f32_16x16x32_bf16 v[108:111], a[156:159], a[252:255], v[108:111]
    s_cmp_le_u32 s4, 14
    s_cselect_b32 s93, s90, s36
    v_mfma_f32_16x16x32_bf16 v[104:107], a[156:159], a[248:251], v[104:107]
    v_mfma_f32_16x16x32_bf16 v[104:107], a[152:155], a[240:243], v[104:107]
    s_add_u32 m0, s32, 81920
    s_add_u32 s41, s92, 524288
    v_mfma_f32_16x16x32_bf16 v[104:107], a[148:151], a[232:235], v[104:107]
    s_waitcnt lgkmcnt(4)
    v_mfma_f32_16x16x32_bf16 v[104:107], a[144:147], a[224:227], v[104:107]
    s_add_u32 s50, s93, 114688
    buffer_load_dwordx4 a[192:195], off, s[80:83], s50 offset:0 sc1
    v_mfma_f32_16x16x32_bf16 v[40:43], a[160:163], a[224:227], v[40:43]
    ds_read_b128 a[144:147], v4 offset:2048
    ds_read_b128 a[148:151], v4 offset:11264
    v_mfma_f32_16x16x32_bf16 v[40:43], a[164:167], a[232:235], v[40:43]
    buffer_load_dwordx4 off, s[80:83], s41 offset:0 sc1 lds
    v_mfma_f32_16x16x32_bf16 v[40:43], a[168:171], a[240:243], v[40:43]
    ds_read_b128 a[152:155], v4 offset:20480
    ds_read_b128 a[156:159], v4 offset:29696
    v_mfma_f32_16x16x32_bf16 v[40:43], a[172:175], a[248:251], v[40:43]
    buffer_load_dwordx4 a[196:199], off, s[80:83], s50 offset:1024 sc1
    v_mfma_f32_16x16x32_bf16 v[44:47], a[172:175], a[252:255], v[44:47]
    v_mfma_f32_16x16x32_bf16 v[44:47], a[168:171], a[244:247], v[44:47]
    s_add_u32 m0, s32, 73728
    s_add_u32 s41, s92, 516096
    v_mfma_f32_16x16x32_bf16 v[44:47], a[164:167], a[236:239], v[44:47]
    s_waitcnt lgkmcnt(4)
    v_mfma_f32_16x16x32_bf16 v[44:47], a[160:163], a[228:231], v[44:47]
    buffer_load_dwordx4 a[200:203], off, s[80:83], s50 offset:2048 sc1
    v_mfma_f32_16x16x32_bf16 v[52:55], a[176:179], a[228:231], v[52:55]
    ds_read_b128 a[160:163], v4 offset:3072
    ds_read_b128 a[164:167], v4 offset:12288
    v_mfma_f32_16x16x32_bf16 v[52:55], a[180:183], a[236:239], v[52:55]
    buffer_load_dwordx4 off, s[80:83], s41 offset:0 sc1 lds
    v_mfma_f32_16x16x32_bf16 v[52:55], a[184:187], a[244:247], v[52:55]
    ds_read_b128 a[168:171], v4 offset:21504
    ds_read_b128 a[172:175], v4 offset:30720
    v_mfma_f32_16x16x32_bf16 v[52:55], a[188:191], a[252:255], v[52:55]
    buffer_load_dwordx4 a[204:207], off, s[80:83], s50 offset:3072 sc1
    v_mfma_f32_16x16x32_bf16 v[48:51], a[188:191], a[248:251], v[48:51]
    v_mfma_f32_16x16x32_bf16 v[48:51], a[184:187], a[240:243], v[48:51]
    buffer_load_dwordx4 off, s[80:83], s41 offset:1024 sc1 lds
    v_mfma_f32_16x16x32_bf16 v[48:51], a[180:183], a[232:235], v[48:51]
    s_waitcnt lgkmcnt(4)
    v_mfma_f32_16x16x32_bf16 v[48:51], a[176:179], a[224:227], v[48:51]
    s_add_u32 s50, s93, 118784
    buffer_load_dwordx4 a[208:211], off, s[80:83], s50 offset:0 sc1
    v_mfma_f32_16x16x32_bf16 v[56:59], a[144:147], a[224:227], v[56:59]
    s_waitcnt vmcnt(14)
    s_barrier
    v_mfma_f32_16x16x32_bf16 v[56:59], a[148:151], a[232:235], v[56:59]
    buffer_load_dwordx4 off, s[80:83], s41 offset:2048 sc1 lds
    v_mfma_f32_16x16x32_bf16 v[56:59], a[152:155], a[240:243], v[56:59]
    ds_read_b128 a[176:179], v5 offset:8192
    ds_read_b128 a[180:183], v5 offset:17408
    v_mfma_f32_16x16x32_bf16 v[56:59], a[156:159], a[248:251], v[56:59]
    buffer_load_dwordx4 a[212:215], off, s[80:83], s50 offset:1024 sc1
    v_mfma_f32_16x16x32_bf16 v[60:63], a[156:159], a[252:255], v[60:63]
    ds_read_b128 a[184:187], v5 offset:26624
    ds_read_b128 a[188:191], v5 offset:35840
    v_mfma_f32_16x16x32_bf16 v[60:63], a[152:155], a[244:247], v[60:63]
    buffer_load_dwordx4 off, s[80:83], s41 offset:3072 sc1 lds
    v_mfma_f32_16x16x32_bf16 v[60:63], a[148:151], a[236:239], v[60:63]
    s_waitcnt lgkmcnt(4)
    v_mfma_f32_16x16x32_bf16 v[60:63], a[144:147], a[228:231], v[60:63]
    buffer_load_dwordx4 a[216:219], off, s[80:83], s50 offset:2048 sc1
    v_mfma_f32_16x16x32_bf16 v[68:71], a[160:163], a[228:231], v[68:71]
    ds_read_b128 a[144:147], v5 offset:0
    ds_read_b128 a[148:151], v5 offset:9216
    v_mfma_f32_16x16x32_bf16 v[68:71], a[164:167], a[236:239], v[68:71]
    s_add_u32 m0, s32, 77824
    s_add_u32 s41, s92, 520192
    v_mfma_f32_16x16x32_bf16 v[68:71], a[168:171], a[244:247], v[68:71]
    ds_read_b128 a[152:155], v5 offset:18432
    ds_read_b128 a[156:159], v5 offset:27648
    v_mfma_f32_16x16x32_bf16 v[68:71], a[172:175], a[252:255], v[68:71]
    v_mfma_f32_16x16x32_bf16 v[64:67], a[172:175], a[248:251], v[64:67]
    v_mfma_f32_16x16x32_bf16 v[64:67], a[168:171], a[240:243], v[64:67]
    buffer_load_dwordx4 a[220:223], off, s[80:83], s50 offset:3072 sc1
    v_mfma_f32_16x16x32_bf16 v[64:67], a[164:167], a[232:235], v[64:67]
    s_waitcnt vmcnt(17) lgkmcnt(4)
    v_mfma_f32_16x16x32_bf16 v[64:67], a[160:163], a[224:227], v[64:67]
    v_mfma_f32_16x16x32_bf16 v[104:107], a[176:179], a[0:3], v[104:107]
    ds_read_b128 a[160:163], v5 offset:1024
    ds_read_b128 a[164:167], v5 offset:10240
    v_mfma_f32_16x16x32_bf16 v[104:107], a[180:183], a[8:11], v[104:107]
    buffer_load_dwordx4 off, s[80:83], s41 offset:0 sc1 lds
    v_mfma_f32_16x16x32_bf16 v[104:107], a[184:187], a[16:19], v[104:107]
    ds_read_b128 a[168:171], v5 offset:19456
    ds_read_b128 a[172:175], v5 offset:28672
    v_mfma_f32_16x16x32_bf16 v[104:107], a[188:191], a[24:27], v[104:107]
    buffer_load_dwordx4 off, s[80:83], s41 offset:1024 sc1 lds
    v_mfma_f32_16x16x32_bf16 v[108:111], a[188:191], a[28:31], v[108:111]
    v_mfma_f32_16x16x32_bf16 v[108:111], a[184:187], a[20:23], v[108:111]
    buffer_load_dwordx4 off, s[80:83], s41 offset:2048 sc1 lds
    v_mfma_f32_16x16x32_bf16 v[108:111], a[180:183], a[12:15], v[108:111]
    s_waitcnt lgkmcnt(4)
    v_mfma_f32_16x16x32_bf16 v[108:111], a[176:179], a[4:7], v[108:111]
    v_mfma_f32_16x16x32_bf16 v[44:47], a[144:147], a[4:7], v[44:47]
    ds_read_b128 a[176:179], v5 offset:2048
    ds_read_b128 a[180:183], v5 offset:11264
    v_mfma_f32_16x16x32_bf16 v[44:47], a[148:151], a[12:15], v[44:47]
    buffer_load_dwordx4 off, s[80:83], s41 offset:3072 sc1 lds
    v_mfma_f32_16x16x32_bf16 v[44:47], a[152:155], a[20:23], v[44:47]
    ds_read_b128 a[184:187], v5 offset:20480
    ds_read_b128 a[188:191], v5 offset:29696
    v_mfma_f32_16x16x32_bf16 v[44:47], a[156:159], a[28:31], v[44:47]
    v_mfma_f32_16x16x32_bf16 v[40:43], a[156:159], a[24:27], v[40:43]
    v_mfma_f32_16x16x32_bf16 v[40:43], a[152:155], a[16:19], v[40:43]
    buffer_load_dwordx4 v[184:187], off, s[80:83], s51 offset:1024 sc1
    v_mfma_f32_16x16x32_bf16 v[40:43], a[148:151], a[8:11], v[40:43]
    s_waitcnt lgkmcnt(4)
    v_mfma_f32_16x16x32_bf16 v[40:43], a[144:147], a[0:3], v[40:43]
    v_mfma_f32_16x16x32_bf16 v[48:51], a[160:163], a[0:3], v[48:51]
    ds_read_b128 a[144:147], v5 offset:3072
    ds_read_b128 a[148:151], v5 offset:12288
    v_mfma_f32_16x16x32_bf16 v[48:51], a[164:167], a[8:11], v[48:51]
    buffer_load_dwordx4 v[188:191], off, s[80:83], s51 offset:2048 sc1
    v_mfma_f32_16x16x32_bf16 v[48:51], a[168:171], a[16:19], v[48:51]
    ds_read_b128 a[152:155], v5 offset:21504
    ds_read_b128 a[156:159], v5 offset:30720
    v_mfma_f32_16x16x32_bf16 v[48:51], a[172:175], a[24:27], v[48:51]
    v_mfma_f32_16x16x32_bf16 v[52:55], a[172:175], a[28:31], v[52:55]
    v_mfma_f32_16x16x32_bf16 v[52:55], a[168:171], a[20:23], v[52:55]
    buffer_load_dwordx4 v[192:195], off, s[80:83], s51 offset:3072 sc1
    v_mfma_f32_16x16x32_bf16 v[52:55], a[164:167], a[12:15], v[52:55]
    s_waitcnt lgkmcnt(4)
    v_mfma_f32_16x16x32_bf16 v[52:55], a[160:163], a[4:7], v[52:55]
    v_mfma_f32_16x16x32_bf16 v[60:63], a[176:179], a[4:7], v[60:63]
    s_waitcnt vmcnt(9)
    s_barrier
    v_mfma_f32_16x16x32_bf16 v[60:63], a[180:183], a[12:15], v[60:63]
    buffer_load_dwordx4 v[196:199], v16, s[12:15], s51 offen sc1
    v_mfma_f32_16x16x32_bf16 v[60:63], a[184:187], a[20:23], v[60:63]
    ds_read_b128 a[160:163], v6 offset:8192
    ds_read_b128 a[164:167], v6 offset:17408
    v_mfma_f32_16x16x32_bf16 v[60:63], a[188:191], a[28:31], v[60:63]
    v_mfma_f32_16x16x32_bf16 v[56:59], a[188:191], a[24:27], v[56:59]
    ds_read_b128 a[168:171], v6 offset:26624
    ds_read_b128 a[172:175], v6 offset:35840
    v_mfma_f32_16x16x32_bf16 v[56:59], a[184:187], a[16:19], v[56:59]
    s_add_u32 s51, s39, 258048
    buffer_load_dwordx4 v[200:203], off, s[80:83], s51 offset:0 sc1
    v_mfma_f32_16x16x32_bf16 v[56:59], a[180:183], a[8:11], v[56:59]
    s_waitcnt lgkmcnt(4)
    v_mfma_f32_16x16x32_bf16 v[56:59], a[176:179], a[0:3], v[56:59]
    v_mfma_f32_16x16x32_bf16 v[64:67], a[144:147], a[0:3], v[64:67]
    ds_read_b128 a[176:179], v6 offset:0
    ds_read_b128 a[180:183], v6 offset:9216
    v_mfma_f32_16x16x32_bf16 v[64:67], a[148:151], a[8:11], v[64:67]
    buffer_load_dwordx4 v[204:207], off, s[80:83], s51 offset:1024 sc1
    v_mfma_f32_16x16x32_bf16 v[64:67], a[152:155], a[16:19], v[64:67]
    ds_read_b128 a[184:187], v6 offset:18432
    ds_read_b128 a[188:191], v6 offset:27648
    v_mfma_f32_16x16x32_bf16 v[64:67], a[156:159], a[24:27], v[64:67]
    v_mfma_f32_16x16x32_bf16 v[68:71], a[156:159], a[28:31], v[68:71]
    v_mfma_f32_16x16x32_bf16 v[68:71], a[152:155], a[20:23], v[68:71]
    buffer_load_dwordx4 v[208:211], off, s[80:83], s51 offset:2048 sc1
    v_mfma_f32_16x16x32_bf16 v[68:71], a[148:151], a[12:15], v[68:71]
    s_waitcnt vmcnt(11) lgkmcnt(4)
    v_mfma_f32_16x16x32_bf16 v[68:71], a[144:147], a[4:7], v[68:71]
    v_mfma_f32_16x16x32_bf16 v[108:111], a[160:163], a[196:199], v[108:111]
    ds_read_b128 a[144:147], v6 offset:1024
    ds_read_b128 a[148:151], v6 offset:10240
    v_mfma_f32_16x16x32_bf16 v[108:111], a[164:167], a[204:207], v[108:111]
    buffer_load_dwordx4 v[212:215], off, s[80:83], s51 offset:3072 sc1
    v_mfma_f32_16x16x32_bf16 v[108:111], a[168:171], a[212:215], v[108:111]
    ds_read_b128 a[152:155], v6 offset:19456
    ds_read_b128 a[156:159], v6 offset:28672
    v_mfma_f32_16x16x32_bf16 v[108:111], a[172:175], a[220:223], v[108:111]
    v_mfma_f32_16x16x32_bf16 v[104:107], a[172:175], a[216:219], v[104:107]
    v_mfma_f32_16x16x32_bf16 v[104:107], a[168:171], a[208:211], v[104:107]
    buffer_load_dwordx4 v[216:219], v16, s[12:15], s51 offen sc1
    v_mfma_f32_16x16x32_bf16 v[104:107], a[164:167], a[200:203], v[104:107]
    s_waitcnt lgkmcnt(4)
    v_mfma_f32_16x16x32_bf16 v[104:107], a[160:163], a[192:195], v[104:107]
    v_mfma_f32_16x16x32_bf16 v[40:43], a[176:179], a[192:195], v[40:43]
    ds_read_b128 a[160:163], v6 offset:2048
    ds_read_b128 a[164:167], v6 offset:11264
    v_mfma_f32_16x16x32_bf16 v[40:43], a[180:183], a[200:203], v[40:43]
    v_mfma_f32_16x16x32_bf16 v[40:43], a[184:187], a[208:211], v[40:43]
    ds_read_b128 a[168:171], v6 offset:20480
    ds_read_b128 a[172:175], v6 offset:29696
    v_mfma_f32_16x16x32_bf16 v[40:43], a[188:191], a[216:219], v[40:43]
    v_mul_f32 v176, v104, v176
    v_mul_f32 v177, v105, v177
    v_mul_f32 v178, v106, v178
    v_mul_f32 v179, v107, v179
    v_mul_f32 v180, v108, v180
    v_mfma_f32_16x16x32_bf16 v[44:47], a[188:191], a[220:223], v[44:47]
    v_mul_f32 v181, v109, v181
    v_mul_f32 v182, v110, v182
    v_mul_f32 v183, v111, v183
    v_mfma_f32_16x16x32_bf16 v[44:47], a[184:187], a[212:215], v[44:47]
    v_cvt_pk_bf16_f32 v224, v176, v177
    v_cvt_pk_bf16_f32 v225, v178, v179
    v_cvt_pk_bf16_f32 v228, v180, v181
    v_mfma_f32_16x16x32_bf16 v[44:47], a[180:183], a[204:207], v[44:47]
    s_waitcnt lgkmcnt(4)
    v_cvt_pk_bf16_f32 v229, v182, v183
    v_cndmask_b32 v226, v228, v224, s[58:59]
    v_mfma_f32_16x16x32_bf16 v[44:47], a[176:179], a[196:199], v[44:47]
    v_cndmask_b32 v227, v229, v225, s[58:59]
    v_cndmask_b32 v224, v224, v228, s[58:59]
    v_cndmask_b32 v225, v225, v229, s[58:59]
    v_mfma_f32_16x16x32_bf16 v[52:55], a[144:147], a[196:199], v[52:55]
    ds_read_b128 a[176:179], v6 offset:3072
    ds_read_b128 a[180:183], v6 offset:12288
    buffer_store_dwordx4 v[224:227], off, s[80:83], s47 sc1
    v_mfma_f32_16x16x32_bf16 v[52:55], a[148:151], a[204:207], v[52:55]
    v_mfma_f32_16x16x32_bf16 v[52:55], a[152:155], a[212:215], v[52:55]
    ds_read_b128 a[184:187], v6 offset:21504
    ds_read_b128 a[188:191], v6 offset:30720
    v_mfma_f32_16x16x32_bf16 v[52:55], a[156:159], a[220:223], v[52:55]
    v_mul_f32 v112, v40, v112
    v_mul_f32 v113, v41, v113
    v_mul_f32 v114, v42, v114
    v_mul_f32 v115, v43, v115
    v_mul_f32 v116, v44, v116
    v_mfma_f32_16x16x32_bf16 v[48:51], a[156:159], a[216:219], v[48:51]
    v_mul_f32 v117, v45, v117
    v_mul_f32 v118, v46, v118
    v_mul_f32 v119, v47, v119
    v_mfma_f32_16x16x32_bf16 v[48:51], a[152:155], a[208:211], v[48:51]
    v_cvt_pk_bf16_f32 v232, v112, v113
    v_cvt_pk_bf16_f32 v233, v114, v115
    v_cvt_pk_bf16_f32 v236, v116, v117
    v_mfma_f32_16x16x32_bf16 v[48:51], a[148:151], a[200:203], v[48:51]
    s_waitcnt lgkmcnt(4)
    v_cvt_pk_bf16_f32 v237, v118, v119
    v_mfma_f32_16x16x32_bf16 v[48:51], a[144:147], a[192:195], v[48:51]
    v_mfma_f32_16x16x32_bf16 v[56:59], a[160:163], a[192:195], v[56:59]
    ds_read_b128 a[144:147], v4 offset:4096
    ds_read_b128 a[148:151], v4 offset:13312
    v_mfma_f32_16x16x32_bf16 v[56:59], a[164:167], a[200:203], v[56:59]
    v_mfma_f32_16x16x32_bf16 v[56:59], a[168:171], a[208:211], v[56:59]
    ds_read_b128 a[152:155], v4 offset:22528
    ds_read_b128 a[156:159], v4 offset:31744
    v_mfma_f32_16x16x32_bf16 v[56:59], a[172:175], a[216:219], v[56:59]
    v_mul_f32 v120, v48, v120
    v_mul_f32 v121, v49, v121
    v_mul_f32 v122, v50, v122
    v_mul_f32 v123, v51, v123
    v_mul_f32 v124, v52, v124
    v_mfma_f32_16x16x32_bf16 v[60:63], a[172:175], a[220:223], v[60:63]
    v_mul_f32 v125, v53, v125
    v_mul_f32 v126, v54, v126
    v_mul_f32 v127, v55, v127
    v_mfma_f32_16x16x32_bf16 v[60:63], a[168:171], a[212:215], v[60:63]
    v_cvt_pk_bf16_f32 v234, v120, v121
    v_cvt_pk_bf16_f32 v235, v122, v123
    v_cvt_pk_bf16_f32 v238, v124, v125
    v_mfma_f32_16x16x32_bf16 v[60:63], a[164:167], a[204:207], v[60:63]
    s_waitcnt lgkmcnt(4)
    v_cvt_pk_bf16_f32 v239, v126, v127
    buffer_store_dwordx4 v[232:235], off, s[80:83], s45 offset:0 sc1
    v_mfma_f32_16x16x32_bf16 v[60:63], a[160:163], a[196:199], v[60:63]
    buffer_store_dwordx4 v[236:239], off, s[80:83], s46 offset:0 sc1
    v_mfma_f32_16x16x32_bf16 v[68:71], a[176:179], a[196:199], v[68:71]
    s_waitcnt vmcnt(12)
    s_barrier
    v_mfma_f32_16x16x32_bf16 v[68:71], a[180:183], a[204:207], v[68:71]
    v_mfma_f32_16x16x32_bf16 v[68:71], a[184:187], a[212:215], v[68:71]
    ds_read_b128 a[160:163], v5 offset:4096
    ds_read_b128 a[164:167], v5 offset:13312
    v_mfma_f32_16x16x32_bf16 v[68:71], a[188:191], a[220:223], v[68:71]
    v_mul_f32 v128, v56, v128
    v_mul_f32 v129, v57, v129
    v_mul_f32 v130, v58, v130
    v_mul_f32 v131, v59, v131
    v_mul_f32 v132, v60, v132
    v_mfma_f32_16x16x32_bf16 v[64:67], a[188:191], a[216:219], v[64:67]
    ds_read_b128 a[168:171], v5 offset:22528
    ds_read_b128 a[172:175], v5 offset:31744
    v_mul_f32 v133, v61, v133
    v_mfma_f32_16x16x32_bf16 v[64:67], a[184:187], a[208:211], v[64:67]
    v_mul_f32 v134, v62, v134
    v_mul_f32 v135, v63, v135
    v_cvt_pk_bf16_f32 v224, v128, v129
    v_mfma_f32_16x16x32_bf16 v[64:67], a[180:183], a[200:203], v[64:67]
    s_waitcnt lgkmcnt(4)
    v_cvt_pk_bf16_f32 v225, v130, v131
    v_cvt_pk_bf16_f32 v228, v132, v133
    v_mfma_f32_16x16x32_bf16 v[64:67], a[176:179], a[192:195], v[64:67]
    v_cvt_pk_bf16_f32 v229, v134, v135
    v_mfma_f32_16x16x32_bf16 v[72:75], a[144:147], a[224:227], v[72:75]
    ds_read_b128 a[176:179], v6 offset:4096
    ds_read_b128 a[180:183], v6 offset:13312
    v_mfma_f32_16x16x32_bf16 v[72:75], a[148:151], a[232:235], v[72:75]
    v_mfma_f32_16x16x32_bf16 v[72:75], a[152:155], a[240:243], v[72:75]
    ds_read_b128 a[184:187], v6 offset:22528
    ds_read_b128 a[188:191], v6 offset:31744
    v_mfma_f32_16x16x32_bf16 v[72:75], a[156:159], a[248:251], v[72:75]
    v_mul_f32 v136, v64, v136
    v_mul_f32 v137, v65, v137
    v_mul_f32 v138, v66, v138
    v_mul_f32 v139, v67, v139
    v_mul_f32 v140, v68, v140
    v_mfma_f32_16x16x32_bf16 v[76:79], a[156:159], a[252:255], v[76:79]
    v_mul_f32 v141, v69, v141
    v_mul_f32 v142, v70, v142
    v_mul_f32 v143, v71, v143
    v_mfma_f32_16x16x32_bf16 v[76:79], a[152:155], a[244:247], v[76:79]
    v_cvt_pk_bf16_f32 v226, v136, v137
    v_cvt_pk_bf16_f32 v227, v138, v139
    v_cvt_pk_bf16_f32 v230, v140, v141
    v_mfma_f32_16x16x32_bf16 v[76:79], a[148:151], a[236:239], v[76:79]
    s_waitcnt lgkmcnt(4)
    v_cvt_pk_bf16_f32 v231, v142, v143
    buffer_store_dwordx4 v[224:227], off, s[80:83], s45 offset:1024 sc1
    v_mfma_f32_16x16x32_bf16 v[76:79], a[144:147], a[228:231], v[76:79]
    buffer_store_dwordx4 v[228:231], off, s[80:83], s46 offset:1024 sc1
    s_lshl_b32 s42, s4, 17
    s_lshl_b32 s54, s3, 14
    v_mfma_f32_16x16x32_bf16 v[76:79], a[160:163], a[4:7], v[76:79]
    ds_read_b128 a[144:147], v4 offset:5120
    ds_read_b128 a[148:151], v4 offset:14336
    s_lshl_b32 s55, s6, 16
    v_mfma_f32_16x16x32_bf16 v[76:79], a[164:167], a[12:15], v[76:79]
    s_add_u32 s54, s54, s55
    s_add_u32 s42, s42, s54
    s_lshl_b32 s44, s30, 7
    v_mfma_f32_16x16x32_bf16 v[76:79], a[168:171], a[20:23], v[76:79]
    ds_read_b128 a[152:155], v4 offset:23552
    ds_read_b128 a[156:159], v4 offset:32768
    s_add_u32 s44, s44, s42
    v_mfma_f32_16x16x32_bf16 v[76:79], a[172:175], a[28:31], v[76:79]
    s_add_u32 s44, s44, 18874368
    s_add_u32 s42, s42, s29
    v_and_b32 v136, 7, v2
    v_mfma_f32_16x16x32_bf16 v[72:75], a[172:175], a[24:27], v[72:75]
    v_lshlrev_b32 v136, 11, v136
    s_lshl_b32 s24, s4, 3
    s_lshl_b32 s25, s6, 2
    v_mfma_f32_16x16x32_bf16 v[72:75], a[168:171], a[16:19], v[72:75]
    s_add_u32 s43, s24, s25
    s_add_u32 s24, s43, s3
    s_mul_i32 s25, s24, 18432
    v_mfma_f32_16x16x32_bf16 v[72:75], a[164:167], a[8:11], v[72:75]
    s_waitcnt lgkmcnt(4)
    s_add_u32 s25, s25, s28
    s_add_u32 s25, s25, 6291456
    v_mfma_f32_16x16x32_bf16 v[72:75], a[160:163], a[0:3], v[72:75]
    s_lshl_b32 s26, s7, 11
    s_add_u32 s26, s26, s25
    s_bfe_u32 s27, s7, 0x10001
    v_mfma_f32_16x16x32_bf16 v[72:75], a[176:179], a[192:195], v[72:75]
    ds_read_b128 a[160:163], v5 offset:5120
    ds_read_b128 a[164:167], v5 offset:14336
    s_lshl_b32 s27, s27, 10
    v_mfma_f32_16x16x32_bf16 v[72:75], a[180:183], a[200:203], v[72:75]
    s_add_u32 s25, s27, s25
    s_and_b32 s27, s7, 1
    s_lshl_b32 s27, s27, 3
    v_mfma_f32_16x16x32_bf16 v[72:75], a[184:187], a[208:211], v[72:75]
    ds_read_b128 a[168:171], v5 offset:23552
    ds_read_b128 a[172:175], v5 offset:32768
    s_add_u32 s27, s25, s27
    v_mfma_f32_16x16x32_bf16 v[72:75], a[188:191], a[216:219], v[72:75]
    s_add_u32 s27, s27, 16384
    s_lshl_b32 s25, s24, 10
    s_add_u32 s25, s25, s28
    v_mfma_f32_16x16x32_bf16 v[76:79], a[188:191], a[220:223], v[76:79]
    s_add_u32 s25, s25, 2621440
    v_lshlrev_b32 v139, 2, v2
    s_and_b32 s54, s24, 7
    v_mfma_f32_16x16x32_bf16 v[76:79], a[184:187], a[212:215], v[76:79]
    s_mul_i32 s54, s54, 9216
    s_add_u32 s54, s54, s28
    s_add_u32 s54, s54, 18874368
    v_mfma_f32_16x16x32_bf16 v[76:79], a[180:183], a[204:207], v[76:79]
    s_waitcnt lgkmcnt(4)
    s_xor_b32 s62, s43, 4
    s_mul_i32 s62, s62, 73728
    v_mfma_f32_16x16x32_bf16 v[76:79], a[176:179], a[196:199], v[76:79]
    s_add_u32 s62, s62, s54
    s_mul_i32 s43, s43, 73728
    s_add_u32 s43, s43, s54
    v_mfma_f32_16x16x32_bf16 v[84:87], a[144:147], a[228:231], v[84:87]
    ds_read_b128 a[176:179], v6 offset:5120
    ds_read_b128 a[180:183], v6 offset:14336
    s_lshr_b32 s56, s37, 11
    v_mfma_f32_16x16x32_bf16 v[84:87], a[148:151], a[236:239], v[84:87]
    s_xor_b32 s58, s56, 32
    s_mov_b32 s54, 61865984
    s_lshl_b32 s61, 1, s30
    v_mfma_f32_16x16x32_bf16 v[84:87], a[152:155], a[244:247], v[84:87]
    ds_read_b128 a[184:187], v6 offset:23552
    ds_read_b128 a[188:191], v6 offset:32768
    s_mul_i32 s56, s56, 5120
    v_mfma_f32_16x16x32_bf16 v[84:87], a[156:159], a[252:255], v[84:87]
    s_add_u32 s56, s56, s54
    s_add_u32 s57, s56, 4096
    s_mul_i32 s58, s58, 5120
    v_mfma_f32_16x16x32_bf16 v[80:83], a[156:159], a[248:251], v[80:83]
    s_add_u32 s58, s58, s54
    s_add_u32 s59, s58, 4096
    s_xor_b32 s54, s3, 0
    v_mfma_f32_16x16x32_bf16 v[80:83], a[152:155], a[240:243], v[80:83]
    s_mul_i32 s55, s54, 73728
    s_add_u32 s72, s55, s62
    s_add_u32 s76, s55, s43
    v_mfma_f32_16x16x32_bf16 v[80:83], a[148:151], a[232:235], v[80:83]
    s_waitcnt lgkmcnt(4)
    s_mul_i32 s55, s54, 15360
    s_add_u32 s55, s55, 0
    v_mfma_f32_16x16x32_bf16 v[80:83], a[144:147], a[224:227], v[80:83]
    v_add_u32 v132, s55, v1
    s_xor_b32 s54, s3, 1
    s_mul_i32 s55, s54, 73728
    v_mfma_f32_16x16x32_bf16 v[80:83], a[160:163], a[0:3], v[80:83]
    ds_read_b128 a[144:147], v4 offset:6144
    ds_read_b128 a[148:151], v4 offset:15360
    s_add_u32 s73, s55, s62
    v_mfma_f32_16x16x32_bf16 v[80:83], a[164:167], a[8:11], v[80:83]
    s_add_u32 s77, s55, s43
    s_mul_i32 s55, s54, 15360
    s_add_u32 s55, s55, 0
    v_mfma_f32_16x16x32_bf16 v[80:83], a[168:171], a[16:19], v[80:83]
    ds_read_b128 a[152:155], v4 offset:24576
    ds_read_b128 a[156:159], v4 offset:33792
    v_add_u32 v133, s55, v1
    v_mfma_f32_16x16x32_bf16 v[80:83], a[172:175], a[24:27], v[80:83]
    s_xor_b32 s54, s3, 2
    s_mul_i32 s55, s54, 73728
    s_add_u32 s74, s55, s62
    v_mfma_f32_16x16x32_bf16 v[84:87], a[172:175], a[28:31], v[84:87]
    s_add_u32 s78, s55, s43
    s_mul_i32 s55, s54, 15360
    s_add_u32 s55, s55, 5120
    v_mfma_f32_16x16x32_bf16 v[84:87], a[168:171], a[20:23], v[84:87]
    v_add_u32 v134, s55, v1
    s_xor_b32 s54, s3, 3
    s_mul_i32 s55, s54, 73728
    v_mfma_f32_16x16x32_bf16 v[84:87], a[164:167], a[12:15], v[84:87]
    s_waitcnt lgkmcnt(4)
    s_add_u32 s75, s55, s62
    s_add_u32 s79, s55, s43
    v_mfma_f32_16x16x32_bf16 v[84:87], a[160:163], a[4:7], v[84:87]
    s_mul_i32 s55, s54, 15360
    s_add_u32 s55, s55, 10240
    v_add_u32 v135, s55, v1
    v_mfma_f32_16x16x32_bf16 v[84:87], a[176:179], a[196:199], v[84:87]
    ds_read_b128 a[160:163], v5 offset:6144
    ds_read_b128 a[164:167], v5 offset:15360
    v_mul_f32 v144, v72, v144
    v_mfma_f32_16x16x32_bf16 v[84:87], a[180:183], a[204:207], v[84:87]
    v_mul_f32 v145, v73, v145
    v_mul_f32 v146, v74, v146
    v_mul_f32 v147, v75, v147
    v_mfma_f32_16x16x32_bf16 v[84:87], a[184:187], a[212:215], v[84:87]
    ds_read_b128 a[168:171], v5 offset:24576
    ds_read_b128 a[172:175], v5 offset:33792
    v_mul_f32 v148, v76, v148
    v_mfma_f32_16x16x32_bf16 v[84:87], a[188:191], a[220:223], v[84:87]
    v_mul_f32 v149, v77, v149
    v_mul_f32 v150, v78, v150
    v_mul_f32 v151, v79, v151
    v_mfma_f32_16x16x32_bf16 v[80:83], a[188:191], a[216:219], v[80:83]
    v_cvt_pk_bf16_f32 v232, v144, v145
    v_cvt_pk_bf16_f32 v233, v146, v147
    v_cvt_pk_bf16_f32 v236, v148, v149
    v_mfma_f32_16x16x32_bf16 v[80:83], a[184:187], a[208:211], v[80:83]
    v_cvt_pk_bf16_f32 v237, v150, v151
    v_mfma_f32_16x16x32_bf16 v[80:83], a[180:183], a[200:203], v[80:83]
    s_waitcnt lgkmcnt(4)
    v_mfma_f32_16x16x32_bf16 v[80:83], a[176:179], a[192:195], v[80:83]
    s_waitcnt vmcnt(0)
    v_lshlrev_b32 v137, 2, v2
    s_add_u32 s95, s37, s29
    s_mov_b64 exec, 0xffff
    buffer_store_dword v12, v137, s[12:15], s95 offen offset:384 sc1
    s_mov_b64 exec, -1
    v_mfma_f32_16x16x32_bf16 v[88:91], a[144:147], a[224:227], v[88:91]
    ds_read_b128 a[176:179], v6 offset:6144
    ds_read_b128 a[180:183], v6 offset:15360
    v_mfma_f32_16x16x32_bf16 v[88:91], a[148:151], a[232:235], v[88:91]
    v_mfma_f32_16x16x32_bf16 v[88:91], a[152:155], a[240:243], v[88:91]
    ds_read_b128 a[184:187], v6 offset:24576
    ds_read_b128 a[188:191], v6 offset:33792
    v_mfma_f32_16x16x32_bf16 v[88:91], a[156:159], a[248:251], v[88:91]
    v_mul_f32 v152, v80, v152
    v_mul_f32 v153, v81, v153
    v_mul_f32 v154, v82, v154
    v_mul_f32 v155, v83, v155
    v_mul_f32 v156, v84, v156
    v_mfma_f32_16x16x32_bf16 v[92:95], a[156:159], a[252:255], v[92:95]
    v_mul_f32 v157, v85, v157
    v_mul_f32 v158, v86, v158
    v_mul_f32 v159, v87, v159
    v_mfma_f32_16x16x32_bf16 v[92:95], a[152:155], a[244:247], v[92:95]
    v_cvt_pk_bf16_f32 v234, v152, v153
    v_cvt_pk_bf16_f32 v235, v154, v155
    v_cvt_pk_bf16_f32 v238, v156, v157
    v_mfma_f32_16x16x32_bf16 v[92:95], a[148:151], a[236:239], v[92:95]
    s_waitcnt lgkmcnt(4)
    v_cvt_pk_bf16_f32 v239, v158, v159
    buffer_store_dwordx4 v[232:235], off, s[80:83], s45 offset:2048 sc1
    v_mfma_f32_16x16x32_bf16 v[92:95], a[144:147], a[228:231], v[92:95]
    buffer_store_dwordx4 v[236:239], off, s[80:83], s46 offset:2048 sc1
    v_mfma_f32_16x16x32_bf16 v[92:95], a[160:163], a[4:7], v[92:95]
    ds_read_b128 a[144:147], v4 offset:7168
    ds_read_b128 a[148:151], v4 offset:16384
    v_mfma_f32_16x16x32_bf16 v[92:95], a[164:167], a[12:15], v[92:95]
    v_mfma_f32_16x16x32_bf16 v[92:95], a[168:171], a[20:23], v[92:95]
    ds_read_b128 a[152:155], v4 offset:25600
    ds_read_b128 a[156:159], v4 offset:34816
    v_mfma_f32_16x16x32_bf16 v[92:95], a[172:175], a[28:31], v[92:95]
    v_mfma_f32_16x16x32_bf16 v[88:91], a[172:175], a[24:27], v[88:91]
    v_mfma_f32_16x16x32_bf16 v[88:91], a[168:171], a[16:19], v[88:91]
    v_mfma_f32_16x16x32_bf16 v[88:91], a[164:167], a[8:11], v[88:91]
    s_waitcnt lgkmcnt(4)
    v_mfma_f32_16x16x32_bf16 v[88:91], a[160:163], a[0:3], v[88:91]
    v_mfma_f32_16x16x32_bf16 v[88:91], a[176:179], a[192:195], v[88:91]
    ds_read_b128 a[160:163], v5 offset:7168
    ds_read_b128 a[164:167], v5 offset:16384
    v_mfma_f32_16x16x32_bf16 v[88:91], a[180:183], a[200:203], v[88:91]
    v_mfma_f32_16x16x32_bf16 v[88:91], a[184:187], a[208:211], v[88:91]
    ds_read_b128 a[168:171], v5 offset:25600
    ds_read_b128 a[172:175], v5 offset:34816
    v_mfma_f32_16x16x32_bf16 v[88:91], a[188:191], a[216:219], v[88:91]
    v_mfma_f32_16x16x32_bf16 v[92:95], a[188:191], a[220:223], v[92:95]
    v_mfma_f32_16x16x32_bf16 v[92:95], a[184:187], a[212:215], v[92:95]
    v_mfma_f32_16x16x32_bf16 v[92:95], a[180:183], a[204:207], v[92:95]
    s_waitcnt lgkmcnt(4)
    v_mfma_f32_16x16x32_bf16 v[92:95], a[176:179], a[196:199], v[92:95]
    v_mfma_f32_16x16x32_bf16 v[100:103], a[144:147], a[228:231], v[100:103]
    ds_read_b128 a[176:179], v6 offset:7168
    ds_read_b128 a[180:183], v6 offset:16384
    v_mfma_f32_16x16x32_bf16 v[100:103], a[148:151], a[236:239], v[100:103]
    v_mfma_f32_16x16x32_bf16 v[100:103], a[152:155], a[244:247], v[100:103]
    ds_read_b128 a[184:187], v6 offset:25600
    ds_read_b128 a[188:191], v6 offset:34816
    v_mfma_f32_16x16x32_bf16 v[100:103], a[156:159], a[252:255], v[100:103]
    v_mul_f32 v160, v88, v160
    v_mul_f32 v161, v89, v161
    v_mul_f32 v162, v90, v162
    v_mul_f32 v163, v91, v163
    v_mul_f32 v164, v92, v164
    v_mfma_f32_16x16x32_bf16 v[96:99], a[156:159], a[248:251], v[96:99]
    v_mul_f32 v165, v93, v165
    v_mul_f32 v166, v94, v166
    v_mul_f32 v167, v95, v167
    v_mfma_f32_16x16x32_bf16 v[96:99], a[152:155], a[240:243], v[96:99]
    v_cvt_pk_bf16_f32 v224, v160, v161
    v_cvt_pk_bf16_f32 v225, v162, v163
    v_cvt_pk_bf16_f32 v228, v164, v165
    v_mfma_f32_16x16x32_bf16 v[96:99], a[148:151], a[232:235], v[96:99]
    s_waitcnt lgkmcnt(4)
    v_cvt_pk_bf16_f32 v229, v166, v167
    v_mfma_f32_16x16x32_bf16 v[96:99], a[144:147], a[224:227], v[96:99]
    v_mfma_f32_16x16x32_bf16 v[96:99], a[160:163], a[0:3], v[96:99]
    v_mfma_f32_16x16x32_bf16 v[96:99], a[164:167], a[8:11], v[96:99]
    v_mfma_f32_16x16x32_bf16 v[96:99], a[168:171], a[16:19], v[96:99]
    v_mfma_f32_16x16x32_bf16 v[96:99], a[172:175], a[24:27], v[96:99]
    v_mfma_f32_16x16x32_bf16 v[100:103], a[172:175], a[28:31], v[100:103]
    v_mfma_f32_16x16x32_bf16 v[100:103], a[168:171], a[20:23], v[100:103]
    v_mfma_f32_16x16x32_bf16 v[100:103], a[164:167], a[12:15], v[100:103]
    s_waitcnt lgkmcnt(0)
    v_mfma_f32_16x16x32_bf16 v[100:103], a[160:163], a[4:7], v[100:103]
    v_mfma_f32_16x16x32_bf16 v[100:103], a[176:179], a[196:199], v[100:103]
    v_mfma_f32_16x16x32_bf16 v[100:103], a[180:183], a[204:207], v[100:103]
    v_mfma_f32_16x16x32_bf16 v[100:103], a[184:187], a[212:215], v[100:103]
    v_mfma_f32_16x16x32_bf16 v[100:103], a[188:191], a[220:223], v[100:103]
    v_mfma_f32_16x16x32_bf16 v[96:99], a[188:191], a[216:219], v[96:99]
    v_mfma_f32_16x16x32_bf16 v[96:99], a[184:187], a[208:211], v[96:99]
    buffer_load_dword v137, v136, s[12:15], s42 offen offset:384 sc1
    v_mfma_f32_16x16x32_bf16 v[96:99], a[180:183], a[200:203], v[96:99]
    v_mfma_f32_16x16x32_bf16 v[96:99], a[176:179], a[192:195], v[96:99]
    s_nop 7
    v_mul_f32 v168, v96, v168
    v_mul_f32 v169, v97, v169
    v_mul_f32 v170, v98, v170
    v_mul_f32 v171, v99, v171
    v_mul_f32 v172, v100, v172
    v_mul_f32 v173, v101, v173
    v_mul_f32 v174, v102, v174
    v_mul_f32 v175, v103, v175
    v_cvt_pk_bf16_f32 v226, v168, v169
    v_cvt_pk_bf16_f32 v227, v170, v171
    v_cvt_pk_bf16_f32 v230, v172, v173
    v_cvt_pk_bf16_f32 v231, v174, v175
    buffer_store_dwordx4 v[224:227], off, s[80:83], s45 offset:3072 sc1
    buffer_store_dwordx4 v[228:231], off, s[80:83], s46 offset:3072 sc1
    s_waitcnt vmcnt(2)
    v_cmp_eq_u32 vcc, 0, v137
    s_nop 3
    s_cbranch_vccnz L_interleave_layers__spectral_fnet__mixer_gmlp__prompt_kernel_28
L_interleave_layers__spectral_fnet__mixer_gmlp__prompt_kernel_29:
    buffer_load_dwordx4 a[172:175], off, s[80:83], s75 offset:0 sc1
    buffer_load_dwordx4 a[168:171], off, s[80:83], s74 offset:0 sc1
    buffer_load_dwordx4 a[164:167], off, s[80:83], s73 offset:0 sc1
    buffer_load_dwordx4 a[160:163], off, s[80:83], s72 offset:0 sc1
    s_barrier
    s_cmp_eq_u32 s30, 0
    s_cbranch_scc1 L_interleave_layers__spectral_fnet__mixer_gmlp__prompt_kernel_31
    buffer_load_dwordx4 v[144:147], v1, s[12:15], s26 offen offset:0 sc1
    buffer_load_dwordx4 v[148:151], v1, s[12:15], s26 offen offset:1024 sc1
    buffer_load_dwordx2 v[152:153], v1, s[12:15], s27 offen sc1
    buffer_load_dword v138, v139, s[12:15], s25 offen offset:64 sc1
    s_lshr_b32 s45, s3, 1
    s_lshl_b32 s45, s45, 5
    s_add_u32 s45, s45, s10
    s_and_b32 s46, s3, 1
    s_lshl_b32 s46, s46, 10
    s_add_u32 s45, s45, s46
    s_mul_i32 s45, s45, 1152
    s_lshl_b32 s49, s7, 6
    s_add_u32 s46, s45, s49
    s_sub_u32 s47, s45, s49
    s_add_u32 s47, s47, 512
    v_lshrrev_b32 v124, 6, v1
    v_and_b32 v125, 48, v1
    v_mul_u32_u24 v143, 73728, v124
    v_add_u32 v140, v143, v125
    v_lshrrev_b32 v126, 1, v125
    v_add_u32 v142, v143, v126
    s_mul_i32 s50, s3, 2816
    s_add_u32 s50, s50, 147456
    v_mul_u32_u24 v124, 176, v124
    v_add3_u32 v123, v124, v125, s50
    v_add3_u32 v124, v124, v126, s50
    v_mul_u32_u24 v122, 176, v2
    v_add_u32 v122, s50, v122
    v_lshl_add_u32 v120, v3, 3, v122
    v_xor_b32 v121, 3, v3
    v_lshl_add_u32 v121, v121, 3, v122
    s_lshr_b32 s49, s7, 1
    s_lshl_b32 s49, s49, 5
    s_add_u32 s50, s49, 512
    s_sub_u32 s49, 610, s49
    s_bitcmp1_b32 s7, 0
    s_cselect_b32 s49, s49, s50
    s_cselect_b32 s50, 3, 0
    s_cselect_b64 s[52:53], -1, 0
    s_add_u32 s49, s49, s45
    s_cmp_ge_u32 s7, 4
    s_cselect_b32 s49, 268435456, s49
    v_cndmask_b32 v122, v120, v121, s[52:53]
    s_waitcnt vmcnt(8)
    v_lshlrev_b32 v137, 2, v2
    s_lshl_b32 s95, s30, 7
    s_add_u32 s95, s95, s37
    s_add_u32 s95, s95, 18874368
    s_mov_b64 exec, 0xffff
    buffer_store_dword v12, v137, s[12:15], s95 offen offset:1792 sc1
    s_mov_b64 exec, -1
    buffer_load_dwordx4 a[188:191], off, s[80:83], s75 offset:1024 sc1
    buffer_load_dwordx4 a[184:187], off, s[80:83], s74 offset:1024 sc1
    buffer_load_dwordx4 a[180:183], off, s[80:83], s73 offset:1024 sc1
    buffer_load_dwordx4 a[176:179], off, s[80:83], s72 offset:1024 sc1
    s_add_u32 s41, s75, 4096
    buffer_load_dwordx4 a[204:207], off, s[80:83], s41 offset:0 sc1
    s_add_u32 s41, s74, 4096
    buffer_load_dwordx4 a[200:203], off, s[80:83], s41 offset:0 sc1
    s_add_u32 s41, s73, 4096
    buffer_load_dwordx4 a[196:199], off, s[80:83], s41 offset:0 sc1
    s_add_u32 s41, s72, 4096
    buffer_load_dwordx4 a[192:195], off, s[80:83], s41 offset:0 sc1
    s_branch L_interleave_layers__spectral_fnet__mixer_gmlp__prompt_kernel_32
L_interleave_layers__spectral_fnet__mixer_gmlp__prompt_kernel_31:
    s_lshl_b32 s11, s3, 4
    v_add_u32 v68, s11, v2
    v_lshrrev_b32 v69, 1, v68
    v_and_b32 v70, 1, v68
    v_lshlrev_b32 v70, 4, v70
    v_cmp_eq_u32 vcc, 1, v68
    s_nop 1
    v_cndmask_b32 v69, v69, 32, vcc
    v_cndmask_b32 v70, v70, 0, vcc
    v_lshlrev_b32 v68, 3, v3
    buffer_load_dwordx4 v[144:147], v1, s[12:15], s26 offen offset:0 sc1
    v_mad_u32_u24 v70, v69, v68, v70
    v_cvt_f32_u32 v69, v69
    v_cvt_f32_u32 v70, v70
    v_mul_f32 v69, 0x3c800000, v69
    v_mul_f32 v70, 0x3c800000, v70
    v_mov_b32 v60, v70
    v_fmamk_f32 v61, v69, 0x40000000, v70
    v_fmamk_f32 v62, v69, 0x40800000, v70
    buffer_load_dwordx4 v[148:151], v1, s[12:15], s26 offen offset:1024 sc1
    v_fmamk_f32 v63, v69, 0x40c00000, v70
    v_fmamk_f32 v64, v69, 0x42000000, v70
    v_fmamk_f32 v65, v69, 0x42080000, v70
    v_fmamk_f32 v66, v69, 0x42100000, v70
    v_fmamk_f32 v67, v69, 0x42180000, v70
    v_cos_f32 v60, v60
    v_cos_f32 v61, v61
    v_cos_f32 v62, v62
    buffer_load_dwordx2 v[152:153], v1, s[12:15], s27 offen sc1
    v_cos_f32 v63, v63
    v_cos_f32 v64, v64
    v_cos_f32 v65, v65
    v_cos_f32 v66, v66
    v_cos_f32 v67, v67
    v_cvt_pk_bf16_f32 v120, v60, v61
    v_cvt_pk_bf16_f32 v121, v62, v63
    v_cvt_pk_bf16_f32 v122, v64, v65
    buffer_load_dword v138, v139, s[12:15], s25 offen offset:64 sc1
    v_cvt_pk_bf16_f32 v123, v66, v67
    v_fmamk_f32 v60, v69, 0x3f800000, v70
    v_fmamk_f32 v61, v69, 0x40400000, v70
    v_fmamk_f32 v62, v69, 0x40a00000, v70
    v_fmamk_f32 v63, v69, 0x40e00000, v70
    v_fmamk_f32 v64, v69, 0x42040000, v70
    v_fmamk_f32 v65, v69, 0x420c0000, v70
    v_fmamk_f32 v66, v69, 0x42140000, v70
    s_waitcnt vmcnt(8)
    v_lshlrev_b32 v137, 2, v2
    s_lshl_b32 s95, s30, 7
    s_add_u32 s95, s95, s37
    s_add_u32 s95, s95, 18874368
    s_mov_b64 exec, 0xffff
    buffer_store_dword v12, v137, s[12:15], s95 offen offset:1792 sc1
    s_mov_b64 exec, -1
    v_fmamk_f32 v67, v69, 0x421c0000, v70
    v_cos_f32 v60, v60
    v_cos_f32 v61, v61
    v_cos_f32 v62, v62
    v_cos_f32 v63, v63
    v_cos_f32 v64, v64
    v_cos_f32 v65, v65
    v_cos_f32 v66, v66
    buffer_load_dwordx4 a[188:191], off, s[80:83], s75 offset:1024 sc1
    v_cos_f32 v67, v67
    v_cvt_pk_bf16_f32 v124, v60, v61
    v_cvt_pk_bf16_f32 v125, v62, v63
    v_cvt_pk_bf16_f32 v126, v64, v65
    v_cvt_pk_bf16_f32 v127, v66, v67
    s_lshl_b32 s45, s6, 1
    s_add_u32 s46, s45, 1
    s_sub_u32 s47, 3, s45
    s_cmp_eq_u32 s4, 0
    s_cselect_b32 s46, s46, s47
    s_cmp_lt_u32 s3, 2
    s_cselect_b32 s45, s45, s46
    s_cselect_b32 s49, 3, 1
    s_cselect_b32 s50, 0, 16
    s_lshl_b32 s46, s4, 2
    s_add_u32 s45, s45, s46
    s_lshr_b32 s52, s45, 2
    s_bfe_u32 s53, s45, 0x10001
    s_sub_u32 s54, 32, s52
    s_cmp_eq_u32 s52, 0
    s_cselect_b32 s54, 16, s54
    s_cmp_eq_u32 s53, 0
    s_cselect_b32 s46, s52, s54
    s_and_b32 s52, s45, 1
    s_lshl_b32 s52, s52, 5
    s_add_u32 s46, s46, s52
    s_and_b32 s47, s3, 1
    s_lshl_b32 s48, s45, 1
    s_add_u32 s48, s48, s47
    s_lshl_b32 s47, s47, 10
    s_add_u32 s46, s46, s47
    s_lshl_b32 s49, s49, 9
    s_lshl_b32 s50, 0xffff, s50
    s_cmp_eq_u32 s10, 0
    s_cselect_b32 s49, 0, s49
    s_cselect_b32 s50, s50, -1
    v_lshl_add_u32 v104, v2, 6, s46
    v_lshlrev_b32 v105, 1, v3
    v_mul_u32_u24 v105, v105, v104
    v_add_u32 v106, s49, v105
    buffer_load_dwordx4 a[184:187], off, s[80:83], s74 offset:1024 sc1
    v_cvt_f32_u32 v104, v104
    v_cvt_f32_u32 v105, v105
    v_cvt_f32_u32 v106, v106
    v_mul_f32 v104, 0x3a000000, v104
    v_mul_f32 v105, 0x3a000000, v105
    v_mul_f32 v106, 0x3a000000, v106
    v_mov_b32 v108, v105
    v_mov_b32 v109, v106
    buffer_load_dwordx4 a[180:183], off, s[80:83], s73 offset:1024 sc1
    v_fmamk_f32 v110, v104, 0x3f800000, v105
    v_fmamk_f32 v111, v104, 0x3f800000, v106
    v_fmamk_f32 v112, v104, 0x41000000, v105
    v_fmamk_f32 v113, v104, 0x41000000, v106
    v_fmamk_f32 v114, v104, 0x41100000, v105
    v_fmamk_f32 v115, v104, 0x41100000, v106
    v_cos_f32 v96, v108
    v_cos_f32 v97, v109
    buffer_load_dwordx4 a[176:179], off, s[80:83], s72 offset:1024 sc1
    v_cos_f32 v98, v110
    v_cos_f32 v99, v111
    v_cos_f32 v100, v112
    v_cos_f32 v101, v113
    v_cos_f32 v102, v114
    v_cos_f32 v103, v115
    v_cvt_pk_bf16_f32 v224, v96, v97
    v_cvt_pk_bf16_f32 v225, v98, v99
    s_add_u32 s41, s75, 4096
    buffer_load_dwordx4 a[204:207], off, s[80:83], s41 offset:0 sc1
    v_cvt_pk_bf16_f32 v226, v100, v101
    v_cvt_pk_bf16_f32 v227, v102, v103
    v_sin_f32 v96, -v108
    v_sin_f32 v97, -v109
    v_sin_f32 v98, -v110
    v_sin_f32 v99, -v111
    v_sin_f32 v100, -v112
    v_sin_f32 v101, -v113
    s_add_u32 s41, s74, 4096
    buffer_load_dwordx4 a[200:203], off, s[80:83], s41 offset:0 sc1
    v_sin_f32 v102, -v114
    v_sin_f32 v103, -v115
    v_cvt_pk_bf16_f32 v232, v96, v97
    v_cvt_pk_bf16_f32 v233, v98, v99
    v_cvt_pk_bf16_f32 v234, v100, v101
    v_cvt_pk_bf16_f32 v235, v102, v103
    v_fmamk_f32 v108, v104, 0x41800000, v105
    v_fmamk_f32 v109, v104, 0x41800000, v106
    s_add_u32 s41, s73, 4096
    buffer_load_dwordx4 a[196:199], off, s[80:83], s41 offset:0 sc1
    v_fmamk_f32 v110, v104, 0x41880000, v105
    v_fmamk_f32 v111, v104, 0x41880000, v106
    v_fmamk_f32 v112, v104, 0x41c00000, v105
    v_fmamk_f32 v113, v104, 0x41c00000, v106
    v_fmamk_f32 v114, v104, 0x41c80000, v105
    v_fmamk_f32 v115, v104, 0x41c80000, v106
    v_cos_f32 v96, v108
    v_cos_f32 v97, v109
    s_add_u32 s41, s72, 4096
    buffer_load_dwordx4 a[192:195], off, s[80:83], s41 offset:0 sc1
    v_cos_f32 v98, v110
    v_cos_f32 v99, v111
    v_cos_f32 v100, v112
    v_cos_f32 v101, v113
    v_cos_f32 v102, v114
    v_cos_f32 v103, v115
    v_cvt_pk_bf16_f32 v228, v96, v97
    v_cvt_pk_bf16_f32 v229, v98, v99
    v_cvt_pk_bf16_f32 v230, v100, v101
    v_cvt_pk_bf16_f32 v231, v102, v103
    v_sin_f32 v96, -v108
    v_sin_f32 v97, -v109
    v_sin_f32 v98, -v110
    v_sin_f32 v99, -v111
    v_sin_f32 v100, -v112
    v_sin_f32 v101, -v113
    v_sin_f32 v102, -v114
    v_sin_f32 v103, -v115
    v_cvt_pk_bf16_f32 v236, v96, v97
    v_cvt_pk_bf16_f32 v237, v98, v99
    v_cvt_pk_bf16_f32 v238, v100, v101
    v_cvt_pk_bf16_f32 v239, v102, v103
    v_and_b32 v224, s50, v224
    v_and_b32 v225, s50, v225
    v_and_b32 v226, s50, v226
    v_and_b32 v227, s50, v227
    v_and_b32 v228, s50, v228
    v_and_b32 v229, s50, v229
    v_and_b32 v230, s50, v230
    v_and_b32 v231, s50, v231
    v_and_b32 v232, s50, v232
    v_and_b32 v233, s50, v233
    v_and_b32 v234, s50, v234
    v_and_b32 v235, s50, v235
    v_and_b32 v236, s50, v236
    v_and_b32 v237, s50, v237
    v_and_b32 v238, s50, v238
    v_and_b32 v239, s50, v239
    s_nop 2
L_interleave_layers__spectral_fnet__mixer_gmlp__prompt_kernel_32:
    s_waitcnt vmcnt(9)
    v_sub_f32 v138, v17, v138
    v_lshlrev_b32 v40, 16, v144
    v_and_b32 v41, 0xffff0000, v144
    v_lshlrev_b32 v42, 16, v145
    v_and_b32 v43, 0xffff0000, v145
    v_lshlrev_b32 v44, 16, v146
    v_and_b32 v45, 0xffff0000, v146
    v_lshlrev_b32 v46, 16, v147
    v_and_b32 v47, 0xffff0000, v147
    v_lshlrev_b32 v48, 16, v148
    v_and_b32 v49, 0xffff0000, v148
    v_lshlrev_b32 v50, 16, v149
    v_and_b32 v51, 0xffff0000, v149
    v_lshlrev_b32 v52, 16, v150
    v_and_b32 v53, 0xffff0000, v150
    v_lshlrev_b32 v54, 16, v151
    v_and_b32 v55, 0xffff0000, v151
    v_lshlrev_b32 v56, 16, v152
    v_and_b32 v57, 0xffff0000, v152
    v_lshlrev_b32 v58, 16, v153
    v_and_b32 v59, 0xffff0000, v153
    v_pk_add_f32 v[40:41], v[40:41], v[138:139] op_sel_hi:[1,0]
    v_pk_add_f32 v[42:43], v[42:43], v[138:139] op_sel_hi:[1,0]
    v_pk_add_f32 v[44:45], v[44:45], v[138:139] op_sel_hi:[1,0]
    v_pk_add_f32 v[46:47], v[46:47], v[138:139] op_sel_hi:[1,0]
    v_pk_add_f32 v[48:49], v[48:49], v[138:139] op_sel_hi:[1,0]
    v_pk_add_f32 v[50:51], v[50:51], v[138:139] op_sel_hi:[1,0]
    v_pk_add_f32 v[52:53], v[52:53], v[138:139] op_sel_hi:[1,0]
    v_pk_add_f32 v[54:55], v[54:55], v[138:139] op_sel_hi:[1,0]
    v_pk_add_f32 v[56:57], v[56:57], v[138:139] op_sel_hi:[1,0]
    v_pk_add_f32 v[58:59], v[58:59], v[138:139] op_sel_hi:[1,0]
    s_cmp_lt_u32 s7, 4
    s_nop 0
    s_cbranch_scc1 L_interleave_layers__spectral_fnet__mixer_gmlp__prompt_kernel_33
    v_mov_b32 v56, 0
    v_mov_b32 v57, 0
    v_mov_b32 v58, 0
    v_mov_b32 v59, 0
    v_mfma_f32_16x16x32_bf16 a[20:23], v[240:243], a[172:175], 0
    s_add_u32 s41, s75, 4096
    buffer_load_dwordx4 a[220:223], off, s[80:83], s41 offset:1024 sc1
    v_mfma_f32_16x16x32_bf16 a[24:27], v[244:247], a[172:175], 0
    v_mfma_f32_16x16x32_bf16 a[28:31], v[248:251], a[172:175], 0
    s_add_u32 s41, s75, 8192
    buffer_load_dwordx4 a[236:239], off, s[80:83], s41 offset:0 sc1
    v_mfma_f32_16x16x32_bf16 a[144:147], v[36:39], a[172:175], 0
    v_mfma_f32_16x16x32_bf16 a[12:15], v[36:39], a[168:171], 0
    s_add_u32 s41, s74, 8192
    buffer_load_dwordx4 a[232:235], off, s[80:83], s41 offset:0 sc1
    v_mfma_f32_16x16x32_bf16 a[8:11], v[248:251], a[168:171], 0
    v_mfma_f32_16x16x32_bf16 a[4:7], v[244:247], a[168:171], 0
    s_add_u32 s41, s74, 4096
    buffer_load_dwordx4 a[216:219], off, s[80:83], s41 offset:1024 sc1
    v_mfma_f32_16x16x32_bf16 a[0:3], v[240:243], a[168:171], 0
    v_mfma_f32_16x16x32_bf16 v[176:179], v[240:243], a[164:167], 0
    s_add_u32 s41, s73, 4096
    buffer_load_dwordx4 a[212:215], off, s[80:83], s41 offset:1024 sc1
    v_mfma_f32_16x16x32_bf16 v[180:183], v[244:247], a[164:167], 0
    v_mfma_f32_16x16x32_bf16 v[144:147], v[248:251], a[164:167], 0
    s_add_u32 s41, s73, 8192
    buffer_load_dwordx4 a[228:231], off, s[80:83], s41 offset:0 sc1
    v_mfma_f32_16x16x32_bf16 v[148:151], v[36:39], a[164:167], 0
    v_mfma_f32_16x16x32_bf16 v[168:171], v[36:39], a[160:163], 0
    s_add_u32 s41, s72, 8192
    buffer_load_dwordx4 a[224:227], off, s[80:83], s41 offset:0 sc1
    v_mfma_f32_16x16x32_bf16 v[164:167], v[248:251], a[160:163], 0
    v_mfma_f32_16x16x32_bf16 v[160:163], v[244:247], a[160:163], 0
    s_add_u32 s41, s72, 4096
    buffer_load_dwordx4 a[208:211], off, s[80:83], s41 offset:1024 sc1
    v_mfma_f32_16x16x32_bf16 v[156:159], v[240:243], a[160:163], 0
    buffer_load_dword v137, v136, s[12:15], s44 offen offset:1792 sc1
    s_waitcnt vmcnt(16)
    v_mfma_f32_16x16x32_bf16 a[20:23], v[28:31], a[188:191], a[20:23]
    buffer_load_dwordx4 a[252:255], off, s[80:83], s79 offset:0 sc1
    s_waitcnt vmcnt(13)
    v_mfma_f32_16x16x32_bf16 a[20:23], a[132:135], a[204:207], a[20:23]
    v_mfma_f32_16x16x32_bf16 a[24:27], a[128:131], a[204:207], a[24:27]
    buffer_load_dwordx4 a[248:251], off, s[80:83], s78 offset:0 sc1
    v_mfma_f32_16x16x32_bf16 a[24:27], v[24:27], a[188:191], a[24:27]
    v_mfma_f32_16x16x32_bf16 a[28:31], v[20:23], a[188:191], a[28:31]
    buffer_load_dwordx4 a[244:247], off, s[80:83], s77 offset:0 sc1
    v_mfma_f32_16x16x32_bf16 a[28:31], a[124:127], a[204:207], a[28:31]
    v_mfma_f32_16x16x32_bf16 a[144:147], a[120:123], a[204:207], a[144:147]
    buffer_load_dwordx4 a[240:243], off, s[80:83], s76 offset:0 sc1
    v_mfma_f32_16x16x32_bf16 a[144:147], a[140:143], a[188:191], a[144:147]
    s_waitcnt vmcnt(15)
    v_mfma_f32_16x16x32_bf16 a[12:15], a[120:123], a[200:203], a[12:15]
    v_mfma_f32_16x16x32_bf16 a[12:15], a[140:143], a[184:187], a[12:15]
    v_mfma_f32_16x16x32_bf16 a[8:11], v[20:23], a[184:187], a[8:11]
    v_mfma_f32_16x16x32_bf16 a[8:11], a[124:127], a[200:203], a[8:11]
    v_mfma_f32_16x16x32_bf16 a[4:7], a[128:131], a[200:203], a[4:7]
    v_mfma_f32_16x16x32_bf16 a[4:7], v[24:27], a[184:187], a[4:7]
    v_mfma_f32_16x16x32_bf16 a[0:3], v[28:31], a[184:187], a[0:3]
    v_mfma_f32_16x16x32_bf16 a[0:3], a[132:135], a[200:203], a[0:3]
    v_mfma_f32_16x16x32_bf16 v[176:179], v[28:31], a[180:183], v[176:179]
    s_waitcnt vmcnt(14)
    v_mfma_f32_16x16x32_bf16 v[176:179], a[132:135], a[196:199], v[176:179]
    v_mfma_f32_16x16x32_bf16 v[180:183], a[128:131], a[196:199], v[180:183]
    v_mfma_f32_16x16x32_bf16 v[180:183], v[24:27], a[180:183], v[180:183]
    v_mfma_f32_16x16x32_bf16 v[144:147], v[20:23], a[180:183], v[144:147]
    v_mfma_f32_16x16x32_bf16 v[144:147], a[124:127], a[196:199], v[144:147]
    v_mfma_f32_16x16x32_bf16 v[148:151], a[120:123], a[196:199], v[148:151]
    v_mfma_f32_16x16x32_bf16 v[148:151], a[140:143], a[180:183], v[148:151]
    s_waitcnt vmcnt(13)
    v_mfma_f32_16x16x32_bf16 v[168:171], a[120:123], a[192:195], v[168:171]
    v_mfma_f32_16x16x32_bf16 v[168:171], a[140:143], a[176:179], v[168:171]
    v_mfma_f32_16x16x32_bf16 v[164:167], v[20:23], a[176:179], v[164:167]
    v_mfma_f32_16x16x32_bf16 v[164:167], a[124:127], a[192:195], v[164:167]
    v_mfma_f32_16x16x32_bf16 v[160:163], a[128:131], a[192:195], v[160:163]
    v_mfma_f32_16x16x32_bf16 v[160:163], v[24:27], a[176:179], v[160:163]
    v_mfma_f32_16x16x32_bf16 v[156:159], v[28:31], a[176:179], v[156:159]
    v_mfma_f32_16x16x32_bf16 v[156:159], a[132:135], a[192:195], v[156:159]
    s_waitcnt vmcnt(4)
    v_cmp_eq_u32 vcc, 0, v137
    s_nop 4
    s_cbranch_vccnz L_interleave_layers__spectral_fnet__mixer_gmlp__prompt_kernel_35
L_interleave_layers__spectral_fnet__mixer_gmlp__prompt_kernel_36:
    v_mfma_f32_16x16x32_bf16 a[20:23], a[112:115], a[220:223], a[20:23]
    v_mfma_f32_16x16x32_bf16 a[20:23], a[92:95], a[234:237], a[20:23]
    v_mfma_f32_16x16x32_bf16 a[24:27], a[88:91], a[234:237], a[24:27]
    v_mfma_f32_16x16x32_bf16 a[24:27], a[108:111], a[220:223], a[24:27]
    v_mfma_f32_16x16x32_bf16 a[28:31], a[104:107], a[220:223], a[28:31]
    v_mfma_f32_16x16x32_bf16 a[28:31], a[84:87], a[234:237], a[28:31]
    v_mfma_f32_16x16x32_bf16 a[144:147], a[80:83], a[234:237], a[144:147]
    v_mfma_f32_16x16x32_bf16 a[144:147], a[100:103], a[220:223], a[144:147]
    v_accvgpr_mov_b32 a234, a238
    v_accvgpr_mov_b32 a235, a239
    s_nop 1
    v_mfma_f32_16x16x32_bf16 a[12:15], a[80:83], a[232:235], a[12:15]
    buffer_load_dwordx4 a[172:175], off, s[80:83], s75 offset:2048 sc1
    v_mfma_f32_16x16x32_bf16 a[12:15], a[100:103], a[216:219], a[12:15]
    v_mfma_f32_16x16x32_bf16 a[8:11], a[104:107], a[216:219], a[8:11]
    buffer_load_dwordx4 a[188:191], off, s[80:83], s75 offset:3072 sc1
    v_mfma_f32_16x16x32_bf16 a[8:11], a[84:87], a[232:235], a[8:11]
    v_mfma_f32_16x16x32_bf16 a[4:7], a[88:91], a[232:235], a[4:7]
    s_add_u32 s41, s75, 4096
    buffer_load_dwordx4 a[204:207], off, s[80:83], s41 offset:2048 sc1
    v_mfma_f32_16x16x32_bf16 a[4:7], a[108:111], a[216:219], a[4:7]
    v_mfma_f32_16x16x32_bf16 a[0:3], a[112:115], a[216:219], a[0:3]
    s_add_u32 s41, s75, 4096
    buffer_load_dwordx4 a[220:223], off, s[80:83], s41 offset:3072 sc1
    v_mfma_f32_16x16x32_bf16 a[0:3], a[92:95], a[232:235], a[0:3]
    v_mfma_f32_16x16x32_bf16 v[176:179], a[112:115], a[212:215], v[176:179]
    buffer_load_dwordx4 a[168:171], off, s[80:83], s74 offset:2048 sc1
    v_mfma_f32_16x16x32_bf16 v[176:179], a[92:95], a[226:229], v[176:179]
    v_mfma_f32_16x16x32_bf16 v[180:183], a[88:91], a[226:229], v[180:183]
    buffer_load_dwordx4 a[184:187], off, s[80:83], s74 offset:3072 sc1
    v_mfma_f32_16x16x32_bf16 v[180:183], a[108:111], a[212:215], v[180:183]
    v_mfma_f32_16x16x32_bf16 v[144:147], a[104:107], a[212:215], v[144:147]
    s_add_u32 s41, s74, 4096
    buffer_load_dwordx4 a[200:203], off, s[80:83], s41 offset:2048 sc1
    v_mfma_f32_16x16x32_bf16 v[144:147], a[84:87], a[226:229], v[144:147]
    v_mfma_f32_16x16x32_bf16 v[148:151], a[80:83], a[226:229], v[148:151]
    s_add_u32 s41, s74, 4096
    buffer_load_dwordx4 a[216:219], off, s[80:83], s41 offset:3072 sc1
    v_mfma_f32_16x16x32_bf16 v[148:151], a[100:103], a[212:215], v[148:151]
    v_accvgpr_mov_b32 a226, a230
    v_accvgpr_mov_b32 a227, a231
    s_nop 1
    v_mfma_f32_16x16x32_bf16 v[168:171], a[80:83], a[224:227], v[168:171]
    buffer_load_dwordx4 a[164:167], off, s[80:83], s73 offset:2048 sc1
    v_mfma_f32_16x16x32_bf16 v[168:171], a[100:103], a[208:211], v[168:171]
    v_mfma_f32_16x16x32_bf16 v[164:167], a[104:107], a[208:211], v[164:167]
    buffer_load_dwordx4 a[180:183], off, s[80:83], s73 offset:3072 sc1
    v_mfma_f32_16x16x32_bf16 v[164:167], a[84:87], a[224:227], v[164:167]
    v_mfma_f32_16x16x32_bf16 v[160:163], a[88:91], a[224:227], v[160:163]
    s_add_u32 s41, s73, 4096
    buffer_load_dwordx4 a[196:199], off, s[80:83], s41 offset:2048 sc1
    v_mfma_f32_16x16x32_bf16 v[160:163], a[108:111], a[208:211], v[160:163]
    v_mfma_f32_16x16x32_bf16 v[156:159], a[112:115], a[208:211], v[156:159]
    s_add_u32 s41, s73, 4096
    buffer_load_dwordx4 a[212:215], off, s[80:83], s41 offset:3072 sc1
    v_mfma_f32_16x16x32_bf16 v[156:159], a[92:95], a[224:227], v[156:159]
    s_waitcnt vmcnt(15)
    v_mfma_f32_16x16x32_bf16 v[100:103], v[240:243], a[252:255], 0
    buffer_load_dwordx4 a[160:163], off, s[80:83], s72 offset:2048 sc1
    v_mfma_f32_16x16x32_bf16 v[104:107], v[244:247], a[252:255], 0
    v_mfma_f32_16x16x32_bf16 v[108:111], v[248:251], a[252:255], 0
    buffer_load_dwordx4 a[176:179], off, s[80:83], s72 offset:3072 sc1
    v_mfma_f32_16x16x32_bf16 v[112:115], v[36:39], a[252:255], 0
    s_waitcnt vmcnt(16)
    v_mfma_f32_16x16x32_bf16 v[92:95], v[36:39], a[248:251], 0
    s_add_u32 s41, s72, 4096
    buffer_load_dwordx4 a[192:195], off, s[80:83], s41 offset:2048 sc1
    v_mfma_f32_16x16x32_bf16 v[88:91], v[248:251], a[248:251], 0
    v_mfma_f32_16x16x32_bf16 v[84:87], v[244:247], a[248:251], 0
    s_add_u32 s41, s72, 4096
    buffer_load_dwordx4 a[208:211], off, s[80:83], s41 offset:3072 sc1
    v_mfma_f32_16x16x32_bf16 v[80:83], v[240:243], a[248:251], 0
    s_waitcnt vmcnt(17)
    v_mfma_f32_16x16x32_bf16 v[60:63], v[240:243], a[244:247], 0
    buffer_load_dwordx4 a[236:239], off, s[80:83], s79 offset:1024 sc1
    v_mfma_f32_16x16x32_bf16 v[64:67], v[244:247], a[244:247], 0
    v_mfma_f32_16x16x32_bf16 v[68:71], v[248:251], a[244:247], 0
    s_add_u32 s41, s79, 4096
    buffer_load_dwordx4 a[252:255], off, s[80:83], s41 offset:0 sc1
    v_mfma_f32_16x16x32_bf16 v[72:75], v[36:39], a[244:247], 0
    s_waitcnt vmcnt(18)
    v_mfma_f32_16x16x32_bf16 v[52:55], v[36:39], a[240:243], v[52:55]
    buffer_load_dwordx4 a[232:235], off, s[80:83], s78 offset:1024 sc1
    v_mfma_f32_16x16x32_bf16 v[48:51], v[248:251], a[240:243], v[48:51]
    v_mfma_f32_16x16x32_bf16 v[44:47], v[244:247], a[240:243], v[44:47]
    s_add_u32 s41, s78, 4096
    buffer_load_dwordx4 a[248:251], off, s[80:83], s41 offset:0 sc1
    v_mfma_f32_16x16x32_bf16 v[40:43], v[240:243], a[240:243], v[40:43]
    s_waitcnt vmcnt(19)
    v_mfma_f32_16x16x32_bf16 a[20:23], a[72:75], a[172:175], a[20:23]
    buffer_load_dwordx4 a[228:231], off, s[80:83], s77 offset:1024 sc1
    s_waitcnt vmcnt(19)
    v_mfma_f32_16x16x32_bf16 a[20:23], a[52:55], a[188:191], a[20:23]
    s_waitcnt vmcnt(18)
    v_mfma_f32_16x16x32_bf16 a[20:23], a[32:35], a[204:207], a[20:23]
    s_add_u32 s41, s77, 4096
    buffer_load_dwordx4 a[244:247], off, s[80:83], s41 offset:0 sc1
    s_waitcnt vmcnt(18)
    v_mfma_f32_16x16x32_bf16 a[20:23], v[200:203], a[220:223], a[20:23]
    v_mfma_f32_16x16x32_bf16 a[24:27], v[204:207], a[220:223], a[24:27]
    buffer_load_dwordx4 a[224:227], off, s[80:83], s76 offset:1024 sc1
    v_mfma_f32_16x16x32_bf16 a[24:27], v[184:187], a[204:207], a[24:27]
    v_mfma_f32_16x16x32_bf16 a[24:27], a[48:51], a[188:191], a[24:27]
    s_add_u32 s41, s76, 4096
    buffer_load_dwordx4 a[240:243], off, s[80:83], s41 offset:0 sc1
    v_mfma_f32_16x16x32_bf16 a[24:27], a[68:71], a[172:175], a[24:27]
    s_nop 0
    ds_write_b128 v135, a[20:23] offset:0
    v_mfma_f32_16x16x32_bf16 a[28:31], a[64:67], a[172:175], a[28:31]
    v_mfma_f32_16x16x32_bf16 a[28:31], a[44:47], a[188:191], a[28:31]
    v_mfma_f32_16x16x32_bf16 a[28:31], v[188:191], a[204:207], a[28:31]
    v_mfma_f32_16x16x32_bf16 a[28:31], v[208:211], a[220:223], a[28:31]
    s_nop 1
    ds_write_b128 v135, a[24:27] offset:1024
    v_mfma_f32_16x16x32_bf16 a[144:147], v[212:215], a[220:223], a[144:147]
    v_mfma_f32_16x16x32_bf16 a[144:147], v[192:195], a[204:207], a[144:147]
    v_mfma_f32_16x16x32_bf16 a[144:147], a[40:43], a[188:191], a[144:147]
    v_mfma_f32_16x16x32_bf16 a[144:147], a[60:63], a[172:175], a[144:147]
    s_nop 0
    ds_write_b128 v135, a[28:31] offset:2048
    s_waitcnt vmcnt(16)
    v_mfma_f32_16x16x32_bf16 a[12:15], v[212:215], a[216:219], a[12:15]
    s_add_u32 s41, s79, 4096
    buffer_load_dwordx4 a[172:175], off, s[80:83], s41 offset:1024 sc1
    v_mfma_f32_16x16x32_bf16 a[12:15], v[192:195], a[200:203], a[12:15]
    v_mfma_f32_16x16x32_bf16 a[12:15], a[40:43], a[184:187], a[12:15]
    s_add_u32 s41, s79, 8192
    buffer_load_dwordx4 a[188:191], off, s[80:83], s41 offset:0 sc1
    v_mfma_f32_16x16x32_bf16 a[12:15], a[60:63], a[168:171], a[12:15]
    ds_write_b128 v135, a[144:147] offset:3072
    v_mfma_f32_16x16x32_bf16 a[8:11], a[64:67], a[168:171], a[8:11]
    buffer_load_dwordx4 a[204:207], off, s[80:83], s79 offset:2048 sc1
    v_mfma_f32_16x16x32_bf16 a[8:11], a[44:47], a[184:187], a[8:11]
    v_mfma_f32_16x16x32_bf16 a[8:11], v[188:191], a[200:203], a[8:11]
    buffer_load_dwordx4 a[220:223], off, s[80:83], s79 offset:3072 sc1
    v_mfma_f32_16x16x32_bf16 a[8:11], v[208:211], a[216:219], a[8:11]
    s_nop 0
    ds_write_b128 v134, a[12:15] offset:3072
    v_mfma_f32_16x16x32_bf16 a[4:7], v[204:207], a[216:219], a[4:7]
    v_mfma_f32_16x16x32_bf16 a[4:7], v[184:187], a[200:203], a[4:7]
    v_mfma_f32_16x16x32_bf16 a[4:7], a[48:51], a[184:187], a[4:7]
    v_mfma_f32_16x16x32_bf16 a[4:7], a[68:71], a[168:171], a[4:7]
    s_nop 1
    ds_write_b128 v134, a[8:11] offset:2048
    v_mfma_f32_16x16x32_bf16 a[0:3], a[72:75], a[168:171], a[0:3]
    v_mfma_f32_16x16x32_bf16 a[0:3], a[52:55], a[184:187], a[0:3]
    v_mfma_f32_16x16x32_bf16 a[0:3], a[32:35], a[200:203], a[0:3]
    v_mfma_f32_16x16x32_bf16 a[0:3], v[200:203], a[216:219], a[0:3]
    s_nop 0
    ds_write_b128 v134, a[4:7] offset:1024
    s_waitcnt vmcnt(19)
    v_mfma_f32_16x16x32_bf16 v[176:179], a[72:75], a[164:167], v[176:179]
    s_add_u32 s41, s78, 8192
    buffer_load_dwordx4 a[184:187], off, s[80:83], s41 offset:0 sc1
    s_waitcnt vmcnt(19)
    v_mfma_f32_16x16x32_bf16 v[176:179], a[52:55], a[180:183], v[176:179]
    s_waitcnt vmcnt(18)
    v_mfma_f32_16x16x32_bf16 v[176:179], a[32:35], a[196:199], v[176:179]
    s_add_u32 s41, s78, 4096
    buffer_load_dwordx4 a[168:171], off, s[80:83], s41 offset:1024 sc1
    s_waitcnt vmcnt(18)
    v_mfma_f32_16x16x32_bf16 v[176:179], v[200:203], a[212:215], v[176:179]
    ds_write_b128 v134, a[0:3] offset:0
    v_mfma_f32_16x16x32_bf16 v[180:183], v[204:207], a[212:215], v[180:183]
    buffer_load_dwordx4 a[200:203], off, s[80:83], s78 offset:2048 sc1
    v_mfma_f32_16x16x32_bf16 v[180:183], v[184:187], a[196:199], v[180:183]
    v_mfma_f32_16x16x32_bf16 v[180:183], a[48:51], a[180:183], v[180:183]
    buffer_load_dwordx4 a[216:219], off, s[80:83], s78 offset:3072 sc1
    v_mfma_f32_16x16x32_bf16 v[180:183], a[68:71], a[164:167], v[180:183]
    s_nop 0
    ds_write_b128 v133, v[176:179] offset:0
    v_mfma_f32_16x16x32_bf16 v[144:147], a[64:67], a[164:167], v[144:147]
    v_mfma_f32_16x16x32_bf16 v[144:147], a[44:47], a[180:183], v[144:147]
    v_mfma_f32_16x16x32_bf16 v[144:147], v[188:191], a[196:199], v[144:147]
    v_mfma_f32_16x16x32_bf16 v[144:147], v[208:211], a[212:215], v[144:147]
    s_nop 1
    ds_write_b128 v133, v[180:183] offset:1024
    v_mfma_f32_16x16x32_bf16 v[148:151], v[212:215], a[212:215], v[148:151]
    v_mfma_f32_16x16x32_bf16 v[148:151], v[192:195], a[196:199], v[148:151]
    v_mfma_f32_16x16x32_bf16 v[148:151], a[40:43], a[180:183], v[148:151]
    v_mfma_f32_16x16x32_bf16 v[148:151], a[60:63], a[164:167], v[148:151]
    s_nop 0
    ds_write_b128 v133, v[144:147] offset:2048
    s_waitcnt vmcnt(16)
    v_mfma_f32_16x16x32_bf16 v[168:171], v[212:215], a[208:211], v[168:171]
    s_add_u32 s41, s77, 4096
    buffer_load_dwordx4 a[164:167], off, s[80:83], s41 offset:1024 sc1
    v_mfma_f32_16x16x32_bf16 v[168:171], v[192:195], a[192:195], v[168:171]
    v_mfma_f32_16x16x32_bf16 v[168:171], a[40:43], a[176:179], v[168:171]
    s_add_u32 s41, s77, 8192
    buffer_load_dwordx4 a[180:183], off, s[80:83], s41 offset:0 sc1
    v_mfma_f32_16x16x32_bf16 v[168:171], a[60:63], a[160:163], v[168:171]
    ds_write_b128 v133, v[148:151] offset:3072
    v_mfma_f32_16x16x32_bf16 v[164:167], a[64:67], a[160:163], v[164:167]
    buffer_load_dwordx4 a[196:199], off, s[80:83], s77 offset:2048 sc1
    v_mfma_f32_16x16x32_bf16 v[164:167], a[44:47], a[176:179], v[164:167]
    v_mfma_f32_16x16x32_bf16 v[164:167], v[188:191], a[192:195], v[164:167]
    buffer_load_dwordx4 a[212:215], off, s[80:83], s77 offset:3072 sc1
    v_mfma_f32_16x16x32_bf16 v[164:167], v[208:211], a[208:211], v[164:167]
    v_mfma_f32_16x16x32_bf16 v[160:163], v[204:207], a[208:211], v[160:163]
    v_mfma_f32_16x16x32_bf16 v[160:163], v[184:187], a[192:195], v[160:163]
    s_waitcnt lgkmcnt(0)
    s_barrier
    ds_read_b128 v[176:179], v132 offset:0
    ds_read_b128 v[180:183], v132 offset:1024
    v_mfma_f32_16x16x32_bf16 v[160:163], a[48:51], a[176:179], v[160:163]
    ds_read_b128 v[144:147], v132 offset:2048
    ds_read_b128 v[148:151], v132 offset:3072
    v_mfma_f32_16x16x32_bf16 v[160:163], a[68:71], a[160:163], v[160:163]
    v_mfma_f32_16x16x32_bf16 v[156:159], a[72:75], a[160:163], v[156:159]
    v_mfma_f32_16x16x32_bf16 v[156:159], a[52:55], a[176:179], v[156:159]
    v_mfma_f32_16x16x32_bf16 v[156:159], a[32:35], a[192:195], v[156:159]
    v_mfma_f32_16x16x32_bf16 v[156:159], v[200:203], a[208:211], v[156:159]
    s_waitcnt vmcnt(19)
    v_mfma_f32_16x16x32_bf16 v[100:103], v[28:31], a[236:239], v[100:103]
    s_add_u32 s41, s76, 8192
    buffer_load_dwordx4 a[176:179], off, s[80:83], s41 offset:0 sc1
    s_waitcnt vmcnt(19)
    v_mfma_f32_16x16x32_bf16 v[100:103], a[132:135], a[252:255], v[100:103]
    v_mfma_f32_16x16x32_bf16 v[104:107], a[128:131], a[252:255], v[104:107]
    s_add_u32 s41, s76, 4096
    buffer_load_dwordx4 a[160:163], off, s[80:83], s41 offset:1024 sc1
    v_mfma_f32_16x16x32_bf16 v[104:107], v[24:27], a[236:239], v[104:107]
    s_waitcnt lgkmcnt(3)
    v_add_f32 v156, v156, v176
    v_add_f32 v157, v157, v177
    v_add_f32 v158, v158, v178
    v_mfma_f32_16x16x32_bf16 v[108:111], v[20:23], a[236:239], v[108:111]
    buffer_load_dwordx4 a[192:195], off, s[80:83], s76 offset:2048 sc1
    v_add_f32 v159, v159, v179
    s_waitcnt lgkmcnt(2)
    v_mfma_f32_16x16x32_bf16 v[108:111], a[124:127], a[252:255], v[108:111]
    v_add_f32 v160, v160, v180
    v_add_f32 v161, v161, v181
    v_add_f32 v162, v162, v182
    v_mfma_f32_16x16x32_bf16 v[112:115], a[120:123], a[252:255], v[112:115]
    buffer_load_dwordx4 a[208:211], off, s[80:83], s76 offset:3072 sc1
    v_add_f32 v163, v163, v183
    s_waitcnt lgkmcnt(1)
    v_mfma_f32_16x16x32_bf16 v[112:115], a[140:143], a[236:239], v[112:115]
    v_add_f32 v164, v164, v144
    v_add_f32 v165, v165, v145
    s_waitcnt vmcnt(20)
    v_mfma_f32_16x16x32_bf16 v[92:95], a[120:123], a[248:251], v[92:95]
    s_add_u32 s41, s79, 4096
    buffer_load_dwordx4 a[236:239], off, s[80:83], s41 offset:2048 sc1
    v_add_f32 v166, v166, v146
    v_mfma_f32_16x16x32_bf16 v[92:95], a[140:143], a[232:235], v[92:95]
    v_add_f32 v167, v167, v147
    s_waitcnt lgkmcnt(0)
    v_add_f32 v168, v168, v148
    v_mfma_f32_16x16x32_bf16 v[88:91], v[20:23], a[232:235], v[88:91]
    s_add_u32 s41, s79, 4096
    buffer_load_dwordx4 a[252:255], off, s[80:83], s41 offset:3072 sc1
    v_add_f32 v169, v169, v149
    v_mfma_f32_16x16x32_bf16 v[88:91], a[124:127], a[248:251], v[88:91]
    v_add_f32 v170, v170, v150
    v_add_f32 v171, v171, v151
    ds_read_b128 v[176:179], v132 offset:5120
    v_mfma_f32_16x16x32_bf16 v[84:87], a[128:131], a[248:251], v[84:87]
    ds_read_b128 v[180:183], v132 offset:6144
    ds_read_b128 v[144:147], v132 offset:7168
    ds_read_b128 v[148:151], v132 offset:8192
    v_mfma_f32_16x16x32_bf16 v[84:87], v[24:27], a[232:235], v[84:87]
    v_mfma_f32_16x16x32_bf16 v[80:83], v[28:31], a[232:235], v[80:83]
    v_mfma_f32_16x16x32_bf16 v[80:83], a[132:135], a[248:251], v[80:83]
    s_waitcnt vmcnt(21)
    v_mfma_f32_16x16x32_bf16 v[60:63], v[28:31], a[228:231], v[60:63]
    s_add_u32 s41, s78, 4096
    buffer_load_dwordx4 a[232:235], off, s[80:83], s41 offset:2048 sc1
    s_waitcnt lgkmcnt(3)
    v_add_f32 v156, v156, v176
    s_waitcnt vmcnt(21)
    v_mfma_f32_16x16x32_bf16 v[60:63], a[132:135], a[244:247], v[60:63]
    v_add_f32 v157, v157, v177
    v_add_f32 v158, v158, v178
    v_add_f32 v159, v159, v179
    v_mfma_f32_16x16x32_bf16 v[64:67], a[128:131], a[244:247], v[64:67]
    s_add_u32 s41, s78, 4096
    buffer_load_dwordx4 a[248:251], off, s[80:83], s41 offset:3072 sc1
    s_waitcnt lgkmcnt(2)
    v_mfma_f32_16x16x32_bf16 v[64:67], v[24:27], a[228:231], v[64:67]
    v_add_f32 v160, v160, v180
    v_add_f32 v161, v161, v181
    v_add_f32 v162, v162, v182
    v_mfma_f32_16x16x32_bf16 v[68:71], v[20:23], a[228:231], v[68:71]
    v_add_f32 v163, v163, v183
    s_waitcnt lgkmcnt(1)
    v_add_f32 v164, v164, v144
    v_mfma_f32_16x16x32_bf16 v[68:71], a[124:127], a[244:247], v[68:71]
    v_add_f32 v165, v165, v145
    v_add_f32 v166, v166, v146
    v_add_f32 v167, v167, v147
    v_mfma_f32_16x16x32_bf16 v[72:75], a[120:123], a[244:247], v[72:75]
    s_waitcnt lgkmcnt(0)
    v_add_f32 v168, v168, v148
    v_add_f32 v169, v169, v149
    v_mfma_f32_16x16x32_bf16 v[72:75], a[140:143], a[228:231], v[72:75]
    v_add_f32 v170, v170, v150
    v_add_f32 v171, v171, v151
    s_waitcnt vmcnt(20)
    v_mfma_f32_16x16x32_bf16 v[52:55], a[120:123], a[240:243], v[52:55]
    s_add_u32 s41, s77, 4096
    buffer_load_dwordx4 a[228:231], off, s[80:83], s41 offset:2048 sc1
    ds_read_b128 v[176:179], v132 offset:10240
    v_mfma_f32_16x16x32_bf16 v[52:55], a[140:143], a[224:227], v[52:55]
    ds_read_b128 v[180:183], v132 offset:11264
    ds_read_b128 v[144:147], v132 offset:12288
    ds_read_b128 v[148:151], v132 offset:13312
    v_mfma_f32_16x16x32_bf16 v[48:51], v[20:23], a[224:227], v[48:51]
    s_add_u32 s41, s77, 4096
    buffer_load_dwordx4 a[244:247], off, s[80:83], s41 offset:3072 sc1
    v_mfma_f32_16x16x32_bf16 v[48:51], a[124:127], a[240:243], v[48:51]
    v_mfma_f32_16x16x32_bf16 v[44:47], a[128:131], a[240:243], v[44:47]
    v_mfma_f32_16x16x32_bf16 v[44:47], v[24:27], a[224:227], v[44:47]
    s_waitcnt lgkmcnt(3)
    v_add_f32 v156, v156, v176
    v_add_f32 v157, v157, v177
    v_add_f32 v158, v158, v178
    v_mfma_f32_16x16x32_bf16 v[40:43], v[28:31], a[224:227], v[40:43]
    v_add_f32 v159, v159, v179
    v_and_or_b32 v156, v156, -4, s61
    v_and_or_b32 v157, v157, -4, s61
    v_mfma_f32_16x16x32_bf16 v[40:43], a[132:135], a[240:243], v[40:43]
    v_and_or_b32 v158, v158, -4, s61
    v_and_or_b32 v159, v159, -4, s61
    s_waitcnt vmcnt(21)
    v_mfma_f32_16x16x32_bf16 v[100:103], a[112:115], a[172:175], v[100:103]
    s_add_u32 s41, s76, 4096
    buffer_load_dwordx4 a[224:227], off, s[80:83], s41 offset:2048 sc1
    buffer_store_dwordx4 v[156:159], v1, s[12:15], s56 offen offset:0 sc1
    s_waitcnt vmcnt(19)
    v_mfma_f32_16x16x32_bf16 v[100:103], a[92:95], a[186:189], v[100:103]
    s_waitcnt lgkmcnt(2)
    v_add_f32 v160, v160, v180
    v_add_f32 v161, v161, v181
    v_mfma_f32_16x16x32_bf16 v[104:107], a[88:91], a[186:189], v[104:107]
    s_add_u32 s41, s76, 4096
    buffer_load_dwordx4 a[240:243], off, s[80:83], s41 offset:3072 sc1
    v_add_f32 v162, v162, v182
    v_mfma_f32_16x16x32_bf16 v[104:107], a[108:111], a[172:175], v[104:107]
    v_add_f32 v163, v163, v183
    v_and_or_b32 v160, v160, -4, s61
    v_and_or_b32 v161, v161, -4, s61
    v_mfma_f32_16x16x32_bf16 v[108:111], a[104:107], a[172:175], v[108:111]
    v_and_or_b32 v162, v162, -4, s61
    v_and_or_b32 v163, v163, -4, s61
    buffer_store_dwordx4 v[160:163], v1, s[12:15], s56 offen offset:1024 sc1
    v_mfma_f32_16x16x32_bf16 v[108:111], a[84:87], a[186:189], v[108:111]
    s_waitcnt lgkmcnt(1)
    v_add_f32 v164, v164, v144
    v_add_f32 v165, v165, v145
    v_mfma_f32_16x16x32_bf16 v[112:115], a[80:83], a[186:189], v[112:115]
    v_add_f32 v166, v166, v146
    v_add_f32 v167, v167, v147
    v_and_or_b32 v164, v164, -4, s61
    v_mfma_f32_16x16x32_bf16 v[112:115], a[100:103], a[172:175], v[112:115]
    v_and_or_b32 v165, v165, -4, s61
    v_accvgpr_mov_b32 a186, a190
    v_accvgpr_mov_b32 a187, a191
    s_nop 1
    v_mfma_f32_16x16x32_bf16 v[92:95], a[80:83], a[184:187], v[92:95]
    v_and_or_b32 v166, v166, -4, s61
    v_and_or_b32 v167, v167, -4, s61
    buffer_store_dwordx4 v[164:167], v1, s[12:15], s56 offen offset:2048 sc1
    s_waitcnt vmcnt(21)
    v_mfma_f32_16x16x32_bf16 v[92:95], a[100:103], a[168:171], v[92:95]
    s_waitcnt lgkmcnt(0)
    v_add_f32 v168, v168, v148
    v_add_f32 v169, v169, v149
    v_mfma_f32_16x16x32_bf16 v[88:91], a[104:107], a[168:171], v[88:91]
    v_add_f32 v170, v170, v150
    v_add_f32 v171, v171, v151
    v_and_or_b32 v168, v168, -4, s61
    v_mfma_f32_16x16x32_bf16 v[88:91], a[84:87], a[184:187], v[88:91]
    v_and_or_b32 v169, v169, -4, s61
    v_and_or_b32 v170, v170, -4, s61
    v_and_or_b32 v171, v171, -4, s61
    v_mfma_f32_16x16x32_bf16 v[84:87], a[88:91], a[184:187], v[84:87]
    buffer_store_dwordx4 v[168:171], v1, s[12:15], s56 offen offset:3072 sc1
    v_add_u32 v132, 61440, v132
    v_add_u32 v133, 61440, v133
    v_mfma_f32_16x16x32_bf16 v[84:87], a[108:111], a[168:171], v[84:87]
    v_add_u32 v134, 61440, v134
    v_add_u32 v135, 61440, v135
    v_mfma_f32_16x16x32_bf16 v[80:83], a[112:115], a[168:171], v[80:83]
    v_mfma_f32_16x16x32_bf16 v[80:83], a[92:95], a[184:187], v[80:83]
    s_waitcnt vmcnt(19)
    v_mfma_f32_16x16x32_bf16 v[60:63], a[112:115], a[164:167], v[60:63]
    s_waitcnt vmcnt(15)
    v_mfma_f32_16x16x32_bf16 v[60:63], a[92:95], a[178:181], v[60:63]
    v_mfma_f32_16x16x32_bf16 v[64:67], a[88:91], a[178:181], v[64:67]
    v_mfma_f32_16x16x32_bf16 v[64:67], a[108:111], a[164:167], v[64:67]
    v_mfma_f32_16x16x32_bf16 v[68:71], a[104:107], a[164:167], v[68:71]
    v_mfma_f32_16x16x32_bf16 v[68:71], a[84:87], a[178:181], v[68:71]
    v_mfma_f32_16x16x32_bf16 v[72:75], a[80:83], a[178:181], v[72:75]
    v_mfma_f32_16x16x32_bf16 v[72:75], a[100:103], a[164:167], v[72:75]
    v_accvgpr_mov_b32 a178, a182
    v_accvgpr_mov_b32 a179, a183
    s_nop 1
    v_mfma_f32_16x16x32_bf16 v[52:55], a[80:83], a[176:179], v[52:55]
    s_waitcnt vmcnt(14)
    v_mfma_f32_16x16x32_bf16 v[52:55], a[100:103], a[160:163], v[52:55]
    v_mfma_f32_16x16x32_bf16 v[48:51], a[104:107], a[160:163], v[48:51]
    v_mfma_f32_16x16x32_bf16 v[48:51], a[84:87], a[176:179], v[48:51]
    v_mfma_f32_16x16x32_bf16 v[44:47], a[88:91], a[176:179], v[44:47]
    v_mfma_f32_16x16x32_bf16 v[44:47], a[108:111], a[160:163], v[44:47]
    v_mfma_f32_16x16x32_bf16 v[40:43], a[112:115], a[160:163], v[40:43]
    v_mfma_f32_16x16x32_bf16 v[40:43], a[92:95], a[176:179], v[40:43]
    v_mfma_f32_16x16x32_bf16 v[100:103], a[72:75], a[204:207], v[100:103]
    v_mfma_f32_16x16x32_bf16 v[100:103], a[52:55], a[220:223], v[100:103]
    s_waitcnt vmcnt(11)
    v_mfma_f32_16x16x32_bf16 v[100:103], a[32:35], a[236:239], v[100:103]
    s_waitcnt vmcnt(10)
    v_mfma_f32_16x16x32_bf16 v[100:103], v[200:203], a[252:255], v[100:103]
    v_mfma_f32_16x16x32_bf16 v[104:107], v[204:207], a[252:255], v[104:107]
    v_mfma_f32_16x16x32_bf16 v[104:107], v[184:187], a[236:239], v[104:107]
    v_mfma_f32_16x16x32_bf16 v[104:107], a[48:51], a[220:223], v[104:107]
    v_mfma_f32_16x16x32_bf16 v[104:107], a[68:71], a[204:207], v[104:107]
    s_nop 3
    ds_write_b128 v135, v[100:103] offset:0
    v_mfma_f32_16x16x32_bf16 v[108:111], a[64:67], a[204:207], v[108:111]
    v_mfma_f32_16x16x32_bf16 v[108:111], a[44:47], a[220:223], v[108:111]
    v_mfma_f32_16x16x32_bf16 v[108:111], v[188:191], a[236:239], v[108:111]
    v_mfma_f32_16x16x32_bf16 v[108:111], v[208:211], a[252:255], v[108:111]
    ds_write_b128 v135, v[104:107] offset:1024
    v_mfma_f32_16x16x32_bf16 v[112:115], v[212:215], a[252:255], v[112:115]
    v_mfma_f32_16x16x32_bf16 v[112:115], v[192:195], a[236:239], v[112:115]
    v_mfma_f32_16x16x32_bf16 v[112:115], a[40:43], a[220:223], v[112:115]
    v_mfma_f32_16x16x32_bf16 v[112:115], a[60:63], a[204:207], v[112:115]
    s_nop 2
    ds_write_b128 v135, v[108:111] offset:2048
    s_waitcnt vmcnt(8)
    v_mfma_f32_16x16x32_bf16 v[92:95], v[212:215], a[248:251], v[92:95]
    v_mfma_f32_16x16x32_bf16 v[92:95], v[192:195], a[232:235], v[92:95]
    v_mfma_f32_16x16x32_bf16 v[92:95], a[40:43], a[216:219], v[92:95]
    v_mfma_f32_16x16x32_bf16 v[92:95], a[60:63], a[200:203], v[92:95]
    ds_write_b128 v135, v[112:115] offset:3072
    v_mfma_f32_16x16x32_bf16 v[88:91], a[64:67], a[200:203], v[88:91]
    v_mfma_f32_16x16x32_bf16 v[88:91], a[44:47], a[216:219], v[88:91]
    v_mfma_f32_16x16x32_bf16 v[88:91], v[188:191], a[232:235], v[88:91]
    v_mfma_f32_16x16x32_bf16 v[88:91], v[208:211], a[248:251], v[88:91]
    s_nop 2
    ds_write_b128 v134, v[92:95] offset:3072
    v_mfma_f32_16x16x32_bf16 v[84:87], v[204:207], a[248:251], v[84:87]
    v_mfma_f32_16x16x32_bf16 v[84:87], v[184:187], a[232:235], v[84:87]
    v_mfma_f32_16x16x32_bf16 v[84:87], a[48:51], a[216:219], v[84:87]
    v_mfma_f32_16x16x32_bf16 v[84:87], a[68:71], a[200:203], v[84:87]
    ds_write_b128 v134, v[88:91] offset:2048
    v_mfma_f32_16x16x32_bf16 v[80:83], a[72:75], a[200:203], v[80:83]
    v_mfma_f32_16x16x32_bf16 v[80:83], a[52:55], a[216:219], v[80:83]
    v_mfma_f32_16x16x32_bf16 v[80:83], a[32:35], a[232:235], v[80:83]
    v_mfma_f32_16x16x32_bf16 v[80:83], v[200:203], a[248:251], v[80:83]
    s_nop 2
    ds_write_b128 v134, v[84:87] offset:1024
    v_mfma_f32_16x16x32_bf16 v[60:63], a[72:75], a[196:199], v[60:63]
    v_mfma_f32_16x16x32_bf16 v[60:63], a[52:55], a[212:215], v[60:63]
    buffer_load_dwordx4 v[176:179], v1, s[12:15], s58 offen offset:0 sc1
    buffer_load_dwordx4 v[180:183], v1, s[12:15], s58 offen offset:1024 sc1
    buffer_load_dwordx4 v[144:147], v1, s[12:15], s58 offen offset:2048 sc1
    buffer_load_dwordx4 v[148:151], v1, s[12:15], s58 offen offset:3072 sc1
    s_waitcnt vmcnt(11)
    v_mfma_f32_16x16x32_bf16 v[60:63], a[32:35], a[228:231], v[60:63]
    s_waitcnt vmcnt(10)
    v_mfma_f32_16x16x32_bf16 v[60:63], v[200:203], a[244:247], v[60:63]
    ds_write_b128 v134, v[80:83] offset:0
    v_mfma_f32_16x16x32_bf16 v[64:67], v[204:207], a[244:247], v[64:67]
    v_mfma_f32_16x16x32_bf16 v[64:67], v[184:187], a[228:231], v[64:67]
    v_mfma_f32_16x16x32_bf16 v[64:67], a[48:51], a[212:215], v[64:67]
    v_mfma_f32_16x16x32_bf16 v[64:67], a[68:71], a[196:199], v[64:67]
    s_nop 2
    ds_write_b128 v133, v[60:63] offset:0
    v_mfma_f32_16x16x32_bf16 v[68:71], a[64:67], a[196:199], v[68:71]
    v_mfma_f32_16x16x32_bf16 v[68:71], a[44:47], a[212:215], v[68:71]
    v_mfma_f32_16x16x32_bf16 v[68:71], v[188:191], a[228:231], v[68:71]
    v_mfma_f32_16x16x32_bf16 v[68:71], v[208:211], a[244:247], v[68:71]
    ds_write_b128 v133, v[64:67] offset:1024
    v_mfma_f32_16x16x32_bf16 v[72:75], v[212:215], a[244:247], v[72:75]
    v_mfma_f32_16x16x32_bf16 v[72:75], v[192:195], a[228:231], v[72:75]
    v_mfma_f32_16x16x32_bf16 v[72:75], a[40:43], a[212:215], v[72:75]
    v_mfma_f32_16x16x32_bf16 v[72:75], a[60:63], a[196:199], v[72:75]
    s_nop 2
    ds_write_b128 v133, v[68:71] offset:2048
    s_waitcnt vmcnt(7)
    v_mfma_f32_16x16x32_bf16 v[52:55], v[212:215], a[240:243], v[52:55]
    v_mfma_f32_16x16x32_bf16 v[52:55], v[192:195], a[224:227], v[52:55]
    v_mfma_f32_16x16x32_bf16 v[52:55], a[40:43], a[208:211], v[52:55]
    v_mfma_f32_16x16x32_bf16 v[52:55], a[60:63], a[192:195], v[52:55]
    ds_write_b128 v133, v[72:75] offset:3072
    v_mfma_f32_16x16x32_bf16 v[48:51], a[64:67], a[192:195], v[48:51]
    v_mfma_f32_16x16x32_bf16 v[48:51], a[44:47], a[208:211], v[48:51]
    v_mfma_f32_16x16x32_bf16 v[48:51], v[188:191], a[224:227], v[48:51]
    v_mfma_f32_16x16x32_bf16 v[48:51], v[208:211], a[240:243], v[48:51]
    v_mfma_f32_16x16x32_bf16 v[44:47], v[204:207], a[240:243], v[44:47]
    v_mfma_f32_16x16x32_bf16 v[44:47], v[184:187], a[224:227], v[44:47]
    s_waitcnt lgkmcnt(0)
    s_barrier
    ds_read_b128 v[60:63], v132 offset:0
    ds_read_b128 v[64:67], v132 offset:1024
    v_mfma_f32_16x16x32_bf16 v[44:47], a[48:51], a[208:211], v[44:47]
    ds_read_b128 v[68:71], v132 offset:2048
    ds_read_b128 v[72:75], v132 offset:3072
    ds_read_b128 v[80:83], v132 offset:5120
    v_mfma_f32_16x16x32_bf16 v[44:47], a[68:71], a[192:195], v[44:47]
    ds_read_b128 v[84:87], v132 offset:6144
    ds_read_b128 v[88:91], v132 offset:7168
    ds_read_b128 v[92:95], v132 offset:8192
    v_mfma_f32_16x16x32_bf16 v[40:43], a[72:75], a[192:195], v[40:43]
    ds_read_b128 v[100:103], v132 offset:10240
    ds_read_b128 v[104:107], v132 offset:11264
    ds_read_b128 v[108:111], v132 offset:12288
    v_mfma_f32_16x16x32_bf16 v[40:43], a[52:55], a[208:211], v[40:43]
    ds_read_b128 v[112:115], v132 offset:13312
    v_mfma_f32_16x16x32_bf16 v[40:43], a[32:35], a[224:227], v[40:43]
    v_mfma_f32_16x16x32_bf16 v[40:43], v[200:203], a[240:243], v[40:43]
    s_waitcnt vmcnt(0)
    v_and_b32 v137, s61, v176
    v_bitop3_b32 v137, v137, v177, v178 bitop3:0x80
    v_bitop3_b32 v137, v137, v179, v180 bitop3:0x80
    v_bitop3_b32 v137, v137, v181, v182 bitop3:0x80
    v_bitop3_b32 v137, v137, v183, v144 bitop3:0x80
    v_bitop3_b32 v137, v137, v145, v146 bitop3:0x80
    v_bitop3_b32 v137, v137, v147, v148 bitop3:0x80
    v_bitop3_b32 v137, v137, v149, v150 bitop3:0x80
    v_bitop3_b32 v137, v137, v151, v176 bitop3:0x80
    v_cmp_eq_u32 vcc, 0, v137
    s_nop 3
    s_cbranch_vccz L_interleave_layers__spectral_fnet__mixer_gmlp__prompt_kernel_39
    s_mov_b32 s40, 0
L_interleave_layers__spectral_fnet__mixer_gmlp__prompt_kernel_41:
    buffer_load_dwordx4 v[176:179], v1, s[12:15], s58 offen offset:0 sc1
    buffer_load_dwordx4 v[180:183], v1, s[12:15], s58 offen offset:1024 sc1
    buffer_load_dwordx4 v[144:147], v1, s[12:15], s58 offen offset:2048 sc1
    buffer_load_dwordx4 v[148:151], v1, s[12:15], s58 offen offset:3072 sc1
    s_add_u32 s40, s40, 1
    s_cmp_gt_u32 s40, 2000000
    s_cbranch_scc1 L_interleave_layers__spectral_fnet__mixer_gmlp__prompt_kernel_40
    s_waitcnt vmcnt(0)
    v_and_b32 v137, s61, v176
    v_bitop3_b32 v137, v137, v177, v178 bitop3:0x80
    v_bitop3_b32 v137, v137, v179, v180 bitop3:0x80
    v_bitop3_b32 v137, v137, v181, v182 bitop3:0x80
    v_bitop3_b32 v137, v137, v183, v144 bitop3:0x80
    v_bitop3_b32 v137, v137, v145, v146 bitop3:0x80
    v_bitop3_b32 v137, v137, v147, v148 bitop3:0x80
    v_bitop3_b32 v137, v137, v149, v150 bitop3:0x80
    v_bitop3_b32 v137, v137, v151, v176 bitop3:0x80
    v_cmp_eq_u32 vcc, 0, v137
    s_nop 3
    s_cbranch_vccnz L_interleave_layers__spectral_fnet__mixer_gmlp__prompt_kernel_41
    s_mov_b64 exec, -1
L_interleave_layers__spectral_fnet__mixer_gmlp__prompt_kernel_39:
    v_pk_add_f32 v[40:41], v[40:41], v[176:177]
    v_pk_add_f32 v[42:43], v[42:43], v[178:179]
    v_pk_add_f32 v[44:45], v[44:45], v[180:181]
    v_pk_add_f32 v[46:47], v[46:47], v[182:183]
    v_pk_add_f32 v[48:49], v[48:49], v[144:145]
    v_pk_add_f32 v[50:51], v[50:51], v[146:147]
    v_pk_add_f32 v[52:53], v[52:53], v[148:149]
    v_pk_add_f32 v[54:55], v[54:55], v[150:151]
    s_waitcnt lgkmcnt(8)
    v_pk_add_f32 v[40:41], v[40:41], v[60:61]
    v_pk_add_f32 v[42:43], v[42:43], v[62:63]
    v_pk_add_f32 v[44:45], v[44:45], v[64:65]
    v_pk_add_f32 v[46:47], v[46:47], v[66:67]
    v_pk_add_f32 v[48:49], v[48:49], v[68:69]
    v_pk_add_f32 v[50:51], v[50:51], v[70:71]
    v_pk_add_f32 v[52:53], v[52:53], v[72:73]
    v_pk_add_f32 v[54:55], v[54:55], v[74:75]
    s_waitcnt lgkmcnt(4)
    v_pk_add_f32 v[40:41], v[40:41], v[80:81]
    v_pk_add_f32 v[42:43], v[42:43], v[82:83]
    v_pk_add_f32 v[44:45], v[44:45], v[84:85]
    v_pk_add_f32 v[46:47], v[46:47], v[86:87]
    v_pk_add_f32 v[48:49], v[48:49], v[88:89]
    v_pk_add_f32 v[50:51], v[50:51], v[90:91]
    v_pk_add_f32 v[52:53], v[52:53], v[92:93]
    v_pk_add_f32 v[54:55], v[54:55], v[94:95]
    s_waitcnt lgkmcnt(0)
    v_pk_add_f32 v[40:41], v[40:41], v[100:101]
    v_pk_add_f32 v[42:43], v[42:43], v[102:103]
    v_pk_add_f32 v[44:45], v[44:45], v[104:105]
    v_pk_add_f32 v[46:47], v[46:47], v[106:107]
    v_pk_add_f32 v[48:49], v[48:49], v[108:109]
    v_pk_add_f32 v[50:51], v[50:51], v[110:111]
    v_pk_add_f32 v[52:53], v[52:53], v[112:113]
    v_pk_add_f32 v[54:55], v[54:55], v[114:115]
    s_nop 1
    s_branch L_interleave_layers__spectral_fnet__mixer_gmlp__prompt_kernel_34
L_interleave_layers__spectral_fnet__mixer_gmlp__prompt_kernel_33:
    v_mfma_f32_16x16x32_bf16 a[20:23], v[240:243], a[172:175], 0
    s_add_u32 s41, s75, 4096
    buffer_load_dwordx4 a[220:223], off, s[80:83], s41 offset:1024 sc1
    v_mfma_f32_16x16x32_bf16 a[24:27], v[244:247], a[172:175], 0
    v_mfma_f32_16x16x32_bf16 a[28:31], v[248:251], a[172:175], 0
    s_add_u32 s41, s75, 8192
    buffer_load_dwordx4 a[236:239], off, s[80:83], s41 offset:0 sc1
    v_mfma_f32_16x16x32_bf16 a[144:147], v[36:39], a[172:175], 0
    v_mfma_f32_16x16x32_bf16 a[148:151], v[32:35], a[172:175], 0
    s_add_u32 s41, s74, 8192
    buffer_load_dwordx4 a[232:235], off, s[80:83], s41 offset:0 sc1
    v_mfma_f32_16x16x32_bf16 a[16:19], v[32:35], a[168:171], 0
    v_mfma_f32_16x16x32_bf16 a[12:15], v[36:39], a[168:171], 0
    s_add_u32 s41, s74, 4096
    buffer_load_dwordx4 a[216:219], off, s[80:83], s41 offset:1024 sc1
    v_mfma_f32_16x16x32_bf16 a[8:11], v[248:251], a[168:171], 0
    v_mfma_f32_16x16x32_bf16 a[4:7], v[244:247], a[168:171], 0
    s_add_u32 s41, s73, 4096
    buffer_load_dwordx4 a[212:215], off, s[80:83], s41 offset:1024 sc1
    v_mfma_f32_16x16x32_bf16 a[0:3], v[240:243], a[168:171], 0
    v_mfma_f32_16x16x32_bf16 v[176:179], v[240:243], a[164:167], 0
    s_add_u32 s41, s73, 8192
    buffer_load_dwordx4 a[228:231], off, s[80:83], s41 offset:0 sc1
    v_mfma_f32_16x16x32_bf16 v[180:183], v[244:247], a[164:167], 0
    v_mfma_f32_16x16x32_bf16 v[144:147], v[248:251], a[164:167], 0
    s_add_u32 s41, s72, 8192
    buffer_load_dwordx4 a[224:227], off, s[80:83], s41 offset:0 sc1
    v_mfma_f32_16x16x32_bf16 v[148:151], v[36:39], a[164:167], 0
    v_mfma_f32_16x16x32_bf16 v[152:155], v[32:35], a[164:167], 0
    s_add_u32 s41, s72, 4096
    buffer_load_dwordx4 a[208:211], off, s[80:83], s41 offset:1024 sc1
    v_mfma_f32_16x16x32_bf16 v[172:175], v[32:35], a[160:163], 0
    v_mfma_f32_16x16x32_bf16 v[168:171], v[36:39], a[160:163], 0
    buffer_load_dwordx4 a[252:255], off, s[80:83], s79 offset:0 sc1
    v_mfma_f32_16x16x32_bf16 v[164:167], v[248:251], a[160:163], 0
    v_mfma_f32_16x16x32_bf16 v[160:163], v[244:247], a[160:163], 0
    buffer_load_dwordx4 a[248:251], off, s[80:83], s78 offset:0 sc1
    v_mfma_f32_16x16x32_bf16 v[156:159], v[240:243], a[160:163], 0
    buffer_load_dword v137, v136, s[12:15], s44 offen offset:1792 sc1
    s_waitcnt vmcnt(18)
    v_mfma_f32_16x16x32_bf16 a[20:23], v[28:31], a[188:191], a[20:23]
    buffer_load_dwordx4 a[244:247], off, s[80:83], s77 offset:0 sc1
    s_waitcnt vmcnt(15)
    v_mfma_f32_16x16x32_bf16 a[20:23], a[132:135], a[204:207], a[20:23]
    v_mfma_f32_16x16x32_bf16 a[24:27], a[128:131], a[204:207], a[24:27]
    buffer_load_dwordx4 a[240:243], off, s[80:83], s76 offset:0 sc1
    v_mfma_f32_16x16x32_bf16 a[24:27], v[24:27], a[188:191], a[24:27]
    v_mfma_f32_16x16x32_bf16 a[28:31], v[20:23], a[188:191], a[28:31]
    v_mfma_f32_16x16x32_bf16 a[28:31], a[124:127], a[204:207], a[28:31]
    v_mfma_f32_16x16x32_bf16 a[144:147], a[120:123], a[204:207], a[144:147]
    v_mfma_f32_16x16x32_bf16 a[144:147], a[140:143], a[188:191], a[144:147]
    v_mfma_f32_16x16x32_bf16 a[148:151], a[136:139], a[188:191], a[148:151]
    v_mfma_f32_16x16x32_bf16 a[148:151], a[116:119], a[204:207], a[148:151]
    v_mfma_f32_16x16x32_bf16 a[16:19], a[136:139], a[184:187], a[16:19]
    s_waitcnt vmcnt(15)
    v_mfma_f32_16x16x32_bf16 a[16:19], a[116:119], a[200:203], a[16:19]
    v_mfma_f32_16x16x32_bf16 a[12:15], a[120:123], a[200:203], a[12:15]
    v_mfma_f32_16x16x32_bf16 a[12:15], a[140:143], a[184:187], a[12:15]
    v_mfma_f32_16x16x32_bf16 a[8:11], v[20:23], a[184:187], a[8:11]
    v_mfma_f32_16x16x32_bf16 a[8:11], a[124:127], a[200:203], a[8:11]
    v_mfma_f32_16x16x32_bf16 a[4:7], a[128:131], a[200:203], a[4:7]
    v_mfma_f32_16x16x32_bf16 a[4:7], v[24:27], a[184:187], a[4:7]
    v_mfma_f32_16x16x32_bf16 a[0:3], v[28:31], a[184:187], a[0:3]
    v_mfma_f32_16x16x32_bf16 a[0:3], a[132:135], a[200:203], a[0:3]
    v_mfma_f32_16x16x32_bf16 v[176:179], v[28:31], a[180:183], v[176:179]
    s_waitcnt vmcnt(14)
    v_mfma_f32_16x16x32_bf16 v[176:179], a[132:135], a[196:199], v[176:179]
    v_mfma_f32_16x16x32_bf16 v[180:183], a[128:131], a[196:199], v[180:183]
    v_mfma_f32_16x16x32_bf16 v[180:183], v[24:27], a[180:183], v[180:183]
    v_mfma_f32_16x16x32_bf16 v[144:147], v[20:23], a[180:183], v[144:147]
    v_mfma_f32_16x16x32_bf16 v[144:147], a[124:127], a[196:199], v[144:147]
    v_mfma_f32_16x16x32_bf16 v[148:151], a[120:123], a[196:199], v[148:151]
    v_mfma_f32_16x16x32_bf16 v[148:151], a[140:143], a[180:183], v[148:151]
    v_mfma_f32_16x16x32_bf16 v[152:155], a[136:139], a[180:183], v[152:155]
    v_mfma_f32_16x16x32_bf16 v[152:155], a[116:119], a[196:199], v[152:155]
    v_mfma_f32_16x16x32_bf16 v[172:175], a[136:139], a[176:179], v[172:175]
    s_waitcnt vmcnt(13)
    v_mfma_f32_16x16x32_bf16 v[172:175], a[116:119], a[192:195], v[172:175]
    v_mfma_f32_16x16x32_bf16 v[168:171], a[120:123], a[192:195], v[168:171]
    v_mfma_f32_16x16x32_bf16 v[168:171], a[140:143], a[176:179], v[168:171]
    v_mfma_f32_16x16x32_bf16 v[164:167], v[20:23], a[176:179], v[164:167]
    v_mfma_f32_16x16x32_bf16 v[164:167], a[124:127], a[192:195], v[164:167]
    v_mfma_f32_16x16x32_bf16 v[160:163], a[128:131], a[192:195], v[160:163]
    v_mfma_f32_16x16x32_bf16 v[160:163], v[24:27], a[176:179], v[160:163]
    v_mfma_f32_16x16x32_bf16 v[156:159], v[28:31], a[176:179], v[156:159]
    v_mfma_f32_16x16x32_bf16 v[156:159], a[132:135], a[192:195], v[156:159]
    s_waitcnt vmcnt(2)
    v_cmp_eq_u32 vcc, 0, v137
    s_nop 4
    s_cbranch_vccnz L_interleave_layers__spectral_fnet__mixer_gmlp__prompt_kernel_42
L_interleave_layers__spectral_fnet__mixer_gmlp__prompt_kernel_43:
    v_mfma_f32_16x16x32_bf16 a[20:23], a[112:115], a[220:223], a[20:23]
    v_mfma_f32_16x16x32_bf16 a[20:23], a[92:95], a[234:237], a[20:23]
    v_mfma_f32_16x16x32_bf16 a[24:27], a[88:91], a[234:237], a[24:27]
    v_mfma_f32_16x16x32_bf16 a[24:27], a[108:111], a[220:223], a[24:27]
    v_mfma_f32_16x16x32_bf16 a[28:31], a[104:107], a[220:223], a[28:31]
    v_mfma_f32_16x16x32_bf16 a[28:31], a[84:87], a[234:237], a[28:31]
    v_mfma_f32_16x16x32_bf16 a[144:147], a[80:83], a[234:237], a[144:147]
    v_mfma_f32_16x16x32_bf16 a[144:147], a[100:103], a[220:223], a[144:147]
    v_mfma_f32_16x16x32_bf16 a[148:151], a[96:99], a[220:223], a[148:151]
    v_mfma_f32_16x16x32_bf16 a[148:151], a[76:79], a[234:237], a[148:151]
    v_accvgpr_mov_b32 a234, a238
    v_accvgpr_mov_b32 a235, a239
    v_mfma_f32_16x16x32_bf16 a[16:19], a[96:99], a[216:219], a[16:19]
    buffer_load_dwordx4 a[172:175], off, s[80:83], s75 offset:2048 sc1
    v_mfma_f32_16x16x32_bf16 a[16:19], a[76:79], a[232:235], a[16:19]
    v_mfma_f32_16x16x32_bf16 a[12:15], a[80:83], a[232:235], a[12:15]
    buffer_load_dwordx4 a[188:191], off, s[80:83], s75 offset:3072 sc1
    v_mfma_f32_16x16x32_bf16 a[12:15], a[100:103], a[216:219], a[12:15]
    v_mfma_f32_16x16x32_bf16 a[8:11], a[104:107], a[216:219], a[8:11]
    s_add_u32 s41, s75, 4096
    buffer_load_dwordx4 a[204:207], off, s[80:83], s41 offset:2048 sc1
    v_mfma_f32_16x16x32_bf16 a[8:11], a[84:87], a[232:235], a[8:11]
    v_mfma_f32_16x16x32_bf16 a[4:7], a[88:91], a[232:235], a[4:7]
    s_add_u32 s41, s75, 4096
    buffer_load_dwordx4 a[220:223], off, s[80:83], s41 offset:3072 sc1
    v_mfma_f32_16x16x32_bf16 a[4:7], a[108:111], a[216:219], a[4:7]
    v_mfma_f32_16x16x32_bf16 a[0:3], a[112:115], a[216:219], a[0:3]
    buffer_load_dwordx4 a[168:171], off, s[80:83], s74 offset:2048 sc1
    v_mfma_f32_16x16x32_bf16 a[0:3], a[92:95], a[232:235], a[0:3]
    v_mfma_f32_16x16x32_bf16 v[176:179], a[112:115], a[212:215], v[176:179]
    buffer_load_dwordx4 a[184:187], off, s[80:83], s74 offset:3072 sc1
    v_mfma_f32_16x16x32_bf16 v[176:179], a[92:95], a[226:229], v[176:179]
    v_mfma_f32_16x16x32_bf16 v[180:183], a[88:91], a[226:229], v[180:183]
    s_add_u32 s41, s74, 4096
    buffer_load_dwordx4 a[200:203], off, s[80:83], s41 offset:2048 sc1
    v_mfma_f32_16x16x32_bf16 v[180:183], a[108:111], a[212:215], v[180:183]
    v_mfma_f32_16x16x32_bf16 v[144:147], a[104:107], a[212:215], v[144:147]
    s_add_u32 s41, s74, 4096
    buffer_load_dwordx4 a[216:219], off, s[80:83], s41 offset:3072 sc1
    v_mfma_f32_16x16x32_bf16 v[144:147], a[84:87], a[226:229], v[144:147]
    v_mfma_f32_16x16x32_bf16 v[148:151], a[80:83], a[226:229], v[148:151]
    buffer_load_dwordx4 a[164:167], off, s[80:83], s73 offset:2048 sc1
    v_mfma_f32_16x16x32_bf16 v[148:151], a[100:103], a[212:215], v[148:151]
    v_mfma_f32_16x16x32_bf16 v[152:155], a[96:99], a[212:215], v[152:155]
    buffer_load_dwordx4 a[180:183], off, s[80:83], s73 offset:3072 sc1
    v_mfma_f32_16x16x32_bf16 v[152:155], a[76:79], a[226:229], v[152:155]
    v_accvgpr_mov_b32 a226, a230
    v_accvgpr_mov_b32 a227, a231
    v_mfma_f32_16x16x32_bf16 v[172:175], a[96:99], a[208:211], v[172:175]
    s_add_u32 s41, s73, 4096
    buffer_load_dwordx4 a[196:199], off, s[80:83], s41 offset:2048 sc1
    v_mfma_f32_16x16x32_bf16 v[172:175], a[76:79], a[224:227], v[172:175]
    v_mfma_f32_16x16x32_bf16 v[168:171], a[80:83], a[224:227], v[168:171]
    s_add_u32 s41, s73, 4096
    buffer_load_dwordx4 a[212:215], off, s[80:83], s41 offset:3072 sc1
    v_mfma_f32_16x16x32_bf16 v[168:171], a[100:103], a[208:211], v[168:171]
    v_mfma_f32_16x16x32_bf16 v[164:167], a[104:107], a[208:211], v[164:167]
    buffer_load_dwordx4 a[160:163], off, s[80:83], s72 offset:2048 sc1
    v_mfma_f32_16x16x32_bf16 v[164:167], a[84:87], a[224:227], v[164:167]
    v_mfma_f32_16x16x32_bf16 v[160:163], a[88:91], a[224:227], v[160:163]
    buffer_load_dwordx4 a[176:179], off, s[80:83], s72 offset:3072 sc1
    v_mfma_f32_16x16x32_bf16 v[160:163], a[108:111], a[208:211], v[160:163]
    v_mfma_f32_16x16x32_bf16 v[156:159], a[112:115], a[208:211], v[156:159]
    s_add_u32 s41, s72, 4096
    buffer_load_dwordx4 a[192:195], off, s[80:83], s41 offset:2048 sc1
    v_mfma_f32_16x16x32_bf16 v[156:159], a[92:95], a[224:227], v[156:159]
    v_mfma_f32_16x16x32_bf16 v[100:103], v[240:243], a[252:255], 0
    s_add_u32 s41, s72, 4096
    buffer_load_dwordx4 a[208:211], off, s[80:83], s41 offset:3072 sc1
    v_mfma_f32_16x16x32_bf16 v[104:107], v[244:247], a[252:255], 0
    v_mfma_f32_16x16x32_bf16 v[108:111], v[248:251], a[252:255], 0
    buffer_load_dwordx4 a[236:239], off, s[80:83], s79 offset:1024 sc1
    v_mfma_f32_16x16x32_bf16 v[112:115], v[36:39], a[252:255], 0
    v_mfma_f32_16x16x32_bf16 v[116:119], v[32:35], a[252:255], 0
    buffer_load_dwordx4 a[232:235], off, s[80:83], s78 offset:1024 sc1
    v_mfma_f32_16x16x32_bf16 v[96:99], v[32:35], a[248:251], 0
    v_mfma_f32_16x16x32_bf16 v[92:95], v[36:39], a[248:251], 0
    s_add_u32 s41, s79, 4096
    buffer_load_dwordx4 a[252:255], off, s[80:83], s41 offset:0 sc1
    v_mfma_f32_16x16x32_bf16 v[88:91], v[248:251], a[248:251], 0
    v_mfma_f32_16x16x32_bf16 v[84:87], v[244:247], a[248:251], 0
    buffer_load_dwordx4 a[228:231], off, s[80:83], s77 offset:1024 sc1
    v_mfma_f32_16x16x32_bf16 v[80:83], v[240:243], a[248:251], 0
    s_waitcnt vmcnt(21)
    v_mfma_f32_16x16x32_bf16 v[60:63], v[240:243], a[244:247], 0
    s_add_u32 s41, s78, 4096
    buffer_load_dwordx4 a[248:251], off, s[80:83], s41 offset:0 sc1
    v_mfma_f32_16x16x32_bf16 v[64:67], v[244:247], a[244:247], 0
    v_mfma_f32_16x16x32_bf16 v[68:71], v[248:251], a[244:247], 0
    buffer_load_dwordx4 a[224:227], off, s[80:83], s76 offset:1024 sc1
    v_mfma_f32_16x16x32_bf16 v[72:75], v[36:39], a[244:247], 0
    v_mfma_f32_16x16x32_bf16 v[76:79], v[32:35], a[244:247], 0
    s_waitcnt vmcnt(22)
    v_mfma_f32_16x16x32_bf16 v[56:59], v[32:35], a[240:243], v[56:59]
    s_add_u32 s41, s77, 4096
    buffer_load_dwordx4 a[244:247], off, s[80:83], s41 offset:0 sc1
    v_mfma_f32_16x16x32_bf16 v[52:55], v[36:39], a[240:243], v[52:55]
    v_mfma_f32_16x16x32_bf16 v[48:51], v[248:251], a[240:243], v[48:51]
    v_mfma_f32_16x16x32_bf16 v[44:47], v[244:247], a[240:243], v[44:47]
    v_mfma_f32_16x16x32_bf16 v[40:43], v[240:243], a[240:243], v[40:43]
    s_waitcnt vmcnt(22)
    v_mfma_f32_16x16x32_bf16 a[20:23], a[72:75], a[172:175], a[20:23]
    s_add_u32 s41, s76, 4096
    buffer_load_dwordx4 a[240:243], off, s[80:83], s41 offset:0 sc1
    s_waitcnt vmcnt(22)
    v_mfma_f32_16x16x32_bf16 a[20:23], a[52:55], a[188:191], a[20:23]
    s_waitcnt vmcnt(21)
    v_mfma_f32_16x16x32_bf16 a[20:23], a[32:35], a[204:207], a[20:23]
    s_waitcnt vmcnt(20)
    v_mfma_f32_16x16x32_bf16 a[20:23], v[200:203], a[220:223], a[20:23]
    v_mfma_f32_16x16x32_bf16 a[24:27], v[204:207], a[220:223], a[24:27]
    v_mfma_f32_16x16x32_bf16 a[24:27], v[184:187], a[204:207], a[24:27]
    v_mfma_f32_16x16x32_bf16 a[24:27], a[48:51], a[188:191], a[24:27]
    v_mfma_f32_16x16x32_bf16 a[24:27], a[68:71], a[172:175], a[24:27]
    s_nop 3
    ds_write_b128 v135, a[20:23] offset:0
    v_mfma_f32_16x16x32_bf16 a[28:31], a[64:67], a[172:175], a[28:31]
    v_mfma_f32_16x16x32_bf16 a[28:31], a[44:47], a[188:191], a[28:31]
    v_mfma_f32_16x16x32_bf16 a[28:31], v[188:191], a[204:207], a[28:31]
    v_mfma_f32_16x16x32_bf16 a[28:31], v[208:211], a[220:223], a[28:31]
    ds_write_b128 v135, a[24:27] offset:1024
    v_mfma_f32_16x16x32_bf16 a[144:147], v[212:215], a[220:223], a[144:147]
    v_mfma_f32_16x16x32_bf16 a[144:147], v[192:195], a[204:207], a[144:147]
    v_mfma_f32_16x16x32_bf16 a[144:147], a[40:43], a[188:191], a[144:147]
    v_mfma_f32_16x16x32_bf16 a[144:147], a[60:63], a[172:175], a[144:147]
    s_nop 2
    ds_write_b128 v135, a[28:31] offset:2048
    v_mfma_f32_16x16x32_bf16 a[148:151], a[56:59], a[172:175], a[148:151]
    v_mfma_f32_16x16x32_bf16 a[148:151], a[36:39], a[188:191], a[148:151]
    v_mfma_f32_16x16x32_bf16 a[148:151], v[196:199], a[204:207], a[148:151]
    v_mfma_f32_16x16x32_bf16 a[148:151], v[216:219], a[220:223], a[148:151]
    ds_write_b128 v135, a[144:147] offset:3072
    s_waitcnt vmcnt(19)
    v_mfma_f32_16x16x32_bf16 a[16:19], a[56:59], a[168:171], a[16:19]
    s_add_u32 s41, s79, 4096
    buffer_load_dwordx4 a[172:175], off, s[80:83], s41 offset:1024 sc1
    s_waitcnt vmcnt(19)
    v_mfma_f32_16x16x32_bf16 a[16:19], a[36:39], a[184:187], a[16:19]
    s_waitcnt vmcnt(18)
    v_mfma_f32_16x16x32_bf16 a[16:19], v[196:199], a[200:203], a[16:19]
    s_add_u32 s41, s79, 8192
    buffer_load_dwordx4 a[188:191], off, s[80:83], s41 offset:0 sc1
    s_waitcnt vmcnt(18)
    v_mfma_f32_16x16x32_bf16 a[16:19], v[216:219], a[216:219], a[16:19]
    ds_write_b128 v135, a[148:151] offset:4096
    v_mfma_f32_16x16x32_bf16 a[12:15], v[212:215], a[216:219], a[12:15]
    buffer_load_dwordx4 a[204:207], off, s[80:83], s79 offset:2048 sc1
    v_mfma_f32_16x16x32_bf16 a[12:15], v[192:195], a[200:203], a[12:15]
    v_mfma_f32_16x16x32_bf16 a[12:15], a[40:43], a[184:187], a[12:15]
    buffer_load_dwordx4 a[220:223], off, s[80:83], s79 offset:3072 sc1
    v_mfma_f32_16x16x32_bf16 a[12:15], a[60:63], a[168:171], a[12:15]
    s_nop 0
    ds_write_b128 v134, a[16:19] offset:4096
    v_mfma_f32_16x16x32_bf16 a[8:11], a[64:67], a[168:171], a[8:11]
    v_mfma_f32_16x16x32_bf16 a[8:11], a[44:47], a[184:187], a[8:11]
    v_mfma_f32_16x16x32_bf16 a[8:11], v[188:191], a[200:203], a[8:11]
    v_mfma_f32_16x16x32_bf16 a[8:11], v[208:211], a[216:219], a[8:11]
    s_nop 1
    ds_write_b128 v134, a[12:15] offset:3072
    v_mfma_f32_16x16x32_bf16 a[4:7], v[204:207], a[216:219], a[4:7]
    v_mfma_f32_16x16x32_bf16 a[4:7], v[184:187], a[200:203], a[4:7]
    v_mfma_f32_16x16x32_bf16 a[4:7], a[48:51], a[184:187], a[4:7]
    v_mfma_f32_16x16x32_bf16 a[4:7], a[68:71], a[168:171], a[4:7]
    s_nop 0
    ds_write_b128 v134, a[8:11] offset:2048
    v_mfma_f32_16x16x32_bf16 a[0:3], a[72:75], a[168:171], a[0:3]
    v_mfma_f32_16x16x32_bf16 a[0:3], a[52:55], a[184:187], a[0:3]
    v_mfma_f32_16x16x32_bf16 a[0:3], a[32:35], a[200:203], a[0:3]
    v_mfma_f32_16x16x32_bf16 a[0:3], v[200:203], a[216:219], a[0:3]
    s_nop 1
    ds_write_b128 v134, a[4:7] offset:1024
    s_waitcnt vmcnt(19)
    v_mfma_f32_16x16x32_bf16 v[176:179], a[72:75], a[164:167], v[176:179]
    s_add_u32 s41, s78, 8192
    buffer_load_dwordx4 a[184:187], off, s[80:83], s41 offset:0 sc1
    s_waitcnt vmcnt(19)
    v_mfma_f32_16x16x32_bf16 v[176:179], a[52:55], a[180:183], v[176:179]
    s_waitcnt vmcnt(18)
    v_mfma_f32_16x16x32_bf16 v[176:179], a[32:35], a[196:199], v[176:179]
    s_add_u32 s41, s78, 4096
    buffer_load_dwordx4 a[168:171], off, s[80:83], s41 offset:1024 sc1
    s_waitcnt vmcnt(18)
    v_mfma_f32_16x16x32_bf16 v[176:179], v[200:203], a[212:215], v[176:179]
    ds_write_b128 v134, a[0:3] offset:0
    v_mfma_f32_16x16x32_bf16 v[180:183], v[204:207], a[212:215], v[180:183]
    buffer_load_dwordx4 a[200:203], off, s[80:83], s78 offset:2048 sc1
    v_mfma_f32_16x16x32_bf16 v[180:183], v[184:187], a[196:199], v[180:183]
    v_mfma_f32_16x16x32_bf16 v[180:183], a[48:51], a[180:183], v[180:183]
    buffer_load_dwordx4 a[216:219], off, s[80:83], s78 offset:3072 sc1
    v_mfma_f32_16x16x32_bf16 v[180:183], a[68:71], a[164:167], v[180:183]
    s_nop 0
    ds_write_b128 v133, v[176:179] offset:0
    v_mfma_f32_16x16x32_bf16 v[144:147], a[64:67], a[164:167], v[144:147]
    v_mfma_f32_16x16x32_bf16 v[144:147], a[44:47], a[180:183], v[144:147]
    v_mfma_f32_16x16x32_bf16 v[144:147], v[188:191], a[196:199], v[144:147]
    v_mfma_f32_16x16x32_bf16 v[144:147], v[208:211], a[212:215], v[144:147]
    s_nop 1
    ds_write_b128 v133, v[180:183] offset:1024
    v_mfma_f32_16x16x32_bf16 v[148:151], v[212:215], a[212:215], v[148:151]
    v_mfma_f32_16x16x32_bf16 v[148:151], v[192:195], a[196:199], v[148:151]
    v_mfma_f32_16x16x32_bf16 v[148:151], a[40:43], a[180:183], v[148:151]
    v_mfma_f32_16x16x32_bf16 v[148:151], a[60:63], a[164:167], v[148:151]
    s_nop 0
    ds_write_b128 v133, v[144:147] offset:2048
    v_mfma_f32_16x16x32_bf16 v[152:155], a[56:59], a[164:167], v[152:155]
    v_mfma_f32_16x16x32_bf16 v[152:155], a[36:39], a[180:183], v[152:155]
    v_mfma_f32_16x16x32_bf16 v[152:155], v[196:199], a[196:199], v[152:155]
    v_mfma_f32_16x16x32_bf16 v[152:155], v[216:219], a[212:215], v[152:155]
    s_nop 1
    ds_write_b128 v133, v[148:151] offset:3072
    s_waitcnt vmcnt(19)
    v_mfma_f32_16x16x32_bf16 v[172:175], a[56:59], a[160:163], v[172:175]
    s_add_u32 s41, s77, 4096
    buffer_load_dwordx4 a[164:167], off, s[80:83], s41 offset:1024 sc1
    s_waitcnt vmcnt(19)
    v_mfma_f32_16x16x32_bf16 v[172:175], a[36:39], a[176:179], v[172:175]
    s_waitcnt vmcnt(18)
    v_mfma_f32_16x16x32_bf16 v[172:175], v[196:199], a[192:195], v[172:175]
    s_add_u32 s41, s77, 8192
    buffer_load_dwordx4 a[180:183], off, s[80:83], s41 offset:0 sc1
    s_waitcnt vmcnt(18)
    v_mfma_f32_16x16x32_bf16 v[172:175], v[216:219], a[208:211], v[172:175]
    ds_write_b128 v133, v[152:155] offset:4096
    v_mfma_f32_16x16x32_bf16 v[168:171], v[212:215], a[208:211], v[168:171]
    buffer_load_dwordx4 a[196:199], off, s[80:83], s77 offset:2048 sc1
    v_mfma_f32_16x16x32_bf16 v[168:171], v[192:195], a[192:195], v[168:171]
    v_mfma_f32_16x16x32_bf16 v[168:171], a[40:43], a[176:179], v[168:171]
    buffer_load_dwordx4 a[212:215], off, s[80:83], s77 offset:3072 sc1
    v_mfma_f32_16x16x32_bf16 v[168:171], a[60:63], a[160:163], v[168:171]
    v_mfma_f32_16x16x32_bf16 v[164:167], a[64:67], a[160:163], v[164:167]
    v_mfma_f32_16x16x32_bf16 v[164:167], a[44:47], a[176:179], v[164:167]
    s_waitcnt lgkmcnt(0)
    s_barrier
    ds_read_b128 v[176:179], v132 offset:0
    ds_read_b128 v[180:183], v132 offset:1024
    v_mfma_f32_16x16x32_bf16 v[164:167], v[188:191], a[192:195], v[164:167]
    ds_read_b128 v[144:147], v132 offset:2048
    ds_read_b128 v[148:151], v132 offset:3072
    ds_read_b128 v[152:155], v132 offset:4096
    v_mfma_f32_16x16x32_bf16 v[164:167], v[208:211], a[208:211], v[164:167]
    v_mfma_f32_16x16x32_bf16 v[160:163], v[204:207], a[208:211], v[160:163]
    v_mfma_f32_16x16x32_bf16 v[160:163], v[184:187], a[192:195], v[160:163]
    v_mfma_f32_16x16x32_bf16 v[160:163], a[48:51], a[176:179], v[160:163]
    v_mfma_f32_16x16x32_bf16 v[160:163], a[68:71], a[160:163], v[160:163]
    v_mfma_f32_16x16x32_bf16 v[156:159], a[72:75], a[160:163], v[156:159]
    v_mfma_f32_16x16x32_bf16 v[156:159], a[52:55], a[176:179], v[156:159]
    v_mfma_f32_16x16x32_bf16 v[156:159], a[32:35], a[192:195], v[156:159]
    v_mfma_f32_16x16x32_bf16 v[156:159], v[200:203], a[208:211], v[156:159]
    s_waitcnt vmcnt(19)
    v_mfma_f32_16x16x32_bf16 v[100:103], v[28:31], a[236:239], v[100:103]
    s_add_u32 s41, s76, 8192
    buffer_load_dwordx4 a[176:179], off, s[80:83], s41 offset:0 sc1
    s_waitcnt vmcnt(18)
    v_mfma_f32_16x16x32_bf16 v[100:103], a[132:135], a[252:255], v[100:103]
    v_mfma_f32_16x16x32_bf16 v[104:107], a[128:131], a[252:255], v[104:107]
    s_add_u32 s41, s76, 4096
    buffer_load_dwordx4 a[160:163], off, s[80:83], s41 offset:1024 sc1
    v_mfma_f32_16x16x32_bf16 v[104:107], v[24:27], a[236:239], v[104:107]
    s_waitcnt lgkmcnt(4)
    v_add_f32 v156, v156, v176
    v_add_f32 v157, v157, v177
    v_add_f32 v158, v158, v178
    v_mfma_f32_16x16x32_bf16 v[108:111], v[20:23], a[236:239], v[108:111]
    buffer_load_dwordx4 a[192:195], off, s[80:83], s76 offset:2048 sc1
    v_add_f32 v159, v159, v179
    s_waitcnt lgkmcnt(3)
    v_mfma_f32_16x16x32_bf16 v[108:111], a[124:127], a[252:255], v[108:111]
    v_add_f32 v160, v160, v180
    v_add_f32 v161, v161, v181
    v_add_f32 v162, v162, v182
    v_mfma_f32_16x16x32_bf16 v[112:115], a[120:123], a[252:255], v[112:115]
    buffer_load_dwordx4 a[208:211], off, s[80:83], s76 offset:3072 sc1
    v_add_f32 v163, v163, v183
    s_waitcnt lgkmcnt(2)
    v_mfma_f32_16x16x32_bf16 v[112:115], a[140:143], a[236:239], v[112:115]
    v_add_f32 v164, v164, v144
    v_add_f32 v165, v165, v145
    v_add_f32 v166, v166, v146
    v_mfma_f32_16x16x32_bf16 v[116:119], a[136:139], a[236:239], v[116:119]
    v_add_f32 v167, v167, v147
    s_waitcnt lgkmcnt(1)
    v_add_f32 v168, v168, v148
    v_mfma_f32_16x16x32_bf16 v[116:119], a[116:119], a[252:255], v[116:119]
    v_add_f32 v169, v169, v149
    v_add_f32 v170, v170, v150
    v_mfma_f32_16x16x32_bf16 v[96:99], a[136:139], a[232:235], v[96:99]
    s_add_u32 s41, s79, 4096
    buffer_load_dwordx4 a[236:239], off, s[80:83], s41 offset:2048 sc1
    v_add_f32 v171, v171, v151
    s_waitcnt vmcnt(20)
    v_mfma_f32_16x16x32_bf16 v[96:99], a[116:119], a[248:251], v[96:99]
    s_waitcnt lgkmcnt(0)
    v_add_f32 v172, v172, v152
    v_add_f32 v173, v173, v153
    v_mfma_f32_16x16x32_bf16 v[92:95], a[120:123], a[248:251], v[92:95]
    s_add_u32 s41, s79, 4096
    buffer_load_dwordx4 a[252:255], off, s[80:83], s41 offset:3072 sc1
    v_add_f32 v174, v174, v154
    v_mfma_f32_16x16x32_bf16 v[92:95], a[140:143], a[232:235], v[92:95]
    v_add_f32 v175, v175, v155
    ds_read_b128 v[176:179], v132 offset:5120
    v_mfma_f32_16x16x32_bf16 v[88:91], v[20:23], a[232:235], v[88:91]
    ds_read_b128 v[180:183], v132 offset:6144
    ds_read_b128 v[144:147], v132 offset:7168
    ds_read_b128 v[148:151], v132 offset:8192
    v_mfma_f32_16x16x32_bf16 v[88:91], a[124:127], a[248:251], v[88:91]
    ds_read_b128 v[152:155], v132 offset:9216
    v_mfma_f32_16x16x32_bf16 v[84:87], a[128:131], a[248:251], v[84:87]
    v_mfma_f32_16x16x32_bf16 v[84:87], v[24:27], a[232:235], v[84:87]
    v_mfma_f32_16x16x32_bf16 v[80:83], v[28:31], a[232:235], v[80:83]
    v_mfma_f32_16x16x32_bf16 v[80:83], a[132:135], a[248:251], v[80:83]
    s_waitcnt lgkmcnt(4)
    v_add_f32 v156, v156, v176
    v_add_f32 v157, v157, v177
    v_mfma_f32_16x16x32_bf16 v[60:63], v[28:31], a[228:231], v[60:63]
    s_add_u32 s41, s78, 4096
    buffer_load_dwordx4 a[232:235], off, s[80:83], s41 offset:2048 sc1
    v_add_f32 v158, v158, v178
    s_waitcnt vmcnt(20)
    v_mfma_f32_16x16x32_bf16 v[60:63], a[132:135], a[244:247], v[60:63]
    v_add_f32 v159, v159, v179
    s_waitcnt lgkmcnt(3)
    v_add_f32 v160, v160, v180
    v_mfma_f32_16x16x32_bf16 v[64:67], a[128:131], a[244:247], v[64:67]
    s_add_u32 s41, s78, 4096
    buffer_load_dwordx4 a[248:251], off, s[80:83], s41 offset:3072 sc1
    v_add_f32 v161, v161, v181
    v_mfma_f32_16x16x32_bf16 v[64:67], v[24:27], a[228:231], v[64:67]
    v_add_f32 v162, v162, v182
    v_add_f32 v163, v163, v183
    s_waitcnt lgkmcnt(2)
    v_mfma_f32_16x16x32_bf16 v[68:71], v[20:23], a[228:231], v[68:71]
    v_add_f32 v164, v164, v144
    v_add_f32 v165, v165, v145
    v_add_f32 v166, v166, v146
    v_mfma_f32_16x16x32_bf16 v[68:71], a[124:127], a[244:247], v[68:71]
    v_add_f32 v167, v167, v147
    s_waitcnt lgkmcnt(1)
    v_add_f32 v168, v168, v148
    v_mfma_f32_16x16x32_bf16 v[72:75], a[120:123], a[244:247], v[72:75]
    v_add_f32 v169, v169, v149
    v_add_f32 v170, v170, v150
    v_add_f32 v171, v171, v151
    v_mfma_f32_16x16x32_bf16 v[72:75], a[140:143], a[228:231], v[72:75]
    s_waitcnt lgkmcnt(0)
    v_add_f32 v172, v172, v152
    v_add_f32 v173, v173, v153
    v_mfma_f32_16x16x32_bf16 v[76:79], a[136:139], a[228:231], v[76:79]
    v_add_f32 v174, v174, v154
    v_add_f32 v175, v175, v155
    ds_read_b128 v[176:179], v132 offset:10240
    v_mfma_f32_16x16x32_bf16 v[76:79], a[116:119], a[244:247], v[76:79]
    ds_read_b128 v[180:183], v132 offset:11264
    v_mfma_f32_16x16x32_bf16 v[56:59], a[136:139], a[224:227], v[56:59]
    s_add_u32 s41, s77, 4096
    buffer_load_dwordx4 a[228:231], off, s[80:83], s41 offset:2048 sc1
    ds_read_b128 v[144:147], v132 offset:12288
    s_waitcnt vmcnt(21)
    v_mfma_f32_16x16x32_bf16 v[56:59], a[116:119], a[240:243], v[56:59]
    ds_read_b128 v[148:151], v132 offset:13312
    ds_read_b128 v[152:155], v132 offset:14336
    v_mfma_f32_16x16x32_bf16 v[52:55], a[120:123], a[240:243], v[52:55]
    s_add_u32 s41, s77, 4096
    buffer_load_dwordx4 a[244:247], off, s[80:83], s41 offset:3072 sc1
    v_mfma_f32_16x16x32_bf16 v[52:55], a[140:143], a[224:227], v[52:55]
    v_mfma_f32_16x16x32_bf16 v[48:51], v[20:23], a[224:227], v[48:51]
    v_mfma_f32_16x16x32_bf16 v[48:51], a[124:127], a[240:243], v[48:51]
    s_waitcnt lgkmcnt(4)
    v_add_f32 v156, v156, v176
    v_add_f32 v157, v157, v177
    v_add_f32 v158, v158, v178
    v_mfma_f32_16x16x32_bf16 v[44:47], a[128:131], a[240:243], v[44:47]
    v_add_f32 v159, v159, v179
    v_and_or_b32 v156, v156, -4, s61
    v_and_or_b32 v157, v157, -4, s61
    v_mfma_f32_16x16x32_bf16 v[44:47], v[24:27], a[224:227], v[44:47]
    v_and_or_b32 v158, v158, -4, s61
    v_and_or_b32 v159, v159, -4, s61
    buffer_store_dwordx4 v[156:159], v1, s[12:15], s56 offen offset:0 sc1
    v_mfma_f32_16x16x32_bf16 v[40:43], v[28:31], a[224:227], v[40:43]
    s_waitcnt lgkmcnt(3)
    v_add_f32 v160, v160, v180
    v_add_f32 v161, v161, v181
    v_mfma_f32_16x16x32_bf16 v[40:43], a[132:135], a[240:243], v[40:43]
    v_add_f32 v162, v162, v182
    v_add_f32 v163, v163, v183
    s_waitcnt vmcnt(22)
    v_mfma_f32_16x16x32_bf16 v[100:103], a[112:115], a[172:175], v[100:103]
    s_add_u32 s41, s76, 4096
    buffer_load_dwordx4 a[224:227], off, s[80:83], s41 offset:2048 sc1
    v_and_or_b32 v160, v160, -4, s61
    s_waitcnt vmcnt(19)
    v_mfma_f32_16x16x32_bf16 v[100:103], a[92:95], a[186:189], v[100:103]
    v_and_or_b32 v161, v161, -4, s61
    v_and_or_b32 v162, v162, -4, s61
    v_and_or_b32 v163, v163, -4, s61
    v_mfma_f32_16x16x32_bf16 v[104:107], a[88:91], a[186:189], v[104:107]
    s_add_u32 s41, s76, 4096
    buffer_load_dwordx4 a[240:243], off, s[80:83], s41 offset:3072 sc1
    buffer_store_dwordx4 v[160:163], v1, s[12:15], s56 offen offset:1024 sc1
    v_mfma_f32_16x16x32_bf16 v[104:107], a[108:111], a[172:175], v[104:107]
    s_waitcnt lgkmcnt(2)
    v_add_f32 v164, v164, v144
    v_add_f32 v165, v165, v145
    v_mfma_f32_16x16x32_bf16 v[108:111], a[104:107], a[172:175], v[108:111]
    v_add_f32 v166, v166, v146
    v_add_f32 v167, v167, v147
    v_and_or_b32 v164, v164, -4, s61
    v_mfma_f32_16x16x32_bf16 v[108:111], a[84:87], a[186:189], v[108:111]
    v_and_or_b32 v165, v165, -4, s61
    v_and_or_b32 v166, v166, -4, s61
    v_mfma_f32_16x16x32_bf16 v[112:115], a[80:83], a[186:189], v[112:115]
    v_and_or_b32 v167, v167, -4, s61
    buffer_store_dwordx4 v[164:167], v1, s[12:15], s56 offen offset:2048 sc1
    s_waitcnt lgkmcnt(1)
    v_mfma_f32_16x16x32_bf16 v[112:115], a[100:103], a[172:175], v[112:115]
    v_add_f32 v168, v168, v148
    v_add_f32 v169, v169, v149
    v_add_f32 v170, v170, v150
    v_mfma_f32_16x16x32_bf16 v[116:119], a[96:99], a[172:175], v[116:119]
    v_add_f32 v171, v171, v151
    v_and_or_b32 v168, v168, -4, s61
    v_and_or_b32 v169, v169, -4, s61
    v_mfma_f32_16x16x32_bf16 v[116:119], a[76:79], a[186:189], v[116:119]
    v_and_or_b32 v170, v170, -4, s61
    v_and_or_b32 v171, v171, -4, s61
    v_accvgpr_mov_b32 a186, a190
    v_accvgpr_mov_b32 a187, a191
    s_waitcnt vmcnt(21)
    v_mfma_f32_16x16x32_bf16 v[96:99], a[96:99], a[168:171], v[96:99]
    buffer_store_dwordx4 v[168:171], v1, s[12:15], s56 offen offset:3072 sc1
    s_waitcnt lgkmcnt(0)
    v_add_f32 v172, v172, v152
    v_mfma_f32_16x16x32_bf16 v[96:99], a[76:79], a[184:187], v[96:99]
    v_add_f32 v173, v173, v153
    v_add_f32 v174, v174, v154
    v_add_f32 v175, v175, v155
    v_mfma_f32_16x16x32_bf16 v[92:95], a[80:83], a[184:187], v[92:95]
    v_and_or_b32 v172, v172, -4, s61
    v_and_or_b32 v173, v173, -4, s61
    v_and_or_b32 v174, v174, -4, s61
    v_mfma_f32_16x16x32_bf16 v[92:95], a[100:103], a[168:171], v[92:95]
    v_and_or_b32 v175, v175, -4, s61
    buffer_store_dwordx4 v[172:175], v1, s[12:15], s57 offen offset:0 sc1
    v_add_u32 v132, 61440, v132
    v_mfma_f32_16x16x32_bf16 v[88:91], a[104:107], a[168:171], v[88:91]
    v_add_u32 v133, 61440, v133
    v_add_u32 v134, 61440, v134
    v_add_u32 v135, 61440, v135
    v_mfma_f32_16x16x32_bf16 v[88:91], a[84:87], a[184:187], v[88:91]
    v_mfma_f32_16x16x32_bf16 v[84:87], a[88:91], a[184:187], v[84:87]
    v_mfma_f32_16x16x32_bf16 v[84:87], a[108:111], a[168:171], v[84:87]
    v_mfma_f32_16x16x32_bf16 v[80:83], a[112:115], a[168:171], v[80:83]
    v_mfma_f32_16x16x32_bf16 v[80:83], a[92:95], a[184:187], v[80:83]
    s_waitcnt vmcnt(20)
    v_mfma_f32_16x16x32_bf16 v[60:63], a[112:115], a[164:167], v[60:63]
    s_waitcnt vmcnt(16)
    v_mfma_f32_16x16x32_bf16 v[60:63], a[92:95], a[178:181], v[60:63]
    v_mfma_f32_16x16x32_bf16 v[64:67], a[88:91], a[178:181], v[64:67]
    v_mfma_f32_16x16x32_bf16 v[64:67], a[108:111], a[164:167], v[64:67]
    v_mfma_f32_16x16x32_bf16 v[68:71], a[104:107], a[164:167], v[68:71]
    v_mfma_f32_16x16x32_bf16 v[68:71], a[84:87], a[178:181], v[68:71]
    v_mfma_f32_16x16x32_bf16 v[72:75], a[80:83], a[178:181], v[72:75]
    v_mfma_f32_16x16x32_bf16 v[72:75], a[100:103], a[164:167], v[72:75]
    v_mfma_f32_16x16x32_bf16 v[76:79], a[96:99], a[164:167], v[76:79]
    v_mfma_f32_16x16x32_bf16 v[76:79], a[76:79], a[178:181], v[76:79]
    v_accvgpr_mov_b32 a178, a182
    v_accvgpr_mov_b32 a179, a183
    s_waitcnt vmcnt(15)
    v_mfma_f32_16x16x32_bf16 v[56:59], a[96:99], a[160:163], v[56:59]
    v_mfma_f32_16x16x32_bf16 v[56:59], a[76:79], a[176:179], v[56:59]
    v_mfma_f32_16x16x32_bf16 v[52:55], a[80:83], a[176:179], v[52:55]
    v_mfma_f32_16x16x32_bf16 v[52:55], a[100:103], a[160:163], v[52:55]
    v_mfma_f32_16x16x32_bf16 v[48:51], a[104:107], a[160:163], v[48:51]
    v_mfma_f32_16x16x32_bf16 v[48:51], a[84:87], a[176:179], v[48:51]
    v_mfma_f32_16x16x32_bf16 v[44:47], a[88:91], a[176:179], v[44:47]
    v_mfma_f32_16x16x32_bf16 v[44:47], a[108:111], a[160:163], v[44:47]
    v_mfma_f32_16x16x32_bf16 v[40:43], a[112:115], a[160:163], v[40:43]
    v_mfma_f32_16x16x32_bf16 v[40:43], a[92:95], a[176:179], v[40:43]
    v_mfma_f32_16x16x32_bf16 v[100:103], a[72:75], a[204:207], v[100:103]
    v_mfma_f32_16x16x32_bf16 v[100:103], a[52:55], a[220:223], v[100:103]
    s_waitcnt vmcnt(12)
    v_mfma_f32_16x16x32_bf16 v[100:103], a[32:35], a[236:239], v[100:103]
    s_waitcnt vmcnt(11)
    v_mfma_f32_16x16x32_bf16 v[100:103], v[200:203], a[252:255], v[100:103]
    v_mfma_f32_16x16x32_bf16 v[104:107], v[204:207], a[252:255], v[104:107]
    v_mfma_f32_16x16x32_bf16 v[104:107], v[184:187], a[236:239], v[104:107]
    v_mfma_f32_16x16x32_bf16 v[104:107], a[48:51], a[220:223], v[104:107]
    v_mfma_f32_16x16x32_bf16 v[104:107], a[68:71], a[204:207], v[104:107]
    s_nop 3
    ds_write_b128 v135, v[100:103] offset:0
    v_mfma_f32_16x16x32_bf16 v[108:111], a[64:67], a[204:207], v[108:111]
    v_mfma_f32_16x16x32_bf16 v[108:111], a[44:47], a[220:223], v[108:111]
    v_mfma_f32_16x16x32_bf16 v[108:111], v[188:191], a[236:239], v[108:111]
    v_mfma_f32_16x16x32_bf16 v[108:111], v[208:211], a[252:255], v[108:111]
    ds_write_b128 v135, v[104:107] offset:1024
    v_mfma_f32_16x16x32_bf16 v[112:115], v[212:215], a[252:255], v[112:115]
    v_mfma_f32_16x16x32_bf16 v[112:115], v[192:195], a[236:239], v[112:115]
    v_mfma_f32_16x16x32_bf16 v[112:115], a[40:43], a[220:223], v[112:115]
    v_mfma_f32_16x16x32_bf16 v[112:115], a[60:63], a[204:207], v[112:115]
    s_nop 2
    ds_write_b128 v135, v[108:111] offset:2048
    v_mfma_f32_16x16x32_bf16 v[116:119], a[56:59], a[204:207], v[116:119]
    v_mfma_f32_16x16x32_bf16 v[116:119], a[36:39], a[220:223], v[116:119]
    v_mfma_f32_16x16x32_bf16 v[116:119], v[196:199], a[236:239], v[116:119]
    v_mfma_f32_16x16x32_bf16 v[116:119], v[216:219], a[252:255], v[116:119]
    ds_write_b128 v135, v[112:115] offset:3072
    v_mfma_f32_16x16x32_bf16 v[96:99], a[56:59], a[200:203], v[96:99]
    v_mfma_f32_16x16x32_bf16 v[96:99], a[36:39], a[216:219], v[96:99]
    s_waitcnt vmcnt(10)
    v_mfma_f32_16x16x32_bf16 v[96:99], v[196:199], a[232:235], v[96:99]
    s_waitcnt vmcnt(9)
    v_mfma_f32_16x16x32_bf16 v[96:99], v[216:219], a[248:251], v[96:99]
    s_nop 0
    ds_write_b128 v135, v[116:119] offset:4096
    v_mfma_f32_16x16x32_bf16 v[92:95], v[212:215], a[248:251], v[92:95]
    v_mfma_f32_16x16x32_bf16 v[92:95], v[192:195], a[232:235], v[92:95]
    v_mfma_f32_16x16x32_bf16 v[92:95], a[40:43], a[216:219], v[92:95]
    v_mfma_f32_16x16x32_bf16 v[92:95], a[60:63], a[200:203], v[92:95]
    s_nop 1
    ds_write_b128 v134, v[96:99] offset:4096
    v_mfma_f32_16x16x32_bf16 v[88:91], a[64:67], a[200:203], v[88:91]
    v_mfma_f32_16x16x32_bf16 v[88:91], a[44:47], a[216:219], v[88:91]
    v_mfma_f32_16x16x32_bf16 v[88:91], v[188:191], a[232:235], v[88:91]
    v_mfma_f32_16x16x32_bf16 v[88:91], v[208:211], a[248:251], v[88:91]
    s_nop 0
    ds_write_b128 v134, v[92:95] offset:3072
    v_mfma_f32_16x16x32_bf16 v[84:87], v[204:207], a[248:251], v[84:87]
    v_mfma_f32_16x16x32_bf16 v[84:87], v[184:187], a[232:235], v[84:87]
    v_mfma_f32_16x16x32_bf16 v[84:87], a[48:51], a[216:219], v[84:87]
    v_mfma_f32_16x16x32_bf16 v[84:87], a[68:71], a[200:203], v[84:87]
    s_nop 1
    ds_write_b128 v134, v[88:91] offset:2048
    v_mfma_f32_16x16x32_bf16 v[80:83], a[72:75], a[200:203], v[80:83]
    v_mfma_f32_16x16x32_bf16 v[80:83], a[52:55], a[216:219], v[80:83]
    v_mfma_f32_16x16x32_bf16 v[80:83], a[32:35], a[232:235], v[80:83]
    v_mfma_f32_16x16x32_bf16 v[80:83], v[200:203], a[248:251], v[80:83]
    s_nop 0
    ds_write_b128 v134, v[84:87] offset:1024
    v_mfma_f32_16x16x32_bf16 v[60:63], a[72:75], a[196:199], v[60:63]
    v_mfma_f32_16x16x32_bf16 v[60:63], a[52:55], a[212:215], v[60:63]
    s_waitcnt vmcnt(8)
    v_mfma_f32_16x16x32_bf16 v[60:63], a[32:35], a[228:231], v[60:63]
    s_waitcnt vmcnt(7)
    v_mfma_f32_16x16x32_bf16 v[60:63], v[200:203], a[244:247], v[60:63]
    ds_write_b128 v134, v[80:83] offset:0
    v_mfma_f32_16x16x32_bf16 v[64:67], v[204:207], a[244:247], v[64:67]
    v_mfma_f32_16x16x32_bf16 v[64:67], v[184:187], a[228:231], v[64:67]
    v_mfma_f32_16x16x32_bf16 v[64:67], a[48:51], a[212:215], v[64:67]
    v_mfma_f32_16x16x32_bf16 v[64:67], a[68:71], a[196:199], v[64:67]
    s_nop 2
    ds_write_b128 v133, v[60:63] offset:0
    v_mfma_f32_16x16x32_bf16 v[68:71], a[64:67], a[196:199], v[68:71]
    v_mfma_f32_16x16x32_bf16 v[68:71], a[44:47], a[212:215], v[68:71]
    buffer_load_dwordx4 v[176:179], v1, s[12:15], s58 offen offset:0 sc1
    buffer_load_dwordx4 v[180:183], v1, s[12:15], s58 offen offset:1024 sc1
    buffer_load_dwordx4 v[144:147], v1, s[12:15], s58 offen offset:2048 sc1
    buffer_load_dwordx4 v[148:151], v1, s[12:15], s58 offen offset:3072 sc1
    v_mfma_f32_16x16x32_bf16 v[68:71], v[188:191], a[228:231], v[68:71]
    buffer_load_dwordx4 v[152:155], v1, s[12:15], s59 offen offset:0 sc1
    v_mfma_f32_16x16x32_bf16 v[68:71], v[208:211], a[244:247], v[68:71]
    ds_write_b128 v133, v[64:67] offset:1024
    v_mfma_f32_16x16x32_bf16 v[72:75], v[212:215], a[244:247], v[72:75]
    v_mfma_f32_16x16x32_bf16 v[72:75], v[192:195], a[228:231], v[72:75]
    v_mfma_f32_16x16x32_bf16 v[72:75], a[40:43], a[212:215], v[72:75]
    v_mfma_f32_16x16x32_bf16 v[72:75], a[60:63], a[196:199], v[72:75]
    s_nop 2
    ds_write_b128 v133, v[68:71] offset:2048
    v_mfma_f32_16x16x32_bf16 v[76:79], a[56:59], a[196:199], v[76:79]
    v_mfma_f32_16x16x32_bf16 v[76:79], a[36:39], a[212:215], v[76:79]
    v_mfma_f32_16x16x32_bf16 v[76:79], v[196:199], a[228:231], v[76:79]
    v_mfma_f32_16x16x32_bf16 v[76:79], v[216:219], a[244:247], v[76:79]
    ds_write_b128 v133, v[72:75] offset:3072
    v_mfma_f32_16x16x32_bf16 v[56:59], a[56:59], a[192:195], v[56:59]
    v_mfma_f32_16x16x32_bf16 v[56:59], a[36:39], a[208:211], v[56:59]
    s_waitcnt vmcnt(10)
    v_mfma_f32_16x16x32_bf16 v[56:59], v[196:199], a[224:227], v[56:59]
    s_waitcnt vmcnt(9)
    v_mfma_f32_16x16x32_bf16 v[56:59], v[216:219], a[240:243], v[56:59]
    s_nop 0
    ds_write_b128 v133, v[76:79] offset:4096
    v_mfma_f32_16x16x32_bf16 v[52:55], v[212:215], a[240:243], v[52:55]
    v_mfma_f32_16x16x32_bf16 v[52:55], v[192:195], a[224:227], v[52:55]
    v_mfma_f32_16x16x32_bf16 v[52:55], a[40:43], a[208:211], v[52:55]
    v_mfma_f32_16x16x32_bf16 v[52:55], a[60:63], a[192:195], v[52:55]
    v_mfma_f32_16x16x32_bf16 v[48:51], a[64:67], a[192:195], v[48:51]
    v_mfma_f32_16x16x32_bf16 v[48:51], a[44:47], a[208:211], v[48:51]
    s_waitcnt lgkmcnt(0)
    s_barrier
    ds_read_b128 v[60:63], v132 offset:0
    ds_read_b128 v[64:67], v132 offset:1024
    v_mfma_f32_16x16x32_bf16 v[48:51], v[188:191], a[224:227], v[48:51]
    ds_read_b128 v[68:71], v132 offset:2048
    ds_read_b128 v[72:75], v132 offset:3072
    ds_read_b128 v[76:79], v132 offset:4096
    v_mfma_f32_16x16x32_bf16 v[48:51], v[208:211], a[240:243], v[48:51]
    ds_read_b128 v[80:83], v132 offset:5120
    ds_read_b128 v[84:87], v132 offset:6144
    ds_read_b128 v[88:91], v132 offset:7168
    v_mfma_f32_16x16x32_bf16 v[44:47], v[204:207], a[240:243], v[44:47]
    ds_read_b128 v[92:95], v132 offset:8192
    ds_read_b128 v[96:99], v132 offset:9216
    ds_read_b128 v[100:103], v132 offset:10240
    v_mfma_f32_16x16x32_bf16 v[44:47], v[184:187], a[224:227], v[44:47]
    ds_read_b128 v[104:107], v132 offset:11264
    ds_read_b128 v[108:111], v132 offset:12288
    ds_read_b128 v[112:115], v132 offset:13312
    v_mfma_f32_16x16x32_bf16 v[44:47], a[48:51], a[208:211], v[44:47]
    ds_read_b128 v[116:119], v132 offset:14336
    v_mfma_f32_16x16x32_bf16 v[44:47], a[68:71], a[192:195], v[44:47]
    v_mfma_f32_16x16x32_bf16 v[40:43], a[72:75], a[192:195], v[40:43]
    v_mfma_f32_16x16x32_bf16 v[40:43], a[52:55], a[208:211], v[40:43]
    v_mfma_f32_16x16x32_bf16 v[40:43], a[32:35], a[224:227], v[40:43]
    v_mfma_f32_16x16x32_bf16 v[40:43], v[200:203], a[240:243], v[40:43]
    s_waitcnt vmcnt(0)
    v_and_b32 v137, s61, v176
    v_bitop3_b32 v137, v137, v177, v178 bitop3:0x80
    v_bitop3_b32 v137, v137, v179, v180 bitop3:0x80
    v_bitop3_b32 v137, v137, v181, v182 bitop3:0x80
    v_bitop3_b32 v137, v137, v183, v144 bitop3:0x80
    v_bitop3_b32 v137, v137, v145, v146 bitop3:0x80
    v_bitop3_b32 v137, v137, v147, v148 bitop3:0x80
    v_bitop3_b32 v137, v137, v149, v150 bitop3:0x80
    v_bitop3_b32 v137, v137, v151, v152 bitop3:0x80
    v_bitop3_b32 v137, v137, v153, v154 bitop3:0x80
    v_bitop3_b32 v137, v137, v155, v176 bitop3:0x80
    v_cmp_eq_u32 vcc, 0, v137
    s_nop 3
    s_cbranch_vccz L_interleave_layers__spectral_fnet__mixer_gmlp__prompt_kernel_46
    s_mov_b32 s40, 0
L_interleave_layers__spectral_fnet__mixer_gmlp__prompt_kernel_48:
    buffer_load_dwordx4 v[176:179], v1, s[12:15], s58 offen offset:0 sc1
    buffer_load_dwordx4 v[180:183], v1, s[12:15], s58 offen offset:1024 sc1
    buffer_load_dwordx4 v[144:147], v1, s[12:15], s58 offen offset:2048 sc1
    buffer_load_dwordx4 v[148:151], v1, s[12:15], s58 offen offset:3072 sc1
    buffer_load_dwordx4 v[152:155], v1, s[12:15], s59 offen offset:0 sc1
    s_add_u32 s40, s40, 1
    s_cmp_gt_u32 s40, 2000000
    s_cbranch_scc1 L_interleave_layers__spectral_fnet__mixer_gmlp__prompt_kernel_47
    s_waitcnt vmcnt(0)
    v_and_b32 v137, s61, v176
    v_bitop3_b32 v137, v137, v177, v178 bitop3:0x80
    v_bitop3_b32 v137, v137, v179, v180 bitop3:0x80
    v_bitop3_b32 v137, v137, v181, v182 bitop3:0x80
    v_bitop3_b32 v137, v137, v183, v144 bitop3:0x80
    v_bitop3_b32 v137, v137, v145, v146 bitop3:0x80
    v_bitop3_b32 v137, v137, v147, v148 bitop3:0x80
    v_bitop3_b32 v137, v137, v149, v150 bitop3:0x80
    v_bitop3_b32 v137, v137, v151, v152 bitop3:0x80
    v_bitop3_b32 v137, v137, v153, v154 bitop3:0x80
    v_bitop3_b32 v137, v137, v155, v176 bitop3:0x80
    v_cmp_eq_u32 vcc, 0, v137
    s_nop 3
    s_cbranch_vccnz L_interleave_layers__spectral_fnet__mixer_gmlp__prompt_kernel_48
    s_mov_b64 exec, -1
L_interleave_layers__spectral_fnet__mixer_gmlp__prompt_kernel_46:
    v_pk_add_f32 v[40:41], v[40:41], v[176:177]
    v_pk_add_f32 v[42:43], v[42:43], v[178:179]
    v_pk_add_f32 v[44:45], v[44:45], v[180:181]
    v_pk_add_f32 v[46:47], v[46:47], v[182:183]
    v_pk_add_f32 v[48:49], v[48:49], v[144:145]
    v_pk_add_f32 v[50:51], v[50:51], v[146:147]
    v_pk_add_f32 v[52:53], v[52:53], v[148:149]
    v_pk_add_f32 v[54:55], v[54:55], v[150:151]
    v_pk_add_f32 v[56:57], v[56:57], v[152:153]
    v_pk_add_f32 v[58:59], v[58:59], v[154:155]
    s_waitcnt lgkmcnt(10)
    v_pk_add_f32 v[40:41], v[40:41], v[60:61]
    v_pk_add_f32 v[42:43], v[42:43], v[62:63]
    v_pk_add_f32 v[44:45], v[44:45], v[64:65]
    v_pk_add_f32 v[46:47], v[46:47], v[66:67]
    v_pk_add_f32 v[48:49], v[48:49], v[68:69]
    v_pk_add_f32 v[50:51], v[50:51], v[70:71]
    v_pk_add_f32 v[52:53], v[52:53], v[72:73]
    v_pk_add_f32 v[54:55], v[54:55], v[74:75]
    v_pk_add_f32 v[56:57], v[56:57], v[76:77]
    v_pk_add_f32 v[58:59], v[58:59], v[78:79]
    s_waitcnt lgkmcnt(5)
    v_pk_add_f32 v[40:41], v[40:41], v[80:81]
    v_pk_add_f32 v[42:43], v[42:43], v[82:83]
    v_pk_add_f32 v[44:45], v[44:45], v[84:85]
    v_pk_add_f32 v[46:47], v[46:47], v[86:87]
    v_pk_add_f32 v[48:49], v[48:49], v[88:89]
    v_pk_add_f32 v[50:51], v[50:51], v[90:91]
    v_pk_add_f32 v[52:53], v[52:53], v[92:93]
    v_pk_add_f32 v[54:55], v[54:55], v[94:95]
    v_pk_add_f32 v[56:57], v[56:57], v[96:97]
    v_pk_add_f32 v[58:59], v[58:59], v[98:99]
    s_waitcnt lgkmcnt(0)
    v_pk_add_f32 v[40:41], v[40:41], v[100:101]
    v_pk_add_f32 v[42:43], v[42:43], v[102:103]
    v_pk_add_f32 v[44:45], v[44:45], v[104:105]
    v_pk_add_f32 v[46:47], v[46:47], v[106:107]
    v_pk_add_f32 v[48:49], v[48:49], v[108:109]
    v_pk_add_f32 v[50:51], v[50:51], v[110:111]
    v_pk_add_f32 v[52:53], v[52:53], v[112:113]
    v_pk_add_f32 v[54:55], v[54:55], v[114:115]
    v_pk_add_f32 v[56:57], v[56:57], v[116:117]
    v_pk_add_f32 v[58:59], v[58:59], v[118:119]
    s_nop 2
L_interleave_layers__spectral_fnet__mixer_gmlp__prompt_kernel_34:
    s_cmp_eq_u32 s30, 0
    s_cbranch_scc1 L_interleave_layers__spectral_fnet__mixer_gmlp__prompt_kernel_49
    v_cvt_pk_bf16_f32 v64, v40, v41
    v_cvt_pk_bf16_f32 v65, v42, v43
    ds_write_b64 v120, v[64:65]
    v_cvt_pk_bf16_f32 v66, v48, v49
    v_cvt_pk_bf16_f32 v67, v50, v51
    ds_write_b64 v120, v[66:67] offset:32
    ds_read_b128 v[76:79], v123
    v_cvt_pk_bf16_f32 v68, v55, v54
    v_cvt_pk_bf16_f32 v69, v53, v52
    ds_write_b64 v121, v[68:69] offset:64
    v_cvt_pk_bf16_f32 v70, v47, v46
    v_cvt_pk_bf16_f32 v71, v45, v44
    ds_write_b64 v121, v[70:71] offset:96
    ds_read_b128 v[80:83], v123 offset:64
    v_cvt_pk_bf16_f32 v72, v56, v57
    v_cvt_pk_bf16_f32 v73, v58, v59
    v_cvt_pk_bf16_f32 v74, v59, v58
    v_cvt_pk_bf16_f32 v75, v57, v56
    v_cndmask_b32 v72, v72, v74, s[52:53]
    v_cndmask_b32 v73, v73, v75, s[52:53]
    ds_write_b64 v122, v[72:73] offset:128
    ds_read_b64 v[84:85], v124 offset:128
    s_waitcnt lgkmcnt(5)
    buffer_store_dwordx4 v[76:79], v140, s[16:19], s46 offen
    s_cmp_eq_u32 s7, 0
    s_cbranch_scc1 L_interleave_layers__spectral_fnet__mixer_gmlp__prompt_kernel_50
    s_waitcnt lgkmcnt(2)
    buffer_store_dwordx4 v[80:83], v140, s[16:19], s47 offen offset:578
    s_waitcnt lgkmcnt(0)
    buffer_store_dwordx2 v[84:85], v142, s[16:19], s49 offen
    s_endpgm
L_interleave_layers__spectral_fnet__mixer_gmlp__prompt_kernel_50:
    v_cmp_eq_u32 vcc, 48, v125
    v_add_u32 v62, 592, v140
    v_add_u32 v63, 64, v143
    v_cndmask_b32 v63, v62, v63, vcc
    s_waitcnt lgkmcnt(0)
    buffer_store_dwordx3 v[80:82], v140, s[16:19], s47 offen offset:578
    buffer_store_short v83, v140, s[16:19], s47 offen offset:590
    buffer_store_short_d16_hi v83, v63, s[16:19], s47 offen
    buffer_store_dwordx2 v[84:85], v142, s[16:19], s49 offen
    s_endpgm
L_interleave_layers__spectral_fnet__mixer_gmlp__prompt_kernel_49:
    v_pk_mul_f32 v[62:63], v[40:41], v[40:41]
    v_pk_add_f32 v[60:61], v[40:41], v[42:43]
    v_pk_fma_f32 v[62:63], v[42:43], v[42:43], v[62:63]
    v_pk_add_f32 v[60:61], v[60:61], v[44:45]
    v_pk_fma_f32 v[62:63], v[44:45], v[44:45], v[62:63]
    v_pk_add_f32 v[60:61], v[60:61], v[46:47]
    v_pk_fma_f32 v[62:63], v[46:47], v[46:47], v[62:63]
    v_pk_add_f32 v[60:61], v[60:61], v[48:49]
    v_pk_fma_f32 v[62:63], v[48:49], v[48:49], v[62:63]
    v_pk_add_f32 v[60:61], v[60:61], v[50:51]
    v_pk_fma_f32 v[62:63], v[50:51], v[50:51], v[62:63]
    v_pk_add_f32 v[60:61], v[60:61], v[52:53]
    v_pk_fma_f32 v[62:63], v[52:53], v[52:53], v[62:63]
    v_pk_add_f32 v[60:61], v[60:61], v[54:55]
    v_pk_fma_f32 v[62:63], v[54:55], v[54:55], v[62:63]
    v_pk_add_f32 v[60:61], v[60:61], v[56:57]
    v_pk_fma_f32 v[62:63], v[56:57], v[56:57], v[62:63]
    v_pk_add_f32 v[60:61], v[60:61], v[58:59]
    v_pk_fma_f32 v[62:63], v[58:59], v[58:59], v[62:63]
    v_add_f32 v60, v60, v61
    v_add_f32 v61, v62, v63
    v_lshrrev_b32 v62, 1, v3
    v_lshlrev_b32 v62, 6, v62
    v_permlane32_swap_b32 v60, v61
    v_add_f32 v60, v60, v61
    v_mov_b32 v61, v60
    v_lshl_add_u32 v62, v2, 2, v62
    s_add_u32 s46, s37, 18875904
    v_permlane16_swap_b32 v60, v61
    v_add_f32 v60, v60, v61
    v_or_b32 v60, 1, v60
    buffer_store_dword v60, v62, s[12:15], s46 offen sc1
    s_lshl_b32 s11, s7, 13
    s_sub_u32 s56, s46, s11
    s_add_u32 s57, s56, 8192
    s_add_u32 s58, s56, 16384
    s_add_u32 s59, s56, 24576
    s_add_u32 s28, s28, 33554432
    s_add_u32 s29, s29, 512
    s_barrier
    v_pk_add_f32 v[68:69], v[40:41], v[44:45]
    v_pk_add_f32 v[76:77], v[40:41], v[44:45] neg_lo:[0,1] neg_hi:[0,1]
    v_pk_add_f32 v[72:73], v[48:49], v[52:53]
    v_pk_add_f32 v[80:81], v[48:49], v[52:53] neg_lo:[0,1] neg_hi:[0,1]
    v_pk_add_f32 v[70:71], v[42:43], v[46:47]
    v_pk_add_f32 v[78:79], v[42:43], v[46:47] neg_lo:[0,1] neg_hi:[0,1]
    v_pk_add_f32 v[74:75], v[50:51], v[54:55]
    v_pk_add_f32 v[82:83], v[50:51], v[54:55] neg_lo:[0,1] neg_hi:[0,1]
    v_mov_b32 v84, v56
    v_mov_b32 v85, v57
    v_mov_b32 v86, v58
    v_mov_b32 v87, v59
    s_mul_i32 s11, s3, 2560
    s_add_u32 s11, s11, 147456
    v_mul_u32_u24 v188, 160, v2
    v_lshl_add_u32 v188, v3, 3, v188
    v_add_u32 v188, s11, v188
    v_lshrrev_b32 v189, 2, v2
    v_lshl_add_u32 v189, v3, 2, v189
    v_mul_u32_u24 v189, 160, v189
    v_and_b32 v190, 3, v2
    v_lshl_add_u32 v189, v190, 3, v189
    v_add_u32 v189, 147456, v189
    v_lshrrev_b32 v190, 1, v2
    v_mul_u32_u24 v190, 73728, v190
    v_and_b32 v192, 1, v2
    v_lshl_add_u32 v191, v192, 3, v190
    v_lshl_add_u32 v191, v3, 4, v191
    v_lshl_add_u32 v190, v192, 4, v190
    v_lshl_add_u32 v190, v3, 5, v190
    v_and_b32 v192, 2, v3
    v_lshl_add_u32 v190, v192, 5, v190
    v_lshrrev_b32 v192, 1, v1
    s_lshl_b32 s24, s3, 5
    s_lshr_b32 s25, s10, 3
    s_add_u32 s24, s24, s25
    s_mul_i32 s24, s24, 18432
    s_bfe_u32 s25, s10, 0x20001
    s_lshl_b32 s25, s25, 8
    s_add_u32 s24, s24, s25
    s_and_b32 s25, s10, 1
    s_lshl_b32 s25, s25, 6
    s_add_u32 s24, s24, s25
    s_add_u32 s24, s24, s28
    s_add_u32 s24, s24, 3145728
    s_lshr_b32 s25, s7, 1
    s_lshl_b32 s25, s25, 10
    s_and_b32 s11, s7, 1
    s_lshl_b32 s11, s11, 7
    s_add_u32 s25, s25, s11
    s_add_u32 s25, s25, s24
    s_add_u32 s25, s25, 16384
    s_lshl_b32 s11, s7, 11
    s_add_u32 s24, s24, s11
    s_lshl_b32 s26, s4, 3
    s_lshl_b32 s27, s6, 2
    s_add_u32 s26, s26, s27
    s_add_u32 s26, s26, s3
    s_mul_i32 s26, s26, 18432
    s_add_u32 s26, s26, s28
    s_lshl_b32 s27, s7, 9
    s_add_u32 s27, s27, s26
    s_add_u32 s27, s27, 16384
    s_add_u32 s26, s26, s11
    s_cmp_ge_u32 s7, 4
    s_cselect_b32 s25, 268435456, s25
    s_cselect_b32 s27, 268435456, s27
    v_and_b32 v63, 1, v3
    v_lshl_add_u32 v62, v63, 15, v62
    s_mul_i32 s11, s7, 48
    v_add_u32 v112, s11, v2
    v_mov_b32 v115, 288
    v_add_u32 v113, 16, v112
    v_add_u32 v114, 32, v112
    v_cmp_eq_u32 vcc, 0, v112
    s_nop 1
    v_cndmask_b32 v112, v112, v115, vcc
    s_lshl_b32 s11, s3, 6
    v_lshl_add_u32 v115, v3, 2, s11
    v_and_b32 v116, 1, v2
    v_xor_b32 v116, 1, v116
    v_or_b32 v116, v116, v115
    v_cmp_eq_u32 s[54:55], 0, v116
    v_cvt_f32_u32 v112, v112
    v_cvt_f32_u32 v113, v113
    v_cvt_f32_u32 v114, v114
    v_cvt_f32_u32 v115, v115
    v_mul_f32 v112, 0x3ae38e39, v112
    v_mul_f32 v113, 0x3ae38e39, v113
    v_mul_f32 v114, 0x3ae38e39, v114
    s_mul_i32 s11, s3, 12288
    v_add_u32 v117, s11, v1
    s_mul_i32 s11, s3, 3072
    v_add_u32 v118, s11, v1
    v_mul_f32 v116, v115, v112
    v_mov_b32 v96, v116
    v_fmamk_f32 v97, v112, 0x3f800000, v116
    v_fmamk_f32 v98, v112, 0x40000000, v116
    v_fmamk_f32 v99, v112, 0x40400000, v116
    v_fmamk_f32 v100, v112, 0x41800000, v116
    v_fmamk_f32 v101, v112, 0x41880000, v116
    v_fmamk_f32 v102, v112, 0x41900000, v116
    v_fmamk_f32 v103, v112, 0x41980000, v116
    v_cos_f32 v88, v96
    v_cos_f32 v89, v97
    v_cos_f32 v90, v98
    v_cos_f32 v91, v99
    v_cos_f32 v92, v100
    v_cos_f32 v93, v101
    v_cos_f32 v94, v102
    v_cos_f32 v95, v103
    v_cvt_pk_bf16_f32 v104, v88, v89
    v_cvt_pk_bf16_f32 v105, v90, v91
    v_cvt_pk_bf16_f32 v106, v92, v93
    v_cvt_pk_bf16_f32 v107, v94, v95
    v_and_b32 v88, 0xffff0000, v104
    v_cndmask_b32 v104, v104, v88, s[54:55]
    ds_write_b128 v117, v[104:107] offset:0
    v_sin_f32 v88, -v96
    v_sin_f32 v89, -v97
    v_sin_f32 v90, -v98
    v_sin_f32 v91, -v99
    v_sin_f32 v92, -v100
    v_sin_f32 v93, -v101
    v_sin_f32 v94, -v102
    v_sin_f32 v95, -v103
    v_cvt_pk_bf16_f32 v108, v88, v89
    v_cvt_pk_bf16_f32 v109, v90, v91
    v_cvt_pk_bf16_f32 v110, v92, v93
    v_cvt_pk_bf16_f32 v111, v94, v95
    ds_write_b128 v117, v[108:111] offset:3072
    buffer_load_dword v64, v62, s[12:15], s56 offen sc1
    buffer_load_dword v65, v62, s[12:15], s57 offen sc1
    buffer_load_dword v66, v62, s[12:15], s58 offen sc1
    buffer_load_dword v67, v62, s[12:15], s59 offen sc1
    v_fmamk_f32 v96, v112, 0x42000000, v116
    v_fmamk_f32 v97, v112, 0x42040000, v116
    v_fmamk_f32 v98, v112, 0x42080000, v116
    v_fmamk_f32 v99, v112, 0x420c0000, v116
    v_fmamk_f32 v100, v112, 0x42400000, v116
    v_fmamk_f32 v101, v112, 0x42440000, v116
    v_fmamk_f32 v102, v112, 0x42480000, v116
    v_fmamk_f32 v103, v112, 0x424c0000, v116
    v_cos_f32 v88, v96
    v_cos_f32 v89, v97
    v_cos_f32 v90, v98
    v_cos_f32 v91, v99
    v_cos_f32 v92, v100
    v_cos_f32 v93, v101
    v_cos_f32 v94, v102
    v_cos_f32 v95, v103
    v_cvt_pk_bf16_f32 v104, v88, v89
    v_cvt_pk_bf16_f32 v105, v90, v91
    v_cvt_pk_bf16_f32 v106, v92, v93
    v_cvt_pk_bf16_f32 v107, v94, v95
    ds_write_b128 v117, v[104:107] offset:6144
    v_sin_f32 v88, -v96
    v_sin_f32 v89, -v97
    v_sin_f32 v90, -v98
    v_sin_f32 v91, -v99
    v_sin_f32 v92, -v100
    v_sin_f32 v93, -v101
    v_sin_f32 v94, -v102
    v_sin_f32 v95, -v103
    v_cvt_pk_bf16_f32 v108, v88, v89
    v_cvt_pk_bf16_f32 v109, v90, v91
    v_cvt_pk_bf16_f32 v110, v92, v93
    v_cvt_pk_bf16_f32 v111, v94, v95
    ds_write_b128 v117, v[108:111] offset:9216
    v_mul_f32 v116, v115, v113
    v_mov_b32 v96, v116
    v_fmamk_f32 v97, v113, 0x3f800000, v116
    v_fmamk_f32 v98, v113, 0x40000000, v116
    v_fmamk_f32 v99, v113, 0x40400000, v116
    v_fmamk_f32 v100, v113, 0x41800000, v116
    v_fmamk_f32 v101, v113, 0x41880000, v116
    v_fmamk_f32 v102, v113, 0x41900000, v116
    v_fmamk_f32 v103, v113, 0x41980000, v116
    v_cos_f32 v88, v96
    v_cos_f32 v89, v97
    v_cos_f32 v90, v98
    v_cos_f32 v91, v99
    v_cos_f32 v92, v100
    v_cos_f32 v93, v101
    v_cos_f32 v94, v102
    v_cos_f32 v95, v103
    v_cvt_pk_bf16_f32 v104, v88, v89
    v_cvt_pk_bf16_f32 v105, v90, v91
    v_cvt_pk_bf16_f32 v106, v92, v93
    v_cvt_pk_bf16_f32 v107, v94, v95
    v_and_b32 v88, 0xffff0000, v104
    v_cndmask_b32 v104, v104, v88, s[54:55]
    ds_write_b128 v117, v[104:107] offset:1024
    v_sin_f32 v88, -v96
    v_sin_f32 v89, -v97
    v_sin_f32 v90, -v98
    v_sin_f32 v91, -v99
    v_sin_f32 v92, -v100
    v_sin_f32 v93, -v101
    v_sin_f32 v94, -v102
    v_sin_f32 v95, -v103
    v_cvt_pk_bf16_f32 v108, v88, v89
    v_cvt_pk_bf16_f32 v109, v90, v91
    v_cvt_pk_bf16_f32 v110, v92, v93
    v_cvt_pk_bf16_f32 v111, v94, v95
    ds_write_b128 v117, v[108:111] offset:4096
    s_waitcnt vmcnt(0)
    v_bitop3_b32 v63, v64, v65, v66 bitop3:0x80
    v_bitop3_b32 v63, v63, v67, 1 bitop3:0x80
    v_cmp_eq_u32 vcc, 0, v63
    s_nop 3
    s_cbranch_vccz L_interleave_layers__spectral_fnet__mixer_gmlp__prompt_kernel_52
    s_mov_b32 s40, 0
L_interleave_layers__spectral_fnet__mixer_gmlp__prompt_kernel_54:
    buffer_load_dword v64, v62, s[12:15], s56 offen sc1
    buffer_load_dword v65, v62, s[12:15], s57 offen sc1
    buffer_load_dword v66, v62, s[12:15], s58 offen sc1
    buffer_load_dword v67, v62, s[12:15], s59 offen sc1
    s_add_u32 s40, s40, 1
    s_cmp_gt_u32 s40, 2000000
    s_cbranch_scc1 L_interleave_layers__spectral_fnet__mixer_gmlp__prompt_kernel_53
    s_waitcnt vmcnt(0)
    v_bitop3_b32 v63, v64, v65, v66 bitop3:0x80
    v_bitop3_b32 v63, v63, v67, 1 bitop3:0x80
    v_cmp_eq_u32 vcc, 0, v63
    s_nop 3
    s_cbranch_vccnz L_interleave_layers__spectral_fnet__mixer_gmlp__prompt_kernel_54
    s_mov_b64 exec, -1
L_interleave_layers__spectral_fnet__mixer_gmlp__prompt_kernel_52:
    v_add_f32 v64, v64, v65
    v_add_f32 v66, v66, v67
    v_add_f32 v60, v64, v66
    v_mov_b32 v61, v60
    s_nop 1
    v_permlane16_swap_b32 v60, v61
    v_add_f32 v60, v60, v61
    v_mov_b32 v61, v60
    s_nop 1
    v_permlane32_swap_b32 v60, v61
    v_mul_f32 v17, 0x3ae38e39, v60
    v_mul_f32 v61, 0x3ae38e39, v61
    v_fma_f32 v61, -v17, v17, v61
    v_max_f32 v61, 0, v61
    v_add_f32 v61, 0x3727c5ac, v61
    v_rsq_f32 v61, v61
    s_nop 0
    v_mul_f32 v60, -v17, v61
    v_pk_mul_f32 v[76:77], v[76:77], v[60:61] op_sel:[0,1] op_sel_hi:[1,1]
    v_pk_mul_f32 v[78:79], v[78:79], v[60:61] op_sel:[0,1] op_sel_hi:[1,1]
    v_pk_mul_f32 v[80:81], v[80:81], v[60:61] op_sel:[0,1] op_sel_hi:[1,1]
    v_pk_mul_f32 v[82:83], v[82:83], v[60:61] op_sel:[0,1] op_sel_hi:[1,1]
    v_pk_fma_f32 v[84:85], v[84:85], v[60:61], v[60:61] op_sel:[0,1,0] op_sel_hi:[1,1,0]
    v_pk_fma_f32 v[86:87], v[86:87], v[60:61], v[60:61] op_sel:[0,1,0] op_sel_hi:[1,1,0]
    v_add_f32 v60, v60, v60
    v_pk_fma_f32 v[68:69], v[68:69], v[60:61], v[60:61] op_sel:[0,1,0] op_sel_hi:[1,1,0]
    v_pk_fma_f32 v[70:71], v[70:71], v[60:61], v[60:61] op_sel:[0,1,0] op_sel_hi:[1,1,0]
    v_pk_fma_f32 v[72:73], v[72:73], v[60:61], v[60:61] op_sel:[0,1,0] op_sel_hi:[1,1,0]
    v_pk_fma_f32 v[74:75], v[74:75], v[60:61], v[60:61] op_sel:[0,1,0] op_sel_hi:[1,1,0]
    v_cvt_pk_bf16_f32 v76, v76, v77
    v_cvt_pk_bf16_f32 v77, v78, v79
    ds_write_b64 v188, v[76:77] offset:64
    v_cvt_pk_bf16_f32 v80, v80, v81
    v_cvt_pk_bf16_f32 v81, v82, v83
    ds_write_b64 v188, v[80:81] offset:96
    v_cvt_pk_bf16_f32 v84, v84, v85
    v_cvt_pk_bf16_f32 v85, v86, v87
    ds_write_b64 v188, v[84:85] offset:128
    v_cvt_pk_bf16_f32 v68, v68, v69
    v_cvt_pk_bf16_f32 v69, v70, v71
    ds_write_b64 v188, v[68:69] offset:0
    v_cvt_pk_bf16_f32 v72, v72, v73
    v_cvt_pk_bf16_f32 v73, v74, v75
    ds_write_b64 v188, v[72:73] offset:32
    v_pk_add_f32 v[40:41], v[40:41], v[16:17] op_sel:[0,1] op_sel_hi:[1,1] neg_lo:[0,1] neg_hi:[0,1]
    v_pk_add_f32 v[42:43], v[42:43], v[16:17] op_sel:[0,1] op_sel_hi:[1,1] neg_lo:[0,1] neg_hi:[0,1]
    v_pk_add_f32 v[44:45], v[44:45], v[16:17] op_sel:[0,1] op_sel_hi:[1,1] neg_lo:[0,1] neg_hi:[0,1]
    v_pk_add_f32 v[46:47], v[46:47], v[16:17] op_sel:[0,1] op_sel_hi:[1,1] neg_lo:[0,1] neg_hi:[0,1]
    v_pk_add_f32 v[48:49], v[48:49], v[16:17] op_sel:[0,1] op_sel_hi:[1,1] neg_lo:[0,1] neg_hi:[0,1]
    v_pk_add_f32 v[50:51], v[50:51], v[16:17] op_sel:[0,1] op_sel_hi:[1,1] neg_lo:[0,1] neg_hi:[0,1]
    v_pk_add_f32 v[52:53], v[52:53], v[16:17] op_sel:[0,1] op_sel_hi:[1,1] neg_lo:[0,1] neg_hi:[0,1]
    v_pk_add_f32 v[54:55], v[54:55], v[16:17] op_sel:[0,1] op_sel_hi:[1,1] neg_lo:[0,1] neg_hi:[0,1]
    v_pk_add_f32 v[56:57], v[56:57], v[16:17] op_sel:[0,1] op_sel_hi:[1,1] neg_lo:[0,1] neg_hi:[0,1]
    v_pk_add_f32 v[58:59], v[58:59], v[16:17] op_sel:[0,1] op_sel_hi:[1,1] neg_lo:[0,1] neg_hi:[0,1]
    s_waitcnt lgkmcnt(0)
    s_barrier
    ds_read_b64_tr_b16 v[128:129], v189 offset:0
    ds_read_b64_tr_b16 v[130:131], v189 offset:2560
    ds_read_b64_tr_b16 v[132:133], v189 offset:5120
    ds_read_b64_tr_b16 v[134:135], v189 offset:7680
    ds_read_b64_tr_b16 v[136:137], v189 offset:32
    ds_read_b64_tr_b16 v[138:139], v189 offset:2592
    ds_read_b64_tr_b16 v[140:141], v189 offset:5152
    ds_read_b64_tr_b16 v[142:143], v189 offset:7712
    ds_read_b64_tr_b16 v[144:145], v189 offset:64
    ds_read_b64_tr_b16 v[146:147], v189 offset:2624
    ds_read_b64_tr_b16 v[148:149], v189 offset:5184
    ds_read_b64_tr_b16 v[150:151], v189 offset:7744
    ds_read_b64_tr_b16 v[152:153], v189 offset:96
    ds_read_b64_tr_b16 v[154:155], v189 offset:2656
    ds_read_b64_tr_b16 v[156:157], v189 offset:5216
    ds_read_b64_tr_b16 v[158:159], v189 offset:7776
    ds_read_b64_tr_b16 v[160:161], v189 offset:128
    ds_read_b64_tr_b16 v[162:163], v189 offset:2688
    ds_read_b64_tr_b16 v[164:165], v189 offset:5248
    ds_read_b64_tr_b16 v[166:167], v189 offset:7808
    s_waitcnt lgkmcnt(15)
    v_mfma_f32_16x16x32_bf16 v[168:171], v[128:131], v[120:123], 0
    v_cvt_pk_bf16_f32 v40, v40, v41
    v_mfma_f32_16x16x32_bf16 v[168:171], v[132:135], v[124:127], v[168:171]
    v_cvt_pk_bf16_f32 v41, v42, v43
    s_waitcnt lgkmcnt(12)
    v_mfma_f32_16x16x32_bf16 v[172:175], v[136:139], v[120:123], 0
    v_cvt_pk_bf16_f32 v42, v44, v45
    v_mfma_f32_16x16x32_bf16 v[172:175], v[140:143], v[124:127], v[172:175]
    v_cvt_pk_bf16_f32 v43, v46, v47
    s_waitcnt lgkmcnt(8)
    v_mfma_f32_16x16x32_bf16 v[176:179], v[144:147], v[120:123], 0
    v_cvt_pk_bf16_f32 v44, v48, v49
    v_mfma_f32_16x16x32_bf16 v[176:179], v[148:151], v[124:127], v[176:179]
    v_cvt_pk_bf16_f32 v45, v50, v51
    s_waitcnt lgkmcnt(4)
    v_mfma_f32_16x16x32_bf16 v[180:183], v[152:155], v[120:123], 0
    v_cvt_pk_bf16_f32 v46, v52, v53
    v_mfma_f32_16x16x32_bf16 v[180:183], v[156:159], v[124:127], v[180:183]
    v_cvt_pk_bf16_f32 v47, v54, v55
    s_waitcnt lgkmcnt(0)
    v_mfma_f32_16x16x32_bf16 v[184:187], v[160:163], v[120:123], 0
    v_cvt_pk_bf16_f32 v48, v56, v57
    v_mfma_f32_16x16x32_bf16 v[184:187], v[164:167], v[124:127], v[184:187]
    v_cvt_pk_bf16_f32 v49, v58, v59
    v_cvt_pk_bf16_f32 v68, v168, v169
    v_cvt_pk_bf16_f32 v69, v170, v171
    v_cvt_pk_bf16_f32 v70, v172, v173
    v_cvt_pk_bf16_f32 v71, v174, v175
    buffer_store_dwordx4 v[68:71], v190, s[12:15], s24 offen offset:0 sc1
    v_cvt_pk_bf16_f32 v72, v176, v177
    v_cvt_pk_bf16_f32 v73, v178, v179
    v_cvt_pk_bf16_f32 v74, v180, v181
    v_cvt_pk_bf16_f32 v75, v182, v183
    buffer_store_dwordx4 v[72:75], v190, s[12:15], s24 offen offset:1024 sc1
    v_cvt_pk_bf16_f32 v76, v184, v185
    v_cvt_pk_bf16_f32 v77, v186, v187
    buffer_store_dwordx2 v[76:77], v191, s[12:15], s25 offen sc1
    buffer_store_dwordx2 v[40:41], v192, s[12:15], s26 offen offset:0 sc1
    buffer_store_dwordx2 v[42:43], v192, s[12:15], s26 offen offset:512 sc1
    buffer_store_dwordx2 v[44:45], v192, s[12:15], s26 offen offset:1024 sc1
    buffer_store_dwordx2 v[46:47], v192, s[12:15], s26 offen offset:1536 sc1
    buffer_store_dwordx2 v[48:49], v192, s[12:15], s27 offen sc1
    v_fmamk_f32 v96, v113, 0x42000000, v116
    v_fmamk_f32 v97, v113, 0x42040000, v116
    v_fmamk_f32 v98, v113, 0x42080000, v116
    v_fmamk_f32 v99, v113, 0x420c0000, v116
    v_fmamk_f32 v100, v113, 0x42400000, v116
    v_fmamk_f32 v101, v113, 0x42440000, v116
    v_fmamk_f32 v102, v113, 0x42480000, v116
    v_fmamk_f32 v103, v113, 0x424c0000, v116
    v_cos_f32 v88, v96
    v_cos_f32 v89, v97
    v_cos_f32 v90, v98
    v_cos_f32 v91, v99
    v_cos_f32 v92, v100
    v_cos_f32 v93, v101
    v_cos_f32 v94, v102
    v_cos_f32 v95, v103
    v_cvt_pk_bf16_f32 v104, v88, v89
    v_cvt_pk_bf16_f32 v105, v90, v91
    v_cvt_pk_bf16_f32 v106, v92, v93
    v_cvt_pk_bf16_f32 v107, v94, v95
    ds_write_b128 v117, v[104:107] offset:7168
    v_sin_f32 v88, -v96
    v_sin_f32 v89, -v97
    v_sin_f32 v90, -v98
    v_sin_f32 v91, -v99
    v_sin_f32 v92, -v100
    v_sin_f32 v93, -v101
    v_sin_f32 v94, -v102
    v_sin_f32 v95, -v103
    v_cvt_pk_bf16_f32 v108, v88, v89
    v_cvt_pk_bf16_f32 v109, v90, v91
    v_cvt_pk_bf16_f32 v110, v92, v93
    v_cvt_pk_bf16_f32 v111, v94, v95
    ds_write_b128 v117, v[108:111] offset:10240
    v_mul_f32 v116, v115, v114
    v_mov_b32 v96, v116
    v_fmamk_f32 v97, v114, 0x3f800000, v116
    v_fmamk_f32 v98, v114, 0x40000000, v116
    v_fmamk_f32 v99, v114, 0x40400000, v116
    v_fmamk_f32 v100, v114, 0x41800000, v116
    v_fmamk_f32 v101, v114, 0x41880000, v116
    v_fmamk_f32 v102, v114, 0x41900000, v116
    v_fmamk_f32 v103, v114, 0x41980000, v116
    v_cos_f32 v88, v96
    v_cos_f32 v89, v97
    v_cos_f32 v90, v98
    v_cos_f32 v91, v99
    v_cos_f32 v92, v100
    v_cos_f32 v93, v101
    v_cos_f32 v94, v102
    v_cos_f32 v95, v103
    v_cvt_pk_bf16_f32 v104, v88, v89
    v_cvt_pk_bf16_f32 v105, v90, v91
    v_cvt_pk_bf16_f32 v106, v92, v93
    v_cvt_pk_bf16_f32 v107, v94, v95
    v_and_b32 v88, 0xffff0000, v104
    v_cndmask_b32 v104, v104, v88, s[54:55]
    ds_write_b128 v117, v[104:107] offset:2048
    v_sin_f32 v88, -v96
    v_sin_f32 v89, -v97
    v_sin_f32 v90, -v98
    v_sin_f32 v91, -v99
    v_sin_f32 v92, -v100
    v_sin_f32 v93, -v101
    v_sin_f32 v94, -v102
    v_sin_f32 v95, -v103
    v_cvt_pk_bf16_f32 v108, v88, v89
    v_cvt_pk_bf16_f32 v109, v90, v91
    v_cvt_pk_bf16_f32 v110, v92, v93
    v_cvt_pk_bf16_f32 v111, v94, v95
    ds_write_b128 v117, v[108:111] offset:5120
    v_fmamk_f32 v96, v114, 0x42000000, v116
    v_fmamk_f32 v97, v114, 0x42040000, v116
    v_fmamk_f32 v98, v114, 0x42080000, v116
    v_fmamk_f32 v99, v114, 0x420c0000, v116
    v_fmamk_f32 v100, v114, 0x42400000, v116
    v_fmamk_f32 v101, v114, 0x42440000, v116
    v_fmamk_f32 v102, v114, 0x42480000, v116
    v_fmamk_f32 v103, v114, 0x424c0000, v116
    v_cos_f32 v88, v96
    v_cos_f32 v89, v97
    v_cos_f32 v90, v98
    v_cos_f32 v91, v99
    v_cos_f32 v92, v100
    v_cos_f32 v93, v101
    v_cos_f32 v94, v102
    v_cos_f32 v95, v103
    v_cvt_pk_bf16_f32 v104, v88, v89
    v_cvt_pk_bf16_f32 v105, v90, v91
    v_cvt_pk_bf16_f32 v106, v92, v93
    v_cvt_pk_bf16_f32 v107, v94, v95
    ds_write_b128 v117, v[104:107] offset:8192
    s_waitcnt vmcnt(0)
    s_barrier
    v_lshlrev_b32 v62, 2, v2
    s_add_u32 s95, s37, s29
    s_mov_b64 exec, 0xffff
    buffer_store_dword v12, v62, s[12:15], s95 offen offset:0 sc1
    s_mov_b64 exec, -1
    s_mov_b32 s30, 1
    v_sin_f32 v88, -v96
    v_sin_f32 v89, -v97
    v_sin_f32 v90, -v98
    v_sin_f32 v91, -v99
    v_sin_f32 v92, -v100
    v_sin_f32 v93, -v101
    v_sin_f32 v94, -v102
    v_sin_f32 v95, -v103
    v_cvt_pk_bf16_f32 v108, v88, v89
    v_cvt_pk_bf16_f32 v109, v90, v91
    v_cvt_pk_bf16_f32 v110, v92, v93
    v_cvt_pk_bf16_f32 v111, v94, v95
    ds_write_b128 v117, v[108:111] offset:11264
    s_lshr_b32 s11, s3, 1
    s_lshl_b32 s11, s11, 4
    s_add_u32 s11, s11, 256
    v_lshl_add_u32 v115, v3, 2, s11
    v_cvt_f32_u32 v115, v115
    s_bitcmp1_b32 s3, 0
    s_cselect_b32 s11, 0x3e800000, 0
    v_fma_f32 v116, v115, v112, s11
    v_fma_f32 v119, -v115, v112, s11
    v_mov_b32 v88, v116
    v_fmamk_f32 v89, v112, 0x3f800000, v116
    v_fmamk_f32 v90, v112, 0x40000000, v116
    v_fmamk_f32 v91, v112, 0x40400000, v116
    v_mov_b32 v92, v119
    v_fmamk_f32 v93, v112, 0xbf800000, v119
    v_fmamk_f32 v94, v112, 0xc0000000, v119
    v_fmamk_f32 v95, v112, 0xc0400000, v119
    v_cos_f32 v88, v88
    v_cos_f32 v89, v89
    v_cos_f32 v90, v90
    v_cos_f32 v91, v91
    v_cos_f32 v92, v92
    v_cos_f32 v93, v93
    v_cos_f32 v94, v94
    v_cos_f32 v95, v95
    v_cvt_pk_bf16_f32 v104, v88, v89
    v_cvt_pk_bf16_f32 v105, v90, v91
    v_cvt_pk_bf16_f32 v106, v92, v93
    v_cvt_pk_bf16_f32 v107, v94, v95
    ds_write_b128 v118, v[104:107] offset:49152
    v_fma_f32 v116, v115, v113, s11
    v_fma_f32 v119, -v115, v113, s11
    v_mov_b32 v88, v116
    v_fmamk_f32 v89, v113, 0x3f800000, v116
    v_fmamk_f32 v90, v113, 0x40000000, v116
    v_fmamk_f32 v91, v113, 0x40400000, v116
    v_mov_b32 v92, v119
    v_fmamk_f32 v93, v113, 0xbf800000, v119
    v_fmamk_f32 v94, v113, 0xc0000000, v119
    v_fmamk_f32 v95, v113, 0xc0400000, v119
    v_cos_f32 v88, v88
    v_cos_f32 v89, v89
    v_cos_f32 v90, v90
    v_cos_f32 v91, v91
    v_cos_f32 v92, v92
    v_cos_f32 v93, v93
    v_cos_f32 v94, v94
    v_cos_f32 v95, v95
    v_cvt_pk_bf16_f32 v108, v88, v89
    v_cvt_pk_bf16_f32 v109, v90, v91
    v_cvt_pk_bf16_f32 v110, v92, v93
    v_cvt_pk_bf16_f32 v111, v94, v95
    ds_write_b128 v118, v[108:111] offset:50176
    v_fma_f32 v116, v115, v114, s11
    v_fma_f32 v119, -v115, v114, s11
    v_mov_b32 v88, v116
    v_fmamk_f32 v89, v114, 0x3f800000, v116
    v_fmamk_f32 v90, v114, 0x40000000, v116
    v_fmamk_f32 v91, v114, 0x40400000, v116
    v_mov_b32 v92, v119
    v_fmamk_f32 v93, v114, 0xbf800000, v119
    v_fmamk_f32 v94, v114, 0xc0000000, v119
    v_fmamk_f32 v95, v114, 0xc0400000, v119
    v_cos_f32 v88, v88
    v_cos_f32 v89, v89
    v_cos_f32 v90, v90
    v_cos_f32 v91, v91
    v_cos_f32 v92, v92
    v_cos_f32 v93, v93
    v_cos_f32 v94, v94
    v_cos_f32 v95, v95
    v_cvt_pk_bf16_f32 v104, v88, v89
    v_cvt_pk_bf16_f32 v105, v90, v91
    v_cvt_pk_bf16_f32 v106, v92, v93
    v_cvt_pk_bf16_f32 v107, v94, v95
    ds_write_b128 v118, v[104:107] offset:51200
    s_nop 0
    s_branch L_layer_interleave_layers__spectral_fnet__mixer_gmlp__prompt_kernel
L_done_interleave_layers__spectral_fnet__mixer_gmlp__prompt_kernel:
L_end_interleave_layers__spectral_fnet__mixer_gmlp__prompt_kernel:
    s_endpgm
L_interleave_layers__spectral_fnet__mixer_gmlp__prompt_kernel_3:
    v_cndmask_b32 v128, v128, v132, s[92:93]
    v_cndmask_b32 v129, v129, v133, s[92:93]
    v_cndmask_b32 v130, v130, v134, s[92:93]
    v_cndmask_b32 v131, v131, v135, s[92:93]
    buffer_store_dwordx4 v[128:131], v19, s[12:15], s42 offen sc1
    s_add_u32 s42, s42, s43
    v_cndmask_b32 v132, v132, v136, s[92:93]
    v_cndmask_b32 v133, v133, v137, s[92:93]
    v_cndmask_b32 v134, v134, v138, s[92:93]
    v_cndmask_b32 v135, v135, v139, s[92:93]
    buffer_store_dwordx4 v[132:135], v19, s[12:15], s42 offen sc1
    s_add_u32 s42, s42, s43
    v_cndmask_b32 v136, v136, v140, s[92:93]
    v_cndmask_b32 v137, v137, v141, s[92:93]
    v_cndmask_b32 v138, v138, v142, s[92:93]
    v_cndmask_b32 v139, v139, v143, s[92:93]
    buffer_store_dwordx4 v[136:139], v19, s[12:15], s42 offen sc1
    s_add_u32 s42, s42, s43
    v_cndmask_b32 v140, v140, v144, s[92:93]
    v_cndmask_b32 v141, v141, v145, s[92:93]
    v_cndmask_b32 v142, v142, v146, s[92:93]
    v_cndmask_b32 v143, v143, v147, s[92:93]
    buffer_store_dwordx4 v[140:143], v19, s[12:15], s42 offen sc1
    s_add_u32 s42, s42, s43
    v_cndmask_b32 v144, v144, v148, s[92:93]
    v_cndmask_b32 v145, v145, v149, s[92:93]
    v_cndmask_b32 v146, v146, v150, s[92:93]
    v_cndmask_b32 v147, v147, v151, s[92:93]
    buffer_store_dwordx4 v[144:147], v19, s[12:15], s42 offen sc1
    s_add_u32 s42, s42, s43
    v_cndmask_b32 v148, v148, v152, s[92:93]
    v_cndmask_b32 v149, v149, v153, s[92:93]
    v_cndmask_b32 v150, v150, v154, s[92:93]
    v_cndmask_b32 v151, v151, v155, s[92:93]
    buffer_store_dwordx4 v[148:151], v19, s[12:15], s42 offen sc1
    s_add_u32 s42, s42, s43
    v_cndmask_b32 v152, v152, v156, s[92:93]
    v_cndmask_b32 v153, v153, v157, s[92:93]
    v_cndmask_b32 v154, v154, v158, s[92:93]
    v_cndmask_b32 v155, v155, v159, s[92:93]
    buffer_store_dwordx4 v[152:155], v19, s[12:15], s42 offen sc1
    s_add_u32 s42, s42, s43
    v_cndmask_b32 v156, v156, v160, s[92:93]
    v_cndmask_b32 v157, v157, v161, s[92:93]
    v_cndmask_b32 v158, v158, v162, s[92:93]
    v_cndmask_b32 v159, v159, v163, s[92:93]
    buffer_store_dwordx4 v[156:159], v19, s[12:15], s42 offen sc1
    s_add_u32 s42, s42, s43
    v_cndmask_b32 v160, v160, v164, s[92:93]
    v_cndmask_b32 v161, v161, v165, s[92:93]
    v_cndmask_b32 v162, v162, v166, s[92:93]
    v_cndmask_b32 v163, v163, v167, s[92:93]
    buffer_store_dwordx4 v[160:163], v19, s[12:15], s42 offen sc1
    s_add_u32 s42, s42, s43
    s_mov_b32 s64, s70
    s_and_b32 s65, s71, 0xffff
    s_mov_b32 s66, 8388608
    s_mov_b32 s67, 0x00020000
    s_lshl_b32 s45, s4, 1
    s_add_u32 s45, s45, s6
    s_lshl_b32 s45, s45, 1
    s_and_b32 s46, s7, 1
    s_add_u32 s45, s45, s46
    s_lshr_b32 s50, s45, 2
    s_bfe_u32 s51, s45, 0x10001
    s_sub_u32 s52, 32, s50
    s_cmp_eq_u32 s50, 0
    s_cselect_b32 s52, 16, s52
    s_cmp_eq_u32 s51, 0
    s_cselect_b32 s68, s50, s52
    s_and_b32 s50, s45, 1
    s_lshl_b32 s50, s50, 5
    s_add_u32 s68, s68, s50
    s_lshl_b32 s46, s3, 7
    s_add_u32 s68, s68, s46
    s_lshl_b32 s68, s68, 12
    s_mul_i32 s69, s3, 8224
    s_and_b32 s44, s3, 1
    s_lshr_b32 s46, s3, 1
    s_lshl_b32 s47, s44, 1
    s_add_u32 s47, s47, s46
    s_lshl_b32 s47, s47, 11
    s_lshl_b32 s45, s45, 17
    s_add_u32 s47, s47, s45
    s_add_u32 s61, s47, 6291456
    s_add_u32 m0, s69, 110592
    s_add_u32 s41, s68, 0
    buffer_load_dwordx4 v1, s[64:67], s41 offen offset:0 lds
    buffer_load_dwordx4 v1, s[64:67], s41 offen offset:1024 lds
    buffer_load_dwordx4 v1, s[64:67], s41 offen offset:2048 lds
    buffer_load_dwordx4 v1, s[64:67], s41 offen offset:3072 lds
    s_add_u32 m0, s69, 114704
    s_add_u32 s41, s68, 262144
    buffer_load_dwordx4 v1, s[64:67], s41 offen offset:0 lds
    buffer_load_dwordx4 v1, s[64:67], s41 offen offset:1024 lds
    buffer_load_dwordx4 v1, s[64:67], s41 offen offset:2048 lds
    buffer_load_dwordx4 v1, s[64:67], s41 offen offset:3072 lds
    v_lshrrev_b32 v28, 2, v2
    v_and_b32 v29, 3, v2
    v_and_b32 v34, 1, v3
    v_lshrrev_b32 v35, 1, v3
    v_lshl_add_u32 v27, v34, 2, v29
    v_mul_u32_u24 v27, 4112, v27
    v_lshl_add_u32 v26, v35, 2, v28
    v_lshl_add_u32 v27, v26, 7, v27
    s_lshl_b32 s45, s3, 5
    v_add_u32 v27, s45, v27
    v_add_u32 v36, 73728, v27
    s_lshl_b32 s45, s3, 12
    s_add_u32 s45, s45, 147456
    v_lshl_add_u32 v32, v34, 2, v28
    v_lshlrev_b32 v26, 1, v29
    v_xor_b32 v32, v32, v26
    v_lshlrev_b32 v32, 4, v32
    v_lshl_add_u32 v26, v35, 2, v29
    v_lshl_add_u32 v32, v26, 7, v32
    v_add_u32 v32, s45, v32
    v_bfe_u32 v26, v1, 7, 2
    v_lshlrev_b32 v33, 5, v26
    v_xor_b32 v33, v33, v1
    v_add_u32 v33, s45, v33
    s_cmp_eq_u32 s44, 1
    s_cselect_b64 vcc, -1, 0
    v_and_b32 v25, 0x70, v1
    v_lshl_add_u32 v25, v35, 8, v25
    v_add_u32 v20, 0, v26
    v_sub_u32 v24, 16, v20
    v_and_b32 v24, 15, v24
    v_cndmask_b32 v20, v20, v24, vcc
    v_lshl_add_u32 v20, v20, 13, v25
    v_add_u32 v21, 4, v26
    v_sub_u32 v24, 16, v21
    v_and_b32 v24, 15, v24
    v_cndmask_b32 v21, v21, v24, vcc
    v_lshl_add_u32 v21, v21, 13, v25
    v_add_u32 v22, 8, v26
    v_sub_u32 v24, 16, v22
    v_and_b32 v24, 15, v24
    v_cndmask_b32 v22, v22, v24, vcc
    v_lshl_add_u32 v22, v22, 13, v25
    v_add_u32 v23, 12, v26
    v_sub_u32 v24, 16, v23
    v_and_b32 v24, 15, v24
    v_cndmask_b32 v23, v23, v24, vcc
    v_lshl_add_u32 v23, v23, 13, v25
    s_mov_b32 s16, s76
    s_and_b32 s17, s77, 0xffff
    s_mov_b32 s18, 2359296
    s_mov_b32 s19, 0x00020000
    s_mov_b32 s80, s8
    s_or_b32 s81, s13, 0x100000
    s_mov_b32 s82, 0x10000000
    s_mov_b32 s83, 0x00800000
    s_mul_i32 s34, s5, 331776
    s_add_u32 s34, s34, s32
    s_mul_i32 s38, s5, 589824
    s_add_u32 s38, s38, s32
    s_add_u32 s38, s38, 9437184
    s_lshl_b32 s36, s31, 17
    s_add_u32 s36, s36, 6291456
    s_lshl_b32 s39, s6, 2
    s_add_u32 s39, s39, s3
    s_mul_i32 s39, s39, 331776
    s_lshl_b32 s11, s7, 12
    s_add_u32 s39, s39, s11
    s_add_u32 s39, s39, 14680064
    s_mul_i32 s11, s7, 3072
    s_sub_u32 s11, 32768, s11
    s_cmp_ge_u32 s7, 4
    s_cselect_b32 s11, 268435456, s11
    v_add_u32 v16, s11, v1
    v_add_u32 v4, 0, v1
    v_add_u32 v5, 36864, v1
    v_add_u32 v6, 73728, v1
    v_add_u32 v7, 110592, v1
    s_waitcnt vmcnt(17)
    v_cmp_gt_u32 vcc, 128, v31
    s_nop 3
    s_cbranch_vccnz L_interleave_layers__spectral_fnet__mixer_gmlp__prompt_kernel_55
L_interleave_layers__spectral_fnet__mixer_gmlp__prompt_kernel_56:
    s_waitcnt vmcnt(8)
    v_lshlrev_b32 v24, 2, v2
    s_add_u32 s95, s37, 18874368
    s_mov_b64 exec, 0xffff
    buffer_store_dword v12, v24, s[12:15], s95 offen offset:1664 sc1
    s_mov_b64 exec, -1
    s_add_u32 m0, s69, 0
    s_add_u32 s41, s68, 2097152
    buffer_load_dwordx4 v1, s[64:67], s41 offen offset:0 lds
    buffer_load_dwordx4 v1, s[64:67], s41 offen offset:1024 lds
    buffer_load_dwordx4 v1, s[64:67], s41 offen offset:2048 lds
    buffer_load_dwordx4 v1, s[64:67], s41 offen offset:3072 lds
    s_add_u32 m0, s69, 4112
    s_add_u32 s41, s68, 2359296
    buffer_load_dwordx4 v1, s[64:67], s41 offen offset:0 lds
    buffer_load_dwordx4 v1, s[64:67], s41 offen offset:1024 lds
    buffer_load_dwordx4 v1, s[64:67], s41 offen offset:2048 lds
    buffer_load_dwordx4 v1, s[64:67], s41 offen offset:3072 lds
    s_and_b32 s11, s3, 1
    s_mul_i32 s11, s11, 72
    v_min_u32 v206, 8, v2
    v_lshl_add_u32 v206, v206, 3, s11
    s_lshr_b32 s11, s5, 2
    v_and_b32 v207, 1, v3
    v_lshl_add_u32 v207, v207, 2, s11
    v_add_u32 v206, v206, v207
    v_lshrrev_b32 v207, 6, v206
    v_add_u32 v207, 3, v207
    v_and_b32 v207, 3, v207
    v_lshlrev_b32 v207, 1, v207
    v_bfe_u32 v208, v206, 1, 5
    v_lshl_add_u32 v207, v208, 3, v207
    v_and_b32 v206, 1, v206
    v_add_u32 v206, v206, v207
    s_and_b32 s11, s5, 3
    s_lshl_b32 s11, s11, 11
    v_lshl_add_u32 v206, v206, 13, s11
    s_mov_b32 s50, 18874368
    s_add_u32 s35, s28, s38
    s_lshr_b32 s45, s3, 1
    s_and_b32 s46, s3, 1
    s_xor_b32 s47, s45, s46
    s_cmp_eq_u32 s4, 0
    s_cselect_b32 s45, s45, s47
    s_lshl_b32 s47, s4, 1
    s_add_u32 s45, s45, s47
    s_lshl_b32 s45, s45, 16
    s_lshl_b32 s46, s46, 12
    s_add_u32 s45, s45, s46
    s_add_u32 s45, s45, s29
    v_lshrrev_b32 v200, 1, v2
    v_min_u32 v200, 5, v200
    v_lshlrev_b32 v200, 13, v200
    v_and_b32 v201, 1, v2
    v_lshl_add_u32 v200, v201, 11, v200
    s_mul_i32 s46, s31, 36864
    s_add_u32 s46, s46, s28
    s_add_u32 s46, s46, 6291456
    s_add_u32 s47, s46, 18432
    v_lshrrev_b32 v216, 1, v3
    v_lshlrev_b32 v216, 10, v216
    v_lshl_add_u32 v216, v2, 2, v216
    v_and_b32 v217, 1, v3
    v_lshl_add_u32 v216, v217, 7, v216
    s_lshl_b32 s48, s31, 11
    s_add_u32 s48, s48, s28
    s_add_u32 s48, s48, 2621440
    s_waitcnt vmcnt(9)
    s_barrier
    ds_read_b64_tr_b16 v[40:41], v36 offset:36864
    ds_read_b64_tr_b16 v[42:43], v36 offset:38912
    ds_read_b64_tr_b16 v[44:45], v36 offset:37888
    ds_read_b64_tr_b16 v[46:47], v36 offset:39936
    ds_read_b64_tr_b16 v[48:49], v36 offset:36872
    ds_read_b64_tr_b16 v[50:51], v36 offset:38920
    ds_read_b64_tr_b16 v[52:53], v36 offset:37896
    ds_read_b64_tr_b16 v[54:55], v36 offset:39944
    ds_read_b64_tr_b16 v[56:57], v36 offset:36880
    ds_read_b64_tr_b16 v[58:59], v36 offset:38928
    ds_read_b64_tr_b16 v[60:61], v36 offset:37904
    ds_read_b64_tr_b16 v[62:63], v36 offset:39952
    ds_read_b64_tr_b16 v[64:65], v36 offset:36888
    ds_read_b64_tr_b16 v[66:67], v36 offset:38936
    ds_read_b64_tr_b16 v[68:69], v36 offset:37912
    ds_read_b64_tr_b16 v[70:71], v36 offset:39960
    s_add_u32 m0, s69, 36864
    s_add_u32 s41, s68, 4194304
    buffer_load_dwordx4 v1, s[64:67], s41 offen offset:0 lds
    buffer_load_dwordx4 v1, s[64:67], s41 offen offset:1024 lds
    buffer_load_dwordx4 v1, s[64:67], s41 offen offset:2048 lds
    buffer_load_dwordx4 v1, s[64:67], s41 offen offset:3072 lds
    s_add_u32 m0, s69, 40976
    s_add_u32 s41, s68, 4456448
    buffer_load_dwordx4 v1, s[64:67], s41 offen offset:0 lds
    buffer_load_dwordx4 v1, s[64:67], s41 offen offset:1024 lds
    buffer_load_dwordx4 v1, s[64:67], s41 offen offset:2048 lds
    buffer_load_dwordx4 v1, s[64:67], s41 offen offset:3072 lds
    s_waitcnt lgkmcnt(0)
    ds_write_b128 v32, v[40:43] offset:0
    ds_write_b128 v32, v[44:47] offset:1024
    ds_write_b128 v32, v[48:51] offset:2048
    ds_write_b128 v32, v[52:55] offset:3072
    ds_read_b128 a[128:131], v33 offset:0
    ds_read_b128 a[132:135], v33 offset:1024
    ds_read_b128 a[136:139], v33 offset:2048
    ds_read_b128 a[140:143], v33 offset:3072
    ds_write_b128 v32, v[56:59] offset:0
    ds_write_b128 v32, v[60:63] offset:1024
    ds_write_b128 v32, v[64:67] offset:2048
    ds_write_b128 v32, v[68:71] offset:3072
    ds_read_b128 a[144:147], v33 offset:0
    ds_read_b128 a[148:151], v33 offset:1024
    ds_read_b128 a[152:155], v33 offset:2048
    ds_read_b128 a[156:159], v33 offset:3072
    s_waitcnt vmcnt(8)
    s_barrier
    s_waitcnt lgkmcnt(0)
    ds_read_b64_tr_b16 v[72:73], v27 offset:0
    ds_read_b64_tr_b16 v[74:75], v27 offset:2048
    ds_read_b64_tr_b16 v[76:77], v27 offset:1024
    ds_read_b64_tr_b16 v[78:79], v27 offset:3072
    ds_read_b64_tr_b16 v[80:81], v27 offset:8
    ds_read_b64_tr_b16 v[82:83], v27 offset:2056
    ds_read_b64_tr_b16 v[84:85], v27 offset:1032
    ds_read_b64_tr_b16 v[86:87], v27 offset:3080
    ds_read_b64_tr_b16 v[88:89], v27 offset:16
    ds_read_b64_tr_b16 v[90:91], v27 offset:2064
    ds_read_b64_tr_b16 v[92:93], v27 offset:1040
    ds_read_b64_tr_b16 v[94:95], v27 offset:3088
    ds_read_b64_tr_b16 v[96:97], v27 offset:24
    ds_read_b64_tr_b16 v[98:99], v27 offset:2072
    ds_read_b64_tr_b16 v[100:101], v27 offset:1048
    ds_read_b64_tr_b16 v[102:103], v27 offset:3096
    s_add_u32 m0, s69, 73728
    s_add_u32 s41, s68, 6291456
    buffer_load_dwordx4 v1, s[64:67], s41 offen offset:0 lds
    buffer_load_dwordx4 v1, s[64:67], s41 offen offset:1024 lds
    buffer_load_dwordx4 v1, s[64:67], s41 offen offset:2048 lds
    buffer_load_dwordx4 v1, s[64:67], s41 offen offset:3072 lds
    s_add_u32 m0, s69, 77840
    s_add_u32 s41, s68, 6553600
    buffer_load_dwordx4 v1, s[64:67], s41 offen offset:0 lds
    buffer_load_dwordx4 v1, s[64:67], s41 offen offset:1024 lds
    buffer_load_dwordx4 v1, s[64:67], s41 offen offset:2048 lds
    buffer_load_dwordx4 v1, s[64:67], s41 offen offset:3072 lds
    buffer_store_dwordx4 a[128:131], v20, s[12:15], s61 offen offset:0 sc1
    buffer_store_dwordx4 a[132:135], v20, s[12:15], s61 offen offset:512 sc1
    buffer_store_dwordx4 a[136:139], v21, s[12:15], s61 offen offset:0 sc1
    buffer_store_dwordx4 a[140:143], v21, s[12:15], s61 offen offset:512 sc1
    buffer_store_dwordx4 a[144:147], v22, s[12:15], s61 offen offset:0 sc1
    buffer_store_dwordx4 a[148:151], v22, s[12:15], s61 offen offset:512 sc1
    buffer_store_dwordx4 a[152:155], v23, s[12:15], s61 offen offset:0 sc1
    buffer_store_dwordx4 a[156:159], v23, s[12:15], s61 offen offset:512 sc1
    s_waitcnt lgkmcnt(0)
    ds_write_b128 v32, v[72:75] offset:0
    ds_write_b128 v32, v[76:79] offset:1024
    ds_write_b128 v32, v[80:83] offset:2048
    ds_write_b128 v32, v[84:87] offset:3072
    ds_read_b128 a[160:163], v33 offset:0
    ds_read_b128 a[164:167], v33 offset:1024
    ds_read_b128 a[168:171], v33 offset:2048
    ds_read_b128 a[172:175], v33 offset:3072
    ds_write_b128 v32, v[88:91] offset:0
    ds_write_b128 v32, v[92:95] offset:1024
    ds_write_b128 v32, v[96:99] offset:2048
    ds_write_b128 v32, v[100:103] offset:3072
    ds_read_b128 a[176:179], v33 offset:0
    ds_read_b128 a[180:183], v33 offset:1024
    ds_read_b128 a[184:187], v33 offset:2048
    ds_read_b128 a[188:191], v33 offset:3072
    s_waitcnt vmcnt(16)
    s_barrier
    s_waitcnt lgkmcnt(0)
    ds_read_b64_tr_b16 v[40:41], v27 offset:36864
    ds_read_b64_tr_b16 v[42:43], v27 offset:38912
    ds_read_b64_tr_b16 v[44:45], v27 offset:37888
    ds_read_b64_tr_b16 v[46:47], v27 offset:39936
    ds_read_b64_tr_b16 v[48:49], v27 offset:36872
    ds_read_b64_tr_b16 v[50:51], v27 offset:38920
    ds_read_b64_tr_b16 v[52:53], v27 offset:37896
    ds_read_b64_tr_b16 v[54:55], v27 offset:39944
    ds_read_b64_tr_b16 v[56:57], v27 offset:36880
    ds_read_b64_tr_b16 v[58:59], v27 offset:38928
    ds_read_b64_tr_b16 v[60:61], v27 offset:37904
    ds_read_b64_tr_b16 v[62:63], v27 offset:39952
    ds_read_b64_tr_b16 v[64:65], v27 offset:36888
    ds_read_b64_tr_b16 v[66:67], v27 offset:38936
    ds_read_b64_tr_b16 v[68:69], v27 offset:37912
    ds_read_b64_tr_b16 v[70:71], v27 offset:39960
    buffer_store_dwordx4 a[160:163], v20, s[12:15], s61 offen offset:128 sc1
    buffer_store_dwordx4 a[164:167], v20, s[12:15], s61 offen offset:640 sc1
    buffer_store_dwordx4 a[168:171], v21, s[12:15], s61 offen offset:128 sc1
    buffer_store_dwordx4 a[172:175], v21, s[12:15], s61 offen offset:640 sc1
    buffer_store_dwordx4 a[176:179], v22, s[12:15], s61 offen offset:128 sc1
    buffer_store_dwordx4 a[180:183], v22, s[12:15], s61 offen offset:640 sc1
    buffer_store_dwordx4 a[184:187], v23, s[12:15], s61 offen offset:128 sc1
    buffer_store_dwordx4 a[188:191], v23, s[12:15], s61 offen offset:640 sc1
    s_waitcnt lgkmcnt(0)
    ds_write_b128 v32, v[40:43] offset:0
    ds_write_b128 v32, v[44:47] offset:1024
    ds_write_b128 v32, v[48:51] offset:2048
    ds_write_b128 v32, v[52:55] offset:3072
    ds_read_b128 a[192:195], v33 offset:0
    ds_read_b128 a[196:199], v33 offset:1024
    ds_read_b128 a[200:203], v33 offset:2048
    ds_read_b128 a[204:207], v33 offset:3072
    ds_write_b128 v32, v[56:59] offset:0
    ds_write_b128 v32, v[60:63] offset:1024
    ds_write_b128 v32, v[64:67] offset:2048
    ds_write_b128 v32, v[68:71] offset:3072
    ds_read_b128 a[208:211], v33 offset:0
    ds_read_b128 a[212:215], v33 offset:1024
    ds_read_b128 a[216:219], v33 offset:2048
    ds_read_b128 a[220:223], v33 offset:3072
    s_waitcnt vmcnt(16)
    s_barrier
    s_waitcnt lgkmcnt(0)
    ds_read_b64_tr_b16 v[72:73], v36 offset:0
    ds_read_b64_tr_b16 v[74:75], v36 offset:2048
    ds_read_b64_tr_b16 v[76:77], v36 offset:1024
    ds_read_b64_tr_b16 v[78:79], v36 offset:3072
    ds_read_b64_tr_b16 v[80:81], v36 offset:8
    ds_read_b64_tr_b16 v[82:83], v36 offset:2056
    ds_read_b64_tr_b16 v[84:85], v36 offset:1032
    ds_read_b64_tr_b16 v[86:87], v36 offset:3080
    ds_read_b64_tr_b16 v[88:89], v36 offset:16
    ds_read_b64_tr_b16 v[90:91], v36 offset:2064
    ds_read_b64_tr_b16 v[92:93], v36 offset:1040
    ds_read_b64_tr_b16 v[94:95], v36 offset:3088
    ds_read_b64_tr_b16 v[96:97], v36 offset:24
    ds_read_b64_tr_b16 v[98:99], v36 offset:2072
    ds_read_b64_tr_b16 v[100:101], v36 offset:1048
    ds_read_b64_tr_b16 v[102:103], v36 offset:3096
    buffer_load_dword v207, v206, s[12:15], s50 offen offset:1664 sc1
    buffer_store_dwordx4 a[192:195], v20, s[12:15], s61 offen offset:1024 sc1
    buffer_store_dwordx4 a[196:199], v20, s[12:15], s61 offen offset:1536 sc1
    buffer_store_dwordx4 a[200:203], v21, s[12:15], s61 offen offset:1024 sc1
    buffer_store_dwordx4 a[204:207], v21, s[12:15], s61 offen offset:1536 sc1
    buffer_store_dwordx4 a[208:211], v22, s[12:15], s61 offen offset:1024 sc1
    buffer_store_dwordx4 a[212:215], v22, s[12:15], s61 offen offset:1536 sc1
    buffer_store_dwordx4 a[216:219], v23, s[12:15], s61 offen offset:1024 sc1
    buffer_store_dwordx4 a[220:223], v23, s[12:15], s61 offen offset:1536 sc1
    s_waitcnt lgkmcnt(0)
    ds_write_b128 v32, v[72:75] offset:0
    ds_write_b128 v32, v[76:79] offset:1024
    ds_write_b128 v32, v[80:83] offset:2048
    ds_write_b128 v32, v[84:87] offset:3072
    ds_read_b128 a[224:227], v33 offset:0
    ds_read_b128 a[228:231], v33 offset:1024
    ds_read_b128 a[232:235], v33 offset:2048
    ds_read_b128 a[236:239], v33 offset:3072
    ds_write_b128 v32, v[88:91] offset:0
    ds_write_b128 v32, v[92:95] offset:1024
    ds_write_b128 v32, v[96:99] offset:2048
    ds_write_b128 v32, v[100:103] offset:3072
    ds_read_b128 a[240:243], v33 offset:0
    ds_read_b128 a[244:247], v33 offset:1024
    ds_read_b128 a[248:251], v33 offset:2048
    ds_read_b128 a[252:255], v33 offset:3072
    s_barrier
    s_waitcnt vmcnt(8)
    v_cmp_eq_u32 vcc, 0, v207
    s_nop 3
    s_cbranch_vccnz L_interleave_layers__spectral_fnet__mixer_gmlp__prompt_kernel_57
L_interleave_layers__spectral_fnet__mixer_gmlp__prompt_kernel_58:
    s_add_u32 m0, s32, 73728
    s_add_u32 s41, s34, 0
    buffer_load_dwordx4 off, s[80:83], s41 offset:0 sc1 lds
    buffer_load_dwordx4 off, s[80:83], s41 offset:1024 sc1 lds
    buffer_load_dwordx4 off, s[80:83], s41 offset:2048 sc1 lds
    buffer_load_dwordx4 off, s[80:83], s41 offset:3072 sc1 lds
    s_add_u32 m0, s32, 77824
    s_add_u32 s41, s34, 4096
    buffer_load_dwordx4 off, s[80:83], s41 offset:0 sc1 lds
    buffer_load_dwordx4 off, s[80:83], s41 offset:1024 sc1 lds
    buffer_load_dwordx4 off, s[80:83], s41 offset:2048 sc1 lds
    buffer_load_dwordx4 off, s[80:83], s41 offset:3072 sc1 lds
    s_add_u32 m0, s32, 81920
    s_add_u32 s41, s34, 8192
    buffer_load_dwordx4 off, s[80:83], s41 offset:0 sc1 lds
    s_add_u32 m0, s32, 110592
    s_add_u32 s41, s34, 36864
    buffer_load_dwordx4 off, s[80:83], s41 offset:0 sc1 lds
    buffer_load_dwordx4 off, s[80:83], s41 offset:1024 sc1 lds
    buffer_load_dwordx4 off, s[80:83], s41 offset:2048 sc1 lds
    buffer_load_dwordx4 off, s[80:83], s41 offset:3072 sc1 lds
    s_add_u32 m0, s32, 114688
    s_add_u32 s41, s34, 40960
    buffer_load_dwordx4 off, s[80:83], s41 offset:0 sc1 lds
    buffer_load_dwordx4 off, s[80:83], s41 offset:1024 sc1 lds
    buffer_load_dwordx4 off, s[80:83], s41 offset:2048 sc1 lds
    buffer_load_dwordx4 off, s[80:83], s41 offset:3072 sc1 lds
    s_add_u32 m0, s32, 118784
    s_add_u32 s41, s34, 45056
    buffer_load_dwordx4 off, s[80:83], s41 offset:0 sc1 lds
    s_waitcnt lgkmcnt(0)
    buffer_store_dwordx4 a[224:227], v20, s[12:15], s61 offen offset:1152 sc1
    buffer_store_dwordx4 a[228:231], v20, s[12:15], s61 offen offset:1664 sc1
    buffer_store_dwordx4 a[232:235], v21, s[12:15], s61 offen offset:1152 sc1
    buffer_store_dwordx4 a[236:239], v21, s[12:15], s61 offen offset:1664 sc1
    buffer_store_dwordx4 a[240:243], v22, s[12:15], s61 offen offset:1152 sc1
    buffer_store_dwordx4 a[244:247], v22, s[12:15], s61 offen offset:1664 sc1
    buffer_store_dwordx4 a[248:251], v23, s[12:15], s61 offen offset:1152 sc1
    buffer_store_dwordx4 a[252:255], v23, s[12:15], s61 offen offset:1664 sc1
    s_nop 0
    s_branch L_join_interleave_layers__spectral_fnet__mixer_gmlp__prompt_kernel
L_interleave_layers__spectral_fnet__mixer_gmlp__prompt_kernel_4:
    s_mov_b32 s40, 0
    s_mov_b64 vcc, -1
L_interleave_layers__spectral_fnet__mixer_gmlp__prompt_kernel_60:
    s_mov_b64 exec, vcc
    buffer_load_dword v31, v30, s[20:23], 0 offen offset:0 sc1
    s_add_u32 s40, s40, 1
    s_cmp_gt_u32 s40, 2000000
    s_cbranch_scc1 L_interleave_layers__spectral_fnet__mixer_gmlp__prompt_kernel_61
    s_waitcnt vmcnt(0)
    v_cmp_gt_u32 vcc, 128, v31
    s_nop 3
    s_cbranch_vccnz L_interleave_layers__spectral_fnet__mixer_gmlp__prompt_kernel_60
L_interleave_layers__spectral_fnet__mixer_gmlp__prompt_kernel_62:
    s_mov_b64 exec, -1
    s_branch L_interleave_layers__spectral_fnet__mixer_gmlp__prompt_kernel_5
L_interleave_layers__spectral_fnet__mixer_gmlp__prompt_kernel_8:
    s_waitcnt vmcnt(0)
    s_branch L_interleave_layers__spectral_fnet__mixer_gmlp__prompt_kernel_9
L_interleave_layers__spectral_fnet__mixer_gmlp__prompt_kernel_10:
    s_mov_b32 s40, 0
L_interleave_layers__spectral_fnet__mixer_gmlp__prompt_kernel_63:
    s_mov_b64 exec, vcc
    buffer_load_dword v207, v206, s[12:15], s47 offen offset:1664 sc1
    s_add_u32 s40, s40, 1
    s_cmp_gt_u32 s40, 2000000
    s_cbranch_scc1 L_interleave_layers__spectral_fnet__mixer_gmlp__prompt_kernel_12
    s_waitcnt vmcnt(0)
    v_cmp_eq_u32 vcc, 0, v207
    s_nop 3
    s_cbranch_vccnz L_interleave_layers__spectral_fnet__mixer_gmlp__prompt_kernel_63
    s_mov_b64 exec, -1
    s_branch L_interleave_layers__spectral_fnet__mixer_gmlp__prompt_kernel_11
L_interleave_layers__spectral_fnet__mixer_gmlp__prompt_kernel_12:
    s_waitcnt vmcnt(0)
    s_mov_b64 exec, -1
    s_branch L_interleave_layers__spectral_fnet__mixer_gmlp__prompt_kernel_11
L_interleave_layers__spectral_fnet__mixer_gmlp__prompt_kernel_6:
    s_waitcnt lgkmcnt(0)
    s_barrier
    s_add_u32 m0, s32, 73728
    s_add_u32 s41, s34, 0
    buffer_load_dwordx4 off, s[80:83], s41 offset:0 sc1 lds
    buffer_load_dwordx4 off, s[80:83], s41 offset:1024 sc1 lds
    buffer_load_dwordx4 off, s[80:83], s41 offset:2048 sc1 lds
    buffer_load_dwordx4 off, s[80:83], s41 offset:3072 sc1 lds
    s_add_u32 m0, s32, 77824
    s_add_u32 s41, s34, 4096
    buffer_load_dwordx4 off, s[80:83], s41 offset:0 sc1 lds
    buffer_load_dwordx4 off, s[80:83], s41 offset:1024 sc1 lds
    buffer_load_dwordx4 off, s[80:83], s41 offset:2048 sc1 lds
    buffer_load_dwordx4 off, s[80:83], s41 offset:3072 sc1 lds
    s_add_u32 m0, s32, 81920
    s_add_u32 s41, s34, 8192
    buffer_load_dwordx4 off, s[80:83], s41 offset:0 sc1 lds
    s_add_u32 m0, s32, 110592
    s_add_u32 s41, s34, 36864
    buffer_load_dwordx4 off, s[80:83], s41 offset:0 sc1 lds
    buffer_load_dwordx4 off, s[80:83], s41 offset:1024 sc1 lds
    buffer_load_dwordx4 off, s[80:83], s41 offset:2048 sc1 lds
    buffer_load_dwordx4 off, s[80:83], s41 offset:3072 sc1 lds
    s_add_u32 m0, s32, 114688
    s_add_u32 s41, s34, 40960
    buffer_load_dwordx4 off, s[80:83], s41 offset:0 sc1 lds
    buffer_load_dwordx4 off, s[80:83], s41 offset:1024 sc1 lds
    buffer_load_dwordx4 off, s[80:83], s41 offset:2048 sc1 lds
    buffer_load_dwordx4 off, s[80:83], s41 offset:3072 sc1 lds
    s_add_u32 m0, s32, 118784
    s_add_u32 s41, s34, 45056
    buffer_load_dwordx4 off, s[80:83], s41 offset:0 sc1 lds
    s_lshr_b32 s45, s3, 1
    s_and_b32 s46, s3, 1
    s_xor_b32 s47, s45, s46
    s_cmp_eq_u32 s4, 0
    s_cselect_b32 s45, s45, s47
    s_lshl_b32 s47, s4, 1
    s_add_u32 s45, s45, s47
    s_lshl_b32 s45, s45, 16
    s_lshl_b32 s46, s46, 12
    s_add_u32 s45, s45, s46
    s_add_u32 s45, s45, s29
    v_lshrrev_b32 v200, 1, v2
    v_min_u32 v200, 5, v200
    v_lshlrev_b32 v200, 13, v200
    v_and_b32 v201, 1, v2
    v_lshl_add_u32 v200, v201, 11, v200
    s_mul_i32 s46, s31, 36864
    s_add_u32 s46, s46, s28
    s_add_u32 s46, s46, 6291456
    s_add_u32 s47, s46, 18432
    v_lshrrev_b32 v216, 1, v3
    v_lshlrev_b32 v216, 10, v216
    v_lshl_add_u32 v216, v2, 2, v216
    v_and_b32 v217, 1, v3
    v_lshl_add_u32 v216, v217, 7, v216
    s_lshl_b32 s48, s31, 11
    s_add_u32 s48, s48, s28
    s_add_u32 s48, s48, 2621440
    s_branch L_join_interleave_layers__spectral_fnet__mixer_gmlp__prompt_kernel
L_interleave_layers__spectral_fnet__mixer_gmlp__prompt_kernel_15:
    s_waitcnt vmcnt(0)
    s_mov_b64 exec, -1
    s_branch L_interleave_layers__spectral_fnet__mixer_gmlp__prompt_kernel_14
L_interleave_layers__spectral_fnet__mixer_gmlp__prompt_kernel_17:
    s_mov_b32 s40, 0
L_interleave_layers__spectral_fnet__mixer_gmlp__prompt_kernel_64:
    s_mov_b64 exec, vcc
    buffer_load_dword v233, v232, s[12:15], s52 offen offset:128 sc1
    s_add_u32 s40, s40, 1
    s_cmp_gt_u32 s40, 2000000
    s_cbranch_scc1 L_interleave_layers__spectral_fnet__mixer_gmlp__prompt_kernel_19
    s_waitcnt vmcnt(0)
    v_cmp_eq_u32 vcc, 0, v233
    s_nop 3
    s_cbranch_vccnz L_interleave_layers__spectral_fnet__mixer_gmlp__prompt_kernel_64
    s_mov_b64 exec, -1
    s_branch L_interleave_layers__spectral_fnet__mixer_gmlp__prompt_kernel_18
L_interleave_layers__spectral_fnet__mixer_gmlp__prompt_kernel_19:
    s_waitcnt vmcnt(0)
    s_mov_b64 exec, -1
    s_branch L_interleave_layers__spectral_fnet__mixer_gmlp__prompt_kernel_18
L_interleave_layers__spectral_fnet__mixer_gmlp__prompt_kernel_22:
    s_waitcnt vmcnt(0)
    s_mov_b64 exec, -1
    s_branch L_interleave_layers__spectral_fnet__mixer_gmlp__prompt_kernel_21
L_interleave_layers__spectral_fnet__mixer_gmlp__prompt_kernel_24:
    s_mov_b32 s40, 0
L_interleave_layers__spectral_fnet__mixer_gmlp__prompt_kernel_65:
    s_mov_b64 exec, vcc
    buffer_load_dword v210, v211, s[12:15], s45 offen offset:256 sc1
    s_add_u32 s40, s40, 1
    s_cmp_gt_u32 s40, 2000000
    s_cbranch_scc1 L_interleave_layers__spectral_fnet__mixer_gmlp__prompt_kernel_26
    s_waitcnt vmcnt(0)
    v_cmp_eq_u32 vcc, 0, v210
    s_nop 3
    s_cbranch_vccnz L_interleave_layers__spectral_fnet__mixer_gmlp__prompt_kernel_65
    s_mov_b64 exec, -1
    s_branch L_interleave_layers__spectral_fnet__mixer_gmlp__prompt_kernel_25
L_interleave_layers__spectral_fnet__mixer_gmlp__prompt_kernel_26:
    s_waitcnt vmcnt(0)
    s_mov_b64 exec, -1
    s_branch L_interleave_layers__spectral_fnet__mixer_gmlp__prompt_kernel_25
L_interleave_layers__spectral_fnet__mixer_gmlp__prompt_kernel_28:
    s_mov_b32 s40, 0
L_interleave_layers__spectral_fnet__mixer_gmlp__prompt_kernel_66:
    s_mov_b64 exec, vcc
    buffer_load_dword v137, v136, s[12:15], s42 offen offset:384 sc1
    s_add_u32 s40, s40, 1
    s_cmp_gt_u32 s40, 2000000
    s_cbranch_scc1 L_interleave_layers__spectral_fnet__mixer_gmlp__prompt_kernel_30
    s_waitcnt vmcnt(0)
    v_cmp_eq_u32 vcc, 0, v137
    s_nop 3
    s_cbranch_vccnz L_interleave_layers__spectral_fnet__mixer_gmlp__prompt_kernel_66
    s_mov_b64 exec, -1
    s_branch L_interleave_layers__spectral_fnet__mixer_gmlp__prompt_kernel_29
L_interleave_layers__spectral_fnet__mixer_gmlp__prompt_kernel_30:
    s_waitcnt vmcnt(0)
    s_mov_b64 exec, -1
    s_branch L_interleave_layers__spectral_fnet__mixer_gmlp__prompt_kernel_29
L_interleave_layers__spectral_fnet__mixer_gmlp__prompt_kernel_35:
    s_mov_b32 s40, 0
L_interleave_layers__spectral_fnet__mixer_gmlp__prompt_kernel_67:
    s_mov_b64 exec, vcc
    buffer_load_dword v137, v136, s[12:15], s44 offen offset:1792 sc1
    s_add_u32 s40, s40, 1
    s_cmp_gt_u32 s40, 2000000
    s_cbranch_scc1 L_interleave_layers__spectral_fnet__mixer_gmlp__prompt_kernel_37
    s_waitcnt vmcnt(0)
    v_cmp_eq_u32 vcc, 0, v137
    s_nop 3
    s_cbranch_vccnz L_interleave_layers__spectral_fnet__mixer_gmlp__prompt_kernel_67
    s_mov_b64 exec, -1
    s_branch L_interleave_layers__spectral_fnet__mixer_gmlp__prompt_kernel_36
L_interleave_layers__spectral_fnet__mixer_gmlp__prompt_kernel_37:
    s_waitcnt vmcnt(0)
    s_mov_b64 exec, -1
    s_branch L_interleave_layers__spectral_fnet__mixer_gmlp__prompt_kernel_36
L_interleave_layers__spectral_fnet__mixer_gmlp__prompt_kernel_40:
    s_waitcnt vmcnt(0)
    s_mov_b64 exec, -1
    s_branch L_interleave_layers__spectral_fnet__mixer_gmlp__prompt_kernel_39
L_interleave_layers__spectral_fnet__mixer_gmlp__prompt_kernel_42:
    s_mov_b32 s40, 0
L_interleave_layers__spectral_fnet__mixer_gmlp__prompt_kernel_68:
    s_mov_b64 exec, vcc
    buffer_load_dword v137, v136, s[12:15], s44 offen offset:1792 sc1
    s_add_u32 s40, s40, 1
    s_cmp_gt_u32 s40, 2000000
    s_cbranch_scc1 L_interleave_layers__spectral_fnet__mixer_gmlp__prompt_kernel_44
    s_waitcnt vmcnt(0)
    v_cmp_eq_u32 vcc, 0, v137
    s_nop 3
    s_cbranch_vccnz L_interleave_layers__spectral_fnet__mixer_gmlp__prompt_kernel_68
    s_mov_b64 exec, -1
    s_branch L_interleave_layers__spectral_fnet__mixer_gmlp__prompt_kernel_43
L_interleave_layers__spectral_fnet__mixer_gmlp__prompt_kernel_44:
    s_waitcnt vmcnt(0)
    s_mov_b64 exec, -1
    s_branch L_interleave_layers__spectral_fnet__mixer_gmlp__prompt_kernel_43
L_interleave_layers__spectral_fnet__mixer_gmlp__prompt_kernel_47:
    s_waitcnt vmcnt(0)
    s_mov_b64 exec, -1
    s_branch L_interleave_layers__spectral_fnet__mixer_gmlp__prompt_kernel_46
L_interleave_layers__spectral_fnet__mixer_gmlp__prompt_kernel_53:
    s_waitcnt vmcnt(0)
    s_mov_b64 exec, -1
    s_branch L_interleave_layers__spectral_fnet__mixer_gmlp__prompt_kernel_52
L_interleave_layers__spectral_fnet__mixer_gmlp__prompt_kernel_55:
    s_mov_b32 s40, 0
    s_mov_b64 vcc, -1
L_interleave_layers__spectral_fnet__mixer_gmlp__prompt_kernel_69:
    s_mov_b64 exec, vcc
    buffer_load_dword v31, v30, s[20:23], 0 offen offset:0 sc1
    s_add_u32 s40, s40, 1
    s_cmp_gt_u32 s40, 2000000
    s_cbranch_scc1 L_interleave_layers__spectral_fnet__mixer_gmlp__prompt_kernel_70
    s_waitcnt vmcnt(0)
    v_cmp_gt_u32 vcc, 128, v31
    s_nop 3
    s_cbranch_vccnz L_interleave_layers__spectral_fnet__mixer_gmlp__prompt_kernel_69
L_interleave_layers__spectral_fnet__mixer_gmlp__prompt_kernel_71:
    s_mov_b64 exec, -1
    s_branch L_interleave_layers__spectral_fnet__mixer_gmlp__prompt_kernel_56
L_interleave_layers__spectral_fnet__mixer_gmlp__prompt_kernel_57:
    s_mov_b32 s40, 0
L_interleave_layers__spectral_fnet__mixer_gmlp__prompt_kernel_72:
    s_mov_b64 exec, vcc
    buffer_load_dword v207, v206, s[12:15], s50 offen offset:1664 sc1
    s_add_u32 s40, s40, 1
    s_cmp_gt_u32 s40, 2000000
    s_cbranch_scc1 L_interleave_layers__spectral_fnet__mixer_gmlp__prompt_kernel_59
    s_waitcnt vmcnt(0)
    v_cmp_eq_u32 vcc, 0, v207
    s_nop 3
    s_cbranch_vccnz L_interleave_layers__spectral_fnet__mixer_gmlp__prompt_kernel_72
    s_mov_b64 exec, -1
    s_branch L_interleave_layers__spectral_fnet__mixer_gmlp__prompt_kernel_58
L_interleave_layers__spectral_fnet__mixer_gmlp__prompt_kernel_59:
    s_waitcnt vmcnt(0)
    s_mov_b64 exec, -1
    s_branch L_interleave_layers__spectral_fnet__mixer_gmlp__prompt_kernel_58
L_interleave_layers__spectral_fnet__mixer_gmlp__prompt_kernel_61:
    s_waitcnt vmcnt(0)
    s_branch L_interleave_layers__spectral_fnet__mixer_gmlp__prompt_kernel_62
L_interleave_layers__spectral_fnet__mixer_gmlp__prompt_kernel_70:
    s_waitcnt vmcnt(0)
    s_branch L_interleave_layers__spectral_fnet__mixer_gmlp__prompt_kernel_71
    s_endpgm
L_last_interleave_layers__spectral_fnet__mixer_gmlp__prompt_kernel:
    s_endpgm
.section .rodata,"a"
.p2align 6
.amdhsa_kernel interleave_layers__spectral_fnet__mixer_gmlp__prompt_kernel
  .amdhsa_next_free_vgpr 512
  .amdhsa_next_free_sgpr 102
  .amdhsa_accum_offset 256
  .amdhsa_group_segment_fixed_size 0
  .amdhsa_kernarg_size 104
  .amdhsa_user_sgpr_count 2
  .amdhsa_user_sgpr_kernarg_segment_ptr 1
  .amdhsa_system_sgpr_workgroup_id_x 1
  .amdhsa_float_denorm_mode_32 3
.end_amdhsa_kernel
```
